```python
import torch

def _softmax(x, axis=-1):
    return torch.softmax(x, dim=axis)

def _gelu(x):
    return torch.nn.functional.gelu(x, approximate='tanh')

def _silu(x):
    return torch.nn.functional.silu(x)

def _sigmoid(x):
    return torch.sigmoid(x)

def _layernorm(x, axis=-1, eps=1e-05):
    m = x.mean(dim=axis, keepdim=True)
    v = x.var(dim=axis, keepdim=True, unbiased=False)
    return (x - m) / torch.sqrt(v + eps)

def _scatter_add(tgt, idx, src, axis=0):
    return tgt.clone().index_add_(axis, idx, src)

def _segment_sum(src, seg, n):
    out = torch.zeros((n,) + src.shape[1:], dtype=src.dtype)
    return out.index_add_(0, seg, src)

def _pad(x, pw):
    flat = tuple((v for pair in reversed(pw) for v in pair))
    return torch.nn.functional.pad(x, flat)
kernel_name = 'interleave_layers__memory_aug_recurrent_mem_tr__glu_gated_bilinear__prompt'

def setup_inputs():

    _w = lambda a: (lambda t: t.to(torch.bfloat16) if t.is_floating_point() else t)(torch.as_tensor(a))

    def _A_setup():
        B, S, Dm = (1, 2048, 512)
        H, Dh = (32, 128)
        M, seg = (8, 32)
        seg = min(seg, S)
        S = S // seg * seg
        return {'x': _w((lambda *s: torch.randn(*s, dtype=torch.bfloat16) * 0.05)(B, S, Dm)), 'mem0': _w((lambda *s: torch.randn(*s, dtype=torch.bfloat16) * 0.2)(B, M, Dm)), 'Wq': _w((lambda *s: torch.randn(*s, dtype=torch.bfloat16) * 1.6)(Dm, H, Dh) * Dm ** (-0.5)), 'Wk': _w((lambda *s: torch.randn(*s, dtype=torch.bfloat16) * 1.6)(Dm, H, Dh) * Dm ** (-0.5)), 'Wv': _w((lambda *s: torch.randn(*s, dtype=torch.bfloat16) * 0.2)(Dm, H, Dh) * Dm ** (-0.5)), 'Wo': _w((lambda *s: torch.randn(*s, dtype=torch.bfloat16) * 0.2)(H, Dh, Dm) * (H * Dh) ** (-0.5)), 'seg_len': seg}
    _A_in = _A_setup()

    def _B_setup():
        B, S, D, F = (1, 2048, 512, 1792)
        return {'x': _w((lambda *s: torch.randn(*s, dtype=torch.bfloat16) * 0.05)(B, S, D)), 'w_gate': _w((lambda *s: torch.randn(*s, dtype=torch.bfloat16) * 0.4)(D, F) * D ** (-0.5)), 'w_up': _w((lambda *s: torch.randn(*s, dtype=torch.bfloat16) * 0.4)(D, F) * D ** (-0.5)), 'w_down': _w((lambda *s: torch.randn(*s, dtype=torch.bfloat16) * 0.4)(F, D) * F ** (-0.5))}
    _B_in = _B_setup()
    return {'A_x': _A_in['x'], 'A_mem0': _A_in['mem0'], 'A_Wq': _A_in['Wq'], 'A_Wk': _A_in['Wk'], 'A_Wv': _A_in['Wv'], 'A_Wo': _A_in['Wo'], 'A_seg_len': _A_in['seg_len'], 'B_x': _B_in['x'], 'B_w_gate': _B_in['w_gate'], 'B_w_up': _B_in['w_up'], 'B_w_down': _B_in['w_down']}

def reference(A_x, A_mem0, A_Wq, A_Wk, A_Wv, A_Wo, A_seg_len, B_x, B_w_gate, B_w_up, B_w_down):

    def _A_ref(x, mem0, Wq, Wk, Wv, Wo, seg_len):
        B, S, Dm = x.shape
        H, Dh = (Wq.shape[1], Wq.shape[2])
        M = mem0.shape[1]
        scale = Dh ** (-0.5)
        n_seg = S // seg_len
        L = M + seg_len
        idx = torch.arange(L)
        mask = (idx[:, None] < M) | (idx[:, None] >= idx[None, :])
        mem = mem0
        outs = []
        for s in range(n_seg):
            xs = x[:, s * seg_len:(s + 1) * seg_len, :].clone()
            h = torch.concatenate([mem, xs], axis=1)
            q = torch.einsum('btd,dhe->bhte', h, Wq)
            k = torch.einsum('btd,dhe->bhte', h, Wk)
            v = torch.einsum('btd,dhe->bhte', h, Wv)
            scores = torch.einsum('bhqe,bhke->bhqk', q, k) * scale
            scores = torch.where(mask[None, None], scores, -1000000000.0)
            p = _softmax(scores, axis=-1)
            o = torch.einsum('bhqk,bhke->bhqe', p, v)
            o = torch.einsum('bhte,hed->btd', o, Wo)
            mem = o[:, :M, :].clone()
            outs.append(o[:, M:, :])
        return torch.concatenate(outs, axis=1)

    def _B_ref(x, w_gate, w_up, w_down):
        g = torch.einsum('bsd,df->bsf', x, w_gate)
        u = torch.einsum('bsd,df->bsf', x, w_up)
        h = g * u
        return torch.einsum('bsf,fd->bsd', h, w_down)
    x = A_x
    x = x + _A_ref(_layernorm(x, axis=-1), A_mem0, A_Wq, A_Wk, A_Wv, A_Wo, A_seg_len)
    x = x + _B_ref(_layernorm(x, axis=-1), B_w_gate, B_w_up, B_w_down)
    x = x + _A_ref(_layernorm(x, axis=-1), A_mem0, A_Wq, A_Wk, A_Wv, A_Wo, A_seg_len)
    x = x + _B_ref(_layernorm(x, axis=-1), B_w_gate, B_w_up, B_w_down)
    return x
```

```asm
  ; @launch grid=(256,1,1) block=(256,1,1) lds=163840
.amdgcn_target "amdgcn-amd-amdhsa--gfx950"
.text
.globl interleave_layers__memory_aug_recurrent_mem_tr__glu_gated_bilinear__prompt_kernel
.p2align 8
.type interleave_layers__memory_aug_recurrent_mem_tr__glu_gated_bilinear__prompt_kernel,@function
interleave_layers__memory_aug_recurrent_mem_tr__glu_gated_bilinear__prompt_kernel:
  s_cmp_ge_u32 s2, 256
  s_cbranch_scc1 L_end
  s_load_dwordx8 s[20:27], s[0:1], 0
  s_load_dwordx4 s[28:31], s[0:1], 32
  s_load_dwordx4 s[32:35], s[0:1], 64
  s_load_dwordx2 s[36:37], s[0:1], 80
  s_load_dwordx2 s[38:39], s[0:1], 88
  s_load_dwordx4 s[40:43], s[0:1], 96
  s_getreg_b32 s18, hwreg(HW_REG_XCC_ID, 0, 4)
  v_lshrrev_b32 v1, 6, v0
  s_mov_b32 s64, 200000
  s_and_b32 s18, s18, 7
  v_readfirstlane_b32 s16, v1
  s_waitcnt lgkmcnt(0)
  s_mov_b32 s4, s42
  s_and_b32 s5, s43, 0xffff
  s_mov_b32 s6, 0x10000000
  s_mov_b32 s7, 0x20000
  s_cmp_eq_u32 s16, 0
  s_cbranch_scc0 L_noticket
  s_lshl_b32 s45, s18, 2
  v_mov_b32 v3, s45
  v_mov_b32 v4, 1
  s_mov_b64 exec, 1
  global_atomic_add v5, v3, v4, s[40:41] sc0 sc1
  s_waitcnt vmcnt(0)
  v_mov_b32 v3, 0x4000
  ds_write_b32 v3, v5
  s_mov_b64 exec, -1
  s_waitcnt lgkmcnt(0)
L_noticket:
  s_mov_b32 s12, s42
  s_and_b32 s13, s43, 0xffff
  s_mov_b32 s14, 0x130000
  s_mov_b32 s15, 0x20000
  s_lshl_b32 s45, s2, 12
  v_lshlrev_b32 v2, 4, v0
  v_add_u32 v2, s45, v2
  v_mov_b64 v[4:5], 0
  v_mov_b64 v[6:7], 0
  v_mov_b64 v[8:9], -1
  v_mov_b64 v[10:11], -1
  s_mov_b32 s45, 0x100000
  buffer_store_dwordx4 v[4:7], v2, s[12:15], 0 offen sc1
  buffer_store_dwordx4 v[4:7], v2, s[12:15], s45 offen sc1
  s_mov_b32 s8, s42
  s_and_b32 s9, s43, 0xffff
  s_mov_b32 s10, 0x1c0000
  s_mov_b32 s11, 0x20000
  s_mov_b32 s45, 0x130000
  buffer_store_dwordx4 v[8:11], v2, s[8:11], s45 offen sc1
  s_and_b32 s66, s2, 3
  v_and_b32 v6, 7, v0
  v_lshrrev_b32 v7, 3, v0
  v_lshlrev_b32 v5, 4, v6
  v_lshl_add_u32 v1, v7, 11, v5
  v_lshlrev_b32 v2, 10, v6
  v_lshl_add_u32 v2, v7, 5, v2
  v_lshrrev_b32 v3, 1, v7
  v_lshlrev_b32 v3, 10, v3
  v_and_b32 v4, 1, v7
  v_lshl_add_u32 v3, v4, 9, v3
  v_add_u32 v3, v3, v5
  v_and_b32 v4, 63, v0
  v_lshlrev_b32 v4, 2, v4
  s_lshl_b32 s45, s16, 8
  v_add_u32 v4, s45, v4
  v_lshlrev_b32 v5, 2, v6
  v_lshlrev_b32 v8, 4, v0
  v_add_u32 v9, 0x1000, v8
  s_mov_b32 s8, s20
  s_and_b32 s9, s21, 0xffff
  s_mov_b32 s10, 0x200000
  s_mov_b32 s11, 0x20000
  s_lshl_b32 s67, s2, 13
  s_lshr_b32 s45, s2, 2
  s_lshl_b32 s45, s45, 15
  s_lshr_b32 s46, s66, 1
  s_lshl_b32 s46, s46, 14
  s_add_u32 s45, s45, s46
  s_and_b32 s46, s66, 1
  s_lshl_b32 s46, s46, 7
  s_add_u32 s45, s45, s46
  s_add_u32 s68, s45, 0x5200000
  buffer_load_dwordx4 v[72:75], v2, s[8:11], s67 offen sc1
  buffer_load_dwordx4 v[76:79], v2, s[8:11], s67 offen offset:16 sc1
  s_waitcnt vmcnt(0)
  s_mov_b32 s49, 0xffff0000
  v_lshlrev_b32 v80, 16, v72
  v_and_b32 v81, s49, v72
  v_lshlrev_b32 v82, 16, v73
  v_and_b32 v83, s49, v73
  v_lshlrev_b32 v84, 16, v74
  v_and_b32 v85, s49, v74
  v_lshlrev_b32 v86, 16, v75
  v_and_b32 v87, s49, v75
  v_lshlrev_b32 v88, 16, v76
  v_and_b32 v89, s49, v76
  v_lshlrev_b32 v90, 16, v77
  v_and_b32 v91, s49, v77
  v_lshlrev_b32 v92, 16, v78
  v_and_b32 v93, s49, v78
  v_lshlrev_b32 v94, 16, v79
  v_and_b32 v95, s49, v79
  v_add_f32 v96, v80, v81
  v_add_f32 v97, v82, v83
  v_add_f32 v96, v96, v84
  v_add_f32 v97, v97, v85
  v_add_f32 v96, v96, v86
  v_add_f32 v97, v97, v87
  v_add_f32 v96, v96, v88
  v_add_f32 v97, v97, v89
  v_add_f32 v96, v96, v90
  v_add_f32 v97, v97, v91
  v_add_f32 v96, v96, v92
  v_add_f32 v97, v97, v93
  v_add_f32 v96, v96, v94
  v_add_f32 v97, v97, v95
  v_add_f32 v96, v96, v97
  s_nop 1
  v_add_f32_dpp v96, v96, v96 row_ror:8 row_mask:0xf bank_mask:0xf
  v_mov_b32 v97, v96
  s_nop 1
  v_permlane16_swap_b32 v96, v97
  v_add_f32 v96, v96, v97
  v_mov_b32 v97, v96
  s_nop 1
  v_permlane32_swap_b32 v96, v97
  v_add_f32 v96, v96, v97
  ds_write_b32 v4, v96 offset:0
  s_waitcnt lgkmcnt(0)
  s_barrier
  ds_read_b32 v96, v5 offset:0
  ds_read_b32 v97, v5 offset:256
  ds_read_b32 v98, v5 offset:512
  ds_read_b32 v99, v5 offset:768
  s_waitcnt lgkmcnt(0)
  v_add_f32 v96, v96, v97
  v_add_f32 v98, v98, v99
  v_add_f32 v96, v96, v98
  v_mul_f32 v96, 0x3b000000, v96
  v_sub_f32 v80, v80, v96
  v_sub_f32 v81, v81, v96
  v_sub_f32 v82, v82, v96
  v_sub_f32 v83, v83, v96
  v_sub_f32 v84, v84, v96
  v_sub_f32 v85, v85, v96
  v_sub_f32 v86, v86, v96
  v_sub_f32 v87, v87, v96
  v_sub_f32 v88, v88, v96
  v_sub_f32 v89, v89, v96
  v_sub_f32 v90, v90, v96
  v_sub_f32 v91, v91, v96
  v_sub_f32 v92, v92, v96
  v_sub_f32 v93, v93, v96
  v_sub_f32 v94, v94, v96
  v_sub_f32 v95, v95, v96
  v_mul_f32 v96, v80, v80
  v_mul_f32 v97, v81, v81
  v_fmac_f32 v96, v82, v82
  v_fmac_f32 v97, v83, v83
  v_fmac_f32 v96, v84, v84
  v_fmac_f32 v97, v85, v85
  v_fmac_f32 v96, v86, v86
  v_fmac_f32 v97, v87, v87
  v_fmac_f32 v96, v88, v88
  v_fmac_f32 v97, v89, v89
  v_fmac_f32 v96, v90, v90
  v_fmac_f32 v97, v91, v91
  v_fmac_f32 v96, v92, v92
  v_fmac_f32 v97, v93, v93
  v_fmac_f32 v96, v94, v94
  v_fmac_f32 v97, v95, v95
  v_add_f32 v96, v96, v97
  s_nop 1
  v_add_f32_dpp v96, v96, v96 row_ror:8 row_mask:0xf bank_mask:0xf
  v_mov_b32 v97, v96
  s_nop 1
  v_permlane16_swap_b32 v96, v97
  v_add_f32 v96, v96, v97
  v_mov_b32 v97, v96
  s_nop 1
  v_permlane32_swap_b32 v96, v97
  v_add_f32 v96, v96, v97
  ds_write_b32 v4, v96 offset:1024
  s_waitcnt lgkmcnt(0)
  s_barrier
  ds_read_b32 v96, v5 offset:1024
  ds_read_b32 v97, v5 offset:1280
  ds_read_b32 v98, v5 offset:1536
  ds_read_b32 v99, v5 offset:1792
  s_waitcnt lgkmcnt(0)
  v_add_f32 v96, v96, v97
  v_add_f32 v98, v98, v99
  v_add_f32 v96, v96, v98
  v_mov_b32 v97, 0x3727c5ac
  v_fmac_f32 v97, 0x3b000000, v96
  v_rsq_f32 v96, v97
  s_nop 0
  v_mul_f32 v80, v80, v96
  v_mul_f32 v81, v81, v96
  v_mul_f32 v82, v82, v96
  v_mul_f32 v83, v83, v96
  v_mul_f32 v84, v84, v96
  v_mul_f32 v85, v85, v96
  v_mul_f32 v86, v86, v96
  v_mul_f32 v87, v87, v96
  v_mul_f32 v88, v88, v96
  v_mul_f32 v89, v89, v96
  v_mul_f32 v90, v90, v96
  v_mul_f32 v91, v91, v96
  v_mul_f32 v92, v92, v96
  v_mul_f32 v93, v93, v96
  v_mul_f32 v94, v94, v96
  v_mul_f32 v95, v95, v96
  v_cvt_pk_bf16_f32 v72, v80, v81
  v_cvt_pk_bf16_f32 v73, v82, v83
  v_cvt_pk_bf16_f32 v74, v84, v85
  v_cvt_pk_bf16_f32 v75, v86, v87
  v_cvt_pk_bf16_f32 v76, v88, v89
  v_cvt_pk_bf16_f32 v77, v90, v91
  v_cvt_pk_bf16_f32 v78, v92, v93
  v_cvt_pk_bf16_f32 v79, v94, v95
  buffer_store_dwordx4 v[72:75], v3, s[4:7], s68 offen sc1
  buffer_store_dwordx4 v[76:79], v3, s[4:7], s68 offen offset:256 sc1
  s_waitcnt vmcnt(0)
  s_barrier
  v_mov_b32 v3, 0x4000
  ds_read_b32 v5, v3
  s_waitcnt lgkmcnt(0)
  v_readfirstlane_b32 s98, v5
  s_barrier
  s_cmp_eq_u32 s16, 0
  s_cbranch_scc0 L_noreg
  v_mov_b32 v4, 1
  v_mov_b32 v6, 32
  s_mov_b64 exec, 1
  global_atomic_add v6, v4, s[40:41] sc1
  s_mov_b64 exec, -1
L_noreg:
  s_mov_b32 s99, 0
  s_mov_b32 s44, 1
  s_lshl_b32 s17, s18, 5
  s_add_u32 s17, s17, s98
  s_cmp_lt_u32 s98, 32
  s_cbranch_scc1 L_dispatch
  s_cmp_eq_u32 s99, 1
  s_cbranch_scc1 L_gs_done_1
  s_cmp_eq_u32 s16, 0
  s_cbranch_scc0 L_gs_w_2
  v_mov_b32 v100, 32
L_gs_p_3:
  s_mov_b64 exec, 1
  global_load_dword v101, v100, s[40:41] sc1
  s_mov_b64 exec, -1
  s_waitcnt vmcnt(0)
  v_readfirstlane_b32 s45, v101
  s_sub_u32 s64, s64, 1
  s_cbranch_scc1 L_abort
  s_cmp_ge_u32 s45, 256
  s_cbranch_scc1 L_gs_q_4
  s_sleep 4
  s_branch L_gs_p_3
L_gs_q_4:
  v_and_b32 v102, 63, v0
  v_lshlrev_b32 v102, 2, v102
  s_mov_b64 exec, 0xff
  global_load_dword v101, v102, s[40:41] sc1
  s_waitcnt vmcnt(0)
  ds_write_b32 v102, v101
  s_mov_b64 exec, -1
  s_waitcnt lgkmcnt(0)
L_gs_w_2:
  s_barrier
  v_mov_b32 v100, 0
  ds_read_b128 v[104:107], v100
  ds_read_b128 v[108:111], v100 offset:16
  s_waitcnt lgkmcnt(0)
  s_mov_b32 s44, 1
  s_mov_b32 s46, 0
  v_readfirstlane_b32 s45, v104
  s_cmp_eq_u32 s45, 32
  s_cselect_b32 s44, s44, 0
  s_cmp_gt_u32 s18, 0
  s_cselect_b32 s45, s45, 0
  s_add_u32 s46, s46, s45
  v_readfirstlane_b32 s45, v105
  s_cmp_eq_u32 s45, 32
  s_cselect_b32 s44, s44, 0
  s_cmp_gt_u32 s18, 1
  s_cselect_b32 s45, s45, 0
  s_add_u32 s46, s46, s45
  v_readfirstlane_b32 s45, v106
  s_cmp_eq_u32 s45, 32
  s_cselect_b32 s44, s44, 0
  s_cmp_gt_u32 s18, 2
  s_cselect_b32 s45, s45, 0
  s_add_u32 s46, s46, s45
  v_readfirstlane_b32 s45, v107
  s_cmp_eq_u32 s45, 32
  s_cselect_b32 s44, s44, 0
  s_cmp_gt_u32 s18, 3
  s_cselect_b32 s45, s45, 0
  s_add_u32 s46, s46, s45
  v_readfirstlane_b32 s45, v108
  s_cmp_eq_u32 s45, 32
  s_cselect_b32 s44, s44, 0
  s_cmp_gt_u32 s18, 4
  s_cselect_b32 s45, s45, 0
  s_add_u32 s46, s46, s45
  v_readfirstlane_b32 s45, v109
  s_cmp_eq_u32 s45, 32
  s_cselect_b32 s44, s44, 0
  s_cmp_gt_u32 s18, 5
  s_cselect_b32 s45, s45, 0
  s_add_u32 s46, s46, s45
  v_readfirstlane_b32 s45, v110
  s_cmp_eq_u32 s45, 32
  s_cselect_b32 s44, s44, 0
  s_cmp_gt_u32 s18, 6
  s_cselect_b32 s45, s45, 0
  s_add_u32 s46, s46, s45
  v_readfirstlane_b32 s45, v111
  s_cmp_eq_u32 s45, 32
  s_cselect_b32 s44, s44, 0
  s_cmp_gt_u32 s18, 7
  s_cselect_b32 s45, s45, 0
  s_add_u32 s46, s46, s45
  s_barrier
  s_mov_b32 s99, 1
  s_cmp_eq_u32 s44, 1
  s_cbranch_scc1 L_gs_done_1
  s_add_u32 s17, s46, s98
  s_branch L_dispatch
L_gs_done_1:
L_dispatch:
  s_cmp_lt_u32 s17, 64
  s_cbranch_scc1 L_role_chain
  s_cmp_lt_u32 s17, 128
  s_cbranch_scc1 L_role_qa
  s_cmp_lt_u32 s17, 160
  s_cbranch_scc1 L_role_g3s
  s_cmp_lt_u32 s17, 188
  s_cbranch_scc1 L_role_g4s
  s_cmp_lt_u32 s17, 192
  s_cbranch_scc1 L_role_f3x
  s_cmp_lt_u32 s17, 208
  s_cbranch_scc1 L_role_g5s
  s_cmp_lt_u32 s17, 216
  s_cbranch_scc1 L_role_f3s
  s_cmp_lt_u32 s17, 224
  s_cbranch_scc1 L_role_f5s
  s_sub_u32 s17, s17, 224
  s_branch L_role_kv
L_role_f3x:
  s_sub_u32 s17, s17, 188
  s_lshr_b32 s19, s17, 1
  s_and_b32 s17, s17, 1
  s_add_u32 s17, s17, 4
  s_branch L_role_f3
L_role_g3s:
  s_sub_u32 s17, s17, 128
  s_lshr_b32 s19, s17, 4
  s_and_b32 s17, s17, 15
  s_branch L_role_g3
L_role_g4s:
  s_sub_u32 s17, s17, 160
  s_cmp_ge_u32 s17, 14
  s_cselect_b32 s19, 1, 0
  s_mul_i32 s45, s19, 14
  s_sub_u32 s17, s17, s45
  s_branch L_role_g4
L_role_g5s:
  s_sub_u32 s17, s17, 192
  s_lshr_b32 s19, s17, 3
  s_and_b32 s17, s17, 7
  s_branch L_role_g5
L_role_f3s:
  s_sub_u32 s17, s17, 208
  s_lshr_b32 s19, s17, 2
  s_and_b32 s17, s17, 3
  s_branch L_role_f3
L_role_f5s:
  s_sub_u32 s17, s17, 216
  s_lshr_b32 s19, s17, 2
  s_and_b32 s17, s17, 3
  s_branch L_role_f5
L_role_chain:
  s_lshr_b32 s19, s17, 5
  s_and_b32 s17, s17, 31
  s_cmp_eq_u32 s44, 1
  s_cbranch_scc0 L_chain_slow
  v_and_b32 v1, 63, v0
  v_lshlrev_b32 v8, 4, v1
  v_and_b32 v124, 2, v1
  v_cmp_eq_u32 vcc, 0, v124
  v_mov_b32 v125, 0xeeee
  v_mov_b32 v126, 0x4444
  v_cndmask_b32 v2, v125, v126, vcc
  v_lshrrev_b32 v124, 4, v1
  v_bfe_u32 v125, v1, 2, 2
  v_and_b32 v126, 3, v1
  v_lshlrev_b32 v127, 8, v124
  v_lshl_add_u32 v127, v125, 5, v127
  v_lshl_add_u32 v127, v126, 3, v127
  v_and_b32 v124, 1, v124
  v_lshlrev_b32 v124, 7, v124
  v_xor_b32 v3, v127, v124
  v_and_b32 v124, 15, v1
  s_lshl_b32 s45, s16, 5
  v_add_u32 v124, s45, v124
  v_lshlrev_b32 v125, 4, v124
  v_lshrrev_b32 v126, 4, v1
  v_lshl_add_u32 v4, v126, 2, v125
  v_lshlrev_b32 v125, 5, v124
  v_lshl_add_u32 v125, v126, 3, v125
  v_bfe_u32 v126, v1, 3, 1
  v_lshlrev_b32 v126, 7, v126
  v_xor_b32 v6, v125, v126
  v_lshrrev_b32 v124, 4, v1
  v_bfe_u32 v125, v1, 2, 2
  v_lshl_add_u32 v125, v124, 2, v125
  v_lshlrev_b32 v126, 4, v125
  v_and_b32 v127, 1, v1
  v_lshl_add_u32 v5, v127, 3, v126
  v_lshlrev_b32 v126, 5, v125
  v_and_b32 v127, 3, v1
  v_lshl_add_u32 v126, v127, 3, v126
  v_lshrrev_b32 v124, 1, v124
  v_lshlrev_b32 v124, 7, v124
  v_xor_b32 v7, v126, v124
  v_and_b32 v124, 7, v1
  v_mul_u32_u24 v124, 272, v124
  v_lshrrev_b32 v125, 4, v1
  v_lshl_add_u32 v124, v125, 2, v124
  s_lshl_b32 s45, s16, 6
  v_add_u32 v9, s45, v124
  v_bfe_u32 v124, v1, 2, 2
  v_lshlrev_b32 v124, 1, v124
  v_and_b32 v126, 1, v1
  v_add_u32 v124, v124, v126
  v_mul_u32_u24 v124, 272, v124
  v_lshl_add_u32 v124, v125, 5, v124
  v_bfe_u32 v125, v1, 1, 1
  v_lshl_add_u32 v10, v125, 4, v124
  s_lshl_b32 s45, s16, 15
  s_add_u32 s45, s45, 0x8000
  v_add_u32 v11, s45, v8
  s_lshl_b32 s45, s16, 11
  v_add_u32 v15, s45, v8
  v_and_b32 v124, 15, v1
  v_lshrrev_b32 v125, 4, v1
  v_lshlrev_b32 v126, 4, v124
  v_lshl_add_u32 v12, v125, 13, v126
  s_lshl_b32 s46, s16, 10
  v_add_u32 v16, s46, v8
  v_bfe_u32 v126, v1, 1, 1
  v_lshlrev_b32 v126, 5, v126
  v_lshrrev_b32 v124, 5, v1
  v_lshl_add_u32 v126, v124, 4, v126
  s_lshl_b32 s46, s16, 6
  v_add_u32 v13, s46, v126
  v_bfe_u32 v126, v1, 2, 2
  v_lshl_add_u32 v126, v125, 2, v126
  v_lshlrev_b32 v126, 8, v126
  v_and_b32 v124, 3, v1
  v_lshl_add_u32 v126, v124, 4, v126
  v_add_u32 v35, s46, v126
  v_bfe_u32 v124, v1, 4, 1
  v_lshlrev_b32 v124, 7, v124
  v_xor_b32 v124, v124, v8
  v_add_u32 v14, s45, v124
  s_mul_i32 s46, s19, 0x40000
  s_add_u32 s46, s46, 0x130000
  s_lshl_b32 s45, s17, 8
  s_add_u32 s47, s46, s45
  s_lshl_b32 s45, s16, 16
  s_add_u32 s66, s47, s45
  s_lshl_b32 s45, s17, 13
  s_add_u32 s74, s46, s45
  s_mul_i32 s75, s19, 0x8000
  s_add_u32 s75, s75, 0x1b0000
  s_mul_i32 s45, s19, 0x2000000
  s_add_u32 s45, s45, 0x200000
  s_lshl_b32 s46, s17, 20
  s_add_u32 s78, s45, s46
  s_mul_i32 s45, s19, 0x800000
  s_add_u32 s45, s45, 0x4200000
  s_lshl_b32 s46, s17, 18
  s_add_u32 s79, s45, s46
  s_lshl_b32 s45, s19, 18
  s_lshl_b32 s46, s17, 7
  s_add_u32 s45, s45, s46
  s_add_u32 s80, s45, 0x0
  s_add_u32 s81, s45, 0x80000
  s_mov_b32 s84, 0x3e0293ee
  s_add_u32 s67, s66, 32768
  s_mov_b32 s87, 0x128000
  s_mov_b32 s58, 0x128000
  s_mov_b32 s86, 0x129000
  s_mov_b32 s83, 0x12b000
  v_mov_b32 v17, -1
  s_add_u32 s57, s74, 4096
  s_cmp_eq_u32 s16, 2
  s_cselect_b32 s54, 1, 0
  s_mov_b32 s55, 0
  s_cmp_eq_u32 s19, 0
  s_cbranch_scc1 L_cg_5
  s_cmp_eq_u32 s99, 1
  s_cbranch_scc1 L_gs_done_6
  s_cmp_eq_u32 s16, 0
  s_cbranch_scc0 L_gs_w_7
  v_mov_b32 v100, 32
L_gs_p_8:
  s_mov_b64 exec, 1
  global_load_dword v101, v100, s[40:41] sc1
  s_mov_b64 exec, -1
  s_waitcnt vmcnt(0)
  v_readfirstlane_b32 s45, v101
  s_sub_u32 s64, s64, 1
  s_cbranch_scc1 L_abort
  s_cmp_ge_u32 s45, 256
  s_cbranch_scc1 L_gs_q_9
  s_sleep 4
  s_branch L_gs_p_8
L_gs_q_9:
  v_and_b32 v102, 63, v0
  v_lshlrev_b32 v102, 2, v102
  s_mov_b64 exec, 0xff
  global_load_dword v101, v102, s[40:41] sc1
  s_waitcnt vmcnt(0)
  ds_write_b32 v102, v101
  s_mov_b64 exec, -1
  s_waitcnt lgkmcnt(0)
L_gs_w_7:
  s_barrier
  v_mov_b32 v100, 0
  ds_read_b128 v[104:107], v100
  ds_read_b128 v[108:111], v100 offset:16
  s_waitcnt lgkmcnt(0)
  s_mov_b32 s44, 1
  s_mov_b32 s46, 0
  v_readfirstlane_b32 s45, v104
  s_cmp_eq_u32 s45, 32
  s_cselect_b32 s44, s44, 0
  s_cmp_gt_u32 s18, 0
  s_cselect_b32 s45, s45, 0
  s_add_u32 s46, s46, s45
  v_readfirstlane_b32 s45, v105
  s_cmp_eq_u32 s45, 32
  s_cselect_b32 s44, s44, 0
  s_cmp_gt_u32 s18, 1
  s_cselect_b32 s45, s45, 0
  s_add_u32 s46, s46, s45
  v_readfirstlane_b32 s45, v106
  s_cmp_eq_u32 s45, 32
  s_cselect_b32 s44, s44, 0
  s_cmp_gt_u32 s18, 2
  s_cselect_b32 s45, s45, 0
  s_add_u32 s46, s46, s45
  v_readfirstlane_b32 s45, v107
  s_cmp_eq_u32 s45, 32
  s_cselect_b32 s44, s44, 0
  s_cmp_gt_u32 s18, 3
  s_cselect_b32 s45, s45, 0
  s_add_u32 s46, s46, s45
  v_readfirstlane_b32 s45, v108
  s_cmp_eq_u32 s45, 32
  s_cselect_b32 s44, s44, 0
  s_cmp_gt_u32 s18, 4
  s_cselect_b32 s45, s45, 0
  s_add_u32 s46, s46, s45
  v_readfirstlane_b32 s45, v109
  s_cmp_eq_u32 s45, 32
  s_cselect_b32 s44, s44, 0
  s_cmp_gt_u32 s18, 5
  s_cselect_b32 s45, s45, 0
  s_add_u32 s46, s46, s45
  v_readfirstlane_b32 s45, v110
  s_cmp_eq_u32 s45, 32
  s_cselect_b32 s44, s44, 0
  s_cmp_gt_u32 s18, 6
  s_cselect_b32 s45, s45, 0
  s_add_u32 s46, s46, s45
  v_readfirstlane_b32 s45, v111
  s_cmp_eq_u32 s45, 32
  s_cselect_b32 s44, s44, 0
  s_cmp_gt_u32 s18, 7
  s_cselect_b32 s45, s45, 0
  s_add_u32 s46, s46, s45
  s_barrier
  s_mov_b32 s99, 1
  s_cmp_eq_u32 s44, 1
  s_cbranch_scc1 L_gs_done_6
  s_add_u32 s17, s46, s98
  s_branch L_dispatch
L_gs_done_6:
L_cg_5:
  v_lshrrev_b32 v124, 4, v1
  v_bfe_u32 v125, v1, 1, 3
  v_xor_b32 v125, v125, v124
  v_lshlrev_b32 v125, 5, v125
  v_and_b32 v126, 1, v1
  v_lshl_add_u32 v125, v126, 4, v125
  v_lshl_add_u32 v125, v124, 13, v125
  s_lshl_b32 s45, s17, 8
  v_add_u32 v40, s45, v125
  v_xor_b32 v41, 128, v40
  v_lshrrev_b32 v124, 4, v1
  v_bfe_u32 v125, v1, 2, 1
  v_lshlrev_b32 v125, 1, v125
  v_bfe_u32 v127, v1, 3, 1
  v_or_b32 v125, v125, v127
  v_lshl_add_u32 v126, v124, 3, v125
  v_lshlrev_b32 v126, 8, v126
  v_and_b32 v124, 1, v124
  v_lshl_add_u32 v124, v124, 2, v125
  s_lshl_b32 s45, s16, 1
  v_xor_b32 v124, s45, v124
  v_lshl_add_u32 v126, v124, 5, v126
  v_and_b32 v125, 3, v1
  v_lshl_add_u32 v42, v125, 3, v126
  v_xor_b32 v46, 32, v42
  s_lshl_b32 s48, s16, 15
  s_add_u32 s48, s48, 0x8000
  s_lshl_b32 s50, s16, 12
  v_lshrrev_b32 v124, 4, v1
  v_bfe_u32 v125, v1, 1, 3
  v_xor_b32 v125, v125, v124
  v_lshlrev_b32 v125, 5, v125
  v_and_b32 v126, 1, v1
  v_lshl_add_u32 v125, v126, 4, v125
  v_lshl_add_u32 v125, v124, 10, v125
  s_lshl_b32 s45, s17, 17
  v_add_u32 v43, s45, v125
  v_xor_b32 v44, 128, v43
  v_lshrrev_b32 v124, 4, v1
  v_bfe_u32 v125, v1, 2, 2
  v_lshl_add_u32 v126, v124, 3, v125
  v_lshlrev_b32 v126, 8, v126
  v_and_b32 v124, 1, v124
  v_lshl_add_u32 v124, v124, 2, v125
  v_lshl_add_u32 v126, v124, 5, v126
  v_and_b32 v125, 3, v1
  v_lshl_add_u32 v126, v125, 3, v126
  v_add_u32 v45, s48, v126
  s_mov_b32 s8, s24
  s_and_b32 s9, s25, 0xffff
  s_mov_b32 s10, 0x400000
  s_mov_b32 s11, 0x20000
  s_lshl_b32 s47, s16, 17
  s_add_u32 s45, s50, 32768
  s_mov_b32 m0, s45
  s_add_u32 s46, s47, 0
  buffer_load_dwordx4 v40, s[8:11], s46 offen lds
  s_add_u32 s45, s50, 33792
  s_mov_b32 m0, s45
  s_add_u32 s46, s47, 32768
  buffer_load_dwordx4 v40, s[8:11], s46 offen lds
  s_add_u32 s45, s50, 34816
  s_mov_b32 m0, s45
  s_add_u32 s46, s47, 65536
  buffer_load_dwordx4 v41, s[8:11], s46 offen lds
  s_add_u32 s45, s50, 35840
  s_mov_b32 m0, s45
  s_add_u32 s46, s47, 98304
  buffer_load_dwordx4 v41, s[8:11], s46 offen lds
  s_lshl_b32 s47, s16, 17
  s_add_u32 s45, s50, 49152
  s_mov_b32 m0, s45
  s_add_u32 s46, s47, 524288
  buffer_load_dwordx4 v40, s[8:11], s46 offen lds
  s_add_u32 s45, s50, 50176
  s_mov_b32 m0, s45
  s_add_u32 s46, s47, 557056
  buffer_load_dwordx4 v40, s[8:11], s46 offen lds
  s_add_u32 s45, s50, 51200
  s_mov_b32 m0, s45
  s_add_u32 s46, s47, 589824
  buffer_load_dwordx4 v41, s[8:11], s46 offen lds
  s_add_u32 s45, s50, 52224
  s_mov_b32 m0, s45
  s_add_u32 s46, s47, 622592
  buffer_load_dwordx4 v41, s[8:11], s46 offen lds
  s_lshl_b32 s47, s16, 17
  s_add_u32 s45, s50, 65536
  s_mov_b32 m0, s45
  s_add_u32 s46, s47, 1048576
  buffer_load_dwordx4 v40, s[8:11], s46 offen lds
  s_add_u32 s45, s50, 66560
  s_mov_b32 m0, s45
  s_add_u32 s46, s47, 1081344
  buffer_load_dwordx4 v40, s[8:11], s46 offen lds
  s_add_u32 s45, s50, 67584
  s_mov_b32 m0, s45
  s_add_u32 s46, s47, 1114112
  buffer_load_dwordx4 v41, s[8:11], s46 offen lds
  s_add_u32 s45, s50, 68608
  s_mov_b32 m0, s45
  s_add_u32 s46, s47, 1146880
  buffer_load_dwordx4 v41, s[8:11], s46 offen lds
  s_lshl_b32 s47, s16, 17
  s_add_u32 s45, s50, 81920
  s_mov_b32 m0, s45
  s_add_u32 s46, s47, 1572864
  buffer_load_dwordx4 v40, s[8:11], s46 offen lds
  s_add_u32 s45, s50, 82944
  s_mov_b32 m0, s45
  s_add_u32 s46, s47, 1605632
  buffer_load_dwordx4 v40, s[8:11], s46 offen lds
  s_add_u32 s45, s50, 83968
  s_mov_b32 m0, s45
  s_add_u32 s46, s47, 1638400
  buffer_load_dwordx4 v41, s[8:11], s46 offen lds
  s_add_u32 s45, s50, 84992
  s_mov_b32 m0, s45
  s_add_u32 s46, s47, 1671168
  buffer_load_dwordx4 v41, s[8:11], s46 offen lds
  s_lshl_b32 s47, s16, 17
  s_add_u32 s45, s50, 98304
  s_mov_b32 m0, s45
  s_add_u32 s46, s47, 2097152
  buffer_load_dwordx4 v40, s[8:11], s46 offen lds
  s_add_u32 s45, s50, 99328
  s_mov_b32 m0, s45
  s_add_u32 s46, s47, 2129920
  buffer_load_dwordx4 v40, s[8:11], s46 offen lds
  s_add_u32 s45, s50, 100352
  s_mov_b32 m0, s45
  s_add_u32 s46, s47, 2162688
  buffer_load_dwordx4 v41, s[8:11], s46 offen lds
  s_add_u32 s45, s50, 101376
  s_mov_b32 m0, s45
  s_add_u32 s46, s47, 2195456
  buffer_load_dwordx4 v41, s[8:11], s46 offen lds
  s_lshl_b32 s47, s16, 17
  s_add_u32 s45, s50, 114688
  s_mov_b32 m0, s45
  s_add_u32 s46, s47, 2621440
  buffer_load_dwordx4 v40, s[8:11], s46 offen lds
  s_add_u32 s45, s50, 115712
  s_mov_b32 m0, s45
  s_add_u32 s46, s47, 2654208
  buffer_load_dwordx4 v40, s[8:11], s46 offen lds
  s_add_u32 s45, s50, 116736
  s_mov_b32 m0, s45
  s_add_u32 s46, s47, 2686976
  buffer_load_dwordx4 v41, s[8:11], s46 offen lds
  s_add_u32 s45, s50, 117760
  s_mov_b32 m0, s45
  s_add_u32 s46, s47, 2719744
  buffer_load_dwordx4 v41, s[8:11], s46 offen lds
  s_lshl_b32 s47, s16, 17
  s_add_u32 s45, s50, 131072
  s_mov_b32 m0, s45
  s_add_u32 s46, s47, 3145728
  buffer_load_dwordx4 v40, s[8:11], s46 offen lds
  s_add_u32 s45, s50, 132096
  s_mov_b32 m0, s45
  s_add_u32 s46, s47, 3178496
  buffer_load_dwordx4 v40, s[8:11], s46 offen lds
  s_add_u32 s45, s50, 133120
  s_mov_b32 m0, s45
  s_add_u32 s46, s47, 3211264
  buffer_load_dwordx4 v41, s[8:11], s46 offen lds
  s_add_u32 s45, s50, 134144
  s_mov_b32 m0, s45
  s_add_u32 s46, s47, 3244032
  buffer_load_dwordx4 v41, s[8:11], s46 offen lds
  s_waitcnt vmcnt(24)
  s_barrier
  s_lshl_b32 s47, s16, 17
  s_add_u32 s45, s50, 147456
  s_mov_b32 m0, s45
  s_add_u32 s46, s47, 3670016
  buffer_load_dwordx4 v40, s[8:11], s46 offen lds
  s_add_u32 s45, s50, 148480
  s_mov_b32 m0, s45
  s_add_u32 s46, s47, 3702784
  buffer_load_dwordx4 v40, s[8:11], s46 offen lds
  s_add_u32 s45, s50, 149504
  s_mov_b32 m0, s45
  s_add_u32 s46, s47, 3735552
  buffer_load_dwordx4 v41, s[8:11], s46 offen lds
  s_add_u32 s45, s50, 150528
  s_mov_b32 m0, s45
  s_add_u32 s46, s47, 3768320
  buffer_load_dwordx4 v41, s[8:11], s46 offen lds
  v_add_u32 v47, 0x8000, v42
  ds_read_b64_tr_b16 v[128:129], v47 offset:0
  ds_read_b64_tr_b16 v[130:131], v47 offset:1024
  ds_read_b64_tr_b16 v[132:133], v47 offset:8192
  ds_read_b64_tr_b16 v[134:135], v47 offset:9216
  v_add_u32 v47, 0x8000, v46
  ds_read_b64_tr_b16 v[192:193], v47 offset:0
  ds_read_b64_tr_b16 v[194:195], v47 offset:1024
  ds_read_b64_tr_b16 v[196:197], v47 offset:8192
  ds_read_b64_tr_b16 v[198:199], v47 offset:9216
  s_waitcnt lgkmcnt(0)
  s_waitcnt vmcnt(24)
  s_barrier
  s_mov_b32 s8, s26
  s_and_b32 s9, s27, 0xffff
  s_mov_b32 s10, 0x400000
  s_mov_b32 s11, 0x20000
  s_lshl_b32 s47, s16, 17
  s_add_u32 s45, s50, 32768
  s_mov_b32 m0, s45
  s_add_u32 s46, s47, 0
  buffer_load_dwordx4 v40, s[8:11], s46 offen lds
  s_add_u32 s45, s50, 33792
  s_mov_b32 m0, s45
  s_add_u32 s46, s47, 32768
  buffer_load_dwordx4 v40, s[8:11], s46 offen lds
  s_add_u32 s45, s50, 34816
  s_mov_b32 m0, s45
  s_add_u32 s46, s47, 65536
  buffer_load_dwordx4 v41, s[8:11], s46 offen lds
  s_add_u32 s45, s50, 35840
  s_mov_b32 m0, s45
  s_add_u32 s46, s47, 98304
  buffer_load_dwordx4 v41, s[8:11], s46 offen lds
  v_add_u32 v47, 0xc000, v42
  ds_read_b64_tr_b16 v[136:137], v47 offset:0
  ds_read_b64_tr_b16 v[138:139], v47 offset:1024
  ds_read_b64_tr_b16 v[140:141], v47 offset:8192
  ds_read_b64_tr_b16 v[142:143], v47 offset:9216
  v_add_u32 v47, 0xc000, v46
  ds_read_b64_tr_b16 v[200:201], v47 offset:0
  ds_read_b64_tr_b16 v[202:203], v47 offset:1024
  ds_read_b64_tr_b16 v[204:205], v47 offset:8192
  ds_read_b64_tr_b16 v[206:207], v47 offset:9216
  s_waitcnt lgkmcnt(0)
  s_waitcnt vmcnt(24)
  s_barrier
  s_lshl_b32 s47, s16, 17
  s_add_u32 s45, s50, 49152
  s_mov_b32 m0, s45
  s_add_u32 s46, s47, 524288
  buffer_load_dwordx4 v40, s[8:11], s46 offen lds
  s_add_u32 s45, s50, 50176
  s_mov_b32 m0, s45
  s_add_u32 s46, s47, 557056
  buffer_load_dwordx4 v40, s[8:11], s46 offen lds
  s_add_u32 s45, s50, 51200
  s_mov_b32 m0, s45
  s_add_u32 s46, s47, 589824
  buffer_load_dwordx4 v41, s[8:11], s46 offen lds
  s_add_u32 s45, s50, 52224
  s_mov_b32 m0, s45
  s_add_u32 s46, s47, 622592
  buffer_load_dwordx4 v41, s[8:11], s46 offen lds
  v_add_u32 v47, 0x10000, v42
  ds_read_b64_tr_b16 v[144:145], v47 offset:0
  ds_read_b64_tr_b16 v[146:147], v47 offset:1024
  ds_read_b64_tr_b16 v[148:149], v47 offset:8192
  ds_read_b64_tr_b16 v[150:151], v47 offset:9216
  v_add_u32 v47, 0x10000, v46
  ds_read_b64_tr_b16 v[208:209], v47 offset:0
  ds_read_b64_tr_b16 v[210:211], v47 offset:1024
  ds_read_b64_tr_b16 v[212:213], v47 offset:8192
  ds_read_b64_tr_b16 v[214:215], v47 offset:9216
  s_waitcnt lgkmcnt(0)
  s_waitcnt vmcnt(24)
  s_barrier
  s_lshl_b32 s47, s16, 17
  s_add_u32 s45, s50, 65536
  s_mov_b32 m0, s45
  s_add_u32 s46, s47, 1048576
  buffer_load_dwordx4 v40, s[8:11], s46 offen lds
  s_add_u32 s45, s50, 66560
  s_mov_b32 m0, s45
  s_add_u32 s46, s47, 1081344
  buffer_load_dwordx4 v40, s[8:11], s46 offen lds
  s_add_u32 s45, s50, 67584
  s_mov_b32 m0, s45
  s_add_u32 s46, s47, 1114112
  buffer_load_dwordx4 v41, s[8:11], s46 offen lds
  s_add_u32 s45, s50, 68608
  s_mov_b32 m0, s45
  s_add_u32 s46, s47, 1146880
  buffer_load_dwordx4 v41, s[8:11], s46 offen lds
  v_add_u32 v47, 0x14000, v42
  ds_read_b64_tr_b16 v[152:153], v47 offset:0
  ds_read_b64_tr_b16 v[154:155], v47 offset:1024
  ds_read_b64_tr_b16 v[156:157], v47 offset:8192
  ds_read_b64_tr_b16 v[158:159], v47 offset:9216
  v_add_u32 v47, 0x14000, v46
  ds_read_b64_tr_b16 v[216:217], v47 offset:0
  ds_read_b64_tr_b16 v[218:219], v47 offset:1024
  ds_read_b64_tr_b16 v[220:221], v47 offset:8192
  ds_read_b64_tr_b16 v[222:223], v47 offset:9216
  s_waitcnt lgkmcnt(0)
  s_waitcnt vmcnt(24)
  s_barrier
  s_lshl_b32 s47, s16, 17
  s_add_u32 s45, s50, 81920
  s_mov_b32 m0, s45
  s_add_u32 s46, s47, 1572864
  buffer_load_dwordx4 v40, s[8:11], s46 offen lds
  s_add_u32 s45, s50, 82944
  s_mov_b32 m0, s45
  s_add_u32 s46, s47, 1605632
  buffer_load_dwordx4 v40, s[8:11], s46 offen lds
  s_add_u32 s45, s50, 83968
  s_mov_b32 m0, s45
  s_add_u32 s46, s47, 1638400
  buffer_load_dwordx4 v41, s[8:11], s46 offen lds
  s_add_u32 s45, s50, 84992
  s_mov_b32 m0, s45
  s_add_u32 s46, s47, 1671168
  buffer_load_dwordx4 v41, s[8:11], s46 offen lds
  v_add_u32 v47, 0x18000, v42
  ds_read_b64_tr_b16 v[160:161], v47 offset:0
  ds_read_b64_tr_b16 v[162:163], v47 offset:1024
  ds_read_b64_tr_b16 v[164:165], v47 offset:8192
  ds_read_b64_tr_b16 v[166:167], v47 offset:9216
  v_add_u32 v47, 0x18000, v46
  ds_read_b64_tr_b16 v[224:225], v47 offset:0
  ds_read_b64_tr_b16 v[226:227], v47 offset:1024
  ds_read_b64_tr_b16 v[228:229], v47 offset:8192
  ds_read_b64_tr_b16 v[230:231], v47 offset:9216
  s_waitcnt lgkmcnt(0)
  s_waitcnt vmcnt(24)
  s_barrier
  s_lshl_b32 s47, s16, 17
  s_add_u32 s45, s50, 98304
  s_mov_b32 m0, s45
  s_add_u32 s46, s47, 2097152
  buffer_load_dwordx4 v40, s[8:11], s46 offen lds
  s_add_u32 s45, s50, 99328
  s_mov_b32 m0, s45
  s_add_u32 s46, s47, 2129920
  buffer_load_dwordx4 v40, s[8:11], s46 offen lds
  s_add_u32 s45, s50, 100352
  s_mov_b32 m0, s45
  s_add_u32 s46, s47, 2162688
  buffer_load_dwordx4 v41, s[8:11], s46 offen lds
  s_add_u32 s45, s50, 101376
  s_mov_b32 m0, s45
  s_add_u32 s46, s47, 2195456
  buffer_load_dwordx4 v41, s[8:11], s46 offen lds
  v_add_u32 v47, 0x1c000, v42
  ds_read_b64_tr_b16 v[168:169], v47 offset:0
  ds_read_b64_tr_b16 v[170:171], v47 offset:1024
  ds_read_b64_tr_b16 v[172:173], v47 offset:8192
  ds_read_b64_tr_b16 v[174:175], v47 offset:9216
  v_add_u32 v47, 0x1c000, v46
  ds_read_b64_tr_b16 v[232:233], v47 offset:0
  ds_read_b64_tr_b16 v[234:235], v47 offset:1024
  ds_read_b64_tr_b16 v[236:237], v47 offset:8192
  ds_read_b64_tr_b16 v[238:239], v47 offset:9216
  s_waitcnt lgkmcnt(0)
  s_waitcnt vmcnt(24)
  s_barrier
  s_lshl_b32 s47, s16, 17
  s_add_u32 s45, s50, 114688
  s_mov_b32 m0, s45
  s_add_u32 s46, s47, 2621440
  buffer_load_dwordx4 v40, s[8:11], s46 offen lds
  s_add_u32 s45, s50, 115712
  s_mov_b32 m0, s45
  s_add_u32 s46, s47, 2654208
  buffer_load_dwordx4 v40, s[8:11], s46 offen lds
  s_add_u32 s45, s50, 116736
  s_mov_b32 m0, s45
  s_add_u32 s46, s47, 2686976
  buffer_load_dwordx4 v41, s[8:11], s46 offen lds
  s_add_u32 s45, s50, 117760
  s_mov_b32 m0, s45
  s_add_u32 s46, s47, 2719744
  buffer_load_dwordx4 v41, s[8:11], s46 offen lds
  v_add_u32 v47, 0x20000, v42
  ds_read_b64_tr_b16 v[176:177], v47 offset:0
  ds_read_b64_tr_b16 v[178:179], v47 offset:1024
  ds_read_b64_tr_b16 v[180:181], v47 offset:8192
  ds_read_b64_tr_b16 v[182:183], v47 offset:9216
  v_add_u32 v47, 0x20000, v46
  ds_read_b64_tr_b16 v[240:241], v47 offset:0
  ds_read_b64_tr_b16 v[242:243], v47 offset:1024
  ds_read_b64_tr_b16 v[244:245], v47 offset:8192
  ds_read_b64_tr_b16 v[246:247], v47 offset:9216
  s_waitcnt lgkmcnt(0)
  s_waitcnt vmcnt(24)
  s_barrier
  s_lshl_b32 s47, s16, 17
  s_add_u32 s45, s50, 131072
  s_mov_b32 m0, s45
  s_add_u32 s46, s47, 3145728
  buffer_load_dwordx4 v40, s[8:11], s46 offen lds
  s_add_u32 s45, s50, 132096
  s_mov_b32 m0, s45
  s_add_u32 s46, s47, 3178496
  buffer_load_dwordx4 v40, s[8:11], s46 offen lds
  s_add_u32 s45, s50, 133120
  s_mov_b32 m0, s45
  s_add_u32 s46, s47, 3211264
  buffer_load_dwordx4 v41, s[8:11], s46 offen lds
  s_add_u32 s45, s50, 134144
  s_mov_b32 m0, s45
  s_add_u32 s46, s47, 3244032
  buffer_load_dwordx4 v41, s[8:11], s46 offen lds
  v_add_u32 v47, 0x24000, v42
  ds_read_b64_tr_b16 v[184:185], v47 offset:0
  ds_read_b64_tr_b16 v[186:187], v47 offset:1024
  ds_read_b64_tr_b16 v[188:189], v47 offset:8192
  ds_read_b64_tr_b16 v[190:191], v47 offset:9216
  v_add_u32 v47, 0x24000, v46
  ds_read_b64_tr_b16 v[248:249], v47 offset:0
  ds_read_b64_tr_b16 v[250:251], v47 offset:1024
  ds_read_b64_tr_b16 v[252:253], v47 offset:8192
  ds_read_b64_tr_b16 v[254:255], v47 offset:9216
  s_waitcnt lgkmcnt(0)
  s_waitcnt vmcnt(24)
  s_barrier
  s_lshl_b32 s47, s16, 17
  s_add_u32 s45, s50, 147456
  s_mov_b32 m0, s45
  s_add_u32 s46, s47, 3670016
  buffer_load_dwordx4 v40, s[8:11], s46 offen lds
  s_add_u32 s45, s50, 148480
  s_mov_b32 m0, s45
  s_add_u32 s46, s47, 3702784
  buffer_load_dwordx4 v40, s[8:11], s46 offen lds
  s_add_u32 s45, s50, 149504
  s_mov_b32 m0, s45
  s_add_u32 s46, s47, 3735552
  buffer_load_dwordx4 v41, s[8:11], s46 offen lds
  s_add_u32 s45, s50, 150528
  s_mov_b32 m0, s45
  s_add_u32 s46, s47, 3768320
  buffer_load_dwordx4 v41, s[8:11], s46 offen lds
  v_add_u32 v47, 0x8000, v42
  ds_read_b64_tr_b16 a[0:1], v47 offset:0
  ds_read_b64_tr_b16 a[2:3], v47 offset:1024
  ds_read_b64_tr_b16 a[4:5], v47 offset:8192
  ds_read_b64_tr_b16 a[6:7], v47 offset:9216
  v_add_u32 v47, 0x8000, v46
  ds_read_b64_tr_b16 a[64:65], v47 offset:0
  ds_read_b64_tr_b16 a[66:67], v47 offset:1024
  ds_read_b64_tr_b16 a[68:69], v47 offset:8192
  ds_read_b64_tr_b16 a[70:71], v47 offset:9216
  s_waitcnt lgkmcnt(0)
  s_waitcnt vmcnt(24)
  s_barrier
  s_mov_b32 s8, s28
  s_and_b32 s9, s29, 0xffff
  s_mov_b32 s10, 0x400000
  s_mov_b32 s11, 0x20000
  s_lshl_b32 s47, s16, 17
  s_add_u32 s45, s50, 32768
  s_mov_b32 m0, s45
  s_add_u32 s46, s47, 0
  buffer_load_dwordx4 v40, s[8:11], s46 offen lds
  s_add_u32 s45, s50, 33792
  s_mov_b32 m0, s45
  s_add_u32 s46, s47, 32768
  buffer_load_dwordx4 v40, s[8:11], s46 offen lds
  s_add_u32 s45, s50, 34816
  s_mov_b32 m0, s45
  s_add_u32 s46, s47, 65536
  buffer_load_dwordx4 v41, s[8:11], s46 offen lds
  s_add_u32 s45, s50, 35840
  s_mov_b32 m0, s45
  s_add_u32 s46, s47, 98304
  buffer_load_dwordx4 v41, s[8:11], s46 offen lds
  v_add_u32 v47, 0xc000, v42
  ds_read_b64_tr_b16 a[8:9], v47 offset:0
  ds_read_b64_tr_b16 a[10:11], v47 offset:1024
  ds_read_b64_tr_b16 a[12:13], v47 offset:8192
  ds_read_b64_tr_b16 a[14:15], v47 offset:9216
  v_add_u32 v47, 0xc000, v46
  ds_read_b64_tr_b16 a[72:73], v47 offset:0
  ds_read_b64_tr_b16 a[74:75], v47 offset:1024
  ds_read_b64_tr_b16 a[76:77], v47 offset:8192
  ds_read_b64_tr_b16 a[78:79], v47 offset:9216
  s_waitcnt lgkmcnt(0)
  s_waitcnt vmcnt(24)
  s_barrier
  s_lshl_b32 s47, s16, 17
  s_add_u32 s45, s50, 49152
  s_mov_b32 m0, s45
  s_add_u32 s46, s47, 524288
  buffer_load_dwordx4 v40, s[8:11], s46 offen lds
  s_add_u32 s45, s50, 50176
  s_mov_b32 m0, s45
  s_add_u32 s46, s47, 557056
  buffer_load_dwordx4 v40, s[8:11], s46 offen lds
  s_add_u32 s45, s50, 51200
  s_mov_b32 m0, s45
  s_add_u32 s46, s47, 589824
  buffer_load_dwordx4 v41, s[8:11], s46 offen lds
  s_add_u32 s45, s50, 52224
  s_mov_b32 m0, s45
  s_add_u32 s46, s47, 622592
  buffer_load_dwordx4 v41, s[8:11], s46 offen lds
  v_add_u32 v47, 0x10000, v42
  ds_read_b64_tr_b16 a[16:17], v47 offset:0
  ds_read_b64_tr_b16 a[18:19], v47 offset:1024
  ds_read_b64_tr_b16 a[20:21], v47 offset:8192
  ds_read_b64_tr_b16 a[22:23], v47 offset:9216
  v_add_u32 v47, 0x10000, v46
  ds_read_b64_tr_b16 a[80:81], v47 offset:0
  ds_read_b64_tr_b16 a[82:83], v47 offset:1024
  ds_read_b64_tr_b16 a[84:85], v47 offset:8192
  ds_read_b64_tr_b16 a[86:87], v47 offset:9216
  s_waitcnt lgkmcnt(0)
  s_waitcnt vmcnt(24)
  s_barrier
  s_lshl_b32 s47, s16, 17
  s_add_u32 s45, s50, 65536
  s_mov_b32 m0, s45
  s_add_u32 s46, s47, 1048576
  buffer_load_dwordx4 v40, s[8:11], s46 offen lds
  s_add_u32 s45, s50, 66560
  s_mov_b32 m0, s45
  s_add_u32 s46, s47, 1081344
  buffer_load_dwordx4 v40, s[8:11], s46 offen lds
  s_add_u32 s45, s50, 67584
  s_mov_b32 m0, s45
  s_add_u32 s46, s47, 1114112
  buffer_load_dwordx4 v41, s[8:11], s46 offen lds
  s_add_u32 s45, s50, 68608
  s_mov_b32 m0, s45
  s_add_u32 s46, s47, 1146880
  buffer_load_dwordx4 v41, s[8:11], s46 offen lds
  v_add_u32 v47, 0x14000, v42
  ds_read_b64_tr_b16 a[24:25], v47 offset:0
  ds_read_b64_tr_b16 a[26:27], v47 offset:1024
  ds_read_b64_tr_b16 a[28:29], v47 offset:8192
  ds_read_b64_tr_b16 a[30:31], v47 offset:9216
  v_add_u32 v47, 0x14000, v46
  ds_read_b64_tr_b16 a[88:89], v47 offset:0
  ds_read_b64_tr_b16 a[90:91], v47 offset:1024
  ds_read_b64_tr_b16 a[92:93], v47 offset:8192
  ds_read_b64_tr_b16 a[94:95], v47 offset:9216
  s_waitcnt lgkmcnt(0)
  s_waitcnt vmcnt(24)
  s_barrier
  s_lshl_b32 s47, s16, 17
  s_add_u32 s45, s50, 81920
  s_mov_b32 m0, s45
  s_add_u32 s46, s47, 1572864
  buffer_load_dwordx4 v40, s[8:11], s46 offen lds
  s_add_u32 s45, s50, 82944
  s_mov_b32 m0, s45
  s_add_u32 s46, s47, 1605632
  buffer_load_dwordx4 v40, s[8:11], s46 offen lds
  s_add_u32 s45, s50, 83968
  s_mov_b32 m0, s45
  s_add_u32 s46, s47, 1638400
  buffer_load_dwordx4 v41, s[8:11], s46 offen lds
  s_add_u32 s45, s50, 84992
  s_mov_b32 m0, s45
  s_add_u32 s46, s47, 1671168
  buffer_load_dwordx4 v41, s[8:11], s46 offen lds
  v_add_u32 v47, 0x18000, v42
  ds_read_b64_tr_b16 a[32:33], v47 offset:0
  ds_read_b64_tr_b16 a[34:35], v47 offset:1024
  ds_read_b64_tr_b16 a[36:37], v47 offset:8192
  ds_read_b64_tr_b16 a[38:39], v47 offset:9216
  v_add_u32 v47, 0x18000, v46
  ds_read_b64_tr_b16 a[96:97], v47 offset:0
  ds_read_b64_tr_b16 a[98:99], v47 offset:1024
  ds_read_b64_tr_b16 a[100:101], v47 offset:8192
  ds_read_b64_tr_b16 a[102:103], v47 offset:9216
  s_waitcnt lgkmcnt(0)
  s_waitcnt vmcnt(24)
  s_barrier
  s_lshl_b32 s47, s16, 17
  s_add_u32 s45, s50, 98304
  s_mov_b32 m0, s45
  s_add_u32 s46, s47, 2097152
  buffer_load_dwordx4 v40, s[8:11], s46 offen lds
  s_add_u32 s45, s50, 99328
  s_mov_b32 m0, s45
  s_add_u32 s46, s47, 2129920
  buffer_load_dwordx4 v40, s[8:11], s46 offen lds
  s_add_u32 s45, s50, 100352
  s_mov_b32 m0, s45
  s_add_u32 s46, s47, 2162688
  buffer_load_dwordx4 v41, s[8:11], s46 offen lds
  s_add_u32 s45, s50, 101376
  s_mov_b32 m0, s45
  s_add_u32 s46, s47, 2195456
  buffer_load_dwordx4 v41, s[8:11], s46 offen lds
  v_add_u32 v47, 0x1c000, v42
  ds_read_b64_tr_b16 a[40:41], v47 offset:0
  ds_read_b64_tr_b16 a[42:43], v47 offset:1024
  ds_read_b64_tr_b16 a[44:45], v47 offset:8192
  ds_read_b64_tr_b16 a[46:47], v47 offset:9216
  v_add_u32 v47, 0x1c000, v46
  ds_read_b64_tr_b16 a[104:105], v47 offset:0
  ds_read_b64_tr_b16 a[106:107], v47 offset:1024
  ds_read_b64_tr_b16 a[108:109], v47 offset:8192
  ds_read_b64_tr_b16 a[110:111], v47 offset:9216
  s_waitcnt lgkmcnt(0)
  s_waitcnt vmcnt(24)
  s_barrier
  s_lshl_b32 s47, s16, 17
  s_add_u32 s45, s50, 114688
  s_mov_b32 m0, s45
  s_add_u32 s46, s47, 2621440
  buffer_load_dwordx4 v40, s[8:11], s46 offen lds
  s_add_u32 s45, s50, 115712
  s_mov_b32 m0, s45
  s_add_u32 s46, s47, 2654208
  buffer_load_dwordx4 v40, s[8:11], s46 offen lds
  s_add_u32 s45, s50, 116736
  s_mov_b32 m0, s45
  s_add_u32 s46, s47, 2686976
  buffer_load_dwordx4 v41, s[8:11], s46 offen lds
  s_add_u32 s45, s50, 117760
  s_mov_b32 m0, s45
  s_add_u32 s46, s47, 2719744
  buffer_load_dwordx4 v41, s[8:11], s46 offen lds
  v_add_u32 v47, 0x20000, v42
  ds_read_b64_tr_b16 a[48:49], v47 offset:0
  ds_read_b64_tr_b16 a[50:51], v47 offset:1024
  ds_read_b64_tr_b16 a[52:53], v47 offset:8192
  ds_read_b64_tr_b16 a[54:55], v47 offset:9216
  v_add_u32 v47, 0x20000, v46
  ds_read_b64_tr_b16 a[112:113], v47 offset:0
  ds_read_b64_tr_b16 a[114:115], v47 offset:1024
  ds_read_b64_tr_b16 a[116:117], v47 offset:8192
  ds_read_b64_tr_b16 a[118:119], v47 offset:9216
  s_waitcnt lgkmcnt(0)
  s_waitcnt vmcnt(24)
  s_barrier
  s_lshl_b32 s47, s16, 17
  s_add_u32 s45, s50, 131072
  s_mov_b32 m0, s45
  s_add_u32 s46, s47, 3145728
  buffer_load_dwordx4 v40, s[8:11], s46 offen lds
  s_add_u32 s45, s50, 132096
  s_mov_b32 m0, s45
  s_add_u32 s46, s47, 3178496
  buffer_load_dwordx4 v40, s[8:11], s46 offen lds
  s_add_u32 s45, s50, 133120
  s_mov_b32 m0, s45
  s_add_u32 s46, s47, 3211264
  buffer_load_dwordx4 v41, s[8:11], s46 offen lds
  s_add_u32 s45, s50, 134144
  s_mov_b32 m0, s45
  s_add_u32 s46, s47, 3244032
  buffer_load_dwordx4 v41, s[8:11], s46 offen lds
  v_add_u32 v47, 0x24000, v42
  ds_read_b64_tr_b16 a[56:57], v47 offset:0
  ds_read_b64_tr_b16 a[58:59], v47 offset:1024
  ds_read_b64_tr_b16 a[60:61], v47 offset:8192
  ds_read_b64_tr_b16 a[62:63], v47 offset:9216
  v_add_u32 v47, 0x24000, v46
  ds_read_b64_tr_b16 a[120:121], v47 offset:0
  ds_read_b64_tr_b16 a[122:123], v47 offset:1024
  ds_read_b64_tr_b16 a[124:125], v47 offset:8192
  ds_read_b64_tr_b16 a[126:127], v47 offset:9216
  s_waitcnt lgkmcnt(0)
  s_waitcnt vmcnt(24)
  s_barrier
  s_lshl_b32 s47, s16, 17
  s_add_u32 s45, s50, 147456
  s_mov_b32 m0, s45
  s_add_u32 s46, s47, 3670016
  buffer_load_dwordx4 v40, s[8:11], s46 offen lds
  s_add_u32 s45, s50, 148480
  s_mov_b32 m0, s45
  s_add_u32 s46, s47, 3702784
  buffer_load_dwordx4 v40, s[8:11], s46 offen lds
  s_add_u32 s45, s50, 149504
  s_mov_b32 m0, s45
  s_add_u32 s46, s47, 3735552
  buffer_load_dwordx4 v41, s[8:11], s46 offen lds
  s_add_u32 s45, s50, 150528
  s_mov_b32 m0, s45
  s_add_u32 s46, s47, 3768320
  buffer_load_dwordx4 v41, s[8:11], s46 offen lds
  v_add_u32 v47, 0x8000, v42
  ds_read_b64_tr_b16 a[128:129], v47 offset:0
  ds_read_b64_tr_b16 a[130:131], v47 offset:1024
  ds_read_b64_tr_b16 a[132:133], v47 offset:8192
  ds_read_b64_tr_b16 a[134:135], v47 offset:9216
  v_add_u32 v47, 0x8000, v46
  ds_read_b64_tr_b16 a[192:193], v47 offset:0
  ds_read_b64_tr_b16 a[194:195], v47 offset:1024
  ds_read_b64_tr_b16 a[196:197], v47 offset:8192
  ds_read_b64_tr_b16 a[198:199], v47 offset:9216
  s_waitcnt lgkmcnt(0)
  s_waitcnt vmcnt(24)
  s_barrier
  s_mov_b32 s12, s30
  s_and_b32 s13, s31, 0xffff
  s_mov_b32 s14, 0x400000
  s_mov_b32 s15, 0x20000
  s_lshl_b32 s47, s16, 14
  s_add_u32 s45, s50, 32768
  s_mov_b32 m0, s45
  s_add_u32 s46, s47, 0
  buffer_load_dwordx4 v43, s[12:15], s46 offen lds
  s_add_u32 s45, s50, 33792
  s_mov_b32 m0, s45
  s_add_u32 s46, s47, 4096
  buffer_load_dwordx4 v43, s[12:15], s46 offen lds
  s_add_u32 s45, s50, 34816
  s_mov_b32 m0, s45
  s_add_u32 s46, s47, 8192
  buffer_load_dwordx4 v44, s[12:15], s46 offen lds
  s_add_u32 s45, s50, 35840
  s_mov_b32 m0, s45
  s_add_u32 s46, s47, 12288
  buffer_load_dwordx4 v44, s[12:15], s46 offen lds
  v_add_u32 v47, 0xc000, v42
  ds_read_b64_tr_b16 a[136:137], v47 offset:0
  ds_read_b64_tr_b16 a[138:139], v47 offset:1024
  ds_read_b64_tr_b16 a[140:141], v47 offset:8192
  ds_read_b64_tr_b16 a[142:143], v47 offset:9216
  v_add_u32 v47, 0xc000, v46
  ds_read_b64_tr_b16 a[200:201], v47 offset:0
  ds_read_b64_tr_b16 a[202:203], v47 offset:1024
  ds_read_b64_tr_b16 a[204:205], v47 offset:8192
  ds_read_b64_tr_b16 a[206:207], v47 offset:9216
  s_waitcnt lgkmcnt(0)
  s_waitcnt vmcnt(24)
  s_barrier
  s_mov_b32 s12, s30
  s_and_b32 s13, s31, 0xffff
  s_mov_b32 s14, 0x400000
  s_mov_b32 s15, 0x20000
  s_lshl_b32 s47, s16, 14
  s_add_u32 s45, s50, 49152
  s_mov_b32 m0, s45
  s_add_u32 s46, s47, 65536
  buffer_load_dwordx4 v43, s[12:15], s46 offen lds
  s_add_u32 s45, s50, 50176
  s_mov_b32 m0, s45
  s_add_u32 s46, s47, 69632
  buffer_load_dwordx4 v43, s[12:15], s46 offen lds
  s_add_u32 s45, s50, 51200
  s_mov_b32 m0, s45
  s_add_u32 s46, s47, 73728
  buffer_load_dwordx4 v44, s[12:15], s46 offen lds
  s_add_u32 s45, s50, 52224
  s_mov_b32 m0, s45
  s_add_u32 s46, s47, 77824
  buffer_load_dwordx4 v44, s[12:15], s46 offen lds
  v_add_u32 v47, 0x10000, v42
  ds_read_b64_tr_b16 a[144:145], v47 offset:0
  ds_read_b64_tr_b16 a[146:147], v47 offset:1024
  ds_read_b64_tr_b16 a[148:149], v47 offset:8192
  ds_read_b64_tr_b16 a[150:151], v47 offset:9216
  v_add_u32 v47, 0x10000, v46
  ds_read_b64_tr_b16 a[208:209], v47 offset:0
  ds_read_b64_tr_b16 a[210:211], v47 offset:1024
  ds_read_b64_tr_b16 a[212:213], v47 offset:8192
  ds_read_b64_tr_b16 a[214:215], v47 offset:9216
  s_waitcnt lgkmcnt(0)
  s_waitcnt vmcnt(24)
  s_barrier
  s_mov_b32 s12, s30
  s_and_b32 s13, s31, 0xffff
  s_mov_b32 s14, 0x400000
  s_mov_b32 s15, 0x20000
  s_lshl_b32 s47, s16, 14
  s_add_u32 s45, s50, 65536
  s_mov_b32 m0, s45
  s_add_u32 s46, s47, 256
  buffer_load_dwordx4 v43, s[12:15], s46 offen lds
  s_add_u32 s45, s50, 66560
  s_mov_b32 m0, s45
  s_add_u32 s46, s47, 4352
  buffer_load_dwordx4 v43, s[12:15], s46 offen lds
  s_add_u32 s45, s50, 67584
  s_mov_b32 m0, s45
  s_add_u32 s46, s47, 8448
  buffer_load_dwordx4 v44, s[12:15], s46 offen lds
  s_add_u32 s45, s50, 68608
  s_mov_b32 m0, s45
  s_add_u32 s46, s47, 12544
  buffer_load_dwordx4 v44, s[12:15], s46 offen lds
  v_add_u32 v47, 0x14000, v42
  ds_read_b64_tr_b16 a[152:153], v47 offset:0
  ds_read_b64_tr_b16 a[154:155], v47 offset:1024
  ds_read_b64_tr_b16 a[156:157], v47 offset:8192
  ds_read_b64_tr_b16 a[158:159], v47 offset:9216
  v_add_u32 v47, 0x14000, v46
  ds_read_b64_tr_b16 a[216:217], v47 offset:0
  ds_read_b64_tr_b16 a[218:219], v47 offset:1024
  ds_read_b64_tr_b16 a[220:221], v47 offset:8192
  ds_read_b64_tr_b16 a[222:223], v47 offset:9216
  s_waitcnt lgkmcnt(0)
  s_waitcnt vmcnt(24)
  s_barrier
  s_mov_b32 s12, s30
  s_and_b32 s13, s31, 0xffff
  s_mov_b32 s14, 0x400000
  s_mov_b32 s15, 0x20000
  s_lshl_b32 s47, s16, 14
  s_add_u32 s45, s50, 81920
  s_mov_b32 m0, s45
  s_add_u32 s46, s47, 65792
  buffer_load_dwordx4 v43, s[12:15], s46 offen lds
  s_add_u32 s45, s50, 82944
  s_mov_b32 m0, s45
  s_add_u32 s46, s47, 69888
  buffer_load_dwordx4 v43, s[12:15], s46 offen lds
  s_add_u32 s45, s50, 83968
  s_mov_b32 m0, s45
  s_add_u32 s46, s47, 73984
  buffer_load_dwordx4 v44, s[12:15], s46 offen lds
  s_add_u32 s45, s50, 84992
  s_mov_b32 m0, s45
  s_add_u32 s46, s47, 78080
  buffer_load_dwordx4 v44, s[12:15], s46 offen lds
  v_add_u32 v47, 0x18000, v42
  ds_read_b64_tr_b16 a[160:161], v47 offset:0
  ds_read_b64_tr_b16 a[162:163], v47 offset:1024
  ds_read_b64_tr_b16 a[164:165], v47 offset:8192
  ds_read_b64_tr_b16 a[166:167], v47 offset:9216
  v_add_u32 v47, 0x18000, v46
  ds_read_b64_tr_b16 a[224:225], v47 offset:0
  ds_read_b64_tr_b16 a[226:227], v47 offset:1024
  ds_read_b64_tr_b16 a[228:229], v47 offset:8192
  ds_read_b64_tr_b16 a[230:231], v47 offset:9216
  s_waitcnt lgkmcnt(0)
  s_waitcnt vmcnt(24)
  s_barrier
  s_mov_b32 s12, s30
  s_and_b32 s13, s31, 0xffff
  s_mov_b32 s14, 0x400000
  s_mov_b32 s15, 0x20000
  s_lshl_b32 s47, s16, 14
  s_add_u32 s45, s50, 98304
  s_mov_b32 m0, s45
  s_add_u32 s46, s47, 512
  buffer_load_dwordx4 v43, s[12:15], s46 offen lds
  s_add_u32 s45, s50, 99328
  s_mov_b32 m0, s45
  s_add_u32 s46, s47, 4608
  buffer_load_dwordx4 v43, s[12:15], s46 offen lds
  s_add_u32 s45, s50, 100352
  s_mov_b32 m0, s45
  s_add_u32 s46, s47, 8704
  buffer_load_dwordx4 v44, s[12:15], s46 offen lds
  s_add_u32 s45, s50, 101376
  s_mov_b32 m0, s45
  s_add_u32 s46, s47, 12800
  buffer_load_dwordx4 v44, s[12:15], s46 offen lds
  v_add_u32 v47, 0x1c000, v42
  ds_read_b64_tr_b16 a[168:169], v47 offset:0
  ds_read_b64_tr_b16 a[170:171], v47 offset:1024
  ds_read_b64_tr_b16 a[172:173], v47 offset:8192
  ds_read_b64_tr_b16 a[174:175], v47 offset:9216
  v_add_u32 v47, 0x1c000, v46
  ds_read_b64_tr_b16 a[232:233], v47 offset:0
  ds_read_b64_tr_b16 a[234:235], v47 offset:1024
  ds_read_b64_tr_b16 a[236:237], v47 offset:8192
  ds_read_b64_tr_b16 a[238:239], v47 offset:9216
  s_waitcnt lgkmcnt(0)
  s_waitcnt vmcnt(24)
  s_barrier
  s_mov_b32 s12, s30
  s_and_b32 s13, s31, 0xffff
  s_mov_b32 s14, 0x400000
  s_mov_b32 s15, 0x20000
  s_lshl_b32 s47, s16, 14
  s_add_u32 s45, s50, 114688
  s_mov_b32 m0, s45
  s_add_u32 s46, s47, 66048
  buffer_load_dwordx4 v43, s[12:15], s46 offen lds
  s_add_u32 s45, s50, 115712
  s_mov_b32 m0, s45
  s_add_u32 s46, s47, 70144
  buffer_load_dwordx4 v43, s[12:15], s46 offen lds
  s_add_u32 s45, s50, 116736
  s_mov_b32 m0, s45
  s_add_u32 s46, s47, 74240
  buffer_load_dwordx4 v44, s[12:15], s46 offen lds
  s_add_u32 s45, s50, 117760
  s_mov_b32 m0, s45
  s_add_u32 s46, s47, 78336
  buffer_load_dwordx4 v44, s[12:15], s46 offen lds
  v_add_u32 v47, 0x20000, v42
  ds_read_b64_tr_b16 a[176:177], v47 offset:0
  ds_read_b64_tr_b16 a[178:179], v47 offset:1024
  ds_read_b64_tr_b16 a[180:181], v47 offset:8192
  ds_read_b64_tr_b16 a[182:183], v47 offset:9216
  v_add_u32 v47, 0x20000, v46
  ds_read_b64_tr_b16 a[240:241], v47 offset:0
  ds_read_b64_tr_b16 a[242:243], v47 offset:1024
  ds_read_b64_tr_b16 a[244:245], v47 offset:8192
  ds_read_b64_tr_b16 a[246:247], v47 offset:9216
  s_waitcnt lgkmcnt(0)
  s_waitcnt vmcnt(24)
  s_barrier
  s_mov_b32 s12, s30
  s_and_b32 s13, s31, 0xffff
  s_mov_b32 s14, 0x400000
  s_mov_b32 s15, 0x20000
  s_lshl_b32 s47, s16, 14
  s_add_u32 s45, s50, 131072
  s_mov_b32 m0, s45
  s_add_u32 s46, s47, 768
  buffer_load_dwordx4 v43, s[12:15], s46 offen lds
  s_add_u32 s45, s50, 132096
  s_mov_b32 m0, s45
  s_add_u32 s46, s47, 4864
  buffer_load_dwordx4 v43, s[12:15], s46 offen lds
  s_add_u32 s45, s50, 133120
  s_mov_b32 m0, s45
  s_add_u32 s46, s47, 8960
  buffer_load_dwordx4 v44, s[12:15], s46 offen lds
  s_add_u32 s45, s50, 134144
  s_mov_b32 m0, s45
  s_add_u32 s46, s47, 13056
  buffer_load_dwordx4 v44, s[12:15], s46 offen lds
  v_add_u32 v47, 0x24000, v42
  ds_read_b64_tr_b16 a[184:185], v47 offset:0
  ds_read_b64_tr_b16 a[186:187], v47 offset:1024
  ds_read_b64_tr_b16 a[188:189], v47 offset:8192
  ds_read_b64_tr_b16 a[190:191], v47 offset:9216
  v_add_u32 v47, 0x24000, v46
  ds_read_b64_tr_b16 a[248:249], v47 offset:0
  ds_read_b64_tr_b16 a[250:251], v47 offset:1024
  ds_read_b64_tr_b16 a[252:253], v47 offset:8192
  ds_read_b64_tr_b16 a[254:255], v47 offset:9216
  s_waitcnt lgkmcnt(0)
  s_barrier
  s_mov_b32 s12, s30
  s_and_b32 s13, s31, 0xffff
  s_mov_b32 s14, 0x400000
  s_mov_b32 s15, 0x20000
  s_lshl_b32 s47, s16, 14
  s_add_u32 s45, s50, 147456
  s_mov_b32 m0, s45
  s_add_u32 s46, s47, 66304
  buffer_load_dwordx4 v43, s[12:15], s46 offen lds
  s_add_u32 s45, s50, 148480
  s_mov_b32 m0, s45
  s_add_u32 s46, s47, 70400
  buffer_load_dwordx4 v43, s[12:15], s46 offen lds
  s_add_u32 s45, s50, 149504
  s_mov_b32 m0, s45
  s_add_u32 s46, s47, 74496
  buffer_load_dwordx4 v44, s[12:15], s46 offen lds
  s_add_u32 s45, s50, 150528
  s_mov_b32 m0, s45
  s_add_u32 s46, s47, 78592
  buffer_load_dwordx4 v44, s[12:15], s46 offen lds
  s_waitcnt vmcnt(0)
  s_barrier
  v_xor_b32 v124, 0, v45
  ds_read_b64_tr_b16 v[48:49], v124 offset:0
  ds_read_b64_tr_b16 v[50:51], v124 offset:1024
  ds_read_b64_tr_b16 v[52:53], v124 offset:8192
  ds_read_b64_tr_b16 v[54:55], v124 offset:9216
  v_xor_b32 v124, 32, v45
  ds_read_b64_tr_b16 v[56:57], v124 offset:0
  ds_read_b64_tr_b16 v[58:59], v124 offset:1024
  ds_read_b64_tr_b16 v[60:61], v124 offset:8192
  ds_read_b64_tr_b16 v[62:63], v124 offset:9216
  v_xor_b32 v124, 64, v45
  ds_read_b64_tr_b16 v[64:65], v124 offset:0
  ds_read_b64_tr_b16 v[66:67], v124 offset:1024
  ds_read_b64_tr_b16 v[68:69], v124 offset:8192
  ds_read_b64_tr_b16 v[70:71], v124 offset:9216
  v_xor_b32 v124, 96, v45
  ds_read_b64_tr_b16 v[72:73], v124 offset:0
  ds_read_b64_tr_b16 v[74:75], v124 offset:1024
  ds_read_b64_tr_b16 v[76:77], v124 offset:8192
  ds_read_b64_tr_b16 v[78:79], v124 offset:9216
  v_xor_b32 v124, 128, v45
  ds_read_b64_tr_b16 v[80:81], v124 offset:0
  ds_read_b64_tr_b16 v[82:83], v124 offset:1024
  ds_read_b64_tr_b16 v[84:85], v124 offset:8192
  ds_read_b64_tr_b16 v[86:87], v124 offset:9216
  v_xor_b32 v124, 160, v45
  ds_read_b64_tr_b16 v[88:89], v124 offset:0
  ds_read_b64_tr_b16 v[90:91], v124 offset:1024
  ds_read_b64_tr_b16 v[92:93], v124 offset:8192
  ds_read_b64_tr_b16 v[94:95], v124 offset:9216
  v_xor_b32 v124, 192, v45
  ds_read_b64_tr_b16 v[96:97], v124 offset:0
  ds_read_b64_tr_b16 v[98:99], v124 offset:1024
  ds_read_b64_tr_b16 v[100:101], v124 offset:8192
  ds_read_b64_tr_b16 v[102:103], v124 offset:9216
  v_xor_b32 v124, 224, v45
  ds_read_b64_tr_b16 v[104:105], v124 offset:0
  ds_read_b64_tr_b16 v[106:107], v124 offset:1024
  ds_read_b64_tr_b16 v[108:109], v124 offset:8192
  ds_read_b64_tr_b16 v[110:111], v124 offset:9216
  s_waitcnt lgkmcnt(0)
  ds_write_b128 v11, v[48:51] offset:0
  ds_write_b128 v11, v[52:55] offset:1024
  ds_write_b128 v11, v[56:59] offset:2048
  ds_write_b128 v11, v[60:63] offset:3072
  ds_write_b128 v11, v[64:67] offset:4096
  ds_write_b128 v11, v[68:71] offset:5120
  ds_write_b128 v11, v[72:75] offset:6144
  ds_write_b128 v11, v[76:79] offset:7168
  ds_write_b128 v11, v[80:83] offset:8192
  ds_write_b128 v11, v[84:87] offset:9216
  ds_write_b128 v11, v[88:91] offset:10240
  ds_write_b128 v11, v[92:95] offset:11264
  ds_write_b128 v11, v[96:99] offset:12288
  ds_write_b128 v11, v[100:103] offset:13312
  ds_write_b128 v11, v[104:107] offset:14336
  ds_write_b128 v11, v[108:111] offset:15360
  s_waitcnt lgkmcnt(0)
  v_xor_b32 v124, 0, v45
  ds_read_b64_tr_b16 v[48:49], v124 offset:16384
  ds_read_b64_tr_b16 v[50:51], v124 offset:17408
  ds_read_b64_tr_b16 v[52:53], v124 offset:24576
  ds_read_b64_tr_b16 v[54:55], v124 offset:25600
  v_xor_b32 v124, 32, v45
  ds_read_b64_tr_b16 v[56:57], v124 offset:16384
  ds_read_b64_tr_b16 v[58:59], v124 offset:17408
  ds_read_b64_tr_b16 v[60:61], v124 offset:24576
  ds_read_b64_tr_b16 v[62:63], v124 offset:25600
  v_xor_b32 v124, 64, v45
  ds_read_b64_tr_b16 v[64:65], v124 offset:16384
  ds_read_b64_tr_b16 v[66:67], v124 offset:17408
  ds_read_b64_tr_b16 v[68:69], v124 offset:24576
  ds_read_b64_tr_b16 v[70:71], v124 offset:25600
  v_xor_b32 v124, 96, v45
  ds_read_b64_tr_b16 v[72:73], v124 offset:16384
  ds_read_b64_tr_b16 v[74:75], v124 offset:17408
  ds_read_b64_tr_b16 v[76:77], v124 offset:24576
  ds_read_b64_tr_b16 v[78:79], v124 offset:25600
  v_xor_b32 v124, 128, v45
  ds_read_b64_tr_b16 v[80:81], v124 offset:16384
  ds_read_b64_tr_b16 v[82:83], v124 offset:17408
  ds_read_b64_tr_b16 v[84:85], v124 offset:24576
  ds_read_b64_tr_b16 v[86:87], v124 offset:25600
  v_xor_b32 v124, 160, v45
  ds_read_b64_tr_b16 v[88:89], v124 offset:16384
  ds_read_b64_tr_b16 v[90:91], v124 offset:17408
  ds_read_b64_tr_b16 v[92:93], v124 offset:24576
  ds_read_b64_tr_b16 v[94:95], v124 offset:25600
  v_xor_b32 v124, 192, v45
  ds_read_b64_tr_b16 v[96:97], v124 offset:16384
  ds_read_b64_tr_b16 v[98:99], v124 offset:17408
  ds_read_b64_tr_b16 v[100:101], v124 offset:24576
  ds_read_b64_tr_b16 v[102:103], v124 offset:25600
  v_xor_b32 v124, 224, v45
  ds_read_b64_tr_b16 v[104:105], v124 offset:16384
  ds_read_b64_tr_b16 v[106:107], v124 offset:17408
  ds_read_b64_tr_b16 v[108:109], v124 offset:24576
  ds_read_b64_tr_b16 v[110:111], v124 offset:25600
  s_waitcnt lgkmcnt(0)
  ds_write_b128 v11, v[48:51] offset:16384
  ds_write_b128 v11, v[52:55] offset:17408
  ds_write_b128 v11, v[56:59] offset:18432
  ds_write_b128 v11, v[60:63] offset:19456
  ds_write_b128 v11, v[64:67] offset:20480
  ds_write_b128 v11, v[68:71] offset:21504
  ds_write_b128 v11, v[72:75] offset:22528
  ds_write_b128 v11, v[76:79] offset:23552
  ds_write_b128 v11, v[80:83] offset:24576
  ds_write_b128 v11, v[84:87] offset:25600
  ds_write_b128 v11, v[88:91] offset:26624
  ds_write_b128 v11, v[92:95] offset:27648
  ds_write_b128 v11, v[96:99] offset:28672
  ds_write_b128 v11, v[100:103] offset:29696
  ds_write_b128 v11, v[104:107] offset:30720
  ds_write_b128 v11, v[108:111] offset:31744
  s_waitcnt lgkmcnt(0)
  s_cmp_eq_u32 s99, 1
  s_cbranch_scc1 L_gs_done_10
  s_cmp_eq_u32 s16, 0
  s_cbranch_scc0 L_gs_w_11
  v_mov_b32 v100, 32
L_gs_p_12:
  s_mov_b64 exec, 1
  global_load_dword v101, v100, s[40:41] sc1
  s_mov_b64 exec, -1
  s_waitcnt vmcnt(0)
  v_readfirstlane_b32 s45, v101
  s_sub_u32 s64, s64, 1
  s_cbranch_scc1 L_abort
  s_cmp_ge_u32 s45, 256
  s_cbranch_scc1 L_gs_q_13
  s_sleep 4
  s_branch L_gs_p_12
L_gs_q_13:
  v_and_b32 v102, 63, v0
  v_lshlrev_b32 v102, 2, v102
  s_mov_b64 exec, 0xff
  global_load_dword v101, v102, s[40:41] sc1
  s_waitcnt vmcnt(0)
  ds_write_b32 v102, v101
  s_mov_b64 exec, -1
  s_waitcnt lgkmcnt(0)
L_gs_w_11:
  s_barrier
  v_mov_b32 v100, 0
  ds_read_b128 v[104:107], v100
  ds_read_b128 v[108:111], v100 offset:16
  s_waitcnt lgkmcnt(0)
  s_mov_b32 s44, 1
  s_mov_b32 s46, 0
  v_readfirstlane_b32 s45, v104
  s_cmp_eq_u32 s45, 32
  s_cselect_b32 s44, s44, 0
  s_cmp_gt_u32 s18, 0
  s_cselect_b32 s45, s45, 0
  s_add_u32 s46, s46, s45
  v_readfirstlane_b32 s45, v105
  s_cmp_eq_u32 s45, 32
  s_cselect_b32 s44, s44, 0
  s_cmp_gt_u32 s18, 1
  s_cselect_b32 s45, s45, 0
  s_add_u32 s46, s46, s45
  v_readfirstlane_b32 s45, v106
  s_cmp_eq_u32 s45, 32
  s_cselect_b32 s44, s44, 0
  s_cmp_gt_u32 s18, 2
  s_cselect_b32 s45, s45, 0
  s_add_u32 s46, s46, s45
  v_readfirstlane_b32 s45, v107
  s_cmp_eq_u32 s45, 32
  s_cselect_b32 s44, s44, 0
  s_cmp_gt_u32 s18, 3
  s_cselect_b32 s45, s45, 0
  s_add_u32 s46, s46, s45
  v_readfirstlane_b32 s45, v108
  s_cmp_eq_u32 s45, 32
  s_cselect_b32 s44, s44, 0
  s_cmp_gt_u32 s18, 4
  s_cselect_b32 s45, s45, 0
  s_add_u32 s46, s46, s45
  v_readfirstlane_b32 s45, v109
  s_cmp_eq_u32 s45, 32
  s_cselect_b32 s44, s44, 0
  s_cmp_gt_u32 s18, 5
  s_cselect_b32 s45, s45, 0
  s_add_u32 s46, s46, s45
  v_readfirstlane_b32 s45, v110
  s_cmp_eq_u32 s45, 32
  s_cselect_b32 s44, s44, 0
  s_cmp_gt_u32 s18, 6
  s_cselect_b32 s45, s45, 0
  s_add_u32 s46, s46, s45
  v_readfirstlane_b32 s45, v111
  s_cmp_eq_u32 s45, 32
  s_cselect_b32 s44, s44, 0
  s_cmp_gt_u32 s18, 7
  s_cselect_b32 s45, s45, 0
  s_add_u32 s46, s46, s45
  s_barrier
  s_mov_b32 s99, 1
  s_cmp_eq_u32 s44, 1
  s_cbranch_scc1 L_gs_done_10
  s_add_u32 s17, s46, s98
  s_branch L_dispatch
L_gs_done_10:
  s_barrier
  s_cmp_eq_u32 s19, 0
  s_cbranch_scc0 L_w0_14
  s_cmp_eq_u32 s16, 0
  s_cbranch_scc0 L_w0_14
  s_lshl_b32 s45, s17, 2
  s_add_u32 s45, s45, 0x12e000
  v_mov_b32 v124, s45
  v_mov_b32 v125, 1
  s_mov_b64 exec, 1
  buffer_store_dword v125, v124, s[4:7], 0 offen sc1
  s_mov_b64 exec, -1
L_w0_14:
  s_mov_b32 s8, s22
  s_and_b32 s9, s23, 0xffff
  s_mov_b32 s10, 0x2000
  s_mov_b32 s11, 0x20000
  v_lshlrev_b32 v124, 2, v0
  s_mov_b32 s45, 0
  buffer_load_dword v48, v124, s[8:11], s45 offen
  s_mov_b32 s45, 1024
  buffer_load_dword v49, v124, s[8:11], s45 offen
  s_mov_b32 s45, 2048
  buffer_load_dword v50, v124, s[8:11], s45 offen
  s_mov_b32 s45, 3072
  buffer_load_dword v51, v124, s[8:11], s45 offen
  s_mov_b32 s45, 4096
  buffer_load_dword v52, v124, s[8:11], s45 offen
  s_mov_b32 s45, 5120
  buffer_load_dword v53, v124, s[8:11], s45 offen
  s_mov_b32 s45, 6144
  buffer_load_dword v54, v124, s[8:11], s45 offen
  s_mov_b32 s45, 7168
  buffer_load_dword v55, v124, s[8:11], s45 offen
  s_mov_b32 s45, 0x05040100
  s_mov_b32 s46, 0x07060302
  v_lshlrev_b32 v125, 5, v0
  v_bfe_u32 v126, v0, 3, 1
  v_lshlrev_b32 v126, 7, v126
  v_xor_b32 v125, v125, v126
  v_mov_b32 v64, 0
  v_mov_b32 v65, 0
  v_mov_b32 v66, 0
  v_mov_b32 v67, 0
  v_lshlrev_b32 v127, 4, v0
  ds_write_b128 v127, v[64:67] offset:28672
  s_waitcnt vmcnt(0)
  v_perm_b32 v56, v49, v48, s45
  v_perm_b32 v57, v49, v48, s46
  v_perm_b32 v58, v51, v50, s45
  v_perm_b32 v59, v51, v50, s46
  v_perm_b32 v60, v53, v52, s45
  v_perm_b32 v61, v53, v52, s46
  v_perm_b32 v62, v55, v54, s45
  v_perm_b32 v63, v55, v54, s46
  ds_write_b128 v125, v[56:59]
  ds_write_b128 v125, v[60:63] offset:16
  buffer_load_dwordx4 v[48:51], v35, s[4:7], s74 offen sc1
  buffer_load_dwordx4 v[52:55], v35, s[4:7], s57 offen sc1
  s_lshl_b32 s45, s16, 11
  s_add_u32 s45, s45, s75
  s_add_u32 s46, s45, 0
  buffer_load_dwordx4 v[56:59], v8, s[4:7], s46 offen sc1
  buffer_load_dwordx4 v[60:63], v8, s[4:7], s46 offen offset:1024 sc1
  s_add_u32 s46, s45, 8192
  buffer_load_dwordx4 v[56:59], v8, s[4:7], s46 offen sc1
  buffer_load_dwordx4 v[60:63], v8, s[4:7], s46 offen offset:1024 sc1
  s_add_u32 s46, s45, 16384
  buffer_load_dwordx4 v[56:59], v8, s[4:7], s46 offen sc1
  buffer_load_dwordx4 v[60:63], v8, s[4:7], s46 offen offset:1024 sc1
  s_add_u32 s46, s45, 24576
  buffer_load_dwordx4 v[56:59], v8, s[4:7], s46 offen sc1
  buffer_load_dwordx4 v[60:63], v8, s[4:7], s46 offen offset:1024 sc1
  s_mov_b32 s65, 0
L_fl_15:
  v_mov_b32 v124, s80
  s_mov_b64 exec, 1
  buffer_load_dword v125, v124, s[4:7], 0 offen sc1
  s_mov_b64 exec, -1
  s_waitcnt vmcnt(0)
  v_readfirstlane_b32 s85, v125
  s_sub_u32 s64, s64, 1
  s_cbranch_scc1 L_abort
  s_cmp_ge_u32 s85, 4
  s_cbranch_scc1 L_fld_16
  s_sleep 4
  s_branch L_fl_15
L_fld_16:
  buffer_load_dwordx4 v[18:21], v15, s[4:7], s78 offen sc1
  buffer_load_dwordx4 v[22:25], v15, s[4:7], s78 offen offset:1024 sc1
  s_add_u32 s49, s78, 8192
  buffer_load_dwordx4 v[26:29], v15, s[4:7], s49 offen sc1
  buffer_load_dwordx4 v[30:33], v15, s[4:7], s49 offen offset:1024 sc1
  s_waitcnt vmcnt(0)
  ds_write_b128 v15, v[18:21] offset:8192
  ds_write_b128 v15, v[22:25] offset:9216
  ds_write_b128 v15, v[26:29] offset:16384
  ds_write_b128 v15, v[30:33] offset:17408
  s_add_u32 s78, s78, 16384
  s_add_u32 s80, s80, 4096
  v_mov_b32 v124, s80
  s_mov_b64 exec, 1
  buffer_load_dword v125, v124, s[4:7], 0 offen sc1
  s_mov_b64 exec, -1
  s_waitcnt vmcnt(0)
  v_readfirstlane_b32 s85, v125
  v_mov_b64 v[68:69], 0
  v_mov_b64 v[70:71], 0
  v_mov_b64 v[72:73], 0
  v_mov_b64 v[74:75], 0
  v_mov_b64 v[76:77], 0
  v_mov_b64 v[78:79], 0
  v_mov_b64 v[80:81], 0
  v_mov_b64 v[82:83], 0
  v_mov_b64 v[84:85], 0
  v_mov_b64 v[86:87], 0
  v_mov_b64 v[88:89], 0
  v_mov_b64 v[90:91], 0
  v_xor_b32 v1, 128, v3
  s_waitcnt lgkmcnt(0)
  s_barrier
L_step_f:
  ds_read_b64_tr_b16 v[36:37], v3 offset:0
  ds_read_b64_tr_b16 v[38:39], v1 offset:0
  ds_read_b64_tr_b16 v[40:41], v3 offset:1024
  ds_read_b64_tr_b16 v[42:43], v1 offset:1024
  ds_read_b64_tr_b16 v[44:45], v3 offset:2048
  ds_read_b64_tr_b16 v[46:47], v1 offset:2048
  buffer_store_dwordx4 v[92:95], v16, s[4:7], s86 offen sc1
  s_cmp_ge_u32 s85, 4
  s_cbranch_scc0 L_kvnotready_f
L_kvready_f:
  s_add_u32 s49, s78, 8192
  buffer_load_dwordx4 v[18:21], v15, s[4:7], s78 offen sc1
  s_waitcnt lgkmcnt(4)
  v_smfmac_f32_16x16x64_bf16 v[68:71], v[36:39], v[128:135], v2
  ds_read_b64_tr_b16 v[48:49], v3 offset:3072
  v_smfmac_f32_16x16x64_bf16 v[72:75], v[36:39], v[192:199], v2
  ds_read_b64_tr_b16 v[50:51], v1 offset:3072
  s_waitcnt lgkmcnt(4)
  v_smfmac_f32_16x16x64_bf16 v[68:71], v[40:43], v[136:143], v2
  ds_read_b64_tr_b16 v[52:53], v3 offset:4096
  v_smfmac_f32_16x16x64_bf16 v[72:75], v[40:43], v[200:207], v2
  ds_read_b64_tr_b16 v[54:55], v1 offset:4096
  buffer_load_dwordx4 v[22:25], v15, s[4:7], s78 offen offset:1024 sc1
  s_waitcnt lgkmcnt(4)
  v_smfmac_f32_16x16x64_bf16 v[68:71], v[44:47], v[144:151], v2
  ds_read_b64_tr_b16 v[56:57], v3 offset:5120
  v_smfmac_f32_16x16x64_bf16 v[72:75], v[44:47], v[208:215], v2
  ds_read_b64_tr_b16 v[58:59], v1 offset:5120
  s_waitcnt lgkmcnt(4)
  v_smfmac_f32_16x16x64_bf16 v[68:71], v[48:51], v[152:159], v2
  ds_read_b64_tr_b16 v[60:61], v3 offset:6144
  v_smfmac_f32_16x16x64_bf16 v[72:75], v[48:51], v[216:223], v2
  ds_read_b64_tr_b16 v[62:63], v1 offset:6144
  buffer_load_dwordx4 v[26:29], v15, s[4:7], s49 offen sc1
  s_waitcnt lgkmcnt(4)
  v_smfmac_f32_16x16x64_bf16 v[68:71], v[52:55], v[160:167], v2
  ds_read_b64_tr_b16 v[64:65], v3 offset:7168
  v_smfmac_f32_16x16x64_bf16 v[72:75], v[52:55], v[224:231], v2
  ds_read_b64_tr_b16 v[66:67], v1 offset:7168
  s_waitcnt lgkmcnt(4)
  v_smfmac_f32_16x16x64_bf16 v[68:71], v[56:59], v[168:175], v2
  v_smfmac_f32_16x16x64_bf16 v[72:75], v[56:59], v[232:239], v2
  buffer_load_dwordx4 v[30:33], v15, s[4:7], s49 offen offset:1024 sc1
  s_waitcnt lgkmcnt(2)
  v_smfmac_f32_16x16x64_bf16 v[68:71], v[60:63], v[176:183], v2
  v_smfmac_f32_16x16x64_bf16 v[72:75], v[60:63], v[240:247], v2
  s_waitcnt lgkmcnt(0)
  v_smfmac_f32_16x16x64_bf16 v[68:71], v[64:67], v[184:191], v2
  v_smfmac_f32_16x16x64_bf16 v[72:75], v[64:67], v[248:255], v2
  v_smfmac_f32_16x16x64_bf16 v[76:79], v[36:39], a[0:7], v2
  s_add_u32 s80, s80, 4096
  v_mov_b32 v127, s80
  v_smfmac_f32_16x16x64_bf16 v[80:83], v[36:39], a[64:71], v2
  v_mov_b32 v124, s58
  v_mov_b32 v125, 4
  v_smfmac_f32_16x16x64_bf16 v[76:79], v[40:43], a[8:15], v2
  s_mov_b64 exec, 1
  buffer_load_dword v34, v127, s[4:7], 0 offen sc1
  v_smfmac_f32_16x16x64_bf16 v[80:83], v[40:43], a[72:79], v2
  v_smfmac_f32_16x16x64_bf16 v[76:79], v[44:47], a[16:23], v2
  s_mov_b64 exec, s[54:55]
  buffer_store_dword v125, v124, s[4:7], 0 offen sc1
  v_smfmac_f32_16x16x64_bf16 v[80:83], v[44:47], a[80:87], v2
  s_mov_b64 exec, -1
  v_smfmac_f32_16x16x64_bf16 v[76:79], v[48:51], a[24:31], v2
  v_smfmac_f32_16x16x64_bf16 v[80:83], v[48:51], a[88:95], v2
  v_add_f32 v68, v68, v70
  v_add_f32 v69, v69, v71
  v_smfmac_f32_16x16x64_bf16 v[76:79], v[52:55], a[32:39], v2
  v_cvt_pk_bf16_f32 v70, v68, v69
  ds_write_b32 v4, v70 offset:24576
  v_smfmac_f32_16x16x64_bf16 v[80:83], v[52:55], a[96:103], v2
  v_add_f32 v72, v72, v74
  v_add_f32 v73, v73, v75
  v_smfmac_f32_16x16x64_bf16 v[76:79], v[56:59], a[40:47], v2
  v_cvt_pk_bf16_f32 v74, v72, v73
  ds_write_b32 v4, v74 offset:24832
  v_smfmac_f32_16x16x64_bf16 v[80:83], v[56:59], a[104:111], v2
  v_smfmac_f32_16x16x64_bf16 v[76:79], v[60:63], a[48:55], v2
  v_smfmac_f32_16x16x64_bf16 v[80:83], v[60:63], a[112:119], v2
  v_smfmac_f32_16x16x64_bf16 v[76:79], v[64:67], a[56:63], v2
  v_smfmac_f32_16x16x64_bf16 v[80:83], v[64:67], a[120:127], v2
  v_smfmac_f32_16x16x64_bf16 v[84:87], v[36:39], a[128:135], v2
  ds_read_b128 v[108:111], v8 offset:8192
  ds_read_b128 v[112:115], v8 offset:12288
  v_smfmac_f32_16x16x64_bf16 v[88:91], v[36:39], a[192:199], v2
  ds_read_b128 v[116:119], v8 offset:9216
  ds_read_b128 v[120:123], v8 offset:13312
  s_nop 1
  v_add_f32 v76, v76, v78
  v_add_f32 v77, v77, v79
  v_cvt_pk_bf16_f32 v78, v76, v77
  ds_write_b32 v6, v78 offset:28672
  v_add_f32 v80, v80, v82
  v_add_f32 v81, v81, v83
  v_cvt_pk_bf16_f32 v82, v80, v81
  ds_write_b32 v6, v82 offset:29184
  v_smfmac_f32_16x16x64_bf16 v[84:87], v[40:43], a[136:143], v2
  v_smfmac_f32_16x16x64_bf16 v[88:91], v[40:43], a[200:207], v2
  v_smfmac_f32_16x16x64_bf16 v[84:87], v[44:47], a[144:151], v2
  v_smfmac_f32_16x16x64_bf16 v[88:91], v[44:47], a[208:215], v2
  s_waitcnt lgkmcnt(0)
  s_barrier
  v_smfmac_f32_16x16x64_bf16 v[84:87], v[48:51], a[152:159], v2
  ds_read_b64_tr_b16 v[92:93], v5 offset:24576
  ds_read_b64_tr_b16 v[94:95], v5 offset:24832
  v_smfmac_f32_16x16x64_bf16 v[88:91], v[48:51], a[216:223], v2
  ds_read_b64_tr_b16 v[96:97], v5 offset:25088
  ds_read_b64_tr_b16 v[98:99], v5 offset:25344
  v_smfmac_f32_16x16x64_bf16 v[84:87], v[52:55], a[160:167], v2
  ds_read_b64_tr_b16 v[100:101], v5 offset:25600
  ds_read_b64_tr_b16 v[102:103], v5 offset:25856
  v_smfmac_f32_16x16x64_bf16 v[88:91], v[52:55], a[224:231], v2
  ds_read_b64_tr_b16 v[104:105], v5 offset:26112
  ds_read_b64_tr_b16 v[106:107], v5 offset:26368
  v_smfmac_f32_16x16x64_bf16 v[84:87], v[56:59], a[168:175], v2
  ds_read_b64_tr_b16 v[68:69], v7 offset:28672
  ds_read_b64_tr_b16 v[70:71], v7 offset:29184
  v_smfmac_f32_16x16x64_bf16 v[88:91], v[56:59], a[232:239], v2
  ds_read_b64_tr_b16 v[72:73], v7 offset:29696
  ds_read_b64_tr_b16 v[74:75], v7 offset:30208
  v_smfmac_f32_16x16x64_bf16 v[84:87], v[60:63], a[176:183], v2
  ds_read_b64_tr_b16 v[76:77], v7 offset:30720
  ds_read_b64_tr_b16 v[78:79], v7 offset:31232
  v_smfmac_f32_16x16x64_bf16 v[88:91], v[60:63], a[240:247], v2
  ds_read_b64_tr_b16 v[80:81], v7 offset:31744
  ds_read_b64_tr_b16 v[82:83], v7 offset:32256
  ds_read_b128 v[36:39], v8 offset:10240
  ds_read_b128 v[40:43], v8 offset:14336
  v_smfmac_f32_16x16x64_bf16 v[84:87], v[64:67], a[184:191], v2
  ds_read_b128 v[44:47], v8 offset:11264
  ds_read_b128 v[48:51], v8 offset:15360
  v_smfmac_f32_16x16x64_bf16 v[88:91], v[64:67], a[248:255], v2
  s_waitcnt lgkmcnt(15)
  v_mfma_f32_16x16x32_bf16 v[52:55], v[108:111], v[92:95], 0
  v_mfma_f32_16x16x32_bf16 v[56:59], v[112:115], v[92:95], 0
  s_waitcnt lgkmcnt(15)
  v_mfma_f32_16x16x32_bf16 v[52:55], v[116:119], v[96:99], v[52:55]
  v_mfma_f32_16x16x32_bf16 v[56:59], v[120:123], v[96:99], v[56:59]
  s_waitcnt lgkmcnt(4)
  v_mfma_f32_16x16x32_bf16 v[60:63], v[68:71], v[92:95], 0
  ds_read_b128 v[108:111], v11 offset:2048
  v_mfma_f32_16x16x32_bf16 v[60:63], v[72:75], v[96:99], v[60:63]
  v_add_f32 v84, v84, v86
  v_add_f32 v85, v85, v87
  v_add_f32 v88, v88, v90
  ds_read_b128 v[112:115], v11 offset:3072
  v_mfma_f32_16x16x32_bf16 v[60:63], v[76:79], v[100:103], v[60:63]
  v_add_f32 v89, v89, v91
  v_cvt_pk_bf16_f32 v86, v84, v85
  v_cvt_pk_bf16_f32 v124, v88, v89
  ds_read_b128 v[116:119], v11 offset:18432
  v_mfma_f32_16x16x32_bf16 v[60:63], v[80:83], v[104:107], v[60:63]
  ds_write_b32 v6, v86 offset:28676
  ds_write_b32 v6, v124 offset:29188
  v_mov_b32 v125, 0
  ds_read_b128 v[120:123], v11 offset:19456
  s_waitcnt lgkmcnt(9)
  v_mfma_f32_16x16x32_bf16 v[52:55], v[36:39], v[100:103], v[52:55]
  v_mov_b32 v80, 0x3f803f80
  v_mov_b32 v81, 0x3f803f80
  s_waitcnt lgkmcnt(8)
  v_mfma_f32_16x16x32_bf16 v[56:59], v[40:43], v[100:103], v[56:59]
  v_mov_b32 v82, 0x3f803f80
  v_mov_b32 v83, 0x3f803f80
  s_waitcnt lgkmcnt(7)
  v_mfma_f32_16x16x32_bf16 v[52:55], v[44:47], v[104:107], v[52:55]
  s_waitcnt lgkmcnt(6)
  v_mfma_f32_16x16x32_bf16 v[56:59], v[48:51], v[104:107], v[56:59]
  ds_read_b128 v[92:95], v15 offset:16384
  ds_read_b128 v[96:99], v15 offset:17408
  v_mov_b32 v106, v86
  v_mov_b32 v105, 0
  v_mov_b32 v107, 0
  s_nop 2
  v_max3_f32 v126, v52, v53, v54
  v_max3_f32 v127, v55, v56, v57
  v_max3_f32 v126, v126, v58, v59
  v_max3_f32 v127, v127, v60, v61
  v_max_f32 v126, v126, v127
  v_mov_b32 v127, v126
  ds_read_b128 v[36:39], v11 offset:0
  ds_read_b128 v[40:43], v11 offset:1024
  v_permlane32_swap_b32 v126, v127
  v_max_f32 v126, v126, v127
  v_mov_b32 v127, v126
  ds_read_b128 v[44:47], v11 offset:16384
  ds_read_b128 v[48:51], v11 offset:17408
  v_permlane16_swap_b32 v126, v127
  v_max_f32 v126, v126, v127
  v_mul_f32 v126, s84, v126
  v_mov_b32 v127, s84
  v_pk_fma_f32 v[52:53], v[52:53], v[126:127], v[126:127] op_sel:[0,1,0] op_sel_hi:[1,1,0] neg_lo:[0,0,1] neg_hi:[0,0,1]
  v_pk_fma_f32 v[54:55], v[54:55], v[126:127], v[126:127] op_sel:[0,1,0] op_sel_hi:[1,1,0] neg_lo:[0,0,1] neg_hi:[0,0,1]
  v_pk_fma_f32 v[56:57], v[56:57], v[126:127], v[126:127] op_sel:[0,1,0] op_sel_hi:[1,1,0] neg_lo:[0,0,1] neg_hi:[0,0,1]
  v_pk_fma_f32 v[58:59], v[58:59], v[126:127], v[126:127] op_sel:[0,1,0] op_sel_hi:[1,1,0] neg_lo:[0,0,1] neg_hi:[0,0,1]
  v_pk_fma_f32 v[60:61], v[60:61], v[126:127], v[126:127] op_sel:[0,1,0] op_sel_hi:[1,1,0] neg_lo:[0,0,1] neg_hi:[0,0,1]
  v_exp_f32 v52, v52
  v_exp_f32 v53, v53
  v_exp_f32 v54, v54
  v_exp_f32 v55, v55
  v_exp_f32 v56, v56
  v_exp_f32 v57, v57
  v_exp_f32 v58, v58
  v_exp_f32 v59, v59
  v_exp_f32 v60, v60
  v_exp_f32 v61, v61
  v_cvt_pk_bf16_f32 v100, v52, v53
  v_cvt_pk_bf16_f32 v101, v54, v55
  v_cvt_pk_bf16_f32 v102, v56, v57
  v_cvt_pk_bf16_f32 v103, v58, v59
  v_cvt_pk_bf16_f32 v104, v60, v61
  s_waitcnt lgkmcnt(4)
  v_mfma_f32_16x16x32_bf16 v[76:79], v[80:83], v[100:103], 0
  ds_read_b128 v[52:55], v11 offset:4096
  ds_read_b128 v[56:59], v11 offset:5120
  v_mfma_f32_16x16x32_bf16 v[84:87], v[92:95], v[100:103], 0
  ds_read_b128 v[60:63], v11 offset:20480
  ds_read_b128 v[64:67], v11 offset:21504
  v_mfma_f32_16x16x16_bf16 v[76:79], v[80:81], v[104:105], v[76:79]
  v_mfma_f32_16x16x32_bf16 v[88:91], v[96:99], v[100:103], 0
  v_mfma_f32_16x16x16_bf16 v[84:87], v[106:107], v[104:105], v[84:87]
  v_mfma_f32_16x16x16_bf16 v[88:91], v[124:125], v[104:105], v[88:91]
  s_cmp_eq_u32 s65, 63
  s_cbranch_scc1 L_chain_fin_f
  s_and_b32 s82, s65, 1
  v_mov_b64 v[68:69], 0
  v_mov_b64 v[70:71], 0
  v_mov_b64 v[72:73], 0
  v_mov_b64 v[74:75], 0
  v_rcp_f32 v126, v76
  v_mov_b64 v[80:81], 0
  v_mov_b64 v[82:83], 0
  v_mov_b64 v[92:93], 0
  v_mov_b64 v[94:95], 0
  v_mov_b64 v[96:97], 0
  v_mov_b64 v[98:99], 0
  v_pk_mul_f32 v[84:85], v[84:85], v[126:127] op_sel_hi:[1,0]
  v_pk_mul_f32 v[86:87], v[86:87], v[126:127] op_sel_hi:[1,0]
  v_pk_mul_f32 v[88:89], v[88:89], v[126:127] op_sel_hi:[1,0]
  v_pk_mul_f32 v[90:91], v[90:91], v[126:127] op_sel_hi:[1,0]
  v_cvt_pk_bf16_f32 v100, v84, v85
  v_cvt_pk_bf16_f32 v101, v86, v87
  v_cvt_pk_bf16_f32 v102, v88, v89
  v_cvt_pk_bf16_f32 v103, v90, v91
  ds_write_b32 v9, v100 offset:24576
  ds_write_b32 v9, v101 offset:24592
  ds_write_b32 v9, v102 offset:24608
  ds_write_b32 v9, v103 offset:24624
  v_mov_b64 v[76:77], 0
  v_mov_b64 v[78:79], 0
  v_mov_b64 v[84:85], 0
  v_mov_b64 v[86:87], 0
  v_mov_b64 v[88:89], 0
  v_mov_b64 v[90:91], 0
  s_waitcnt lgkmcnt(0)
  s_barrier
  ds_read_b128 v[100:103], v10 offset:24576
  ds_read_b128 v[104:107], v10 offset:24704
  s_waitcnt lgkmcnt(1)
  v_smfmac_f32_16x16x64_bf16 v[68:71], v[100:103], v[36:43], v2
  ds_read_b128 v[36:39], v11 offset:6144
  ds_read_b128 v[40:43], v11 offset:7168
  s_waitcnt lgkmcnt(2)
  v_smfmac_f32_16x16x64_bf16 v[68:71], v[104:107], v[44:51], v2
  ds_read_b128 v[44:47], v11 offset:22528
  ds_read_b128 v[48:51], v11 offset:23552
  v_smfmac_f32_16x16x64_bf16 v[72:75], v[100:103], v[108:115], v2
  ds_read_b128 v[108:111], v11 offset:8192
  ds_read_b128 v[112:115], v11 offset:9216
  v_smfmac_f32_16x16x64_bf16 v[72:75], v[104:107], v[116:123], v2
  ds_read_b128 v[116:119], v11 offset:24576
  ds_read_b128 v[120:123], v11 offset:25600
  v_smfmac_f32_16x16x64_bf16 v[76:79], v[100:103], v[52:59], v2
  ds_read_b128 v[52:55], v11 offset:10240
  ds_read_b128 v[56:59], v11 offset:11264
  v_smfmac_f32_16x16x64_bf16 v[76:79], v[104:107], v[60:67], v2
  ds_read_b128 v[60:63], v11 offset:26624
  ds_read_b128 v[64:67], v11 offset:27648
  s_waitcnt lgkmcnt(10)
  v_smfmac_f32_16x16x64_bf16 v[80:83], v[100:103], v[36:43], v2
  ds_read_b128 v[36:39], v11 offset:12288
  ds_read_b128 v[40:43], v11 offset:13312
  s_waitcnt lgkmcnt(10)
  v_smfmac_f32_16x16x64_bf16 v[80:83], v[104:107], v[44:51], v2
  ds_read_b128 v[44:47], v11 offset:28672
  ds_read_b128 v[48:51], v11 offset:29696
  s_waitcnt lgkmcnt(10)
  v_smfmac_f32_16x16x64_bf16 v[84:87], v[100:103], v[108:115], v2
  ds_read_b128 v[108:111], v11 offset:14336
  ds_read_b128 v[112:115], v11 offset:15360
  s_waitcnt lgkmcnt(10)
  v_smfmac_f32_16x16x64_bf16 v[84:87], v[104:107], v[116:123], v2
  ds_read_b128 v[116:119], v11 offset:30720
  ds_read_b128 v[120:123], v11 offset:31744
  s_waitcnt lgkmcnt(10)
  v_smfmac_f32_16x16x64_bf16 v[88:91], v[100:103], v[52:59], v2
  v_add_f32 v68, v68, v70
  v_add_f32 v69, v69, v71
  v_add_f32 v72, v72, v74
  v_add_f32 v73, v73, v75
  s_waitcnt lgkmcnt(8)
  v_smfmac_f32_16x16x64_bf16 v[88:91], v[104:107], v[60:67], v2
  v_add_f32 v76, v76, v78
  v_add_f32 v77, v77, v79
  v_add_f32 v80, v80, v82
  v_add_f32 v81, v81, v83
  s_waitcnt lgkmcnt(6)
  v_smfmac_f32_16x16x64_bf16 v[92:95], v[100:103], v[36:43], v2
  v_cvt_pk_bf16_f32 v124, v68, v69
  v_cvt_pk_bf16_f32 v125, v72, v73
  v_cvt_pk_bf16_f32 v126, v76, v77
  v_cvt_pk_bf16_f32 v127, v80, v81
  s_waitcnt lgkmcnt(4)
  v_smfmac_f32_16x16x64_bf16 v[92:95], v[104:107], v[44:51], v2
  s_nop 0
  v_permlane32_swap_b32 v124, v126
  v_permlane32_swap_b32 v125, v127
  s_nop 1
  s_waitcnt lgkmcnt(2)
  v_smfmac_f32_16x16x64_bf16 v[96:99], v[100:103], v[108:115], v2
  v_permlane16_swap_b32 v124, v125
  v_permlane16_swap_b32 v126, v127
  v_and_or_b32 v124, v124, -2, s82
  buffer_store_dwordx4 v[124:127], v12, s[4:7], s66 offen
  s_waitcnt lgkmcnt(0)
  v_smfmac_f32_16x16x64_bf16 v[96:99], v[104:107], v[116:123], v2
  s_nop 4
  v_pk_add_f32 v[84:85], v[84:85], v[86:87]
  v_pk_add_f32 v[88:89], v[88:89], v[90:91]
  v_pk_add_f32 v[92:93], v[92:93], v[94:95]
  v_pk_add_f32 v[96:97], v[96:97], v[98:99]
  v_cvt_pk_bf16_f32 v68, v84, v85
  v_cvt_pk_bf16_f32 v69, v88, v89
  v_cvt_pk_bf16_f32 v70, v92, v93
  v_cvt_pk_bf16_f32 v71, v96, v97
  s_nop 0
  v_permlane32_swap_b32 v68, v70
  v_permlane32_swap_b32 v69, v71
  s_nop 1
  v_permlane16_swap_b32 v68, v69
  v_permlane16_swap_b32 v70, v71
  v_and_or_b32 v68, v68, -2, s82
  buffer_store_dwordx4 v[68:71], v12, s[4:7], s67 offen
  s_waitcnt vmcnt(2)
  ds_write_b128 v15, v[18:21] offset:8192
  ds_write_b128 v15, v[22:25] offset:9216
  ds_write_b128 v15, v[26:29] offset:16384
  ds_write_b128 v15, v[30:33] offset:17408
  v_readfirstlane_b32 s85, v34
  s_add_u32 s45, s65, 1
  s_and_b32 s46, s45, 3
  s_lshl_b32 s46, s46, 13
  s_add_u32 s47, s46, s75
  s_add_u32 s45, s65, 3
  s_and_b32 s46, s45, 3
  s_lshl_b32 s83, s46, 13
  s_add_u32 s83, s83, s75
  s_lshl_b32 s45, s17, 8
  s_add_u32 s76, s47, s45
  s_add_u32 s83, s83, s45
  s_lshl_b32 s45, s16, 6
  s_add_u32 s83, s83, s45
  s_lshl_b32 s45, s16, 11
  s_add_u32 s77, s47, s45
  v_bfe_u32 v76, v8, 6, 2
  v_bfe_u32 v77, v8, 4, 1
  v_lshlrev_b32 v77, 4, v77
  v_mov_b32 v78, 0x3f80
  v_lshlrev_b32 v77, v77, v78
  v_bfe_u32 v78, v8, 5, 1
  v_cmp_eq_u32 vcc, 0, v78
  v_mov_b32 v79, 0
  s_nop 0
  v_cndmask_b32 v77, v79, v77, vcc
  v_cmp_eq_u32 vcc, 0, v76
  v_mov_b32 v68, 0
  s_nop 0
  v_cndmask_b32 v68, v79, v77, vcc
  v_cmp_eq_u32 vcc, 1, v76
  v_mov_b32 v69, 0
  s_nop 0
  v_cndmask_b32 v69, v79, v77, vcc
  v_cmp_eq_u32 vcc, 2, v76
  v_mov_b32 v70, 0
  s_nop 0
  v_cndmask_b32 v70, v79, v77, vcc
  v_cmp_eq_u32 vcc, 3, v76
  v_mov_b32 v71, 0
  s_nop 0
  v_cndmask_b32 v71, v79, v77, vcc
  buffer_load_dwordx4 v[36:39], v35, s[4:7], s74 offen sc1
  buffer_load_dwordx4 v[40:43], v35, s[4:7], s57 offen sc1
  s_branch L_pollB1_18
L_pollB_17:
  buffer_load_dwordx4 v[36:39], v35, s[4:7], s74 offen sc1
  buffer_load_dwordx4 v[40:43], v35, s[4:7], s57 offen sc1
  s_nop 0
L_pollB1_18:
  s_waitcnt vmcnt(0)
  v_mfma_f32_16x16x32_bf16 v[72:75], v[68:71], v[36:39], 0
  v_xor_b32 v76, s82, v36
  v_mfma_f32_16x16x32_bf16 v[72:75], v[68:71], v[40:43], v[72:75]
  v_xor_b32 v77, s82, v40
  v_or_b32 v76, v76, v77
  v_and_b32 v76, 1, v76
  v_cmp_ne_u32 vcc, 0, v76
  s_sub_u32 s64, s64, 1
  s_cbranch_scc1 L_abort
  s_cbranch_vccnz L_pollB_17
  s_nop 0
  v_add_f32_dpp v72, v72, v72 row_ror:4 row_mask:0xf bank_mask:0xf
  v_add_f32_dpp v73, v73, v73 row_ror:4 row_mask:0xf bank_mask:0xf
  s_nop 0
  v_add_f32_dpp v72, v72, v72 row_ror:8 row_mask:0xf bank_mask:0xf
  v_add_f32_dpp v73, v73, v73 row_ror:8 row_mask:0xf bank_mask:0xf
  v_cvt_pk_bf16_f32 v76, v72, v73
  s_nop 1
  v_mov_b32_dpp v77, v76 quad_perm:[1,0,3,2] row_mask:0xf bank_mask:0xf
  v_mov_b32 v78, v76
  s_nop 0
  v_mov_b32 v79, v77
  v_permlane16_swap_b32 v76, v78
  s_nop 0
  v_permlane16_swap_b32 v77, v79
  s_mov_b32 exec_lo, 5
  s_mov_b32 exec_hi, 5
  v_min_u32 v76, -2, v76
  buffer_store_dwordx4 v[76:79], v13, s[4:7], s76 offen
  s_mov_b64 exec, -1
L_cutend_f:
  s_add_u32 s65, s65, 1
  s_add_u32 s78, s78, 16384
  s_mov_b32 s86, s79
  s_add_u32 s79, s79, 4096
  s_mov_b32 s58, s87
  s_mov_b32 s87, s81
  s_add_u32 s81, s81, 4096
  v_mov_b64 v[68:69], 0
  v_mov_b64 v[70:71], 0
  v_mov_b64 v[72:73], 0
  v_mov_b64 v[74:75], 0
  v_mov_b64 v[76:77], 0
  v_mov_b64 v[78:79], 0
  v_mov_b64 v[80:81], 0
  v_mov_b64 v[82:83], 0
  v_mov_b64 v[84:85], 0
  v_mov_b64 v[86:87], 0
  v_mov_b64 v[88:89], 0
  v_mov_b64 v[90:91], 0
  v_xor_b32 v1, 128, v3
  v_mov_b64 v[96:97], -1
  v_mov_b64 v[98:99], -1
  s_mov_b64 exec, 15
  buffer_store_dwordx4 v[96:99], v8, s[4:7], s83 offen
  s_mov_b64 exec, -1
  s_waitcnt vmcnt(0)
L_pollC_19:
  buffer_load_dwordx4 v[36:39], v8, s[4:7], s77 offen offset:0 sc1
  buffer_load_dwordx4 v[40:43], v8, s[4:7], s77 offen offset:1024 sc1
  s_waitcnt vmcnt(0)
  v_cmp_eq_u32 vcc, -1, v36
  v_cmp_eq_u32 s[46:47], -1, v40
  s_or_b64 vcc, vcc, s[46:47]
  s_sub_u32 s64, s64, 1
  s_cbranch_scc1 L_abort
  s_cbranch_vccnz L_pollC_19
  ds_write_b128 v14, v[36:39] offset:0
  ds_write_b128 v14, v[40:43] offset:1024
  ds_read_b128 v[92:95], v16 offset:28672
  s_waitcnt lgkmcnt(0)
  s_barrier
  s_branch L_step_f
L_kvnotready_f:
  s_cmp_ge_u32 s65, 63
  s_cbranch_scc1 L_kvready_f
L_fl_20:
  v_mov_b32 v124, s80
  s_mov_b64 exec, 1
  buffer_load_dword v125, v124, s[4:7], 0 offen sc1
  s_mov_b64 exec, -1
  s_waitcnt vmcnt(0)
  v_readfirstlane_b32 s85, v125
  s_sub_u32 s64, s64, 1
  s_cbranch_scc1 L_abort
  s_cmp_ge_u32 s85, 4
  s_cbranch_scc1 L_fld_21
  s_sleep 4
  s_branch L_fl_20
L_fld_21:
  s_branch L_kvready_f
L_chain_fin_f:
  s_waitcnt vmcnt(0) lgkmcnt(0)
  s_barrier
  v_mov_b32 v124, s87
  v_mov_b32 v125, 4
  s_mov_b64 exec, s[54:55]
  buffer_store_dword v125, v124, s[4:7], 0 offen sc1
  s_mov_b64 exec, -1
  ds_read_b128 v[72:75], v16 offset:28672
  s_waitcnt lgkmcnt(0)
  buffer_store_dwordx4 v[72:75], v16, s[4:7], s79 offen sc1
  s_waitcnt vmcnt(0)
  s_barrier
  v_mov_b32 v124, s81
  v_mov_b32 v125, 4
  s_mov_b64 exec, s[54:55]
  buffer_store_dword v125, v124, s[4:7], 0 offen sc1
  s_mov_b64 exec, -1
  s_waitcnt vmcnt(0)
  s_branch L_end
L_chain_slow:
  v_and_b32 v1, 63, v0
  v_lshlrev_b32 v8, 4, v1
  v_and_b32 v124, 2, v1
  v_cmp_eq_u32 vcc, 0, v124
  v_mov_b32 v125, 0xeeee
  v_mov_b32 v126, 0x4444
  v_cndmask_b32 v2, v125, v126, vcc
  v_lshrrev_b32 v124, 4, v1
  v_bfe_u32 v125, v1, 2, 2
  v_and_b32 v126, 3, v1
  v_lshlrev_b32 v127, 8, v124
  v_lshl_add_u32 v127, v125, 5, v127
  v_lshl_add_u32 v127, v126, 3, v127
  v_and_b32 v124, 1, v124
  v_lshlrev_b32 v124, 7, v124
  v_xor_b32 v3, v127, v124
  v_and_b32 v124, 15, v1
  s_lshl_b32 s45, s16, 5
  v_add_u32 v124, s45, v124
  v_lshlrev_b32 v125, 4, v124
  v_lshrrev_b32 v126, 4, v1
  v_lshl_add_u32 v4, v126, 2, v125
  v_lshlrev_b32 v125, 5, v124
  v_lshl_add_u32 v125, v126, 3, v125
  v_bfe_u32 v126, v1, 3, 1
  v_lshlrev_b32 v126, 7, v126
  v_xor_b32 v6, v125, v126
  v_lshrrev_b32 v124, 4, v1
  v_bfe_u32 v125, v1, 2, 2
  v_lshl_add_u32 v125, v124, 2, v125
  v_lshlrev_b32 v126, 4, v125
  v_and_b32 v127, 1, v1
  v_lshl_add_u32 v5, v127, 3, v126
  v_lshlrev_b32 v126, 5, v125
  v_and_b32 v127, 3, v1
  v_lshl_add_u32 v126, v127, 3, v126
  v_lshrrev_b32 v124, 1, v124
  v_lshlrev_b32 v124, 7, v124
  v_xor_b32 v7, v126, v124
  v_and_b32 v124, 7, v1
  v_mul_u32_u24 v124, 272, v124
  v_lshrrev_b32 v125, 4, v1
  v_lshl_add_u32 v124, v125, 2, v124
  s_lshl_b32 s45, s16, 6
  v_add_u32 v9, s45, v124
  v_bfe_u32 v124, v1, 2, 2
  v_lshlrev_b32 v124, 1, v124
  v_and_b32 v126, 1, v1
  v_add_u32 v124, v124, v126
  v_mul_u32_u24 v124, 272, v124
  v_lshl_add_u32 v124, v125, 5, v124
  v_bfe_u32 v125, v1, 1, 1
  v_lshl_add_u32 v10, v125, 4, v124
  s_lshl_b32 s45, s16, 15
  s_add_u32 s45, s45, 0x8000
  v_add_u32 v11, s45, v8
  s_lshl_b32 s45, s16, 11
  v_add_u32 v15, s45, v8
  v_and_b32 v124, 15, v1
  v_lshrrev_b32 v125, 4, v1
  v_lshlrev_b32 v126, 4, v124
  v_lshl_add_u32 v12, v125, 13, v126
  s_lshl_b32 s46, s16, 10
  v_add_u32 v16, s46, v8
  v_bfe_u32 v126, v1, 1, 1
  v_lshlrev_b32 v126, 5, v126
  v_lshrrev_b32 v124, 5, v1
  v_lshl_add_u32 v126, v124, 4, v126
  s_lshl_b32 s46, s16, 6
  v_add_u32 v13, s46, v126
  v_bfe_u32 v126, v1, 2, 2
  v_lshl_add_u32 v126, v125, 2, v126
  v_lshlrev_b32 v126, 8, v126
  v_and_b32 v124, 3, v1
  v_lshl_add_u32 v126, v124, 4, v126
  v_add_u32 v35, s46, v126
  v_bfe_u32 v124, v1, 4, 1
  v_lshlrev_b32 v124, 7, v124
  v_xor_b32 v124, v124, v8
  v_add_u32 v14, s45, v124
  s_mul_i32 s46, s19, 0x40000
  s_add_u32 s46, s46, 0x130000
  s_lshl_b32 s45, s17, 8
  s_add_u32 s47, s46, s45
  s_lshl_b32 s45, s16, 16
  s_add_u32 s66, s47, s45
  s_lshl_b32 s45, s17, 13
  s_add_u32 s74, s46, s45
  s_mul_i32 s75, s19, 0x8000
  s_add_u32 s75, s75, 0x1b0000
  s_mul_i32 s45, s19, 0x2000000
  s_add_u32 s45, s45, 0x200000
  s_lshl_b32 s46, s17, 20
  s_add_u32 s78, s45, s46
  s_mul_i32 s45, s19, 0x800000
  s_add_u32 s45, s45, 0x4200000
  s_lshl_b32 s46, s17, 18
  s_add_u32 s79, s45, s46
  s_lshl_b32 s45, s19, 18
  s_lshl_b32 s46, s17, 7
  s_add_u32 s45, s45, s46
  s_add_u32 s80, s45, 0x0
  s_add_u32 s81, s45, 0x80000
  s_mov_b32 s84, 0x3e0293ee
  s_add_u32 s67, s66, 32768
  s_mov_b32 s87, 0x128000
  s_mov_b32 s58, 0x128000
  s_mov_b32 s86, 0x129000
  s_mov_b32 s83, 0x12b000
  v_mov_b32 v17, -1
  s_add_u32 s57, s74, 4096
  s_cmp_eq_u32 s16, 2
  s_cselect_b32 s54, 1, 0
  s_mov_b32 s55, 0
  s_cmp_eq_u32 s19, 0
  s_cbranch_scc1 L_cg_22
L_cg_22:
  v_lshrrev_b32 v124, 4, v1
  v_bfe_u32 v125, v1, 1, 3
  v_xor_b32 v125, v125, v124
  v_lshlrev_b32 v125, 5, v125
  v_and_b32 v126, 1, v1
  v_lshl_add_u32 v125, v126, 4, v125
  v_lshl_add_u32 v125, v124, 13, v125
  s_lshl_b32 s45, s17, 8
  v_add_u32 v40, s45, v125
  v_xor_b32 v41, 128, v40
  v_lshrrev_b32 v124, 4, v1
  v_bfe_u32 v125, v1, 2, 1
  v_lshlrev_b32 v125, 1, v125
  v_bfe_u32 v127, v1, 3, 1
  v_or_b32 v125, v125, v127
  v_lshl_add_u32 v126, v124, 3, v125
  v_lshlrev_b32 v126, 8, v126
  v_and_b32 v124, 1, v124
  v_lshl_add_u32 v124, v124, 2, v125
  s_lshl_b32 s45, s16, 1
  v_xor_b32 v124, s45, v124
  v_lshl_add_u32 v126, v124, 5, v126
  v_and_b32 v125, 3, v1
  v_lshl_add_u32 v42, v125, 3, v126
  v_xor_b32 v46, 32, v42
  s_lshl_b32 s48, s16, 15
  s_add_u32 s48, s48, 0x8000
  s_lshl_b32 s50, s16, 12
  v_lshrrev_b32 v124, 4, v1
  v_bfe_u32 v125, v1, 1, 3
  v_xor_b32 v125, v125, v124
  v_lshlrev_b32 v125, 5, v125
  v_and_b32 v126, 1, v1
  v_lshl_add_u32 v125, v126, 4, v125
  v_lshl_add_u32 v125, v124, 10, v125
  s_lshl_b32 s45, s17, 17
  v_add_u32 v43, s45, v125
  v_xor_b32 v44, 128, v43
  v_lshrrev_b32 v124, 4, v1
  v_bfe_u32 v125, v1, 2, 2
  v_lshl_add_u32 v126, v124, 3, v125
  v_lshlrev_b32 v126, 8, v126
  v_and_b32 v124, 1, v124
  v_lshl_add_u32 v124, v124, 2, v125
  v_lshl_add_u32 v126, v124, 5, v126
  v_and_b32 v125, 3, v1
  v_lshl_add_u32 v126, v125, 3, v126
  v_add_u32 v45, s48, v126
  s_mov_b32 s8, s24
  s_and_b32 s9, s25, 0xffff
  s_mov_b32 s10, 0x400000
  s_mov_b32 s11, 0x20000
  s_lshl_b32 s47, s16, 17
  s_add_u32 s45, s50, 32768
  s_mov_b32 m0, s45
  s_add_u32 s46, s47, 0
  buffer_load_dwordx4 v40, s[8:11], s46 offen lds
  s_add_u32 s45, s50, 33792
  s_mov_b32 m0, s45
  s_add_u32 s46, s47, 32768
  buffer_load_dwordx4 v40, s[8:11], s46 offen lds
  s_add_u32 s45, s50, 34816
  s_mov_b32 m0, s45
  s_add_u32 s46, s47, 65536
  buffer_load_dwordx4 v41, s[8:11], s46 offen lds
  s_add_u32 s45, s50, 35840
  s_mov_b32 m0, s45
  s_add_u32 s46, s47, 98304
  buffer_load_dwordx4 v41, s[8:11], s46 offen lds
  s_lshl_b32 s47, s16, 17
  s_add_u32 s45, s50, 49152
  s_mov_b32 m0, s45
  s_add_u32 s46, s47, 524288
  buffer_load_dwordx4 v40, s[8:11], s46 offen lds
  s_add_u32 s45, s50, 50176
  s_mov_b32 m0, s45
  s_add_u32 s46, s47, 557056
  buffer_load_dwordx4 v40, s[8:11], s46 offen lds
  s_add_u32 s45, s50, 51200
  s_mov_b32 m0, s45
  s_add_u32 s46, s47, 589824
  buffer_load_dwordx4 v41, s[8:11], s46 offen lds
  s_add_u32 s45, s50, 52224
  s_mov_b32 m0, s45
  s_add_u32 s46, s47, 622592
  buffer_load_dwordx4 v41, s[8:11], s46 offen lds
  s_lshl_b32 s47, s16, 17
  s_add_u32 s45, s50, 65536
  s_mov_b32 m0, s45
  s_add_u32 s46, s47, 1048576
  buffer_load_dwordx4 v40, s[8:11], s46 offen lds
  s_add_u32 s45, s50, 66560
  s_mov_b32 m0, s45
  s_add_u32 s46, s47, 1081344
  buffer_load_dwordx4 v40, s[8:11], s46 offen lds
  s_add_u32 s45, s50, 67584
  s_mov_b32 m0, s45
  s_add_u32 s46, s47, 1114112
  buffer_load_dwordx4 v41, s[8:11], s46 offen lds
  s_add_u32 s45, s50, 68608
  s_mov_b32 m0, s45
  s_add_u32 s46, s47, 1146880
  buffer_load_dwordx4 v41, s[8:11], s46 offen lds
  s_lshl_b32 s47, s16, 17
  s_add_u32 s45, s50, 81920
  s_mov_b32 m0, s45
  s_add_u32 s46, s47, 1572864
  buffer_load_dwordx4 v40, s[8:11], s46 offen lds
  s_add_u32 s45, s50, 82944
  s_mov_b32 m0, s45
  s_add_u32 s46, s47, 1605632
  buffer_load_dwordx4 v40, s[8:11], s46 offen lds
  s_add_u32 s45, s50, 83968
  s_mov_b32 m0, s45
  s_add_u32 s46, s47, 1638400
  buffer_load_dwordx4 v41, s[8:11], s46 offen lds
  s_add_u32 s45, s50, 84992
  s_mov_b32 m0, s45
  s_add_u32 s46, s47, 1671168
  buffer_load_dwordx4 v41, s[8:11], s46 offen lds
  s_lshl_b32 s47, s16, 17
  s_add_u32 s45, s50, 98304
  s_mov_b32 m0, s45
  s_add_u32 s46, s47, 2097152
  buffer_load_dwordx4 v40, s[8:11], s46 offen lds
  s_add_u32 s45, s50, 99328
  s_mov_b32 m0, s45
  s_add_u32 s46, s47, 2129920
  buffer_load_dwordx4 v40, s[8:11], s46 offen lds
  s_add_u32 s45, s50, 100352
  s_mov_b32 m0, s45
  s_add_u32 s46, s47, 2162688
  buffer_load_dwordx4 v41, s[8:11], s46 offen lds
  s_add_u32 s45, s50, 101376
  s_mov_b32 m0, s45
  s_add_u32 s46, s47, 2195456
  buffer_load_dwordx4 v41, s[8:11], s46 offen lds
  s_lshl_b32 s47, s16, 17
  s_add_u32 s45, s50, 114688
  s_mov_b32 m0, s45
  s_add_u32 s46, s47, 2621440
  buffer_load_dwordx4 v40, s[8:11], s46 offen lds
  s_add_u32 s45, s50, 115712
  s_mov_b32 m0, s45
  s_add_u32 s46, s47, 2654208
  buffer_load_dwordx4 v40, s[8:11], s46 offen lds
  s_add_u32 s45, s50, 116736
  s_mov_b32 m0, s45
  s_add_u32 s46, s47, 2686976
  buffer_load_dwordx4 v41, s[8:11], s46 offen lds
  s_add_u32 s45, s50, 117760
  s_mov_b32 m0, s45
  s_add_u32 s46, s47, 2719744
  buffer_load_dwordx4 v41, s[8:11], s46 offen lds
  s_lshl_b32 s47, s16, 17
  s_add_u32 s45, s50, 131072
  s_mov_b32 m0, s45
  s_add_u32 s46, s47, 3145728
  buffer_load_dwordx4 v40, s[8:11], s46 offen lds
  s_add_u32 s45, s50, 132096
  s_mov_b32 m0, s45
  s_add_u32 s46, s47, 3178496
  buffer_load_dwordx4 v40, s[8:11], s46 offen lds
  s_add_u32 s45, s50, 133120
  s_mov_b32 m0, s45
  s_add_u32 s46, s47, 3211264
  buffer_load_dwordx4 v41, s[8:11], s46 offen lds
  s_add_u32 s45, s50, 134144
  s_mov_b32 m0, s45
  s_add_u32 s46, s47, 3244032
  buffer_load_dwordx4 v41, s[8:11], s46 offen lds
  s_waitcnt vmcnt(24)
  s_barrier
  s_lshl_b32 s47, s16, 17
  s_add_u32 s45, s50, 147456
  s_mov_b32 m0, s45
  s_add_u32 s46, s47, 3670016
  buffer_load_dwordx4 v40, s[8:11], s46 offen lds
  s_add_u32 s45, s50, 148480
  s_mov_b32 m0, s45
  s_add_u32 s46, s47, 3702784
  buffer_load_dwordx4 v40, s[8:11], s46 offen lds
  s_add_u32 s45, s50, 149504
  s_mov_b32 m0, s45
  s_add_u32 s46, s47, 3735552
  buffer_load_dwordx4 v41, s[8:11], s46 offen lds
  s_add_u32 s45, s50, 150528
  s_mov_b32 m0, s45
  s_add_u32 s46, s47, 3768320
  buffer_load_dwordx4 v41, s[8:11], s46 offen lds
  v_add_u32 v47, 0x8000, v42
  ds_read_b64_tr_b16 v[128:129], v47 offset:0
  ds_read_b64_tr_b16 v[130:131], v47 offset:1024
  ds_read_b64_tr_b16 v[132:133], v47 offset:8192
  ds_read_b64_tr_b16 v[134:135], v47 offset:9216
  v_add_u32 v47, 0x8000, v46
  ds_read_b64_tr_b16 v[192:193], v47 offset:0
  ds_read_b64_tr_b16 v[194:195], v47 offset:1024
  ds_read_b64_tr_b16 v[196:197], v47 offset:8192
  ds_read_b64_tr_b16 v[198:199], v47 offset:9216
  s_waitcnt lgkmcnt(0)
  s_waitcnt vmcnt(24)
  s_barrier
  s_mov_b32 s8, s26
  s_and_b32 s9, s27, 0xffff
  s_mov_b32 s10, 0x400000
  s_mov_b32 s11, 0x20000
  s_lshl_b32 s47, s16, 17
  s_add_u32 s45, s50, 32768
  s_mov_b32 m0, s45
  s_add_u32 s46, s47, 0
  buffer_load_dwordx4 v40, s[8:11], s46 offen lds
  s_add_u32 s45, s50, 33792
  s_mov_b32 m0, s45
  s_add_u32 s46, s47, 32768
  buffer_load_dwordx4 v40, s[8:11], s46 offen lds
  s_add_u32 s45, s50, 34816
  s_mov_b32 m0, s45
  s_add_u32 s46, s47, 65536
  buffer_load_dwordx4 v41, s[8:11], s46 offen lds
  s_add_u32 s45, s50, 35840
  s_mov_b32 m0, s45
  s_add_u32 s46, s47, 98304
  buffer_load_dwordx4 v41, s[8:11], s46 offen lds
  v_add_u32 v47, 0xc000, v42
  ds_read_b64_tr_b16 v[136:137], v47 offset:0
  ds_read_b64_tr_b16 v[138:139], v47 offset:1024
  ds_read_b64_tr_b16 v[140:141], v47 offset:8192
  ds_read_b64_tr_b16 v[142:143], v47 offset:9216
  v_add_u32 v47, 0xc000, v46
  ds_read_b64_tr_b16 v[200:201], v47 offset:0
  ds_read_b64_tr_b16 v[202:203], v47 offset:1024
  ds_read_b64_tr_b16 v[204:205], v47 offset:8192
  ds_read_b64_tr_b16 v[206:207], v47 offset:9216
  s_waitcnt lgkmcnt(0)
  s_waitcnt vmcnt(24)
  s_barrier
  s_lshl_b32 s47, s16, 17
  s_add_u32 s45, s50, 49152
  s_mov_b32 m0, s45
  s_add_u32 s46, s47, 524288
  buffer_load_dwordx4 v40, s[8:11], s46 offen lds
  s_add_u32 s45, s50, 50176
  s_mov_b32 m0, s45
  s_add_u32 s46, s47, 557056
  buffer_load_dwordx4 v40, s[8:11], s46 offen lds
  s_add_u32 s45, s50, 51200
  s_mov_b32 m0, s45
  s_add_u32 s46, s47, 589824
  buffer_load_dwordx4 v41, s[8:11], s46 offen lds
  s_add_u32 s45, s50, 52224
  s_mov_b32 m0, s45
  s_add_u32 s46, s47, 622592
  buffer_load_dwordx4 v41, s[8:11], s46 offen lds
  v_add_u32 v47, 0x10000, v42
  ds_read_b64_tr_b16 v[144:145], v47 offset:0
  ds_read_b64_tr_b16 v[146:147], v47 offset:1024
  ds_read_b64_tr_b16 v[148:149], v47 offset:8192
  ds_read_b64_tr_b16 v[150:151], v47 offset:9216
  v_add_u32 v47, 0x10000, v46
  ds_read_b64_tr_b16 v[208:209], v47 offset:0
  ds_read_b64_tr_b16 v[210:211], v47 offset:1024
  ds_read_b64_tr_b16 v[212:213], v47 offset:8192
  ds_read_b64_tr_b16 v[214:215], v47 offset:9216
  s_waitcnt lgkmcnt(0)
  s_waitcnt vmcnt(24)
  s_barrier
  s_lshl_b32 s47, s16, 17
  s_add_u32 s45, s50, 65536
  s_mov_b32 m0, s45
  s_add_u32 s46, s47, 1048576
  buffer_load_dwordx4 v40, s[8:11], s46 offen lds
  s_add_u32 s45, s50, 66560
  s_mov_b32 m0, s45
  s_add_u32 s46, s47, 1081344
  buffer_load_dwordx4 v40, s[8:11], s46 offen lds
  s_add_u32 s45, s50, 67584
  s_mov_b32 m0, s45
  s_add_u32 s46, s47, 1114112
  buffer_load_dwordx4 v41, s[8:11], s46 offen lds
  s_add_u32 s45, s50, 68608
  s_mov_b32 m0, s45
  s_add_u32 s46, s47, 1146880
  buffer_load_dwordx4 v41, s[8:11], s46 offen lds
  v_add_u32 v47, 0x14000, v42
  ds_read_b64_tr_b16 v[152:153], v47 offset:0
  ds_read_b64_tr_b16 v[154:155], v47 offset:1024
  ds_read_b64_tr_b16 v[156:157], v47 offset:8192
  ds_read_b64_tr_b16 v[158:159], v47 offset:9216
  v_add_u32 v47, 0x14000, v46
  ds_read_b64_tr_b16 v[216:217], v47 offset:0
  ds_read_b64_tr_b16 v[218:219], v47 offset:1024
  ds_read_b64_tr_b16 v[220:221], v47 offset:8192
  ds_read_b64_tr_b16 v[222:223], v47 offset:9216
  s_waitcnt lgkmcnt(0)
  s_waitcnt vmcnt(24)
  s_barrier
  s_lshl_b32 s47, s16, 17
  s_add_u32 s45, s50, 81920
  s_mov_b32 m0, s45
  s_add_u32 s46, s47, 1572864
  buffer_load_dwordx4 v40, s[8:11], s46 offen lds
  s_add_u32 s45, s50, 82944
  s_mov_b32 m0, s45
  s_add_u32 s46, s47, 1605632
  buffer_load_dwordx4 v40, s[8:11], s46 offen lds
  s_add_u32 s45, s50, 83968
  s_mov_b32 m0, s45
  s_add_u32 s46, s47, 1638400
  buffer_load_dwordx4 v41, s[8:11], s46 offen lds
  s_add_u32 s45, s50, 84992
  s_mov_b32 m0, s45
  s_add_u32 s46, s47, 1671168
  buffer_load_dwordx4 v41, s[8:11], s46 offen lds
  v_add_u32 v47, 0x18000, v42
  ds_read_b64_tr_b16 v[160:161], v47 offset:0
  ds_read_b64_tr_b16 v[162:163], v47 offset:1024
  ds_read_b64_tr_b16 v[164:165], v47 offset:8192
  ds_read_b64_tr_b16 v[166:167], v47 offset:9216
  v_add_u32 v47, 0x18000, v46
  ds_read_b64_tr_b16 v[224:225], v47 offset:0
  ds_read_b64_tr_b16 v[226:227], v47 offset:1024
  ds_read_b64_tr_b16 v[228:229], v47 offset:8192
  ds_read_b64_tr_b16 v[230:231], v47 offset:9216
  s_waitcnt lgkmcnt(0)
  s_waitcnt vmcnt(24)
  s_barrier
  s_lshl_b32 s47, s16, 17
  s_add_u32 s45, s50, 98304
  s_mov_b32 m0, s45
  s_add_u32 s46, s47, 2097152
  buffer_load_dwordx4 v40, s[8:11], s46 offen lds
  s_add_u32 s45, s50, 99328
  s_mov_b32 m0, s45
  s_add_u32 s46, s47, 2129920
  buffer_load_dwordx4 v40, s[8:11], s46 offen lds
  s_add_u32 s45, s50, 100352
  s_mov_b32 m0, s45
  s_add_u32 s46, s47, 2162688
  buffer_load_dwordx4 v41, s[8:11], s46 offen lds
  s_add_u32 s45, s50, 101376
  s_mov_b32 m0, s45
  s_add_u32 s46, s47, 2195456
  buffer_load_dwordx4 v41, s[8:11], s46 offen lds
  v_add_u32 v47, 0x1c000, v42
  ds_read_b64_tr_b16 v[168:169], v47 offset:0
  ds_read_b64_tr_b16 v[170:171], v47 offset:1024
  ds_read_b64_tr_b16 v[172:173], v47 offset:8192
  ds_read_b64_tr_b16 v[174:175], v47 offset:9216
  v_add_u32 v47, 0x1c000, v46
  ds_read_b64_tr_b16 v[232:233], v47 offset:0
  ds_read_b64_tr_b16 v[234:235], v47 offset:1024
  ds_read_b64_tr_b16 v[236:237], v47 offset:8192
  ds_read_b64_tr_b16 v[238:239], v47 offset:9216
  s_waitcnt lgkmcnt(0)
  s_waitcnt vmcnt(24)
  s_barrier
  s_lshl_b32 s47, s16, 17
  s_add_u32 s45, s50, 114688
  s_mov_b32 m0, s45
  s_add_u32 s46, s47, 2621440
  buffer_load_dwordx4 v40, s[8:11], s46 offen lds
  s_add_u32 s45, s50, 115712
  s_mov_b32 m0, s45
  s_add_u32 s46, s47, 2654208
  buffer_load_dwordx4 v40, s[8:11], s46 offen lds
  s_add_u32 s45, s50, 116736
  s_mov_b32 m0, s45
  s_add_u32 s46, s47, 2686976
  buffer_load_dwordx4 v41, s[8:11], s46 offen lds
  s_add_u32 s45, s50, 117760
  s_mov_b32 m0, s45
  s_add_u32 s46, s47, 2719744
  buffer_load_dwordx4 v41, s[8:11], s46 offen lds
  v_add_u32 v47, 0x20000, v42
  ds_read_b64_tr_b16 v[176:177], v47 offset:0
  ds_read_b64_tr_b16 v[178:179], v47 offset:1024
  ds_read_b64_tr_b16 v[180:181], v47 offset:8192
  ds_read_b64_tr_b16 v[182:183], v47 offset:9216
  v_add_u32 v47, 0x20000, v46
  ds_read_b64_tr_b16 v[240:241], v47 offset:0
  ds_read_b64_tr_b16 v[242:243], v47 offset:1024
  ds_read_b64_tr_b16 v[244:245], v47 offset:8192
  ds_read_b64_tr_b16 v[246:247], v47 offset:9216
  s_waitcnt lgkmcnt(0)
  s_waitcnt vmcnt(24)
  s_barrier
  s_lshl_b32 s47, s16, 17
  s_add_u32 s45, s50, 131072
  s_mov_b32 m0, s45
  s_add_u32 s46, s47, 3145728
  buffer_load_dwordx4 v40, s[8:11], s46 offen lds
  s_add_u32 s45, s50, 132096
  s_mov_b32 m0, s45
  s_add_u32 s46, s47, 3178496
  buffer_load_dwordx4 v40, s[8:11], s46 offen lds
  s_add_u32 s45, s50, 133120
  s_mov_b32 m0, s45
  s_add_u32 s46, s47, 3211264
  buffer_load_dwordx4 v41, s[8:11], s46 offen lds
  s_add_u32 s45, s50, 134144
  s_mov_b32 m0, s45
  s_add_u32 s46, s47, 3244032
  buffer_load_dwordx4 v41, s[8:11], s46 offen lds
  v_add_u32 v47, 0x24000, v42
  ds_read_b64_tr_b16 v[184:185], v47 offset:0
  ds_read_b64_tr_b16 v[186:187], v47 offset:1024
  ds_read_b64_tr_b16 v[188:189], v47 offset:8192
  ds_read_b64_tr_b16 v[190:191], v47 offset:9216
  v_add_u32 v47, 0x24000, v46
  ds_read_b64_tr_b16 v[248:249], v47 offset:0
  ds_read_b64_tr_b16 v[250:251], v47 offset:1024
  ds_read_b64_tr_b16 v[252:253], v47 offset:8192
  ds_read_b64_tr_b16 v[254:255], v47 offset:9216
  s_waitcnt lgkmcnt(0)
  s_waitcnt vmcnt(24)
  s_barrier
  s_lshl_b32 s47, s16, 17
  s_add_u32 s45, s50, 147456
  s_mov_b32 m0, s45
  s_add_u32 s46, s47, 3670016
  buffer_load_dwordx4 v40, s[8:11], s46 offen lds
  s_add_u32 s45, s50, 148480
  s_mov_b32 m0, s45
  s_add_u32 s46, s47, 3702784
  buffer_load_dwordx4 v40, s[8:11], s46 offen lds
  s_add_u32 s45, s50, 149504
  s_mov_b32 m0, s45
  s_add_u32 s46, s47, 3735552
  buffer_load_dwordx4 v41, s[8:11], s46 offen lds
  s_add_u32 s45, s50, 150528
  s_mov_b32 m0, s45
  s_add_u32 s46, s47, 3768320
  buffer_load_dwordx4 v41, s[8:11], s46 offen lds
  v_add_u32 v47, 0x8000, v42
  ds_read_b64_tr_b16 a[0:1], v47 offset:0
  ds_read_b64_tr_b16 a[2:3], v47 offset:1024
  ds_read_b64_tr_b16 a[4:5], v47 offset:8192
  ds_read_b64_tr_b16 a[6:7], v47 offset:9216
  v_add_u32 v47, 0x8000, v46
  ds_read_b64_tr_b16 a[64:65], v47 offset:0
  ds_read_b64_tr_b16 a[66:67], v47 offset:1024
  ds_read_b64_tr_b16 a[68:69], v47 offset:8192
  ds_read_b64_tr_b16 a[70:71], v47 offset:9216
  s_waitcnt lgkmcnt(0)
  s_waitcnt vmcnt(24)
  s_barrier
  s_mov_b32 s8, s28
  s_and_b32 s9, s29, 0xffff
  s_mov_b32 s10, 0x400000
  s_mov_b32 s11, 0x20000
  s_lshl_b32 s47, s16, 17
  s_add_u32 s45, s50, 32768
  s_mov_b32 m0, s45
  s_add_u32 s46, s47, 0
  buffer_load_dwordx4 v40, s[8:11], s46 offen lds
  s_add_u32 s45, s50, 33792
  s_mov_b32 m0, s45
  s_add_u32 s46, s47, 32768
  buffer_load_dwordx4 v40, s[8:11], s46 offen lds
  s_add_u32 s45, s50, 34816
  s_mov_b32 m0, s45
  s_add_u32 s46, s47, 65536
  buffer_load_dwordx4 v41, s[8:11], s46 offen lds
  s_add_u32 s45, s50, 35840
  s_mov_b32 m0, s45
  s_add_u32 s46, s47, 98304
  buffer_load_dwordx4 v41, s[8:11], s46 offen lds
  v_add_u32 v47, 0xc000, v42
  ds_read_b64_tr_b16 a[8:9], v47 offset:0
  ds_read_b64_tr_b16 a[10:11], v47 offset:1024
  ds_read_b64_tr_b16 a[12:13], v47 offset:8192
  ds_read_b64_tr_b16 a[14:15], v47 offset:9216
  v_add_u32 v47, 0xc000, v46
  ds_read_b64_tr_b16 a[72:73], v47 offset:0
  ds_read_b64_tr_b16 a[74:75], v47 offset:1024
  ds_read_b64_tr_b16 a[76:77], v47 offset:8192
  ds_read_b64_tr_b16 a[78:79], v47 offset:9216
  s_waitcnt lgkmcnt(0)
  s_waitcnt vmcnt(24)
  s_barrier
  s_lshl_b32 s47, s16, 17
  s_add_u32 s45, s50, 49152
  s_mov_b32 m0, s45
  s_add_u32 s46, s47, 524288
  buffer_load_dwordx4 v40, s[8:11], s46 offen lds
  s_add_u32 s45, s50, 50176
  s_mov_b32 m0, s45
  s_add_u32 s46, s47, 557056
  buffer_load_dwordx4 v40, s[8:11], s46 offen lds
  s_add_u32 s45, s50, 51200
  s_mov_b32 m0, s45
  s_add_u32 s46, s47, 589824
  buffer_load_dwordx4 v41, s[8:11], s46 offen lds
  s_add_u32 s45, s50, 52224
  s_mov_b32 m0, s45
  s_add_u32 s46, s47, 622592
  buffer_load_dwordx4 v41, s[8:11], s46 offen lds
  v_add_u32 v47, 0x10000, v42
  ds_read_b64_tr_b16 a[16:17], v47 offset:0
  ds_read_b64_tr_b16 a[18:19], v47 offset:1024
  ds_read_b64_tr_b16 a[20:21], v47 offset:8192
  ds_read_b64_tr_b16 a[22:23], v47 offset:9216
  v_add_u32 v47, 0x10000, v46
  ds_read_b64_tr_b16 a[80:81], v47 offset:0
  ds_read_b64_tr_b16 a[82:83], v47 offset:1024
  ds_read_b64_tr_b16 a[84:85], v47 offset:8192
  ds_read_b64_tr_b16 a[86:87], v47 offset:9216
  s_waitcnt lgkmcnt(0)
  s_waitcnt vmcnt(24)
  s_barrier
  s_lshl_b32 s47, s16, 17
  s_add_u32 s45, s50, 65536
  s_mov_b32 m0, s45
  s_add_u32 s46, s47, 1048576
  buffer_load_dwordx4 v40, s[8:11], s46 offen lds
  s_add_u32 s45, s50, 66560
  s_mov_b32 m0, s45
  s_add_u32 s46, s47, 1081344
  buffer_load_dwordx4 v40, s[8:11], s46 offen lds
  s_add_u32 s45, s50, 67584
  s_mov_b32 m0, s45
  s_add_u32 s46, s47, 1114112
  buffer_load_dwordx4 v41, s[8:11], s46 offen lds
  s_add_u32 s45, s50, 68608
  s_mov_b32 m0, s45
  s_add_u32 s46, s47, 1146880
  buffer_load_dwordx4 v41, s[8:11], s46 offen lds
  v_add_u32 v47, 0x14000, v42
  ds_read_b64_tr_b16 a[24:25], v47 offset:0
  ds_read_b64_tr_b16 a[26:27], v47 offset:1024
  ds_read_b64_tr_b16 a[28:29], v47 offset:8192
  ds_read_b64_tr_b16 a[30:31], v47 offset:9216
  v_add_u32 v47, 0x14000, v46
  ds_read_b64_tr_b16 a[88:89], v47 offset:0
  ds_read_b64_tr_b16 a[90:91], v47 offset:1024
  ds_read_b64_tr_b16 a[92:93], v47 offset:8192
  ds_read_b64_tr_b16 a[94:95], v47 offset:9216
  s_waitcnt lgkmcnt(0)
  s_waitcnt vmcnt(24)
  s_barrier
  s_lshl_b32 s47, s16, 17
  s_add_u32 s45, s50, 81920
  s_mov_b32 m0, s45
  s_add_u32 s46, s47, 1572864
  buffer_load_dwordx4 v40, s[8:11], s46 offen lds
  s_add_u32 s45, s50, 82944
  s_mov_b32 m0, s45
  s_add_u32 s46, s47, 1605632
  buffer_load_dwordx4 v40, s[8:11], s46 offen lds
  s_add_u32 s45, s50, 83968
  s_mov_b32 m0, s45
  s_add_u32 s46, s47, 1638400
  buffer_load_dwordx4 v41, s[8:11], s46 offen lds
  s_add_u32 s45, s50, 84992
  s_mov_b32 m0, s45
  s_add_u32 s46, s47, 1671168
  buffer_load_dwordx4 v41, s[8:11], s46 offen lds
  v_add_u32 v47, 0x18000, v42
  ds_read_b64_tr_b16 a[32:33], v47 offset:0
  ds_read_b64_tr_b16 a[34:35], v47 offset:1024
  ds_read_b64_tr_b16 a[36:37], v47 offset:8192
  ds_read_b64_tr_b16 a[38:39], v47 offset:9216
  v_add_u32 v47, 0x18000, v46
  ds_read_b64_tr_b16 a[96:97], v47 offset:0
  ds_read_b64_tr_b16 a[98:99], v47 offset:1024
  ds_read_b64_tr_b16 a[100:101], v47 offset:8192
  ds_read_b64_tr_b16 a[102:103], v47 offset:9216
  s_waitcnt lgkmcnt(0)
  s_waitcnt vmcnt(24)
  s_barrier
  s_lshl_b32 s47, s16, 17
  s_add_u32 s45, s50, 98304
  s_mov_b32 m0, s45
  s_add_u32 s46, s47, 2097152
  buffer_load_dwordx4 v40, s[8:11], s46 offen lds
  s_add_u32 s45, s50, 99328
  s_mov_b32 m0, s45
  s_add_u32 s46, s47, 2129920
  buffer_load_dwordx4 v40, s[8:11], s46 offen lds
  s_add_u32 s45, s50, 100352
  s_mov_b32 m0, s45
  s_add_u32 s46, s47, 2162688
  buffer_load_dwordx4 v41, s[8:11], s46 offen lds
  s_add_u32 s45, s50, 101376
  s_mov_b32 m0, s45
  s_add_u32 s46, s47, 2195456
  buffer_load_dwordx4 v41, s[8:11], s46 offen lds
  v_add_u32 v47, 0x1c000, v42
  ds_read_b64_tr_b16 a[40:41], v47 offset:0
  ds_read_b64_tr_b16 a[42:43], v47 offset:1024
  ds_read_b64_tr_b16 a[44:45], v47 offset:8192
  ds_read_b64_tr_b16 a[46:47], v47 offset:9216
  v_add_u32 v47, 0x1c000, v46
  ds_read_b64_tr_b16 a[104:105], v47 offset:0
  ds_read_b64_tr_b16 a[106:107], v47 offset:1024
  ds_read_b64_tr_b16 a[108:109], v47 offset:8192
  ds_read_b64_tr_b16 a[110:111], v47 offset:9216
  s_waitcnt lgkmcnt(0)
  s_waitcnt vmcnt(24)
  s_barrier
  s_lshl_b32 s47, s16, 17
  s_add_u32 s45, s50, 114688
  s_mov_b32 m0, s45
  s_add_u32 s46, s47, 2621440
  buffer_load_dwordx4 v40, s[8:11], s46 offen lds
  s_add_u32 s45, s50, 115712
  s_mov_b32 m0, s45
  s_add_u32 s46, s47, 2654208
  buffer_load_dwordx4 v40, s[8:11], s46 offen lds
  s_add_u32 s45, s50, 116736
  s_mov_b32 m0, s45
  s_add_u32 s46, s47, 2686976
  buffer_load_dwordx4 v41, s[8:11], s46 offen lds
  s_add_u32 s45, s50, 117760
  s_mov_b32 m0, s45
  s_add_u32 s46, s47, 2719744
  buffer_load_dwordx4 v41, s[8:11], s46 offen lds
  v_add_u32 v47, 0x20000, v42
  ds_read_b64_tr_b16 a[48:49], v47 offset:0
  ds_read_b64_tr_b16 a[50:51], v47 offset:1024
  ds_read_b64_tr_b16 a[52:53], v47 offset:8192
  ds_read_b64_tr_b16 a[54:55], v47 offset:9216
  v_add_u32 v47, 0x20000, v46
  ds_read_b64_tr_b16 a[112:113], v47 offset:0
  ds_read_b64_tr_b16 a[114:115], v47 offset:1024
  ds_read_b64_tr_b16 a[116:117], v47 offset:8192
  ds_read_b64_tr_b16 a[118:119], v47 offset:9216
  s_waitcnt lgkmcnt(0)
  s_waitcnt vmcnt(24)
  s_barrier
  s_lshl_b32 s47, s16, 17
  s_add_u32 s45, s50, 131072
  s_mov_b32 m0, s45
  s_add_u32 s46, s47, 3145728
  buffer_load_dwordx4 v40, s[8:11], s46 offen lds
  s_add_u32 s45, s50, 132096
  s_mov_b32 m0, s45
  s_add_u32 s46, s47, 3178496
  buffer_load_dwordx4 v40, s[8:11], s46 offen lds
  s_add_u32 s45, s50, 133120
  s_mov_b32 m0, s45
  s_add_u32 s46, s47, 3211264
  buffer_load_dwordx4 v41, s[8:11], s46 offen lds
  s_add_u32 s45, s50, 134144
  s_mov_b32 m0, s45
  s_add_u32 s46, s47, 3244032
  buffer_load_dwordx4 v41, s[8:11], s46 offen lds
  v_add_u32 v47, 0x24000, v42
  ds_read_b64_tr_b16 a[56:57], v47 offset:0
  ds_read_b64_tr_b16 a[58:59], v47 offset:1024
  ds_read_b64_tr_b16 a[60:61], v47 offset:8192
  ds_read_b64_tr_b16 a[62:63], v47 offset:9216
  v_add_u32 v47, 0x24000, v46
  ds_read_b64_tr_b16 a[120:121], v47 offset:0
  ds_read_b64_tr_b16 a[122:123], v47 offset:1024
  ds_read_b64_tr_b16 a[124:125], v47 offset:8192
  ds_read_b64_tr_b16 a[126:127], v47 offset:9216
  s_waitcnt lgkmcnt(0)
  s_waitcnt vmcnt(24)
  s_barrier
  s_lshl_b32 s47, s16, 17
  s_add_u32 s45, s50, 147456
  s_mov_b32 m0, s45
  s_add_u32 s46, s47, 3670016
  buffer_load_dwordx4 v40, s[8:11], s46 offen lds
  s_add_u32 s45, s50, 148480
  s_mov_b32 m0, s45
  s_add_u32 s46, s47, 3702784
  buffer_load_dwordx4 v40, s[8:11], s46 offen lds
  s_add_u32 s45, s50, 149504
  s_mov_b32 m0, s45
  s_add_u32 s46, s47, 3735552
  buffer_load_dwordx4 v41, s[8:11], s46 offen lds
  s_add_u32 s45, s50, 150528
  s_mov_b32 m0, s45
  s_add_u32 s46, s47, 3768320
  buffer_load_dwordx4 v41, s[8:11], s46 offen lds
  v_add_u32 v47, 0x8000, v42
  ds_read_b64_tr_b16 a[128:129], v47 offset:0
  ds_read_b64_tr_b16 a[130:131], v47 offset:1024
  ds_read_b64_tr_b16 a[132:133], v47 offset:8192
  ds_read_b64_tr_b16 a[134:135], v47 offset:9216
  v_add_u32 v47, 0x8000, v46
  ds_read_b64_tr_b16 a[192:193], v47 offset:0
  ds_read_b64_tr_b16 a[194:195], v47 offset:1024
  ds_read_b64_tr_b16 a[196:197], v47 offset:8192
  ds_read_b64_tr_b16 a[198:199], v47 offset:9216
  s_waitcnt lgkmcnt(0)
  s_waitcnt vmcnt(24)
  s_barrier
  s_mov_b32 s12, s30
  s_and_b32 s13, s31, 0xffff
  s_mov_b32 s14, 0x400000
  s_mov_b32 s15, 0x20000
  s_lshl_b32 s47, s16, 14
  s_add_u32 s45, s50, 32768
  s_mov_b32 m0, s45
  s_add_u32 s46, s47, 0
  buffer_load_dwordx4 v43, s[12:15], s46 offen lds
  s_add_u32 s45, s50, 33792
  s_mov_b32 m0, s45
  s_add_u32 s46, s47, 4096
  buffer_load_dwordx4 v43, s[12:15], s46 offen lds
  s_add_u32 s45, s50, 34816
  s_mov_b32 m0, s45
  s_add_u32 s46, s47, 8192
  buffer_load_dwordx4 v44, s[12:15], s46 offen lds
  s_add_u32 s45, s50, 35840
  s_mov_b32 m0, s45
  s_add_u32 s46, s47, 12288
  buffer_load_dwordx4 v44, s[12:15], s46 offen lds
  v_add_u32 v47, 0xc000, v42
  ds_read_b64_tr_b16 a[136:137], v47 offset:0
  ds_read_b64_tr_b16 a[138:139], v47 offset:1024
  ds_read_b64_tr_b16 a[140:141], v47 offset:8192
  ds_read_b64_tr_b16 a[142:143], v47 offset:9216
  v_add_u32 v47, 0xc000, v46
  ds_read_b64_tr_b16 a[200:201], v47 offset:0
  ds_read_b64_tr_b16 a[202:203], v47 offset:1024
  ds_read_b64_tr_b16 a[204:205], v47 offset:8192
  ds_read_b64_tr_b16 a[206:207], v47 offset:9216
  s_waitcnt lgkmcnt(0)
  s_waitcnt vmcnt(24)
  s_barrier
  s_mov_b32 s12, s30
  s_and_b32 s13, s31, 0xffff
  s_mov_b32 s14, 0x400000
  s_mov_b32 s15, 0x20000
  s_lshl_b32 s47, s16, 14
  s_add_u32 s45, s50, 49152
  s_mov_b32 m0, s45
  s_add_u32 s46, s47, 65536
  buffer_load_dwordx4 v43, s[12:15], s46 offen lds
  s_add_u32 s45, s50, 50176
  s_mov_b32 m0, s45
  s_add_u32 s46, s47, 69632
  buffer_load_dwordx4 v43, s[12:15], s46 offen lds
  s_add_u32 s45, s50, 51200
  s_mov_b32 m0, s45
  s_add_u32 s46, s47, 73728
  buffer_load_dwordx4 v44, s[12:15], s46 offen lds
  s_add_u32 s45, s50, 52224
  s_mov_b32 m0, s45
  s_add_u32 s46, s47, 77824
  buffer_load_dwordx4 v44, s[12:15], s46 offen lds
  v_add_u32 v47, 0x10000, v42
  ds_read_b64_tr_b16 a[144:145], v47 offset:0
  ds_read_b64_tr_b16 a[146:147], v47 offset:1024
  ds_read_b64_tr_b16 a[148:149], v47 offset:8192
  ds_read_b64_tr_b16 a[150:151], v47 offset:9216
  v_add_u32 v47, 0x10000, v46
  ds_read_b64_tr_b16 a[208:209], v47 offset:0
  ds_read_b64_tr_b16 a[210:211], v47 offset:1024
  ds_read_b64_tr_b16 a[212:213], v47 offset:8192
  ds_read_b64_tr_b16 a[214:215], v47 offset:9216
  s_waitcnt lgkmcnt(0)
  s_waitcnt vmcnt(24)
  s_barrier
  s_mov_b32 s12, s30
  s_and_b32 s13, s31, 0xffff
  s_mov_b32 s14, 0x400000
  s_mov_b32 s15, 0x20000
  s_lshl_b32 s47, s16, 14
  s_add_u32 s45, s50, 65536
  s_mov_b32 m0, s45
  s_add_u32 s46, s47, 256
  buffer_load_dwordx4 v43, s[12:15], s46 offen lds
  s_add_u32 s45, s50, 66560
  s_mov_b32 m0, s45
  s_add_u32 s46, s47, 4352
  buffer_load_dwordx4 v43, s[12:15], s46 offen lds
  s_add_u32 s45, s50, 67584
  s_mov_b32 m0, s45
  s_add_u32 s46, s47, 8448
  buffer_load_dwordx4 v44, s[12:15], s46 offen lds
  s_add_u32 s45, s50, 68608
  s_mov_b32 m0, s45
  s_add_u32 s46, s47, 12544
  buffer_load_dwordx4 v44, s[12:15], s46 offen lds
  v_add_u32 v47, 0x14000, v42
  ds_read_b64_tr_b16 a[152:153], v47 offset:0
  ds_read_b64_tr_b16 a[154:155], v47 offset:1024
  ds_read_b64_tr_b16 a[156:157], v47 offset:8192
  ds_read_b64_tr_b16 a[158:159], v47 offset:9216
  v_add_u32 v47, 0x14000, v46
  ds_read_b64_tr_b16 a[216:217], v47 offset:0
  ds_read_b64_tr_b16 a[218:219], v47 offset:1024
  ds_read_b64_tr_b16 a[220:221], v47 offset:8192
  ds_read_b64_tr_b16 a[222:223], v47 offset:9216
  s_waitcnt lgkmcnt(0)
  s_waitcnt vmcnt(24)
  s_barrier
  s_mov_b32 s12, s30
  s_and_b32 s13, s31, 0xffff
  s_mov_b32 s14, 0x400000
  s_mov_b32 s15, 0x20000
  s_lshl_b32 s47, s16, 14
  s_add_u32 s45, s50, 81920
  s_mov_b32 m0, s45
  s_add_u32 s46, s47, 65792
  buffer_load_dwordx4 v43, s[12:15], s46 offen lds
  s_add_u32 s45, s50, 82944
  s_mov_b32 m0, s45
  s_add_u32 s46, s47, 69888
  buffer_load_dwordx4 v43, s[12:15], s46 offen lds
  s_add_u32 s45, s50, 83968
  s_mov_b32 m0, s45
  s_add_u32 s46, s47, 73984
  buffer_load_dwordx4 v44, s[12:15], s46 offen lds
  s_add_u32 s45, s50, 84992
  s_mov_b32 m0, s45
  s_add_u32 s46, s47, 78080
  buffer_load_dwordx4 v44, s[12:15], s46 offen lds
  v_add_u32 v47, 0x18000, v42
  ds_read_b64_tr_b16 a[160:161], v47 offset:0
  ds_read_b64_tr_b16 a[162:163], v47 offset:1024
  ds_read_b64_tr_b16 a[164:165], v47 offset:8192
  ds_read_b64_tr_b16 a[166:167], v47 offset:9216
  v_add_u32 v47, 0x18000, v46
  ds_read_b64_tr_b16 a[224:225], v47 offset:0
  ds_read_b64_tr_b16 a[226:227], v47 offset:1024
  ds_read_b64_tr_b16 a[228:229], v47 offset:8192
  ds_read_b64_tr_b16 a[230:231], v47 offset:9216
  s_waitcnt lgkmcnt(0)
  s_waitcnt vmcnt(24)
  s_barrier
  s_mov_b32 s12, s30
  s_and_b32 s13, s31, 0xffff
  s_mov_b32 s14, 0x400000
  s_mov_b32 s15, 0x20000
  s_lshl_b32 s47, s16, 14
  s_add_u32 s45, s50, 98304
  s_mov_b32 m0, s45
  s_add_u32 s46, s47, 512
  buffer_load_dwordx4 v43, s[12:15], s46 offen lds
  s_add_u32 s45, s50, 99328
  s_mov_b32 m0, s45
  s_add_u32 s46, s47, 4608
  buffer_load_dwordx4 v43, s[12:15], s46 offen lds
  s_add_u32 s45, s50, 100352
  s_mov_b32 m0, s45
  s_add_u32 s46, s47, 8704
  buffer_load_dwordx4 v44, s[12:15], s46 offen lds
  s_add_u32 s45, s50, 101376
  s_mov_b32 m0, s45
  s_add_u32 s46, s47, 12800
  buffer_load_dwordx4 v44, s[12:15], s46 offen lds
  v_add_u32 v47, 0x1c000, v42
  ds_read_b64_tr_b16 a[168:169], v47 offset:0
  ds_read_b64_tr_b16 a[170:171], v47 offset:1024
  ds_read_b64_tr_b16 a[172:173], v47 offset:8192
  ds_read_b64_tr_b16 a[174:175], v47 offset:9216
  v_add_u32 v47, 0x1c000, v46
  ds_read_b64_tr_b16 a[232:233], v47 offset:0
  ds_read_b64_tr_b16 a[234:235], v47 offset:1024
  ds_read_b64_tr_b16 a[236:237], v47 offset:8192
  ds_read_b64_tr_b16 a[238:239], v47 offset:9216
  s_waitcnt lgkmcnt(0)
  s_waitcnt vmcnt(24)
  s_barrier
  s_mov_b32 s12, s30
  s_and_b32 s13, s31, 0xffff
  s_mov_b32 s14, 0x400000
  s_mov_b32 s15, 0x20000
  s_lshl_b32 s47, s16, 14
  s_add_u32 s45, s50, 114688
  s_mov_b32 m0, s45
  s_add_u32 s46, s47, 66048
  buffer_load_dwordx4 v43, s[12:15], s46 offen lds
  s_add_u32 s45, s50, 115712
  s_mov_b32 m0, s45
  s_add_u32 s46, s47, 70144
  buffer_load_dwordx4 v43, s[12:15], s46 offen lds
  s_add_u32 s45, s50, 116736
  s_mov_b32 m0, s45
  s_add_u32 s46, s47, 74240
  buffer_load_dwordx4 v44, s[12:15], s46 offen lds
  s_add_u32 s45, s50, 117760
  s_mov_b32 m0, s45
  s_add_u32 s46, s47, 78336
  buffer_load_dwordx4 v44, s[12:15], s46 offen lds
  v_add_u32 v47, 0x20000, v42
  ds_read_b64_tr_b16 a[176:177], v47 offset:0
  ds_read_b64_tr_b16 a[178:179], v47 offset:1024
  ds_read_b64_tr_b16 a[180:181], v47 offset:8192
  ds_read_b64_tr_b16 a[182:183], v47 offset:9216
  v_add_u32 v47, 0x20000, v46
  ds_read_b64_tr_b16 a[240:241], v47 offset:0
  ds_read_b64_tr_b16 a[242:243], v47 offset:1024
  ds_read_b64_tr_b16 a[244:245], v47 offset:8192
  ds_read_b64_tr_b16 a[246:247], v47 offset:9216
  s_waitcnt lgkmcnt(0)
  s_waitcnt vmcnt(24)
  s_barrier
  s_mov_b32 s12, s30
  s_and_b32 s13, s31, 0xffff
  s_mov_b32 s14, 0x400000
  s_mov_b32 s15, 0x20000
  s_lshl_b32 s47, s16, 14
  s_add_u32 s45, s50, 131072
  s_mov_b32 m0, s45
  s_add_u32 s46, s47, 768
  buffer_load_dwordx4 v43, s[12:15], s46 offen lds
  s_add_u32 s45, s50, 132096
  s_mov_b32 m0, s45
  s_add_u32 s46, s47, 4864
  buffer_load_dwordx4 v43, s[12:15], s46 offen lds
  s_add_u32 s45, s50, 133120
  s_mov_b32 m0, s45
  s_add_u32 s46, s47, 8960
  buffer_load_dwordx4 v44, s[12:15], s46 offen lds
  s_add_u32 s45, s50, 134144
  s_mov_b32 m0, s45
  s_add_u32 s46, s47, 13056
  buffer_load_dwordx4 v44, s[12:15], s46 offen lds
  v_add_u32 v47, 0x24000, v42
  ds_read_b64_tr_b16 a[184:185], v47 offset:0
  ds_read_b64_tr_b16 a[186:187], v47 offset:1024
  ds_read_b64_tr_b16 a[188:189], v47 offset:8192
  ds_read_b64_tr_b16 a[190:191], v47 offset:9216
  v_add_u32 v47, 0x24000, v46
  ds_read_b64_tr_b16 a[248:249], v47 offset:0
  ds_read_b64_tr_b16 a[250:251], v47 offset:1024
  ds_read_b64_tr_b16 a[252:253], v47 offset:8192
  ds_read_b64_tr_b16 a[254:255], v47 offset:9216
  s_waitcnt lgkmcnt(0)
  s_barrier
  s_mov_b32 s12, s30
  s_and_b32 s13, s31, 0xffff
  s_mov_b32 s14, 0x400000
  s_mov_b32 s15, 0x20000
  s_lshl_b32 s47, s16, 14
  s_add_u32 s45, s50, 147456
  s_mov_b32 m0, s45
  s_add_u32 s46, s47, 66304
  buffer_load_dwordx4 v43, s[12:15], s46 offen lds
  s_add_u32 s45, s50, 148480
  s_mov_b32 m0, s45
  s_add_u32 s46, s47, 70400
  buffer_load_dwordx4 v43, s[12:15], s46 offen lds
  s_add_u32 s45, s50, 149504
  s_mov_b32 m0, s45
  s_add_u32 s46, s47, 74496
  buffer_load_dwordx4 v44, s[12:15], s46 offen lds
  s_add_u32 s45, s50, 150528
  s_mov_b32 m0, s45
  s_add_u32 s46, s47, 78592
  buffer_load_dwordx4 v44, s[12:15], s46 offen lds
  s_waitcnt vmcnt(0)
  s_barrier
  v_xor_b32 v124, 0, v45
  ds_read_b64_tr_b16 v[48:49], v124 offset:0
  ds_read_b64_tr_b16 v[50:51], v124 offset:1024
  ds_read_b64_tr_b16 v[52:53], v124 offset:8192
  ds_read_b64_tr_b16 v[54:55], v124 offset:9216
  v_xor_b32 v124, 32, v45
  ds_read_b64_tr_b16 v[56:57], v124 offset:0
  ds_read_b64_tr_b16 v[58:59], v124 offset:1024
  ds_read_b64_tr_b16 v[60:61], v124 offset:8192
  ds_read_b64_tr_b16 v[62:63], v124 offset:9216
  v_xor_b32 v124, 64, v45
  ds_read_b64_tr_b16 v[64:65], v124 offset:0
  ds_read_b64_tr_b16 v[66:67], v124 offset:1024
  ds_read_b64_tr_b16 v[68:69], v124 offset:8192
  ds_read_b64_tr_b16 v[70:71], v124 offset:9216
  v_xor_b32 v124, 96, v45
  ds_read_b64_tr_b16 v[72:73], v124 offset:0
  ds_read_b64_tr_b16 v[74:75], v124 offset:1024
  ds_read_b64_tr_b16 v[76:77], v124 offset:8192
  ds_read_b64_tr_b16 v[78:79], v124 offset:9216
  v_xor_b32 v124, 128, v45
  ds_read_b64_tr_b16 v[80:81], v124 offset:0
  ds_read_b64_tr_b16 v[82:83], v124 offset:1024
  ds_read_b64_tr_b16 v[84:85], v124 offset:8192
  ds_read_b64_tr_b16 v[86:87], v124 offset:9216
  v_xor_b32 v124, 160, v45
  ds_read_b64_tr_b16 v[88:89], v124 offset:0
  ds_read_b64_tr_b16 v[90:91], v124 offset:1024
  ds_read_b64_tr_b16 v[92:93], v124 offset:8192
  ds_read_b64_tr_b16 v[94:95], v124 offset:9216
  v_xor_b32 v124, 192, v45
  ds_read_b64_tr_b16 v[96:97], v124 offset:0
  ds_read_b64_tr_b16 v[98:99], v124 offset:1024
  ds_read_b64_tr_b16 v[100:101], v124 offset:8192
  ds_read_b64_tr_b16 v[102:103], v124 offset:9216
  v_xor_b32 v124, 224, v45
  ds_read_b64_tr_b16 v[104:105], v124 offset:0
  ds_read_b64_tr_b16 v[106:107], v124 offset:1024
  ds_read_b64_tr_b16 v[108:109], v124 offset:8192
  ds_read_b64_tr_b16 v[110:111], v124 offset:9216
  s_waitcnt lgkmcnt(0)
  ds_write_b128 v11, v[48:51] offset:0
  ds_write_b128 v11, v[52:55] offset:1024
  ds_write_b128 v11, v[56:59] offset:2048
  ds_write_b128 v11, v[60:63] offset:3072
  ds_write_b128 v11, v[64:67] offset:4096
  ds_write_b128 v11, v[68:71] offset:5120
  ds_write_b128 v11, v[72:75] offset:6144
  ds_write_b128 v11, v[76:79] offset:7168
  ds_write_b128 v11, v[80:83] offset:8192
  ds_write_b128 v11, v[84:87] offset:9216
  ds_write_b128 v11, v[88:91] offset:10240
  ds_write_b128 v11, v[92:95] offset:11264
  ds_write_b128 v11, v[96:99] offset:12288
  ds_write_b128 v11, v[100:103] offset:13312
  ds_write_b128 v11, v[104:107] offset:14336
  ds_write_b128 v11, v[108:111] offset:15360
  s_waitcnt lgkmcnt(0)
  v_xor_b32 v124, 0, v45
  ds_read_b64_tr_b16 v[48:49], v124 offset:16384
  ds_read_b64_tr_b16 v[50:51], v124 offset:17408
  ds_read_b64_tr_b16 v[52:53], v124 offset:24576
  ds_read_b64_tr_b16 v[54:55], v124 offset:25600
  v_xor_b32 v124, 32, v45
  ds_read_b64_tr_b16 v[56:57], v124 offset:16384
  ds_read_b64_tr_b16 v[58:59], v124 offset:17408
  ds_read_b64_tr_b16 v[60:61], v124 offset:24576
  ds_read_b64_tr_b16 v[62:63], v124 offset:25600
  v_xor_b32 v124, 64, v45
  ds_read_b64_tr_b16 v[64:65], v124 offset:16384
  ds_read_b64_tr_b16 v[66:67], v124 offset:17408
  ds_read_b64_tr_b16 v[68:69], v124 offset:24576
  ds_read_b64_tr_b16 v[70:71], v124 offset:25600
  v_xor_b32 v124, 96, v45
  ds_read_b64_tr_b16 v[72:73], v124 offset:16384
  ds_read_b64_tr_b16 v[74:75], v124 offset:17408
  ds_read_b64_tr_b16 v[76:77], v124 offset:24576
  ds_read_b64_tr_b16 v[78:79], v124 offset:25600
  v_xor_b32 v124, 128, v45
  ds_read_b64_tr_b16 v[80:81], v124 offset:16384
  ds_read_b64_tr_b16 v[82:83], v124 offset:17408
  ds_read_b64_tr_b16 v[84:85], v124 offset:24576
  ds_read_b64_tr_b16 v[86:87], v124 offset:25600
  v_xor_b32 v124, 160, v45
  ds_read_b64_tr_b16 v[88:89], v124 offset:16384
  ds_read_b64_tr_b16 v[90:91], v124 offset:17408
  ds_read_b64_tr_b16 v[92:93], v124 offset:24576
  ds_read_b64_tr_b16 v[94:95], v124 offset:25600
  v_xor_b32 v124, 192, v45
  ds_read_b64_tr_b16 v[96:97], v124 offset:16384
  ds_read_b64_tr_b16 v[98:99], v124 offset:17408
  ds_read_b64_tr_b16 v[100:101], v124 offset:24576
  ds_read_b64_tr_b16 v[102:103], v124 offset:25600
  v_xor_b32 v124, 224, v45
  ds_read_b64_tr_b16 v[104:105], v124 offset:16384
  ds_read_b64_tr_b16 v[106:107], v124 offset:17408
  ds_read_b64_tr_b16 v[108:109], v124 offset:24576
  ds_read_b64_tr_b16 v[110:111], v124 offset:25600
  s_waitcnt lgkmcnt(0)
  ds_write_b128 v11, v[48:51] offset:16384
  ds_write_b128 v11, v[52:55] offset:17408
  ds_write_b128 v11, v[56:59] offset:18432
  ds_write_b128 v11, v[60:63] offset:19456
  ds_write_b128 v11, v[64:67] offset:20480
  ds_write_b128 v11, v[68:71] offset:21504
  ds_write_b128 v11, v[72:75] offset:22528
  ds_write_b128 v11, v[76:79] offset:23552
  ds_write_b128 v11, v[80:83] offset:24576
  ds_write_b128 v11, v[84:87] offset:25600
  ds_write_b128 v11, v[88:91] offset:26624
  ds_write_b128 v11, v[92:95] offset:27648
  ds_write_b128 v11, v[96:99] offset:28672
  ds_write_b128 v11, v[100:103] offset:29696
  ds_write_b128 v11, v[104:107] offset:30720
  ds_write_b128 v11, v[108:111] offset:31744
  s_waitcnt lgkmcnt(0)
  s_barrier
  s_cmp_eq_u32 s19, 0
  s_cbranch_scc0 L_w0_23
  s_cmp_eq_u32 s16, 0
  s_cbranch_scc0 L_w0_23
  s_lshl_b32 s45, s17, 2
  s_add_u32 s45, s45, 0x12e000
  v_mov_b32 v124, s45
  v_mov_b32 v125, 1
  s_mov_b64 exec, 1
  buffer_store_dword v125, v124, s[4:7], 0 offen sc1
  s_mov_b64 exec, -1
L_w0_23:
  s_mov_b32 s8, s22
  s_and_b32 s9, s23, 0xffff
  s_mov_b32 s10, 0x2000
  s_mov_b32 s11, 0x20000
  v_lshlrev_b32 v124, 2, v0
  s_mov_b32 s45, 0
  buffer_load_dword v48, v124, s[8:11], s45 offen
  s_mov_b32 s45, 1024
  buffer_load_dword v49, v124, s[8:11], s45 offen
  s_mov_b32 s45, 2048
  buffer_load_dword v50, v124, s[8:11], s45 offen
  s_mov_b32 s45, 3072
  buffer_load_dword v51, v124, s[8:11], s45 offen
  s_mov_b32 s45, 4096
  buffer_load_dword v52, v124, s[8:11], s45 offen
  s_mov_b32 s45, 5120
  buffer_load_dword v53, v124, s[8:11], s45 offen
  s_mov_b32 s45, 6144
  buffer_load_dword v54, v124, s[8:11], s45 offen
  s_mov_b32 s45, 7168
  buffer_load_dword v55, v124, s[8:11], s45 offen
  s_mov_b32 s45, 0x05040100
  s_mov_b32 s46, 0x07060302
  v_lshlrev_b32 v125, 5, v0
  v_bfe_u32 v126, v0, 3, 1
  v_lshlrev_b32 v126, 7, v126
  v_xor_b32 v125, v125, v126
  v_mov_b32 v64, 0
  v_mov_b32 v65, 0
  v_mov_b32 v66, 0
  v_mov_b32 v67, 0
  v_lshlrev_b32 v127, 4, v0
  ds_write_b128 v127, v[64:67] offset:28672
  s_waitcnt vmcnt(0)
  v_perm_b32 v56, v49, v48, s45
  v_perm_b32 v57, v49, v48, s46
  v_perm_b32 v58, v51, v50, s45
  v_perm_b32 v59, v51, v50, s46
  v_perm_b32 v60, v53, v52, s45
  v_perm_b32 v61, v53, v52, s46
  v_perm_b32 v62, v55, v54, s45
  v_perm_b32 v63, v55, v54, s46
  ds_write_b128 v125, v[56:59]
  ds_write_b128 v125, v[60:63] offset:16
  buffer_load_dwordx4 v[48:51], v35, s[4:7], s74 offen sc1
  buffer_load_dwordx4 v[52:55], v35, s[4:7], s57 offen sc1
  s_lshl_b32 s45, s16, 11
  s_add_u32 s45, s45, s75
  s_add_u32 s46, s45, 0
  buffer_load_dwordx4 v[56:59], v8, s[4:7], s46 offen sc1
  buffer_load_dwordx4 v[60:63], v8, s[4:7], s46 offen offset:1024 sc1
  s_add_u32 s46, s45, 8192
  buffer_load_dwordx4 v[56:59], v8, s[4:7], s46 offen sc1
  buffer_load_dwordx4 v[60:63], v8, s[4:7], s46 offen offset:1024 sc1
  s_add_u32 s46, s45, 16384
  buffer_load_dwordx4 v[56:59], v8, s[4:7], s46 offen sc1
  buffer_load_dwordx4 v[60:63], v8, s[4:7], s46 offen offset:1024 sc1
  s_add_u32 s46, s45, 24576
  buffer_load_dwordx4 v[56:59], v8, s[4:7], s46 offen sc1
  buffer_load_dwordx4 v[60:63], v8, s[4:7], s46 offen offset:1024 sc1
  s_mov_b32 s65, 0
L_fl_24:
  v_mov_b32 v124, s80
  s_mov_b64 exec, 1
  buffer_load_dword v125, v124, s[4:7], 0 offen sc1
  s_mov_b64 exec, -1
  s_waitcnt vmcnt(0)
  v_readfirstlane_b32 s85, v125
  s_sub_u32 s64, s64, 1
  s_cbranch_scc1 L_abort
  s_cmp_ge_u32 s85, 4
  s_cbranch_scc1 L_fld_25
  s_sleep 4
  s_branch L_fl_24
L_fld_25:
  buffer_load_dwordx4 v[18:21], v15, s[4:7], s78 offen sc1
  buffer_load_dwordx4 v[22:25], v15, s[4:7], s78 offen offset:1024 sc1
  s_add_u32 s49, s78, 8192
  buffer_load_dwordx4 v[26:29], v15, s[4:7], s49 offen sc1
  buffer_load_dwordx4 v[30:33], v15, s[4:7], s49 offen offset:1024 sc1
  s_waitcnt vmcnt(0)
  ds_write_b128 v15, v[18:21] offset:8192
  ds_write_b128 v15, v[22:25] offset:9216
  ds_write_b128 v15, v[26:29] offset:16384
  ds_write_b128 v15, v[30:33] offset:17408
  s_add_u32 s78, s78, 16384
  s_add_u32 s80, s80, 4096
  v_mov_b32 v124, s80
  s_mov_b64 exec, 1
  buffer_load_dword v125, v124, s[4:7], 0 offen sc1
  s_mov_b64 exec, -1
  s_waitcnt vmcnt(0)
  v_readfirstlane_b32 s85, v125
  v_mov_b64 v[68:69], 0
  v_mov_b64 v[70:71], 0
  v_mov_b64 v[72:73], 0
  v_mov_b64 v[74:75], 0
  v_mov_b64 v[76:77], 0
  v_mov_b64 v[78:79], 0
  v_mov_b64 v[80:81], 0
  v_mov_b64 v[82:83], 0
  v_mov_b64 v[84:85], 0
  v_mov_b64 v[86:87], 0
  v_mov_b64 v[88:89], 0
  v_mov_b64 v[90:91], 0
  v_xor_b32 v1, 128, v3
  s_waitcnt lgkmcnt(0)
  s_barrier
L_step_s:
  ds_read_b64_tr_b16 v[36:37], v3 offset:0
  ds_read_b64_tr_b16 v[38:39], v1 offset:0
  ds_read_b64_tr_b16 v[40:41], v3 offset:1024
  ds_read_b64_tr_b16 v[42:43], v1 offset:1024
  ds_read_b64_tr_b16 v[44:45], v3 offset:2048
  ds_read_b64_tr_b16 v[46:47], v1 offset:2048
  buffer_store_dwordx4 v[92:95], v16, s[4:7], s86 offen sc1
  s_cmp_ge_u32 s85, 4
  s_cbranch_scc0 L_kvnotready_s
L_kvready_s:
  s_add_u32 s49, s78, 8192
  buffer_load_dwordx4 v[18:21], v15, s[4:7], s78 offen sc1
  s_waitcnt lgkmcnt(4)
  v_smfmac_f32_16x16x64_bf16 v[68:71], v[36:39], v[128:135], v2
  ds_read_b64_tr_b16 v[48:49], v3 offset:3072
  v_smfmac_f32_16x16x64_bf16 v[72:75], v[36:39], v[192:199], v2
  ds_read_b64_tr_b16 v[50:51], v1 offset:3072
  s_waitcnt lgkmcnt(4)
  v_smfmac_f32_16x16x64_bf16 v[68:71], v[40:43], v[136:143], v2
  ds_read_b64_tr_b16 v[52:53], v3 offset:4096
  v_smfmac_f32_16x16x64_bf16 v[72:75], v[40:43], v[200:207], v2
  ds_read_b64_tr_b16 v[54:55], v1 offset:4096
  buffer_load_dwordx4 v[22:25], v15, s[4:7], s78 offen offset:1024 sc1
  s_waitcnt lgkmcnt(4)
  v_smfmac_f32_16x16x64_bf16 v[68:71], v[44:47], v[144:151], v2
  ds_read_b64_tr_b16 v[56:57], v3 offset:5120
  v_smfmac_f32_16x16x64_bf16 v[72:75], v[44:47], v[208:215], v2
  ds_read_b64_tr_b16 v[58:59], v1 offset:5120
  s_waitcnt lgkmcnt(4)
  v_smfmac_f32_16x16x64_bf16 v[68:71], v[48:51], v[152:159], v2
  ds_read_b64_tr_b16 v[60:61], v3 offset:6144
  v_smfmac_f32_16x16x64_bf16 v[72:75], v[48:51], v[216:223], v2
  ds_read_b64_tr_b16 v[62:63], v1 offset:6144
  buffer_load_dwordx4 v[26:29], v15, s[4:7], s49 offen sc1
  s_waitcnt lgkmcnt(4)
  v_smfmac_f32_16x16x64_bf16 v[68:71], v[52:55], v[160:167], v2
  ds_read_b64_tr_b16 v[64:65], v3 offset:7168
  v_smfmac_f32_16x16x64_bf16 v[72:75], v[52:55], v[224:231], v2
  ds_read_b64_tr_b16 v[66:67], v1 offset:7168
  s_waitcnt lgkmcnt(4)
  v_smfmac_f32_16x16x64_bf16 v[68:71], v[56:59], v[168:175], v2
  v_smfmac_f32_16x16x64_bf16 v[72:75], v[56:59], v[232:239], v2
  buffer_load_dwordx4 v[30:33], v15, s[4:7], s49 offen offset:1024 sc1
  s_waitcnt lgkmcnt(2)
  v_smfmac_f32_16x16x64_bf16 v[68:71], v[60:63], v[176:183], v2
  v_smfmac_f32_16x16x64_bf16 v[72:75], v[60:63], v[240:247], v2
  s_waitcnt lgkmcnt(0)
  v_smfmac_f32_16x16x64_bf16 v[68:71], v[64:67], v[184:191], v2
  v_smfmac_f32_16x16x64_bf16 v[72:75], v[64:67], v[248:255], v2
  v_smfmac_f32_16x16x64_bf16 v[76:79], v[36:39], a[0:7], v2
  s_add_u32 s80, s80, 4096
  v_mov_b32 v127, s80
  v_smfmac_f32_16x16x64_bf16 v[80:83], v[36:39], a[64:71], v2
  v_mov_b32 v124, s58
  v_mov_b32 v125, 4
  v_smfmac_f32_16x16x64_bf16 v[76:79], v[40:43], a[8:15], v2
  s_mov_b64 exec, 1
  buffer_load_dword v34, v127, s[4:7], 0 offen sc1
  v_smfmac_f32_16x16x64_bf16 v[80:83], v[40:43], a[72:79], v2
  v_smfmac_f32_16x16x64_bf16 v[76:79], v[44:47], a[16:23], v2
  s_mov_b64 exec, s[54:55]
  buffer_store_dword v125, v124, s[4:7], 0 offen sc1
  v_smfmac_f32_16x16x64_bf16 v[80:83], v[44:47], a[80:87], v2
  s_mov_b64 exec, -1
  v_smfmac_f32_16x16x64_bf16 v[76:79], v[48:51], a[24:31], v2
  v_smfmac_f32_16x16x64_bf16 v[80:83], v[48:51], a[88:95], v2
  v_add_f32 v68, v68, v70
  v_add_f32 v69, v69, v71
  v_smfmac_f32_16x16x64_bf16 v[76:79], v[52:55], a[32:39], v2
  v_cvt_pk_bf16_f32 v70, v68, v69
  ds_write_b32 v4, v70 offset:24576
  v_smfmac_f32_16x16x64_bf16 v[80:83], v[52:55], a[96:103], v2
  v_add_f32 v72, v72, v74
  v_add_f32 v73, v73, v75
  v_smfmac_f32_16x16x64_bf16 v[76:79], v[56:59], a[40:47], v2
  v_cvt_pk_bf16_f32 v74, v72, v73
  ds_write_b32 v4, v74 offset:24832
  v_smfmac_f32_16x16x64_bf16 v[80:83], v[56:59], a[104:111], v2
  v_smfmac_f32_16x16x64_bf16 v[76:79], v[60:63], a[48:55], v2
  v_smfmac_f32_16x16x64_bf16 v[80:83], v[60:63], a[112:119], v2
  v_smfmac_f32_16x16x64_bf16 v[76:79], v[64:67], a[56:63], v2
  v_smfmac_f32_16x16x64_bf16 v[80:83], v[64:67], a[120:127], v2
  v_smfmac_f32_16x16x64_bf16 v[84:87], v[36:39], a[128:135], v2
  ds_read_b128 v[108:111], v8 offset:8192
  ds_read_b128 v[112:115], v8 offset:12288
  v_smfmac_f32_16x16x64_bf16 v[88:91], v[36:39], a[192:199], v2
  ds_read_b128 v[116:119], v8 offset:9216
  ds_read_b128 v[120:123], v8 offset:13312
  s_nop 1
  v_add_f32 v76, v76, v78
  v_add_f32 v77, v77, v79
  v_cvt_pk_bf16_f32 v78, v76, v77
  ds_write_b32 v6, v78 offset:28672
  v_add_f32 v80, v80, v82
  v_add_f32 v81, v81, v83
  v_cvt_pk_bf16_f32 v82, v80, v81
  ds_write_b32 v6, v82 offset:29184
  v_smfmac_f32_16x16x64_bf16 v[84:87], v[40:43], a[136:143], v2
  v_smfmac_f32_16x16x64_bf16 v[88:91], v[40:43], a[200:207], v2
  v_smfmac_f32_16x16x64_bf16 v[84:87], v[44:47], a[144:151], v2
  v_smfmac_f32_16x16x64_bf16 v[88:91], v[44:47], a[208:215], v2
  s_waitcnt lgkmcnt(0)
  s_barrier
  v_smfmac_f32_16x16x64_bf16 v[84:87], v[48:51], a[152:159], v2
  ds_read_b64_tr_b16 v[92:93], v5 offset:24576
  ds_read_b64_tr_b16 v[94:95], v5 offset:24832
  v_smfmac_f32_16x16x64_bf16 v[88:91], v[48:51], a[216:223], v2
  ds_read_b64_tr_b16 v[96:97], v5 offset:25088
  ds_read_b64_tr_b16 v[98:99], v5 offset:25344
  v_smfmac_f32_16x16x64_bf16 v[84:87], v[52:55], a[160:167], v2
  ds_read_b64_tr_b16 v[100:101], v5 offset:25600
  ds_read_b64_tr_b16 v[102:103], v5 offset:25856
  v_smfmac_f32_16x16x64_bf16 v[88:91], v[52:55], a[224:231], v2
  ds_read_b64_tr_b16 v[104:105], v5 offset:26112
  ds_read_b64_tr_b16 v[106:107], v5 offset:26368
  v_smfmac_f32_16x16x64_bf16 v[84:87], v[56:59], a[168:175], v2
  ds_read_b64_tr_b16 v[68:69], v7 offset:28672
  ds_read_b64_tr_b16 v[70:71], v7 offset:29184
  v_smfmac_f32_16x16x64_bf16 v[88:91], v[56:59], a[232:239], v2
  ds_read_b64_tr_b16 v[72:73], v7 offset:29696
  ds_read_b64_tr_b16 v[74:75], v7 offset:30208
  v_smfmac_f32_16x16x64_bf16 v[84:87], v[60:63], a[176:183], v2
  ds_read_b64_tr_b16 v[76:77], v7 offset:30720
  ds_read_b64_tr_b16 v[78:79], v7 offset:31232
  v_smfmac_f32_16x16x64_bf16 v[88:91], v[60:63], a[240:247], v2
  ds_read_b64_tr_b16 v[80:81], v7 offset:31744
  ds_read_b64_tr_b16 v[82:83], v7 offset:32256
  ds_read_b128 v[36:39], v8 offset:10240
  ds_read_b128 v[40:43], v8 offset:14336
  v_smfmac_f32_16x16x64_bf16 v[84:87], v[64:67], a[184:191], v2
  ds_read_b128 v[44:47], v8 offset:11264
  ds_read_b128 v[48:51], v8 offset:15360
  v_smfmac_f32_16x16x64_bf16 v[88:91], v[64:67], a[248:255], v2
  s_waitcnt lgkmcnt(15)
  v_mfma_f32_16x16x32_bf16 v[52:55], v[108:111], v[92:95], 0
  v_mfma_f32_16x16x32_bf16 v[56:59], v[112:115], v[92:95], 0
  s_waitcnt lgkmcnt(15)
  v_mfma_f32_16x16x32_bf16 v[52:55], v[116:119], v[96:99], v[52:55]
  v_mfma_f32_16x16x32_bf16 v[56:59], v[120:123], v[96:99], v[56:59]
  s_waitcnt lgkmcnt(4)
  v_mfma_f32_16x16x32_bf16 v[60:63], v[68:71], v[92:95], 0
  ds_read_b128 v[108:111], v11 offset:2048
  v_mfma_f32_16x16x32_bf16 v[60:63], v[72:75], v[96:99], v[60:63]
  v_add_f32 v84, v84, v86
  v_add_f32 v85, v85, v87
  v_add_f32 v88, v88, v90
  ds_read_b128 v[112:115], v11 offset:3072
  v_mfma_f32_16x16x32_bf16 v[60:63], v[76:79], v[100:103], v[60:63]
  v_add_f32 v89, v89, v91
  v_cvt_pk_bf16_f32 v86, v84, v85
  v_cvt_pk_bf16_f32 v124, v88, v89
  ds_read_b128 v[116:119], v11 offset:18432
  v_mfma_f32_16x16x32_bf16 v[60:63], v[80:83], v[104:107], v[60:63]
  ds_write_b32 v6, v86 offset:28676
  ds_write_b32 v6, v124 offset:29188
  v_mov_b32 v125, 0
  ds_read_b128 v[120:123], v11 offset:19456
  s_waitcnt lgkmcnt(9)
  v_mfma_f32_16x16x32_bf16 v[52:55], v[36:39], v[100:103], v[52:55]
  v_mov_b32 v80, 0x3f803f80
  v_mov_b32 v81, 0x3f803f80
  s_waitcnt lgkmcnt(8)
  v_mfma_f32_16x16x32_bf16 v[56:59], v[40:43], v[100:103], v[56:59]
  v_mov_b32 v82, 0x3f803f80
  v_mov_b32 v83, 0x3f803f80
  s_waitcnt lgkmcnt(7)
  v_mfma_f32_16x16x32_bf16 v[52:55], v[44:47], v[104:107], v[52:55]
  s_waitcnt lgkmcnt(6)
  v_mfma_f32_16x16x32_bf16 v[56:59], v[48:51], v[104:107], v[56:59]
  ds_read_b128 v[92:95], v15 offset:16384
  ds_read_b128 v[96:99], v15 offset:17408
  v_mov_b32 v106, v86
  v_mov_b32 v105, 0
  v_mov_b32 v107, 0
  s_nop 2
  v_max3_f32 v126, v52, v53, v54
  v_max3_f32 v127, v55, v56, v57
  v_max3_f32 v126, v126, v58, v59
  v_max3_f32 v127, v127, v60, v61
  v_max_f32 v126, v126, v127
  v_mov_b32 v127, v126
  ds_read_b128 v[36:39], v11 offset:0
  ds_read_b128 v[40:43], v11 offset:1024
  v_permlane32_swap_b32 v126, v127
  v_max_f32 v126, v126, v127
  v_mov_b32 v127, v126
  ds_read_b128 v[44:47], v11 offset:16384
  ds_read_b128 v[48:51], v11 offset:17408
  v_permlane16_swap_b32 v126, v127
  v_max_f32 v126, v126, v127
  v_mul_f32 v126, s84, v126
  v_mov_b32 v127, s84
  v_pk_fma_f32 v[52:53], v[52:53], v[126:127], v[126:127] op_sel:[0,1,0] op_sel_hi:[1,1,0] neg_lo:[0,0,1] neg_hi:[0,0,1]
  v_pk_fma_f32 v[54:55], v[54:55], v[126:127], v[126:127] op_sel:[0,1,0] op_sel_hi:[1,1,0] neg_lo:[0,0,1] neg_hi:[0,0,1]
  v_pk_fma_f32 v[56:57], v[56:57], v[126:127], v[126:127] op_sel:[0,1,0] op_sel_hi:[1,1,0] neg_lo:[0,0,1] neg_hi:[0,0,1]
  v_pk_fma_f32 v[58:59], v[58:59], v[126:127], v[126:127] op_sel:[0,1,0] op_sel_hi:[1,1,0] neg_lo:[0,0,1] neg_hi:[0,0,1]
  v_pk_fma_f32 v[60:61], v[60:61], v[126:127], v[126:127] op_sel:[0,1,0] op_sel_hi:[1,1,0] neg_lo:[0,0,1] neg_hi:[0,0,1]
  v_exp_f32 v52, v52
  v_exp_f32 v53, v53
  v_exp_f32 v54, v54
  v_exp_f32 v55, v55
  v_exp_f32 v56, v56
  v_exp_f32 v57, v57
  v_exp_f32 v58, v58
  v_exp_f32 v59, v59
  v_exp_f32 v60, v60
  v_exp_f32 v61, v61
  v_cvt_pk_bf16_f32 v100, v52, v53
  v_cvt_pk_bf16_f32 v101, v54, v55
  v_cvt_pk_bf16_f32 v102, v56, v57
  v_cvt_pk_bf16_f32 v103, v58, v59
  v_cvt_pk_bf16_f32 v104, v60, v61
  s_waitcnt lgkmcnt(4)
  v_mfma_f32_16x16x32_bf16 v[76:79], v[80:83], v[100:103], 0
  ds_read_b128 v[52:55], v11 offset:4096
  ds_read_b128 v[56:59], v11 offset:5120
  v_mfma_f32_16x16x32_bf16 v[84:87], v[92:95], v[100:103], 0
  ds_read_b128 v[60:63], v11 offset:20480
  ds_read_b128 v[64:67], v11 offset:21504
  v_mfma_f32_16x16x16_bf16 v[76:79], v[80:81], v[104:105], v[76:79]
  v_mfma_f32_16x16x32_bf16 v[88:91], v[96:99], v[100:103], 0
  v_mfma_f32_16x16x16_bf16 v[84:87], v[106:107], v[104:105], v[84:87]
  v_mfma_f32_16x16x16_bf16 v[88:91], v[124:125], v[104:105], v[88:91]
  s_cmp_eq_u32 s65, 63
  s_cbranch_scc1 L_chain_fin_s
  s_and_b32 s82, s65, 1
  v_mov_b64 v[68:69], 0
  v_mov_b64 v[70:71], 0
  v_mov_b64 v[72:73], 0
  v_mov_b64 v[74:75], 0
  v_rcp_f32 v126, v76
  v_mov_b64 v[80:81], 0
  v_mov_b64 v[82:83], 0
  v_mov_b64 v[92:93], 0
  v_mov_b64 v[94:95], 0
  v_mov_b64 v[96:97], 0
  v_mov_b64 v[98:99], 0
  v_pk_mul_f32 v[84:85], v[84:85], v[126:127] op_sel_hi:[1,0]
  v_pk_mul_f32 v[86:87], v[86:87], v[126:127] op_sel_hi:[1,0]
  v_pk_mul_f32 v[88:89], v[88:89], v[126:127] op_sel_hi:[1,0]
  v_pk_mul_f32 v[90:91], v[90:91], v[126:127] op_sel_hi:[1,0]
  v_cvt_pk_bf16_f32 v100, v84, v85
  v_cvt_pk_bf16_f32 v101, v86, v87
  v_cvt_pk_bf16_f32 v102, v88, v89
  v_cvt_pk_bf16_f32 v103, v90, v91
  ds_write_b32 v9, v100 offset:24576
  ds_write_b32 v9, v101 offset:24592
  ds_write_b32 v9, v102 offset:24608
  ds_write_b32 v9, v103 offset:24624
  v_mov_b64 v[76:77], 0
  v_mov_b64 v[78:79], 0
  v_mov_b64 v[84:85], 0
  v_mov_b64 v[86:87], 0
  v_mov_b64 v[88:89], 0
  v_mov_b64 v[90:91], 0
  s_waitcnt lgkmcnt(0)
  s_barrier
  ds_read_b128 v[100:103], v10 offset:24576
  ds_read_b128 v[104:107], v10 offset:24704
  s_waitcnt lgkmcnt(1)
  v_smfmac_f32_16x16x64_bf16 v[68:71], v[100:103], v[36:43], v2
  ds_read_b128 v[36:39], v11 offset:6144
  ds_read_b128 v[40:43], v11 offset:7168
  s_waitcnt lgkmcnt(2)
  v_smfmac_f32_16x16x64_bf16 v[68:71], v[104:107], v[44:51], v2
  ds_read_b128 v[44:47], v11 offset:22528
  ds_read_b128 v[48:51], v11 offset:23552
  v_smfmac_f32_16x16x64_bf16 v[72:75], v[100:103], v[108:115], v2
  ds_read_b128 v[108:111], v11 offset:8192
  ds_read_b128 v[112:115], v11 offset:9216
  v_smfmac_f32_16x16x64_bf16 v[72:75], v[104:107], v[116:123], v2
  ds_read_b128 v[116:119], v11 offset:24576
  ds_read_b128 v[120:123], v11 offset:25600
  v_smfmac_f32_16x16x64_bf16 v[76:79], v[100:103], v[52:59], v2
  ds_read_b128 v[52:55], v11 offset:10240
  ds_read_b128 v[56:59], v11 offset:11264
  v_smfmac_f32_16x16x64_bf16 v[76:79], v[104:107], v[60:67], v2
  ds_read_b128 v[60:63], v11 offset:26624
  ds_read_b128 v[64:67], v11 offset:27648
  s_waitcnt lgkmcnt(10)
  v_smfmac_f32_16x16x64_bf16 v[80:83], v[100:103], v[36:43], v2
  ds_read_b128 v[36:39], v11 offset:12288
  ds_read_b128 v[40:43], v11 offset:13312
  s_waitcnt lgkmcnt(10)
  v_smfmac_f32_16x16x64_bf16 v[80:83], v[104:107], v[44:51], v2
  ds_read_b128 v[44:47], v11 offset:28672
  ds_read_b128 v[48:51], v11 offset:29696
  s_waitcnt lgkmcnt(10)
  v_smfmac_f32_16x16x64_bf16 v[84:87], v[100:103], v[108:115], v2
  ds_read_b128 v[108:111], v11 offset:14336
  ds_read_b128 v[112:115], v11 offset:15360
  s_waitcnt lgkmcnt(10)
  v_smfmac_f32_16x16x64_bf16 v[84:87], v[104:107], v[116:123], v2
  ds_read_b128 v[116:119], v11 offset:30720
  ds_read_b128 v[120:123], v11 offset:31744
  s_waitcnt lgkmcnt(10)
  v_smfmac_f32_16x16x64_bf16 v[88:91], v[100:103], v[52:59], v2
  v_add_f32 v68, v68, v70
  v_add_f32 v69, v69, v71
  v_add_f32 v72, v72, v74
  v_add_f32 v73, v73, v75
  s_waitcnt lgkmcnt(8)
  v_smfmac_f32_16x16x64_bf16 v[88:91], v[104:107], v[60:67], v2
  v_add_f32 v76, v76, v78
  v_add_f32 v77, v77, v79
  v_add_f32 v80, v80, v82
  v_add_f32 v81, v81, v83
  s_waitcnt lgkmcnt(6)
  v_smfmac_f32_16x16x64_bf16 v[92:95], v[100:103], v[36:43], v2
  v_cvt_pk_bf16_f32 v124, v68, v69
  v_cvt_pk_bf16_f32 v125, v72, v73
  v_cvt_pk_bf16_f32 v126, v76, v77
  v_cvt_pk_bf16_f32 v127, v80, v81
  s_waitcnt lgkmcnt(4)
  v_smfmac_f32_16x16x64_bf16 v[92:95], v[104:107], v[44:51], v2
  s_nop 0
  v_permlane32_swap_b32 v124, v126
  v_permlane32_swap_b32 v125, v127
  s_nop 1
  s_waitcnt lgkmcnt(2)
  v_smfmac_f32_16x16x64_bf16 v[96:99], v[100:103], v[108:115], v2
  v_permlane16_swap_b32 v124, v125
  v_permlane16_swap_b32 v126, v127
  v_and_or_b32 v124, v124, -2, s82
  buffer_store_dwordx4 v[124:127], v12, s[4:7], s66 offen sc1
  s_waitcnt lgkmcnt(0)
  v_smfmac_f32_16x16x64_bf16 v[96:99], v[104:107], v[116:123], v2
  s_nop 4
  v_pk_add_f32 v[84:85], v[84:85], v[86:87]
  v_pk_add_f32 v[88:89], v[88:89], v[90:91]
  v_pk_add_f32 v[92:93], v[92:93], v[94:95]
  v_pk_add_f32 v[96:97], v[96:97], v[98:99]
  v_cvt_pk_bf16_f32 v68, v84, v85
  v_cvt_pk_bf16_f32 v69, v88, v89
  v_cvt_pk_bf16_f32 v70, v92, v93
  v_cvt_pk_bf16_f32 v71, v96, v97
  s_nop 0
  v_permlane32_swap_b32 v68, v70
  v_permlane32_swap_b32 v69, v71
  s_nop 1
  v_permlane16_swap_b32 v68, v69
  v_permlane16_swap_b32 v70, v71
  v_and_or_b32 v68, v68, -2, s82
  buffer_store_dwordx4 v[68:71], v12, s[4:7], s67 offen sc1
  s_waitcnt vmcnt(2)
  ds_write_b128 v15, v[18:21] offset:8192
  ds_write_b128 v15, v[22:25] offset:9216
  ds_write_b128 v15, v[26:29] offset:16384
  ds_write_b128 v15, v[30:33] offset:17408
  v_readfirstlane_b32 s85, v34
  s_add_u32 s45, s65, 1
  s_and_b32 s46, s45, 3
  s_lshl_b32 s46, s46, 13
  s_add_u32 s47, s46, s75
  s_add_u32 s45, s65, 3
  s_and_b32 s46, s45, 3
  s_lshl_b32 s83, s46, 13
  s_add_u32 s83, s83, s75
  s_lshl_b32 s45, s17, 8
  s_add_u32 s76, s47, s45
  s_add_u32 s83, s83, s45
  s_lshl_b32 s45, s16, 6
  s_add_u32 s83, s83, s45
  s_lshl_b32 s45, s16, 11
  s_add_u32 s77, s47, s45
  v_bfe_u32 v76, v8, 6, 2
  v_bfe_u32 v77, v8, 4, 1
  v_lshlrev_b32 v77, 4, v77
  v_mov_b32 v78, 0x3f80
  v_lshlrev_b32 v77, v77, v78
  v_bfe_u32 v78, v8, 5, 1
  v_cmp_eq_u32 vcc, 0, v78
  v_mov_b32 v79, 0
  s_nop 0
  v_cndmask_b32 v77, v79, v77, vcc
  v_cmp_eq_u32 vcc, 0, v76
  v_mov_b32 v68, 0
  s_nop 0
  v_cndmask_b32 v68, v79, v77, vcc
  v_cmp_eq_u32 vcc, 1, v76
  v_mov_b32 v69, 0
  s_nop 0
  v_cndmask_b32 v69, v79, v77, vcc
  v_cmp_eq_u32 vcc, 2, v76
  v_mov_b32 v70, 0
  s_nop 0
  v_cndmask_b32 v70, v79, v77, vcc
  v_cmp_eq_u32 vcc, 3, v76
  v_mov_b32 v71, 0
  s_nop 0
  v_cndmask_b32 v71, v79, v77, vcc
  buffer_load_dwordx4 v[36:39], v35, s[4:7], s74 offen sc1
  buffer_load_dwordx4 v[40:43], v35, s[4:7], s57 offen sc1
  s_branch L_pollB1_27
L_pollB_26:
  buffer_load_dwordx4 v[36:39], v35, s[4:7], s74 offen sc1
  buffer_load_dwordx4 v[40:43], v35, s[4:7], s57 offen sc1
  s_nop 0
L_pollB1_27:
  s_waitcnt vmcnt(0)
  v_mfma_f32_16x16x32_bf16 v[72:75], v[68:71], v[36:39], 0
  v_xor_b32 v76, s82, v36
  v_mfma_f32_16x16x32_bf16 v[72:75], v[68:71], v[40:43], v[72:75]
  v_xor_b32 v77, s82, v40
  v_or_b32 v76, v76, v77
  v_and_b32 v76, 1, v76
  v_cmp_ne_u32 vcc, 0, v76
  s_sub_u32 s64, s64, 1
  s_cbranch_scc1 L_abort
  s_cbranch_vccnz L_pollB_26
  s_nop 0
  v_add_f32_dpp v72, v72, v72 row_ror:4 row_mask:0xf bank_mask:0xf
  v_add_f32_dpp v73, v73, v73 row_ror:4 row_mask:0xf bank_mask:0xf
  s_nop 0
  v_add_f32_dpp v72, v72, v72 row_ror:8 row_mask:0xf bank_mask:0xf
  v_add_f32_dpp v73, v73, v73 row_ror:8 row_mask:0xf bank_mask:0xf
  v_cvt_pk_bf16_f32 v76, v72, v73
  s_nop 1
  v_mov_b32_dpp v77, v76 quad_perm:[1,0,3,2] row_mask:0xf bank_mask:0xf
  v_mov_b32 v78, v76
  s_nop 0
  v_mov_b32 v79, v77
  v_permlane16_swap_b32 v76, v78
  s_nop 0
  v_permlane16_swap_b32 v77, v79
  s_mov_b32 exec_lo, 5
  s_mov_b32 exec_hi, 5
  v_min_u32 v76, -2, v76
  buffer_store_dwordx4 v[76:79], v13, s[4:7], s76 offen sc1
  s_mov_b64 exec, -1
L_cutend_s:
  s_add_u32 s65, s65, 1
  s_add_u32 s78, s78, 16384
  s_mov_b32 s86, s79
  s_add_u32 s79, s79, 4096
  s_mov_b32 s58, s87
  s_mov_b32 s87, s81
  s_add_u32 s81, s81, 4096
  v_mov_b64 v[68:69], 0
  v_mov_b64 v[70:71], 0
  v_mov_b64 v[72:73], 0
  v_mov_b64 v[74:75], 0
  v_mov_b64 v[76:77], 0
  v_mov_b64 v[78:79], 0
  v_mov_b64 v[80:81], 0
  v_mov_b64 v[82:83], 0
  v_mov_b64 v[84:85], 0
  v_mov_b64 v[86:87], 0
  v_mov_b64 v[88:89], 0
  v_mov_b64 v[90:91], 0
  v_xor_b32 v1, 128, v3
  v_mov_b64 v[96:97], -1
  v_mov_b64 v[98:99], -1
  s_mov_b64 exec, 15
  buffer_store_dwordx4 v[96:99], v8, s[4:7], s83 offen sc1
  s_mov_b64 exec, -1
  s_waitcnt vmcnt(0)
L_pollC_28:
  buffer_load_dwordx4 v[36:39], v8, s[4:7], s77 offen offset:0 sc1
  buffer_load_dwordx4 v[40:43], v8, s[4:7], s77 offen offset:1024 sc1
  s_waitcnt vmcnt(0)
  v_cmp_eq_u32 vcc, -1, v36
  v_cmp_eq_u32 s[46:47], -1, v40
  s_or_b64 vcc, vcc, s[46:47]
  s_sub_u32 s64, s64, 1
  s_cbranch_scc1 L_abort
  s_cbranch_vccnz L_pollC_28
  ds_write_b128 v14, v[36:39] offset:0
  ds_write_b128 v14, v[40:43] offset:1024
  ds_read_b128 v[92:95], v16 offset:28672
  s_waitcnt lgkmcnt(0)
  s_barrier
  s_branch L_step_s
L_kvnotready_s:
  s_cmp_ge_u32 s65, 63
  s_cbranch_scc1 L_kvready_s
L_fl_29:
  v_mov_b32 v124, s80
  s_mov_b64 exec, 1
  buffer_load_dword v125, v124, s[4:7], 0 offen sc1
  s_mov_b64 exec, -1
  s_waitcnt vmcnt(0)
  v_readfirstlane_b32 s85, v125
  s_sub_u32 s64, s64, 1
  s_cbranch_scc1 L_abort
  s_cmp_ge_u32 s85, 4
  s_cbranch_scc1 L_fld_30
  s_sleep 4
  s_branch L_fl_29
L_fld_30:
  s_branch L_kvready_s
L_chain_fin_s:
  s_waitcnt vmcnt(0) lgkmcnt(0)
  s_barrier
  v_mov_b32 v124, s87
  v_mov_b32 v125, 4
  s_mov_b64 exec, s[54:55]
  buffer_store_dword v125, v124, s[4:7], 0 offen sc1
  s_mov_b64 exec, -1
  ds_read_b128 v[72:75], v16 offset:28672
  s_waitcnt lgkmcnt(0)
  buffer_store_dwordx4 v[72:75], v16, s[4:7], s79 offen sc1
  s_waitcnt vmcnt(0)
  s_barrier
  v_mov_b32 v124, s81
  v_mov_b32 v125, 4
  s_mov_b64 exec, s[54:55]
  buffer_store_dword v125, v124, s[4:7], 0 offen sc1
  s_mov_b64 exec, -1
  s_waitcnt vmcnt(0)
  s_branch L_end
L_role_qa:
  s_sub_u32 s17, s17, 64
  s_lshr_b32 s19, s17, 5
  s_and_b32 s17, s17, 31
  v_and_b32 v1, 63, v0
  v_lshlrev_b32 v2, 4, v1
  s_mul_i32 s50, s16, 40960
  s_lshl_b32 s45, s17, 8
  s_lshl_b32 s46, s16, 6
  s_add_u32 s51, s45, s46
  s_cmp_eq_u32 s19, 1
  s_cbranch_scc0 L_qonly_31
  v_bfe_u32 v12, v1, 4, 1
  v_bfe_u32 v13, v1, 5, 1
  v_xor_b32 v12, v12, v13
  v_lshlrev_b32 v12, 1, v12
  v_and_b32 v13, 3, v1
  v_xor_b32 v12, v12, v13
  v_lshlrev_b32 v12, 4, v12
  v_lshrrev_b32 v13, 2, v1
  s_mov_b32 s45, 8192
  v_mul_lo_u32 v13, s45, v13
  v_add_u32 v15, v12, v13
  v_lshrrev_b32 v12, 4, v1
  v_bfe_u32 v13, v1, 2, 2
  v_lshl_add_u32 v14, v12, 3, v13
  v_lshlrev_b32 v14, 6, v14
  v_and_b32 v8, 3, v1
  v_lshl_add_u32 v14, v8, 3, v14
  v_and_b32 v8, 1, v12
  v_lshl_add_u32 v14, v8, 5, v14
  v_add_u32 v8, s50, v14
  v_xor_b32 v9, 32, v8
  v_lshl_add_u32 v14, v12, 2, v13
  v_lshlrev_b32 v14, 6, v14
  v_and_b32 v10, 3, v1
  v_lshl_add_u32 v14, v10, 3, v14
  v_lshrrev_b32 v13, 1, v12
  v_xor_b32 v13, v13, v12
  v_and_b32 v13, 1, v13
  v_lshl_add_u32 v14, v13, 5, v14
  v_add_u32 v10, s50, v14
  v_xor_b32 v11, 32, v10
  s_mov_b32 s8, s26
  s_and_b32 s9, s27, 0xffff
  s_mov_b32 s10, 0x400000
  s_mov_b32 s11, 0x20000
  s_add_u32 s45, s50, 0
  s_mov_b32 m0, s45
  s_add_u32 s46, s51, 0
  buffer_load_dwordx4 v15, s[8:11], s46 offen lds
  s_add_u32 s45, s50, 1024
  s_mov_b32 m0, s45
  s_add_u32 s46, s51, 131072
  buffer_load_dwordx4 v15, s[8:11], s46 offen lds
  s_add_u32 s45, s50, 2048
  s_mov_b32 m0, s45
  s_add_u32 s46, s51, 262144
  buffer_load_dwordx4 v15, s[8:11], s46 offen lds
  s_add_u32 s45, s50, 3072
  s_mov_b32 m0, s45
  s_add_u32 s46, s51, 393216
  buffer_load_dwordx4 v15, s[8:11], s46 offen lds
  s_add_u32 s45, s50, 4096
  s_mov_b32 m0, s45
  s_add_u32 s46, s51, 524288
  buffer_load_dwordx4 v15, s[8:11], s46 offen lds
  s_add_u32 s45, s50, 5120
  s_mov_b32 m0, s45
  s_add_u32 s46, s51, 655360
  buffer_load_dwordx4 v15, s[8:11], s46 offen lds
  s_add_u32 s45, s50, 6144
  s_mov_b32 m0, s45
  s_add_u32 s46, s51, 786432
  buffer_load_dwordx4 v15, s[8:11], s46 offen lds
  s_add_u32 s45, s50, 7168
  s_mov_b32 m0, s45
  s_add_u32 s46, s51, 917504
  buffer_load_dwordx4 v15, s[8:11], s46 offen lds
  s_add_u32 s45, s50, 8192
  s_mov_b32 m0, s45
  s_add_u32 s46, s51, 1048576
  buffer_load_dwordx4 v15, s[8:11], s46 offen lds
  s_add_u32 s45, s50, 9216
  s_mov_b32 m0, s45
  s_add_u32 s46, s51, 1179648
  buffer_load_dwordx4 v15, s[8:11], s46 offen lds
  s_add_u32 s45, s50, 10240
  s_mov_b32 m0, s45
  s_add_u32 s46, s51, 1310720
  buffer_load_dwordx4 v15, s[8:11], s46 offen lds
  s_add_u32 s45, s50, 11264
  s_mov_b32 m0, s45
  s_add_u32 s46, s51, 1441792
  buffer_load_dwordx4 v15, s[8:11], s46 offen lds
  s_add_u32 s45, s50, 12288
  s_mov_b32 m0, s45
  s_add_u32 s46, s51, 1572864
  buffer_load_dwordx4 v15, s[8:11], s46 offen lds
  s_add_u32 s45, s50, 13312
  s_mov_b32 m0, s45
  s_add_u32 s46, s51, 1703936
  buffer_load_dwordx4 v15, s[8:11], s46 offen lds
  s_add_u32 s45, s50, 14336
  s_mov_b32 m0, s45
  s_add_u32 s46, s51, 1835008
  buffer_load_dwordx4 v15, s[8:11], s46 offen lds
  s_add_u32 s45, s50, 15360
  s_mov_b32 m0, s45
  s_add_u32 s46, s51, 1966080
  buffer_load_dwordx4 v15, s[8:11], s46 offen lds
  s_add_u32 s45, s50, 16384
  s_mov_b32 m0, s45
  s_add_u32 s46, s51, 2097152
  buffer_load_dwordx4 v15, s[8:11], s46 offen lds
  s_add_u32 s45, s50, 17408
  s_mov_b32 m0, s45
  s_add_u32 s46, s51, 2228224
  buffer_load_dwordx4 v15, s[8:11], s46 offen lds
  s_add_u32 s45, s50, 18432
  s_mov_b32 m0, s45
  s_add_u32 s46, s51, 2359296
  buffer_load_dwordx4 v15, s[8:11], s46 offen lds
  s_add_u32 s45, s50, 19456
  s_mov_b32 m0, s45
  s_add_u32 s46, s51, 2490368
  buffer_load_dwordx4 v15, s[8:11], s46 offen lds
  s_add_u32 s45, s50, 20480
  s_mov_b32 m0, s45
  s_add_u32 s46, s51, 2621440
  buffer_load_dwordx4 v15, s[8:11], s46 offen lds
  s_add_u32 s45, s50, 21504
  s_mov_b32 m0, s45
  s_add_u32 s46, s51, 2752512
  buffer_load_dwordx4 v15, s[8:11], s46 offen lds
  s_add_u32 s45, s50, 22528
  s_mov_b32 m0, s45
  s_add_u32 s46, s51, 2883584
  buffer_load_dwordx4 v15, s[8:11], s46 offen lds
  s_add_u32 s45, s50, 23552
  s_mov_b32 m0, s45
  s_add_u32 s46, s51, 3014656
  buffer_load_dwordx4 v15, s[8:11], s46 offen lds
  s_add_u32 s45, s50, 24576
  s_mov_b32 m0, s45
  s_add_u32 s46, s51, 3145728
  buffer_load_dwordx4 v15, s[8:11], s46 offen lds
  s_add_u32 s45, s50, 25600
  s_mov_b32 m0, s45
  s_add_u32 s46, s51, 3276800
  buffer_load_dwordx4 v15, s[8:11], s46 offen lds
  s_add_u32 s45, s50, 26624
  s_mov_b32 m0, s45
  s_add_u32 s46, s51, 3407872
  buffer_load_dwordx4 v15, s[8:11], s46 offen lds
  s_add_u32 s45, s50, 27648
  s_mov_b32 m0, s45
  s_add_u32 s46, s51, 3538944
  buffer_load_dwordx4 v15, s[8:11], s46 offen lds
  s_add_u32 s45, s50, 28672
  s_mov_b32 m0, s45
  s_add_u32 s46, s51, 3670016
  buffer_load_dwordx4 v15, s[8:11], s46 offen lds
  s_add_u32 s45, s50, 29696
  s_mov_b32 m0, s45
  s_add_u32 s46, s51, 3801088
  buffer_load_dwordx4 v15, s[8:11], s46 offen lds
  s_add_u32 s45, s50, 30720
  s_mov_b32 m0, s45
  s_add_u32 s46, s51, 3932160
  buffer_load_dwordx4 v15, s[8:11], s46 offen lds
  s_add_u32 s45, s50, 31744
  s_mov_b32 m0, s45
  s_add_u32 s46, s51, 4063232
  buffer_load_dwordx4 v15, s[8:11], s46 offen lds
  s_waitcnt vmcnt(28)
  ds_read_b64_tr_b16 a[0:1], v8 offset:0
  ds_read_b64_tr_b16 a[2:3], v9 offset:256
  ds_read_b64_tr_b16 a[4:5], v8 offset:2048
  ds_read_b64_tr_b16 a[6:7], v9 offset:2304
  ds_read_b64_tr_b16 a[64:65], v9 offset:0
  ds_read_b64_tr_b16 a[66:67], v8 offset:256
  ds_read_b64_tr_b16 a[68:69], v9 offset:2048
  ds_read_b64_tr_b16 a[70:71], v8 offset:2304
  s_waitcnt lgkmcnt(0)
  s_mov_b32 s8, s28
  s_and_b32 s9, s29, 0xffff
  s_mov_b32 s10, 0x400000
  s_mov_b32 s11, 0x20000
  s_add_u32 s45, s50, 0
  s_mov_b32 m0, s45
  s_add_u32 s46, s51, 0
  buffer_load_dwordx4 v15, s[8:11], s46 offen lds
  s_add_u32 s45, s50, 1024
  s_mov_b32 m0, s45
  s_add_u32 s46, s51, 131072
  buffer_load_dwordx4 v15, s[8:11], s46 offen lds
  s_add_u32 s45, s50, 2048
  s_mov_b32 m0, s45
  s_add_u32 s46, s51, 262144
  buffer_load_dwordx4 v15, s[8:11], s46 offen lds
  s_add_u32 s45, s50, 3072
  s_mov_b32 m0, s45
  s_add_u32 s46, s51, 393216
  buffer_load_dwordx4 v15, s[8:11], s46 offen lds
  s_waitcnt vmcnt(28)
  ds_read_b64_tr_b16 a[8:9], v8 offset:4096
  ds_read_b64_tr_b16 a[10:11], v9 offset:4352
  ds_read_b64_tr_b16 a[12:13], v8 offset:6144
  ds_read_b64_tr_b16 a[14:15], v9 offset:6400
  ds_read_b64_tr_b16 a[72:73], v9 offset:4096
  ds_read_b64_tr_b16 a[74:75], v8 offset:4352
  ds_read_b64_tr_b16 a[76:77], v9 offset:6144
  ds_read_b64_tr_b16 a[78:79], v8 offset:6400
  s_waitcnt lgkmcnt(0)
  s_add_u32 s45, s50, 4096
  s_mov_b32 m0, s45
  s_add_u32 s46, s51, 524288
  buffer_load_dwordx4 v15, s[8:11], s46 offen lds
  s_add_u32 s45, s50, 5120
  s_mov_b32 m0, s45
  s_add_u32 s46, s51, 655360
  buffer_load_dwordx4 v15, s[8:11], s46 offen lds
  s_add_u32 s45, s50, 6144
  s_mov_b32 m0, s45
  s_add_u32 s46, s51, 786432
  buffer_load_dwordx4 v15, s[8:11], s46 offen lds
  s_add_u32 s45, s50, 7168
  s_mov_b32 m0, s45
  s_add_u32 s46, s51, 917504
  buffer_load_dwordx4 v15, s[8:11], s46 offen lds
  s_waitcnt vmcnt(28)
  ds_read_b64_tr_b16 a[16:17], v8 offset:8192
  ds_read_b64_tr_b16 a[18:19], v9 offset:8448
  ds_read_b64_tr_b16 a[20:21], v8 offset:10240
  ds_read_b64_tr_b16 a[22:23], v9 offset:10496
  ds_read_b64_tr_b16 a[80:81], v9 offset:8192
  ds_read_b64_tr_b16 a[82:83], v8 offset:8448
  ds_read_b64_tr_b16 a[84:85], v9 offset:10240
  ds_read_b64_tr_b16 a[86:87], v8 offset:10496
  s_waitcnt lgkmcnt(0)
  s_add_u32 s45, s50, 8192
  s_mov_b32 m0, s45
  s_add_u32 s46, s51, 1048576
  buffer_load_dwordx4 v15, s[8:11], s46 offen lds
  s_add_u32 s45, s50, 9216
  s_mov_b32 m0, s45
  s_add_u32 s46, s51, 1179648
  buffer_load_dwordx4 v15, s[8:11], s46 offen lds
  s_add_u32 s45, s50, 10240
  s_mov_b32 m0, s45
  s_add_u32 s46, s51, 1310720
  buffer_load_dwordx4 v15, s[8:11], s46 offen lds
  s_add_u32 s45, s50, 11264
  s_mov_b32 m0, s45
  s_add_u32 s46, s51, 1441792
  buffer_load_dwordx4 v15, s[8:11], s46 offen lds
  s_waitcnt vmcnt(28)
  ds_read_b64_tr_b16 a[24:25], v8 offset:12288
  ds_read_b64_tr_b16 a[26:27], v9 offset:12544
  ds_read_b64_tr_b16 a[28:29], v8 offset:14336
  ds_read_b64_tr_b16 a[30:31], v9 offset:14592
  ds_read_b64_tr_b16 a[88:89], v9 offset:12288
  ds_read_b64_tr_b16 a[90:91], v8 offset:12544
  ds_read_b64_tr_b16 a[92:93], v9 offset:14336
  ds_read_b64_tr_b16 a[94:95], v8 offset:14592
  s_waitcnt lgkmcnt(0)
  s_add_u32 s45, s50, 12288
  s_mov_b32 m0, s45
  s_add_u32 s46, s51, 1572864
  buffer_load_dwordx4 v15, s[8:11], s46 offen lds
  s_add_u32 s45, s50, 13312
  s_mov_b32 m0, s45
  s_add_u32 s46, s51, 1703936
  buffer_load_dwordx4 v15, s[8:11], s46 offen lds
  s_add_u32 s45, s50, 14336
  s_mov_b32 m0, s45
  s_add_u32 s46, s51, 1835008
  buffer_load_dwordx4 v15, s[8:11], s46 offen lds
  s_add_u32 s45, s50, 15360
  s_mov_b32 m0, s45
  s_add_u32 s46, s51, 1966080
  buffer_load_dwordx4 v15, s[8:11], s46 offen lds
  s_waitcnt vmcnt(28)
  ds_read_b64_tr_b16 a[32:33], v8 offset:16384
  ds_read_b64_tr_b16 a[34:35], v9 offset:16640
  ds_read_b64_tr_b16 a[36:37], v8 offset:18432
  ds_read_b64_tr_b16 a[38:39], v9 offset:18688
  ds_read_b64_tr_b16 a[96:97], v9 offset:16384
  ds_read_b64_tr_b16 a[98:99], v8 offset:16640
  ds_read_b64_tr_b16 a[100:101], v9 offset:18432
  ds_read_b64_tr_b16 a[102:103], v8 offset:18688
  s_waitcnt lgkmcnt(0)
  s_add_u32 s45, s50, 16384
  s_mov_b32 m0, s45
  s_add_u32 s46, s51, 2097152
  buffer_load_dwordx4 v15, s[8:11], s46 offen lds
  s_add_u32 s45, s50, 17408
  s_mov_b32 m0, s45
  s_add_u32 s46, s51, 2228224
  buffer_load_dwordx4 v15, s[8:11], s46 offen lds
  s_add_u32 s45, s50, 18432
  s_mov_b32 m0, s45
  s_add_u32 s46, s51, 2359296
  buffer_load_dwordx4 v15, s[8:11], s46 offen lds
  s_add_u32 s45, s50, 19456
  s_mov_b32 m0, s45
  s_add_u32 s46, s51, 2490368
  buffer_load_dwordx4 v15, s[8:11], s46 offen lds
  s_waitcnt vmcnt(28)
  ds_read_b64_tr_b16 a[40:41], v8 offset:20480
  ds_read_b64_tr_b16 a[42:43], v9 offset:20736
  ds_read_b64_tr_b16 a[44:45], v8 offset:22528
  ds_read_b64_tr_b16 a[46:47], v9 offset:22784
  ds_read_b64_tr_b16 a[104:105], v9 offset:20480
  ds_read_b64_tr_b16 a[106:107], v8 offset:20736
  ds_read_b64_tr_b16 a[108:109], v9 offset:22528
  ds_read_b64_tr_b16 a[110:111], v8 offset:22784
  s_waitcnt lgkmcnt(0)
  s_add_u32 s45, s50, 20480
  s_mov_b32 m0, s45
  s_add_u32 s46, s51, 2621440
  buffer_load_dwordx4 v15, s[8:11], s46 offen lds
  s_add_u32 s45, s50, 21504
  s_mov_b32 m0, s45
  s_add_u32 s46, s51, 2752512
  buffer_load_dwordx4 v15, s[8:11], s46 offen lds
  s_add_u32 s45, s50, 22528
  s_mov_b32 m0, s45
  s_add_u32 s46, s51, 2883584
  buffer_load_dwordx4 v15, s[8:11], s46 offen lds
  s_add_u32 s45, s50, 23552
  s_mov_b32 m0, s45
  s_add_u32 s46, s51, 3014656
  buffer_load_dwordx4 v15, s[8:11], s46 offen lds
  s_waitcnt vmcnt(28)
  ds_read_b64_tr_b16 a[48:49], v8 offset:24576
  ds_read_b64_tr_b16 a[50:51], v9 offset:24832
  ds_read_b64_tr_b16 a[52:53], v8 offset:26624
  ds_read_b64_tr_b16 a[54:55], v9 offset:26880
  ds_read_b64_tr_b16 a[112:113], v9 offset:24576
  ds_read_b64_tr_b16 a[114:115], v8 offset:24832
  ds_read_b64_tr_b16 a[116:117], v9 offset:26624
  ds_read_b64_tr_b16 a[118:119], v8 offset:26880
  s_waitcnt lgkmcnt(0)
  s_add_u32 s45, s50, 24576
  s_mov_b32 m0, s45
  s_add_u32 s46, s51, 3145728
  buffer_load_dwordx4 v15, s[8:11], s46 offen lds
  s_add_u32 s45, s50, 25600
  s_mov_b32 m0, s45
  s_add_u32 s46, s51, 3276800
  buffer_load_dwordx4 v15, s[8:11], s46 offen lds
  s_add_u32 s45, s50, 26624
  s_mov_b32 m0, s45
  s_add_u32 s46, s51, 3407872
  buffer_load_dwordx4 v15, s[8:11], s46 offen lds
  s_add_u32 s45, s50, 27648
  s_mov_b32 m0, s45
  s_add_u32 s46, s51, 3538944
  buffer_load_dwordx4 v15, s[8:11], s46 offen lds
  s_waitcnt vmcnt(28)
  ds_read_b64_tr_b16 a[56:57], v8 offset:28672
  ds_read_b64_tr_b16 a[58:59], v9 offset:28928
  ds_read_b64_tr_b16 a[60:61], v8 offset:30720
  ds_read_b64_tr_b16 a[62:63], v9 offset:30976
  ds_read_b64_tr_b16 a[120:121], v9 offset:28672
  ds_read_b64_tr_b16 a[122:123], v8 offset:28928
  ds_read_b64_tr_b16 a[124:125], v9 offset:30720
  ds_read_b64_tr_b16 a[126:127], v8 offset:30976
  s_waitcnt lgkmcnt(0)
  s_add_u32 s45, s50, 28672
  s_mov_b32 m0, s45
  s_add_u32 s46, s51, 3670016
  buffer_load_dwordx4 v15, s[8:11], s46 offen lds
  s_add_u32 s45, s50, 29696
  s_mov_b32 m0, s45
  s_add_u32 s46, s51, 3801088
  buffer_load_dwordx4 v15, s[8:11], s46 offen lds
  s_add_u32 s45, s50, 30720
  s_mov_b32 m0, s45
  s_add_u32 s46, s51, 3932160
  buffer_load_dwordx4 v15, s[8:11], s46 offen lds
  s_add_u32 s45, s50, 31744
  s_mov_b32 m0, s45
  s_add_u32 s46, s51, 4063232
  buffer_load_dwordx4 v15, s[8:11], s46 offen lds
  s_waitcnt vmcnt(28)
  ds_read_b64_tr_b16 a[128:129], v8 offset:0
  ds_read_b64_tr_b16 a[130:131], v9 offset:256
  ds_read_b64_tr_b16 a[132:133], v8 offset:2048
  ds_read_b64_tr_b16 a[134:135], v9 offset:2304
  ds_read_b64_tr_b16 a[192:193], v9 offset:0
  ds_read_b64_tr_b16 a[194:195], v8 offset:256
  ds_read_b64_tr_b16 a[196:197], v9 offset:2048
  ds_read_b64_tr_b16 a[198:199], v8 offset:2304
  s_waitcnt lgkmcnt(0)
  s_waitcnt vmcnt(24)
  ds_read_b64_tr_b16 a[136:137], v8 offset:4096
  ds_read_b64_tr_b16 a[138:139], v9 offset:4352
  ds_read_b64_tr_b16 a[140:141], v8 offset:6144
  ds_read_b64_tr_b16 a[142:143], v9 offset:6400
  ds_read_b64_tr_b16 a[200:201], v9 offset:4096
  ds_read_b64_tr_b16 a[202:203], v8 offset:4352
  ds_read_b64_tr_b16 a[204:205], v9 offset:6144
  ds_read_b64_tr_b16 a[206:207], v8 offset:6400
  s_waitcnt lgkmcnt(0)
  s_waitcnt vmcnt(20)
  ds_read_b64_tr_b16 a[144:145], v8 offset:8192
  ds_read_b64_tr_b16 a[146:147], v9 offset:8448
  ds_read_b64_tr_b16 a[148:149], v8 offset:10240
  ds_read_b64_tr_b16 a[150:151], v9 offset:10496
  ds_read_b64_tr_b16 a[208:209], v9 offset:8192
  ds_read_b64_tr_b16 a[210:211], v8 offset:8448
  ds_read_b64_tr_b16 a[212:213], v9 offset:10240
  ds_read_b64_tr_b16 a[214:215], v8 offset:10496
  s_waitcnt lgkmcnt(0)
  s_waitcnt vmcnt(16)
  ds_read_b64_tr_b16 a[152:153], v8 offset:12288
  ds_read_b64_tr_b16 a[154:155], v9 offset:12544
  ds_read_b64_tr_b16 a[156:157], v8 offset:14336
  ds_read_b64_tr_b16 a[158:159], v9 offset:14592
  ds_read_b64_tr_b16 a[216:217], v9 offset:12288
  ds_read_b64_tr_b16 a[218:219], v8 offset:12544
  ds_read_b64_tr_b16 a[220:221], v9 offset:14336
  ds_read_b64_tr_b16 a[222:223], v8 offset:14592
  s_waitcnt lgkmcnt(0)
  s_waitcnt vmcnt(12)
  ds_read_b64_tr_b16 a[160:161], v8 offset:16384
  ds_read_b64_tr_b16 a[162:163], v9 offset:16640
  ds_read_b64_tr_b16 a[164:165], v8 offset:18432
  ds_read_b64_tr_b16 a[166:167], v9 offset:18688
  ds_read_b64_tr_b16 a[224:225], v9 offset:16384
  ds_read_b64_tr_b16 a[226:227], v8 offset:16640
  ds_read_b64_tr_b16 a[228:229], v9 offset:18432
  ds_read_b64_tr_b16 a[230:231], v8 offset:18688
  s_waitcnt lgkmcnt(0)
  s_waitcnt vmcnt(8)
  ds_read_b64_tr_b16 a[168:169], v8 offset:20480
  ds_read_b64_tr_b16 a[170:171], v9 offset:20736
  ds_read_b64_tr_b16 a[172:173], v8 offset:22528
  ds_read_b64_tr_b16 a[174:175], v9 offset:22784
  ds_read_b64_tr_b16 a[232:233], v9 offset:20480
  ds_read_b64_tr_b16 a[234:235], v8 offset:20736
  ds_read_b64_tr_b16 a[236:237], v9 offset:22528
  ds_read_b64_tr_b16 a[238:239], v8 offset:22784
  s_waitcnt lgkmcnt(0)
  s_waitcnt vmcnt(4)
  ds_read_b64_tr_b16 a[176:177], v8 offset:24576
  ds_read_b64_tr_b16 a[178:179], v9 offset:24832
  ds_read_b64_tr_b16 a[180:181], v8 offset:26624
  ds_read_b64_tr_b16 a[182:183], v9 offset:26880
  ds_read_b64_tr_b16 a[240:241], v9 offset:24576
  ds_read_b64_tr_b16 a[242:243], v8 offset:24832
  ds_read_b64_tr_b16 a[244:245], v9 offset:26624
  ds_read_b64_tr_b16 a[246:247], v8 offset:26880
  s_waitcnt lgkmcnt(0)
  s_waitcnt vmcnt(0)
  ds_read_b64_tr_b16 a[184:185], v8 offset:28672
  ds_read_b64_tr_b16 a[186:187], v9 offset:28928
  ds_read_b64_tr_b16 a[188:189], v8 offset:30720
  ds_read_b64_tr_b16 a[190:191], v9 offset:30976
  ds_read_b64_tr_b16 a[248:249], v9 offset:28672
  ds_read_b64_tr_b16 a[250:251], v8 offset:28928
  ds_read_b64_tr_b16 a[252:253], v9 offset:30720
  ds_read_b64_tr_b16 a[254:255], v8 offset:30976
  s_waitcnt lgkmcnt(0)
  s_barrier
  s_cmp_eq_u32 s99, 1
  s_cbranch_scc1 L_gs_done_32
  s_cmp_eq_u32 s16, 0
  s_cbranch_scc0 L_gs_w_33
  v_mov_b32 v100, 32
L_gs_p_34:
  s_mov_b64 exec, 1
  global_load_dword v101, v100, s[40:41] sc1
  s_mov_b64 exec, -1
  s_waitcnt vmcnt(0)
  v_readfirstlane_b32 s45, v101
  s_sub_u32 s64, s64, 1
  s_cbranch_scc1 L_abort
  s_cmp_ge_u32 s45, 256
  s_cbranch_scc1 L_gs_q_35
  s_sleep 4
  s_branch L_gs_p_34
L_gs_q_35:
  v_and_b32 v102, 63, v0
  v_lshlrev_b32 v102, 2, v102
  s_mov_b64 exec, 0xff
  global_load_dword v101, v102, s[40:41] sc1
  s_waitcnt vmcnt(0)
  ds_write_b32 v102, v101
  s_mov_b64 exec, -1
  s_waitcnt lgkmcnt(0)
L_gs_w_33:
  s_barrier
  v_mov_b32 v100, 0
  ds_read_b128 v[104:107], v100
  ds_read_b128 v[108:111], v100 offset:16
  s_waitcnt lgkmcnt(0)
  s_mov_b32 s44, 1
  s_mov_b32 s46, 0
  v_readfirstlane_b32 s45, v104
  s_cmp_eq_u32 s45, 32
  s_cselect_b32 s44, s44, 0
  s_cmp_gt_u32 s18, 0
  s_cselect_b32 s45, s45, 0
  s_add_u32 s46, s46, s45
  v_readfirstlane_b32 s45, v105
  s_cmp_eq_u32 s45, 32
  s_cselect_b32 s44, s44, 0
  s_cmp_gt_u32 s18, 1
  s_cselect_b32 s45, s45, 0
  s_add_u32 s46, s46, s45
  v_readfirstlane_b32 s45, v106
  s_cmp_eq_u32 s45, 32
  s_cselect_b32 s44, s44, 0
  s_cmp_gt_u32 s18, 2
  s_cselect_b32 s45, s45, 0
  s_add_u32 s46, s46, s45
  v_readfirstlane_b32 s45, v107
  s_cmp_eq_u32 s45, 32
  s_cselect_b32 s44, s44, 0
  s_cmp_gt_u32 s18, 3
  s_cselect_b32 s45, s45, 0
  s_add_u32 s46, s46, s45
  v_readfirstlane_b32 s45, v108
  s_cmp_eq_u32 s45, 32
  s_cselect_b32 s44, s44, 0
  s_cmp_gt_u32 s18, 4
  s_cselect_b32 s45, s45, 0
  s_add_u32 s46, s46, s45
  v_readfirstlane_b32 s45, v109
  s_cmp_eq_u32 s45, 32
  s_cselect_b32 s44, s44, 0
  s_cmp_gt_u32 s18, 5
  s_cselect_b32 s45, s45, 0
  s_add_u32 s46, s46, s45
  v_readfirstlane_b32 s45, v110
  s_cmp_eq_u32 s45, 32
  s_cselect_b32 s44, s44, 0
  s_cmp_gt_u32 s18, 6
  s_cselect_b32 s45, s45, 0
  s_add_u32 s46, s46, s45
  v_readfirstlane_b32 s45, v111
  s_cmp_eq_u32 s45, 32
  s_cselect_b32 s44, s44, 0
  s_cmp_gt_u32 s18, 7
  s_cselect_b32 s45, s45, 0
  s_add_u32 s46, s46, s45
  s_barrier
  s_mov_b32 s99, 1
  s_cmp_eq_u32 s44, 1
  s_cbranch_scc1 L_gs_done_32
  s_add_u32 s17, s46, s98
  s_branch L_dispatch
L_gs_done_32:
  s_lshl_b32 s71, s16, 10
  v_add_u32 v3, s71, v2
  s_mov_b32 s66, 0x5208000
  s_lshl_b32 s45, s17, 20
  s_add_u32 s67, s45, 0x204000
  s_mov_b32 s68, 0xf800000
  s_lshl_b32 s45, s17, 7
  s_add_u32 s69, s45, 0x1000
  s_mov_b32 s70, 0x128000
  s_mov_b32 s72, 0
  s_mov_b32 s76, 0
  s_cmp_eq_u32 s16, 0
  s_cselect_b32 s74, 1, 0
  s_mov_b32 s75, 0
  s_add_u32 s45, s71, 0
  s_mov_b32 m0, s45
  s_add_u32 s46, s66, 0
  buffer_load_dwordx4 v3, s[4:7], s46 offen sc1 lds
  s_add_u32 s45, s71, 4096
  s_mov_b32 m0, s45
  s_add_u32 s46, s66, 4096
  buffer_load_dwordx4 v3, s[4:7], s46 offen sc1 lds
  s_add_u32 s45, s71, 8192
  s_mov_b32 m0, s45
  s_add_u32 s46, s66, 8192
  buffer_load_dwordx4 v3, s[4:7], s46 offen sc1 lds
  s_add_u32 s45, s71, 12288
  s_mov_b32 m0, s45
  s_add_u32 s46, s66, 12288
  buffer_load_dwordx4 v3, s[4:7], s46 offen sc1 lds
  s_add_u32 s45, s71, 16384
  s_mov_b32 m0, s45
  s_add_u32 s46, s66, 16384
  buffer_load_dwordx4 v3, s[4:7], s46 offen sc1 lds
  s_add_u32 s45, s71, 20480
  s_mov_b32 m0, s45
  s_add_u32 s46, s66, 20480
  buffer_load_dwordx4 v3, s[4:7], s46 offen sc1 lds
  s_add_u32 s45, s71, 24576
  s_mov_b32 m0, s45
  s_add_u32 s46, s66, 24576
  buffer_load_dwordx4 v3, s[4:7], s46 offen sc1 lds
  s_add_u32 s45, s71, 28672
  s_mov_b32 m0, s45
  s_add_u32 s46, s66, 28672
  buffer_load_dwordx4 v3, s[4:7], s46 offen sc1 lds
  s_waitcnt vmcnt(0)
  s_barrier
L_help_36:
  s_add_u32 s66, s66, 65536
  s_xor_b32 s77, s72, 0x8000
  s_add_u32 s77, s77, s71
  v_add_u32 v6, s72, v2
  ds_read_b128 v[12:15], v6 offset:0
  ds_read_b128 v[16:19], v6 offset:1024
  s_waitcnt lgkmcnt(1)
  v_mfma_f32_16x16x32_bf16 v[32:35], a[0:3], v[12:15], 0
  ds_read_b128 v[20:23], v6 offset:2048
  v_mfma_f32_16x16x32_bf16 v[40:43], a[64:67], v[12:15], 0
  v_mfma_f32_16x16x32_bf16 v[48:51], v[12:15], a[128:131], 0
  v_mfma_f32_16x16x32_bf16 v[56:59], v[12:15], a[192:195], 0
  s_waitcnt lgkmcnt(1)
  v_mfma_f32_16x16x32_bf16 v[32:35], a[4:7], v[16:19], v[32:35]
  ds_read_b128 v[12:15], v6 offset:3072
  v_mfma_f32_16x16x32_bf16 v[40:43], a[68:71], v[16:19], v[40:43]
  v_mfma_f32_16x16x32_bf16 v[48:51], v[16:19], a[132:135], v[48:51]
  v_mfma_f32_16x16x32_bf16 v[56:59], v[16:19], a[196:199], v[56:59]
  s_waitcnt lgkmcnt(1)
  v_mfma_f32_16x16x32_bf16 v[32:35], a[8:11], v[20:23], v[32:35]
  ds_read_b128 v[16:19], v6 offset:4096
  v_cvt_pk_bf16_f32 v96, v64, v65
  v_mfma_f32_16x16x32_bf16 v[40:43], a[72:75], v[20:23], v[40:43]
  v_cvt_pk_bf16_f32 v97, v66, v67
  v_cvt_pk_bf16_f32 v98, v72, v73
  v_mfma_f32_16x16x32_bf16 v[48:51], v[20:23], a[136:139], v[48:51]
  v_cvt_pk_bf16_f32 v99, v74, v75
  v_mfma_f32_16x16x32_bf16 v[56:59], v[20:23], a[200:203], v[56:59]
  s_waitcnt lgkmcnt(1)
  v_mfma_f32_16x16x32_bf16 v[32:35], a[12:15], v[12:15], v[32:35]
  ds_read_b128 v[20:23], v6 offset:5120
  s_add_u32 s45, s68, 0
  v_mfma_f32_16x16x32_bf16 v[40:43], a[76:79], v[12:15], v[40:43]
  buffer_store_dwordx4 v[96:99], v3, s[4:7], s45 offen sc1
  v_cvt_pk_bf16_f32 v100, v68, v69
  v_mfma_f32_16x16x32_bf16 v[48:51], v[12:15], a[140:143], v[48:51]
  v_cvt_pk_bf16_f32 v101, v70, v71
  v_mfma_f32_16x16x32_bf16 v[56:59], v[12:15], a[204:207], v[56:59]
  s_waitcnt lgkmcnt(1)
  v_mfma_f32_16x16x32_bf16 v[32:35], a[16:19], v[16:19], v[32:35]
  ds_read_b128 v[12:15], v6 offset:6144
  v_cvt_pk_bf16_f32 v102, v76, v77
  v_mfma_f32_16x16x32_bf16 v[40:43], a[80:83], v[16:19], v[40:43]
  v_cvt_pk_bf16_f32 v103, v78, v79
  s_add_u32 s45, s68, 4096
  v_mfma_f32_16x16x32_bf16 v[48:51], v[16:19], a[144:147], v[48:51]
  buffer_store_dwordx4 v[100:103], v3, s[4:7], s45 offen sc1
  v_mfma_f32_16x16x32_bf16 v[56:59], v[16:19], a[208:211], v[56:59]
  s_waitcnt lgkmcnt(1)
  v_mfma_f32_16x16x32_bf16 v[32:35], a[20:23], v[20:23], v[32:35]
  ds_read_b128 v[16:19], v6 offset:7168
  v_cvt_pk_bf16_f32 v104, v80, v81
  v_mfma_f32_16x16x32_bf16 v[40:43], a[84:87], v[20:23], v[40:43]
  v_cvt_pk_bf16_f32 v105, v82, v83
  v_cvt_pk_bf16_f32 v106, v84, v85
  v_mfma_f32_16x16x32_bf16 v[48:51], v[20:23], a[148:151], v[48:51]
  v_cvt_pk_bf16_f32 v107, v86, v87
  v_mfma_f32_16x16x32_bf16 v[56:59], v[20:23], a[212:215], v[56:59]
  s_waitcnt lgkmcnt(1)
  v_mfma_f32_16x16x32_bf16 v[32:35], a[24:27], v[12:15], v[32:35]
  ds_read_b128 v[20:23], v6 offset:8192
  s_add_u32 s45, s71, s68
  v_mfma_f32_16x16x32_bf16 v[40:43], a[88:91], v[12:15], v[40:43]
  s_add_u32 s45, s45, 8192
  buffer_store_dwordx4 v[104:107], v3, s[4:7], s45 offen sc1
  v_mfma_f32_16x16x32_bf16 v[48:51], v[12:15], a[152:155], v[48:51]
  v_cvt_pk_bf16_f32 v108, v88, v89
  v_mfma_f32_16x16x32_bf16 v[56:59], v[12:15], a[216:219], v[56:59]
  s_waitcnt lgkmcnt(1)
  v_mfma_f32_16x16x32_bf16 v[32:35], a[28:31], v[16:19], v[32:35]
  ds_read_b128 v[12:15], v6 offset:9216
  v_cvt_pk_bf16_f32 v109, v90, v91
  v_mfma_f32_16x16x32_bf16 v[40:43], a[92:95], v[16:19], v[40:43]
  v_cvt_pk_bf16_f32 v110, v92, v93
  v_cvt_pk_bf16_f32 v111, v94, v95
  v_mfma_f32_16x16x32_bf16 v[48:51], v[16:19], a[156:159], v[48:51]
  s_add_u32 s45, s71, s68
  v_mfma_f32_16x16x32_bf16 v[56:59], v[16:19], a[220:223], v[56:59]
  s_waitcnt lgkmcnt(1)
  v_mfma_f32_16x16x32_bf16 v[32:35], a[32:35], v[20:23], v[32:35]
  ds_read_b128 v[16:19], v6 offset:10240
  s_add_u32 s45, s45, 9216
  v_mfma_f32_16x16x32_bf16 v[40:43], a[96:99], v[20:23], v[40:43]
  buffer_store_dwordx4 v[108:111], v3, s[4:7], s45 offen sc1
  v_mfma_f32_16x16x32_bf16 v[48:51], v[20:23], a[160:163], v[48:51]
  v_mfma_f32_16x16x32_bf16 v[56:59], v[20:23], a[224:227], v[56:59]
  s_waitcnt lgkmcnt(1)
  v_mfma_f32_16x16x32_bf16 v[32:35], a[36:39], v[12:15], v[32:35]
  ds_read_b128 v[20:23], v6 offset:11264
  v_mfma_f32_16x16x32_bf16 v[40:43], a[100:103], v[12:15], v[40:43]
  v_mfma_f32_16x16x32_bf16 v[48:51], v[12:15], a[164:167], v[48:51]
  v_mfma_f32_16x16x32_bf16 v[56:59], v[12:15], a[228:231], v[56:59]
  s_waitcnt lgkmcnt(1)
  v_mfma_f32_16x16x32_bf16 v[32:35], a[40:43], v[16:19], v[32:35]
  ds_read_b128 v[12:15], v6 offset:12288
  s_add_u32 s47, s77, 0
  v_mfma_f32_16x16x32_bf16 v[40:43], a[104:107], v[16:19], v[40:43]
  s_mov_b32 m0, s47
  s_add_u32 s48, s66, 0
  v_mfma_f32_16x16x32_bf16 v[48:51], v[16:19], a[168:171], v[48:51]
  buffer_load_dwordx4 v3, s[4:7], s48 offen sc1 lds
  v_mfma_f32_16x16x32_bf16 v[56:59], v[16:19], a[232:235], v[56:59]
  s_waitcnt lgkmcnt(1)
  v_mfma_f32_16x16x32_bf16 v[32:35], a[44:47], v[20:23], v[32:35]
  ds_read_b128 v[16:19], v6 offset:13312
  s_add_u32 s47, s77, 4096
  v_mfma_f32_16x16x32_bf16 v[40:43], a[108:111], v[20:23], v[40:43]
  s_mov_b32 m0, s47
  s_add_u32 s48, s66, 4096
  v_mfma_f32_16x16x32_bf16 v[48:51], v[20:23], a[172:175], v[48:51]
  buffer_load_dwordx4 v3, s[4:7], s48 offen sc1 lds
  v_mfma_f32_16x16x32_bf16 v[56:59], v[20:23], a[236:239], v[56:59]
  s_waitcnt lgkmcnt(1)
  v_mfma_f32_16x16x32_bf16 v[32:35], a[48:51], v[12:15], v[32:35]
  ds_read_b128 v[20:23], v6 offset:14336
  s_add_u32 s47, s77, 8192
  v_mfma_f32_16x16x32_bf16 v[40:43], a[112:115], v[12:15], v[40:43]
  s_mov_b32 m0, s47
  s_add_u32 s48, s66, 8192
  v_mfma_f32_16x16x32_bf16 v[48:51], v[12:15], a[176:179], v[48:51]
  buffer_load_dwordx4 v3, s[4:7], s48 offen sc1 lds
  v_mfma_f32_16x16x32_bf16 v[56:59], v[12:15], a[240:243], v[56:59]
  s_waitcnt lgkmcnt(1)
  v_mfma_f32_16x16x32_bf16 v[32:35], a[52:55], v[16:19], v[32:35]
  ds_read_b128 v[12:15], v6 offset:15360
  s_add_u32 s47, s77, 12288
  v_mfma_f32_16x16x32_bf16 v[40:43], a[116:119], v[16:19], v[40:43]
  s_mov_b32 m0, s47
  s_add_u32 s48, s66, 12288
  v_mfma_f32_16x16x32_bf16 v[48:51], v[16:19], a[180:183], v[48:51]
  buffer_load_dwordx4 v3, s[4:7], s48 offen sc1 lds
  v_mfma_f32_16x16x32_bf16 v[56:59], v[16:19], a[244:247], v[56:59]
  s_waitcnt lgkmcnt(1)
  v_mfma_f32_16x16x32_bf16 v[32:35], a[56:59], v[20:23], v[32:35]
  ds_read_b128 v[16:19], v6 offset:16384
  s_add_u32 s47, s77, 16384
  v_mfma_f32_16x16x32_bf16 v[40:43], a[120:123], v[20:23], v[40:43]
  s_mov_b32 m0, s47
  s_add_u32 s48, s66, 16384
  v_mfma_f32_16x16x32_bf16 v[48:51], v[20:23], a[184:187], v[48:51]
  buffer_load_dwordx4 v3, s[4:7], s48 offen sc1 lds
  v_mfma_f32_16x16x32_bf16 v[56:59], v[20:23], a[248:251], v[56:59]
  s_waitcnt lgkmcnt(1)
  v_mfma_f32_16x16x32_bf16 v[32:35], a[60:63], v[12:15], v[32:35]
  ds_read_b128 v[20:23], v6 offset:17408
  s_add_u32 s47, s77, 20480
  v_mfma_f32_16x16x32_bf16 v[40:43], a[124:127], v[12:15], v[40:43]
  s_mov_b32 m0, s47
  s_add_u32 s48, s66, 20480
  v_mfma_f32_16x16x32_bf16 v[48:51], v[12:15], a[188:191], v[48:51]
  buffer_load_dwordx4 v3, s[4:7], s48 offen sc1 lds
  v_mfma_f32_16x16x32_bf16 v[56:59], v[12:15], a[252:255], v[56:59]
  s_waitcnt lgkmcnt(1)
  v_mfma_f32_16x16x32_bf16 v[36:39], a[0:3], v[16:19], 0
  ds_read_b128 v[12:15], v6 offset:18432
  s_add_u32 s47, s77, 24576
  v_mfma_f32_16x16x32_bf16 v[44:47], a[64:67], v[16:19], 0
  s_mov_b32 m0, s47
  s_add_u32 s48, s66, 24576
  v_mfma_f32_16x16x32_bf16 v[52:55], v[16:19], a[128:131], 0
  buffer_load_dwordx4 v3, s[4:7], s48 offen sc1 lds
  v_mfma_f32_16x16x32_bf16 v[60:63], v[16:19], a[192:195], 0
  s_waitcnt lgkmcnt(1)
  v_mfma_f32_16x16x32_bf16 v[36:39], a[4:7], v[20:23], v[36:39]
  ds_read_b128 v[16:19], v6 offset:19456
  s_add_u32 s47, s77, 28672
  v_mfma_f32_16x16x32_bf16 v[44:47], a[68:71], v[20:23], v[44:47]
  s_mov_b32 m0, s47
  s_add_u32 s48, s66, 28672
  v_mfma_f32_16x16x32_bf16 v[52:55], v[20:23], a[132:135], v[52:55]
  buffer_load_dwordx4 v3, s[4:7], s48 offen sc1 lds
  v_mfma_f32_16x16x32_bf16 v[60:63], v[20:23], a[196:199], v[60:63]
  s_waitcnt lgkmcnt(1)
  v_mfma_f32_16x16x32_bf16 v[36:39], a[8:11], v[12:15], v[36:39]
  ds_read_b128 v[20:23], v6 offset:20480
  v_mfma_f32_16x16x32_bf16 v[44:47], a[72:75], v[12:15], v[44:47]
  v_mfma_f32_16x16x32_bf16 v[52:55], v[12:15], a[136:139], v[52:55]
  v_mfma_f32_16x16x32_bf16 v[60:63], v[12:15], a[200:203], v[60:63]
  s_waitcnt lgkmcnt(1)
  v_mfma_f32_16x16x32_bf16 v[36:39], a[12:15], v[16:19], v[36:39]
  ds_read_b128 v[12:15], v6 offset:21504
  v_mfma_f32_16x16x32_bf16 v[44:47], a[76:79], v[16:19], v[44:47]
  v_mfma_f32_16x16x32_bf16 v[52:55], v[16:19], a[140:143], v[52:55]
  v_mfma_f32_16x16x32_bf16 v[60:63], v[16:19], a[204:207], v[60:63]
  s_waitcnt lgkmcnt(1)
  v_mfma_f32_16x16x32_bf16 v[36:39], a[16:19], v[20:23], v[36:39]
  ds_read_b128 v[16:19], v6 offset:22528
  v_mfma_f32_16x16x32_bf16 v[44:47], a[80:83], v[20:23], v[44:47]
  v_mfma_f32_16x16x32_bf16 v[52:55], v[20:23], a[144:147], v[52:55]
  v_mfma_f32_16x16x32_bf16 v[60:63], v[20:23], a[208:211], v[60:63]
  s_waitcnt lgkmcnt(1)
  v_mfma_f32_16x16x32_bf16 v[36:39], a[20:23], v[12:15], v[36:39]
  ds_read_b128 v[20:23], v6 offset:23552
  v_mfma_f32_16x16x32_bf16 v[44:47], a[84:87], v[12:15], v[44:47]
  v_mfma_f32_16x16x32_bf16 v[52:55], v[12:15], a[148:151], v[52:55]
  v_mfma_f32_16x16x32_bf16 v[60:63], v[12:15], a[212:215], v[60:63]
  s_waitcnt lgkmcnt(1)
  v_mfma_f32_16x16x32_bf16 v[36:39], a[24:27], v[16:19], v[36:39]
  ds_read_b128 v[12:15], v6 offset:24576
  v_mfma_f32_16x16x32_bf16 v[44:47], a[88:91], v[16:19], v[44:47]
  v_mfma_f32_16x16x32_bf16 v[52:55], v[16:19], a[152:155], v[52:55]
  v_mfma_f32_16x16x32_bf16 v[60:63], v[16:19], a[216:219], v[60:63]
  s_waitcnt lgkmcnt(1)
  v_mfma_f32_16x16x32_bf16 v[36:39], a[28:31], v[20:23], v[36:39]
  ds_read_b128 v[16:19], v6 offset:25600
  v_mfma_f32_16x16x32_bf16 v[44:47], a[92:95], v[20:23], v[44:47]
  v_mfma_f32_16x16x32_bf16 v[52:55], v[20:23], a[156:159], v[52:55]
  v_mfma_f32_16x16x32_bf16 v[60:63], v[20:23], a[220:223], v[60:63]
  s_waitcnt lgkmcnt(1)
  v_mfma_f32_16x16x32_bf16 v[36:39], a[32:35], v[12:15], v[36:39]
  ds_read_b128 v[20:23], v6 offset:26624
  v_mfma_f32_16x16x32_bf16 v[44:47], a[96:99], v[12:15], v[44:47]
  v_mfma_f32_16x16x32_bf16 v[52:55], v[12:15], a[160:163], v[52:55]
  v_mfma_f32_16x16x32_bf16 v[60:63], v[12:15], a[224:227], v[60:63]
  s_waitcnt lgkmcnt(1)
  v_mfma_f32_16x16x32_bf16 v[36:39], a[36:39], v[16:19], v[36:39]
  ds_read_b128 v[12:15], v6 offset:27648
  v_mfma_f32_16x16x32_bf16 v[44:47], a[100:103], v[16:19], v[44:47]
  v_mfma_f32_16x16x32_bf16 v[52:55], v[16:19], a[164:167], v[52:55]
  v_mfma_f32_16x16x32_bf16 v[60:63], v[16:19], a[228:231], v[60:63]
  s_waitcnt vmcnt(8)
  s_barrier
  v_mov_b32 v4, s70
  v_mov_b32 v5, 4
  s_mov_b64 exec, s[74:75]
  buffer_store_dword v5, v4, s[4:7], 0 offen sc1
  s_mov_b64 exec, -1
  s_waitcnt lgkmcnt(1)
  v_mfma_f32_16x16x32_bf16 v[36:39], a[40:43], v[20:23], v[36:39]
  ds_read_b128 v[16:19], v6 offset:28672
  v_mfma_f32_16x16x32_bf16 v[44:47], a[104:107], v[20:23], v[44:47]
  v_mfma_f32_16x16x32_bf16 v[52:55], v[20:23], a[168:171], v[52:55]
  v_mfma_f32_16x16x32_bf16 v[60:63], v[20:23], a[232:235], v[60:63]
  s_waitcnt lgkmcnt(1)
  v_mfma_f32_16x16x32_bf16 v[36:39], a[44:47], v[12:15], v[36:39]
  ds_read_b128 v[20:23], v6 offset:29696
  v_mfma_f32_16x16x32_bf16 v[44:47], a[108:111], v[12:15], v[44:47]
  v_mfma_f32_16x16x32_bf16 v[52:55], v[12:15], a[172:175], v[52:55]
  v_mfma_f32_16x16x32_bf16 v[60:63], v[12:15], a[236:239], v[60:63]
  s_waitcnt lgkmcnt(1)
  v_mfma_f32_16x16x32_bf16 v[36:39], a[48:51], v[16:19], v[36:39]
  ds_read_b128 v[12:15], v6 offset:30720
  v_mfma_f32_16x16x32_bf16 v[44:47], a[112:115], v[16:19], v[44:47]
  v_mfma_f32_16x16x32_bf16 v[52:55], v[16:19], a[176:179], v[52:55]
  v_mfma_f32_16x16x32_bf16 v[60:63], v[16:19], a[240:243], v[60:63]
  s_waitcnt lgkmcnt(1)
  v_mfma_f32_16x16x32_bf16 v[36:39], a[52:55], v[20:23], v[36:39]
  ds_read_b128 v[16:19], v6 offset:31744
  v_mfma_f32_16x16x32_bf16 v[44:47], a[116:119], v[20:23], v[44:47]
  v_mfma_f32_16x16x32_bf16 v[52:55], v[20:23], a[180:183], v[52:55]
  v_mfma_f32_16x16x32_bf16 v[60:63], v[20:23], a[244:247], v[60:63]
  s_waitcnt lgkmcnt(1)
  v_mfma_f32_16x16x32_bf16 v[36:39], a[56:59], v[12:15], v[36:39]
  v_mfma_f32_16x16x32_bf16 v[44:47], a[120:123], v[12:15], v[44:47]
  v_mfma_f32_16x16x32_bf16 v[52:55], v[12:15], a[184:187], v[52:55]
  v_mfma_f32_16x16x32_bf16 v[60:63], v[12:15], a[248:251], v[60:63]
  s_waitcnt lgkmcnt(0)
  v_mfma_f32_16x16x32_bf16 v[36:39], a[60:63], v[16:19], v[36:39]
  v_mfma_f32_16x16x32_bf16 v[44:47], a[124:127], v[16:19], v[44:47]
  v_mfma_f32_16x16x32_bf16 v[52:55], v[16:19], a[188:191], v[52:55]
  v_mfma_f32_16x16x32_bf16 v[60:63], v[16:19], a[252:255], v[60:63]
  s_waitcnt vmcnt(1)
  s_barrier
  s_mov_b32 s68, s67
  s_mov_b32 s70, s69
  s_add_u32 s69, s69, 8192
  s_add_u32 s67, s67, 32768
  s_xor_b32 s72, s72, 0x8000
  s_add_u32 s66, s66, 65536
  s_xor_b32 s77, s72, 0x8000
  s_add_u32 s77, s77, s71
  v_add_u32 v6, s72, v2
  ds_read_b128 v[12:15], v6 offset:0
  ds_read_b128 v[16:19], v6 offset:1024
  s_waitcnt lgkmcnt(1)
  v_mfma_f32_16x16x32_bf16 v[64:67], a[0:3], v[12:15], 0
  ds_read_b128 v[20:23], v6 offset:2048
  v_mfma_f32_16x16x32_bf16 v[72:75], a[64:67], v[12:15], 0
  v_mfma_f32_16x16x32_bf16 v[80:83], v[12:15], a[128:131], 0
  v_mfma_f32_16x16x32_bf16 v[88:91], v[12:15], a[192:195], 0
  s_waitcnt lgkmcnt(1)
  v_mfma_f32_16x16x32_bf16 v[64:67], a[4:7], v[16:19], v[64:67]
  ds_read_b128 v[12:15], v6 offset:3072
  v_mfma_f32_16x16x32_bf16 v[72:75], a[68:71], v[16:19], v[72:75]
  v_mfma_f32_16x16x32_bf16 v[80:83], v[16:19], a[132:135], v[80:83]
  v_mfma_f32_16x16x32_bf16 v[88:91], v[16:19], a[196:199], v[88:91]
  s_waitcnt lgkmcnt(1)
  v_mfma_f32_16x16x32_bf16 v[64:67], a[8:11], v[20:23], v[64:67]
  ds_read_b128 v[16:19], v6 offset:4096
  v_cvt_pk_bf16_f32 v96, v32, v33
  v_mfma_f32_16x16x32_bf16 v[72:75], a[72:75], v[20:23], v[72:75]
  v_cvt_pk_bf16_f32 v97, v34, v35
  v_cvt_pk_bf16_f32 v98, v40, v41
  v_mfma_f32_16x16x32_bf16 v[80:83], v[20:23], a[136:139], v[80:83]
  v_cvt_pk_bf16_f32 v99, v42, v43
  v_mfma_f32_16x16x32_bf16 v[88:91], v[20:23], a[200:203], v[88:91]
  s_waitcnt lgkmcnt(1)
  v_mfma_f32_16x16x32_bf16 v[64:67], a[12:15], v[12:15], v[64:67]
  ds_read_b128 v[20:23], v6 offset:5120
  s_add_u32 s45, s68, 0
  v_mfma_f32_16x16x32_bf16 v[72:75], a[76:79], v[12:15], v[72:75]
  buffer_store_dwordx4 v[96:99], v3, s[4:7], s45 offen sc1
  v_cvt_pk_bf16_f32 v100, v36, v37
  v_mfma_f32_16x16x32_bf16 v[80:83], v[12:15], a[140:143], v[80:83]
  v_cvt_pk_bf16_f32 v101, v38, v39
  v_mfma_f32_16x16x32_bf16 v[88:91], v[12:15], a[204:207], v[88:91]
  s_waitcnt lgkmcnt(1)
  v_mfma_f32_16x16x32_bf16 v[64:67], a[16:19], v[16:19], v[64:67]
  ds_read_b128 v[12:15], v6 offset:6144
  v_cvt_pk_bf16_f32 v102, v44, v45
  v_mfma_f32_16x16x32_bf16 v[72:75], a[80:83], v[16:19], v[72:75]
  v_cvt_pk_bf16_f32 v103, v46, v47
  s_add_u32 s45, s68, 4096
  v_mfma_f32_16x16x32_bf16 v[80:83], v[16:19], a[144:147], v[80:83]
  buffer_store_dwordx4 v[100:103], v3, s[4:7], s45 offen sc1
  v_mfma_f32_16x16x32_bf16 v[88:91], v[16:19], a[208:211], v[88:91]
  s_waitcnt lgkmcnt(1)
  v_mfma_f32_16x16x32_bf16 v[64:67], a[20:23], v[20:23], v[64:67]
  ds_read_b128 v[16:19], v6 offset:7168
  v_cvt_pk_bf16_f32 v104, v48, v49
  v_mfma_f32_16x16x32_bf16 v[72:75], a[84:87], v[20:23], v[72:75]
  v_cvt_pk_bf16_f32 v105, v50, v51
  v_cvt_pk_bf16_f32 v106, v52, v53
  v_mfma_f32_16x16x32_bf16 v[80:83], v[20:23], a[148:151], v[80:83]
  v_cvt_pk_bf16_f32 v107, v54, v55
  v_mfma_f32_16x16x32_bf16 v[88:91], v[20:23], a[212:215], v[88:91]
  s_waitcnt lgkmcnt(1)
  v_mfma_f32_16x16x32_bf16 v[64:67], a[24:27], v[12:15], v[64:67]
  ds_read_b128 v[20:23], v6 offset:8192
  s_add_u32 s45, s71, s68
  v_mfma_f32_16x16x32_bf16 v[72:75], a[88:91], v[12:15], v[72:75]
  s_add_u32 s45, s45, 8192
  buffer_store_dwordx4 v[104:107], v3, s[4:7], s45 offen sc1
  v_mfma_f32_16x16x32_bf16 v[80:83], v[12:15], a[152:155], v[80:83]
  v_cvt_pk_bf16_f32 v108, v56, v57
  v_mfma_f32_16x16x32_bf16 v[88:91], v[12:15], a[216:219], v[88:91]
  s_waitcnt lgkmcnt(1)
  v_mfma_f32_16x16x32_bf16 v[64:67], a[28:31], v[16:19], v[64:67]
  ds_read_b128 v[12:15], v6 offset:9216
  v_cvt_pk_bf16_f32 v109, v58, v59
  v_mfma_f32_16x16x32_bf16 v[72:75], a[92:95], v[16:19], v[72:75]
  v_cvt_pk_bf16_f32 v110, v60, v61
  v_cvt_pk_bf16_f32 v111, v62, v63
  v_mfma_f32_16x16x32_bf16 v[80:83], v[16:19], a[156:159], v[80:83]
  s_add_u32 s45, s71, s68
  v_mfma_f32_16x16x32_bf16 v[88:91], v[16:19], a[220:223], v[88:91]
  s_waitcnt lgkmcnt(1)
  v_mfma_f32_16x16x32_bf16 v[64:67], a[32:35], v[20:23], v[64:67]
  ds_read_b128 v[16:19], v6 offset:10240
  s_add_u32 s45, s45, 9216
  v_mfma_f32_16x16x32_bf16 v[72:75], a[96:99], v[20:23], v[72:75]
  buffer_store_dwordx4 v[108:111], v3, s[4:7], s45 offen sc1
  v_mfma_f32_16x16x32_bf16 v[80:83], v[20:23], a[160:163], v[80:83]
  v_mfma_f32_16x16x32_bf16 v[88:91], v[20:23], a[224:227], v[88:91]
  s_waitcnt lgkmcnt(1)
  v_mfma_f32_16x16x32_bf16 v[64:67], a[36:39], v[12:15], v[64:67]
  ds_read_b128 v[20:23], v6 offset:11264
  v_mfma_f32_16x16x32_bf16 v[72:75], a[100:103], v[12:15], v[72:75]
  v_mfma_f32_16x16x32_bf16 v[80:83], v[12:15], a[164:167], v[80:83]
  v_mfma_f32_16x16x32_bf16 v[88:91], v[12:15], a[228:231], v[88:91]
  s_waitcnt lgkmcnt(1)
  v_mfma_f32_16x16x32_bf16 v[64:67], a[40:43], v[16:19], v[64:67]
  ds_read_b128 v[12:15], v6 offset:12288
  s_add_u32 s47, s77, 0
  v_mfma_f32_16x16x32_bf16 v[72:75], a[104:107], v[16:19], v[72:75]
  s_mov_b32 m0, s47
  s_add_u32 s48, s66, 0
  v_mfma_f32_16x16x32_bf16 v[80:83], v[16:19], a[168:171], v[80:83]
  buffer_load_dwordx4 v3, s[4:7], s48 offen sc1 lds
  v_mfma_f32_16x16x32_bf16 v[88:91], v[16:19], a[232:235], v[88:91]
  s_waitcnt lgkmcnt(1)
  v_mfma_f32_16x16x32_bf16 v[64:67], a[44:47], v[20:23], v[64:67]
  ds_read_b128 v[16:19], v6 offset:13312
  s_add_u32 s47, s77, 4096
  v_mfma_f32_16x16x32_bf16 v[72:75], a[108:111], v[20:23], v[72:75]
  s_mov_b32 m0, s47
  s_add_u32 s48, s66, 4096
  v_mfma_f32_16x16x32_bf16 v[80:83], v[20:23], a[172:175], v[80:83]
  buffer_load_dwordx4 v3, s[4:7], s48 offen sc1 lds
  v_mfma_f32_16x16x32_bf16 v[88:91], v[20:23], a[236:239], v[88:91]
  s_waitcnt lgkmcnt(1)
  v_mfma_f32_16x16x32_bf16 v[64:67], a[48:51], v[12:15], v[64:67]
  ds_read_b128 v[20:23], v6 offset:14336
  s_add_u32 s47, s77, 8192
  v_mfma_f32_16x16x32_bf16 v[72:75], a[112:115], v[12:15], v[72:75]
  s_mov_b32 m0, s47
  s_add_u32 s48, s66, 8192
  v_mfma_f32_16x16x32_bf16 v[80:83], v[12:15], a[176:179], v[80:83]
  buffer_load_dwordx4 v3, s[4:7], s48 offen sc1 lds
  v_mfma_f32_16x16x32_bf16 v[88:91], v[12:15], a[240:243], v[88:91]
  s_waitcnt lgkmcnt(1)
  v_mfma_f32_16x16x32_bf16 v[64:67], a[52:55], v[16:19], v[64:67]
  ds_read_b128 v[12:15], v6 offset:15360
  s_add_u32 s47, s77, 12288
  v_mfma_f32_16x16x32_bf16 v[72:75], a[116:119], v[16:19], v[72:75]
  s_mov_b32 m0, s47
  s_add_u32 s48, s66, 12288
  v_mfma_f32_16x16x32_bf16 v[80:83], v[16:19], a[180:183], v[80:83]
  buffer_load_dwordx4 v3, s[4:7], s48 offen sc1 lds
  v_mfma_f32_16x16x32_bf16 v[88:91], v[16:19], a[244:247], v[88:91]
  s_waitcnt lgkmcnt(1)
  v_mfma_f32_16x16x32_bf16 v[64:67], a[56:59], v[20:23], v[64:67]
  ds_read_b128 v[16:19], v6 offset:16384
  s_add_u32 s47, s77, 16384
  v_mfma_f32_16x16x32_bf16 v[72:75], a[120:123], v[20:23], v[72:75]
  s_mov_b32 m0, s47
  s_add_u32 s48, s66, 16384
  v_mfma_f32_16x16x32_bf16 v[80:83], v[20:23], a[184:187], v[80:83]
  buffer_load_dwordx4 v3, s[4:7], s48 offen sc1 lds
  v_mfma_f32_16x16x32_bf16 v[88:91], v[20:23], a[248:251], v[88:91]
  s_waitcnt lgkmcnt(1)
  v_mfma_f32_16x16x32_bf16 v[64:67], a[60:63], v[12:15], v[64:67]
  ds_read_b128 v[20:23], v6 offset:17408
  s_add_u32 s47, s77, 20480
  v_mfma_f32_16x16x32_bf16 v[72:75], a[124:127], v[12:15], v[72:75]
  s_mov_b32 m0, s47
  s_add_u32 s48, s66, 20480
  v_mfma_f32_16x16x32_bf16 v[80:83], v[12:15], a[188:191], v[80:83]
  buffer_load_dwordx4 v3, s[4:7], s48 offen sc1 lds
  v_mfma_f32_16x16x32_bf16 v[88:91], v[12:15], a[252:255], v[88:91]
  s_waitcnt lgkmcnt(1)
  v_mfma_f32_16x16x32_bf16 v[68:71], a[0:3], v[16:19], 0
  ds_read_b128 v[12:15], v6 offset:18432
  s_add_u32 s47, s77, 24576
  v_mfma_f32_16x16x32_bf16 v[76:79], a[64:67], v[16:19], 0
  s_mov_b32 m0, s47
  s_add_u32 s48, s66, 24576
  v_mfma_f32_16x16x32_bf16 v[84:87], v[16:19], a[128:131], 0
  buffer_load_dwordx4 v3, s[4:7], s48 offen sc1 lds
  v_mfma_f32_16x16x32_bf16 v[92:95], v[16:19], a[192:195], 0
  s_waitcnt lgkmcnt(1)
  v_mfma_f32_16x16x32_bf16 v[68:71], a[4:7], v[20:23], v[68:71]
  ds_read_b128 v[16:19], v6 offset:19456
  s_add_u32 s47, s77, 28672
  v_mfma_f32_16x16x32_bf16 v[76:79], a[68:71], v[20:23], v[76:79]
  s_mov_b32 m0, s47
  s_add_u32 s48, s66, 28672
  v_mfma_f32_16x16x32_bf16 v[84:87], v[20:23], a[132:135], v[84:87]
  buffer_load_dwordx4 v3, s[4:7], s48 offen sc1 lds
  v_mfma_f32_16x16x32_bf16 v[92:95], v[20:23], a[196:199], v[92:95]
  s_waitcnt lgkmcnt(1)
  v_mfma_f32_16x16x32_bf16 v[68:71], a[8:11], v[12:15], v[68:71]
  ds_read_b128 v[20:23], v6 offset:20480
  v_mfma_f32_16x16x32_bf16 v[76:79], a[72:75], v[12:15], v[76:79]
  v_mfma_f32_16x16x32_bf16 v[84:87], v[12:15], a[136:139], v[84:87]
  v_mfma_f32_16x16x32_bf16 v[92:95], v[12:15], a[200:203], v[92:95]
  s_waitcnt lgkmcnt(1)
  v_mfma_f32_16x16x32_bf16 v[68:71], a[12:15], v[16:19], v[68:71]
  ds_read_b128 v[12:15], v6 offset:21504
  v_mfma_f32_16x16x32_bf16 v[76:79], a[76:79], v[16:19], v[76:79]
  v_mfma_f32_16x16x32_bf16 v[84:87], v[16:19], a[140:143], v[84:87]
  v_mfma_f32_16x16x32_bf16 v[92:95], v[16:19], a[204:207], v[92:95]
  s_waitcnt lgkmcnt(1)
  v_mfma_f32_16x16x32_bf16 v[68:71], a[16:19], v[20:23], v[68:71]
  ds_read_b128 v[16:19], v6 offset:22528
  v_mfma_f32_16x16x32_bf16 v[76:79], a[80:83], v[20:23], v[76:79]
  v_mfma_f32_16x16x32_bf16 v[84:87], v[20:23], a[144:147], v[84:87]
  v_mfma_f32_16x16x32_bf16 v[92:95], v[20:23], a[208:211], v[92:95]
  s_waitcnt lgkmcnt(1)
  v_mfma_f32_16x16x32_bf16 v[68:71], a[20:23], v[12:15], v[68:71]
  ds_read_b128 v[20:23], v6 offset:23552
  v_mfma_f32_16x16x32_bf16 v[76:79], a[84:87], v[12:15], v[76:79]
  v_mfma_f32_16x16x32_bf16 v[84:87], v[12:15], a[148:151], v[84:87]
  v_mfma_f32_16x16x32_bf16 v[92:95], v[12:15], a[212:215], v[92:95]
  s_waitcnt lgkmcnt(1)
  v_mfma_f32_16x16x32_bf16 v[68:71], a[24:27], v[16:19], v[68:71]
  ds_read_b128 v[12:15], v6 offset:24576
  v_mfma_f32_16x16x32_bf16 v[76:79], a[88:91], v[16:19], v[76:79]
  v_mfma_f32_16x16x32_bf16 v[84:87], v[16:19], a[152:155], v[84:87]
  v_mfma_f32_16x16x32_bf16 v[92:95], v[16:19], a[216:219], v[92:95]
  s_waitcnt lgkmcnt(1)
  v_mfma_f32_16x16x32_bf16 v[68:71], a[28:31], v[20:23], v[68:71]
  ds_read_b128 v[16:19], v6 offset:25600
  v_mfma_f32_16x16x32_bf16 v[76:79], a[92:95], v[20:23], v[76:79]
  v_mfma_f32_16x16x32_bf16 v[84:87], v[20:23], a[156:159], v[84:87]
  v_mfma_f32_16x16x32_bf16 v[92:95], v[20:23], a[220:223], v[92:95]
  s_waitcnt lgkmcnt(1)
  v_mfma_f32_16x16x32_bf16 v[68:71], a[32:35], v[12:15], v[68:71]
  ds_read_b128 v[20:23], v6 offset:26624
  v_mfma_f32_16x16x32_bf16 v[76:79], a[96:99], v[12:15], v[76:79]
  v_mfma_f32_16x16x32_bf16 v[84:87], v[12:15], a[160:163], v[84:87]
  v_mfma_f32_16x16x32_bf16 v[92:95], v[12:15], a[224:227], v[92:95]
  s_waitcnt lgkmcnt(1)
  v_mfma_f32_16x16x32_bf16 v[68:71], a[36:39], v[16:19], v[68:71]
  ds_read_b128 v[12:15], v6 offset:27648
  v_mfma_f32_16x16x32_bf16 v[76:79], a[100:103], v[16:19], v[76:79]
  v_mfma_f32_16x16x32_bf16 v[84:87], v[16:19], a[164:167], v[84:87]
  v_mfma_f32_16x16x32_bf16 v[92:95], v[16:19], a[228:231], v[92:95]
  s_waitcnt vmcnt(8)
  s_barrier
  v_mov_b32 v4, s70
  v_mov_b32 v5, 4
  s_mov_b64 exec, s[74:75]
  buffer_store_dword v5, v4, s[4:7], 0 offen sc1
  s_mov_b64 exec, -1
  s_waitcnt lgkmcnt(1)
  v_mfma_f32_16x16x32_bf16 v[68:71], a[40:43], v[20:23], v[68:71]
  ds_read_b128 v[16:19], v6 offset:28672
  v_mfma_f32_16x16x32_bf16 v[76:79], a[104:107], v[20:23], v[76:79]
  v_mfma_f32_16x16x32_bf16 v[84:87], v[20:23], a[168:171], v[84:87]
  v_mfma_f32_16x16x32_bf16 v[92:95], v[20:23], a[232:235], v[92:95]
  s_waitcnt lgkmcnt(1)
  v_mfma_f32_16x16x32_bf16 v[68:71], a[44:47], v[12:15], v[68:71]
  ds_read_b128 v[20:23], v6 offset:29696
  v_mfma_f32_16x16x32_bf16 v[76:79], a[108:111], v[12:15], v[76:79]
  v_mfma_f32_16x16x32_bf16 v[84:87], v[12:15], a[172:175], v[84:87]
  v_mfma_f32_16x16x32_bf16 v[92:95], v[12:15], a[236:239], v[92:95]
  s_waitcnt lgkmcnt(1)
  v_mfma_f32_16x16x32_bf16 v[68:71], a[48:51], v[16:19], v[68:71]
  ds_read_b128 v[12:15], v6 offset:30720
  v_mfma_f32_16x16x32_bf16 v[76:79], a[112:115], v[16:19], v[76:79]
  v_mfma_f32_16x16x32_bf16 v[84:87], v[16:19], a[176:179], v[84:87]
  v_mfma_f32_16x16x32_bf16 v[92:95], v[16:19], a[240:243], v[92:95]
  s_waitcnt lgkmcnt(1)
  v_mfma_f32_16x16x32_bf16 v[68:71], a[52:55], v[20:23], v[68:71]
  ds_read_b128 v[16:19], v6 offset:31744
  v_mfma_f32_16x16x32_bf16 v[76:79], a[116:119], v[20:23], v[76:79]
  v_mfma_f32_16x16x32_bf16 v[84:87], v[20:23], a[180:183], v[84:87]
  v_mfma_f32_16x16x32_bf16 v[92:95], v[20:23], a[244:247], v[92:95]
  s_waitcnt lgkmcnt(1)
  v_mfma_f32_16x16x32_bf16 v[68:71], a[56:59], v[12:15], v[68:71]
  v_mfma_f32_16x16x32_bf16 v[76:79], a[120:123], v[12:15], v[76:79]
  v_mfma_f32_16x16x32_bf16 v[84:87], v[12:15], a[184:187], v[84:87]
  v_mfma_f32_16x16x32_bf16 v[92:95], v[12:15], a[248:251], v[92:95]
  s_waitcnt lgkmcnt(0)
  v_mfma_f32_16x16x32_bf16 v[68:71], a[60:63], v[16:19], v[68:71]
  v_mfma_f32_16x16x32_bf16 v[76:79], a[124:127], v[16:19], v[76:79]
  v_mfma_f32_16x16x32_bf16 v[84:87], v[16:19], a[188:191], v[84:87]
  v_mfma_f32_16x16x32_bf16 v[92:95], v[16:19], a[252:255], v[92:95]
  s_waitcnt vmcnt(1)
  s_barrier
  s_mov_b32 s68, s67
  s_mov_b32 s70, s69
  s_add_u32 s69, s69, 8192
  s_add_u32 s67, s67, 32768
  s_xor_b32 s72, s72, 0x8000
  s_add_u32 s76, s76, 2
  s_cmp_lt_u32 s76, 32
  s_cbranch_scc1 L_help_36
  s_nop 7
  v_cvt_pk_bf16_f32 v96, v64, v65
  v_cvt_pk_bf16_f32 v97, v66, v67
  v_cvt_pk_bf16_f32 v98, v72, v73
  v_cvt_pk_bf16_f32 v99, v74, v75
  s_add_u32 s45, s68, 0
  buffer_store_dwordx4 v[96:99], v3, s[4:7], s45 offen sc1
  v_cvt_pk_bf16_f32 v100, v68, v69
  v_cvt_pk_bf16_f32 v101, v70, v71
  v_cvt_pk_bf16_f32 v102, v76, v77
  v_cvt_pk_bf16_f32 v103, v78, v79
  s_add_u32 s45, s68, 4096
  buffer_store_dwordx4 v[100:103], v3, s[4:7], s45 offen sc1
  v_cvt_pk_bf16_f32 v104, v80, v81
  v_cvt_pk_bf16_f32 v105, v82, v83
  v_cvt_pk_bf16_f32 v106, v84, v85
  v_cvt_pk_bf16_f32 v107, v86, v87
  s_add_u32 s45, s71, s68
  s_add_u32 s45, s45, 8192
  buffer_store_dwordx4 v[104:107], v3, s[4:7], s45 offen sc1
  v_cvt_pk_bf16_f32 v108, v88, v89
  v_cvt_pk_bf16_f32 v109, v90, v91
  v_cvt_pk_bf16_f32 v110, v92, v93
  v_cvt_pk_bf16_f32 v111, v94, v95
  s_add_u32 s45, s71, s68
  s_add_u32 s45, s45, 9216
  buffer_store_dwordx4 v[108:111], v3, s[4:7], s45 offen sc1
  s_waitcnt vmcnt(0)
  s_barrier
  v_mov_b32 v4, s70
  v_mov_b32 v5, 4
  s_mov_b64 exec, s[74:75]
  buffer_store_dword v5, v4, s[4:7], 0 offen sc1
  s_mov_b64 exec, -1
  s_waitcnt vmcnt(0)
  s_barrier
  s_mul_i32 s50, s16, 40960
  s_lshl_b32 s45, s17, 8
  s_lshl_b32 s46, s16, 6
  s_add_u32 s51, s45, s46
L_qonly_31:
  v_bfe_u32 v12, v1, 4, 1
  v_bfe_u32 v13, v1, 5, 1
  v_xor_b32 v12, v12, v13
  v_lshlrev_b32 v12, 1, v12
  v_and_b32 v13, 3, v1
  v_xor_b32 v12, v12, v13
  v_lshlrev_b32 v12, 4, v12
  v_lshrrev_b32 v13, 2, v1
  s_mov_b32 s45, 8192
  v_mul_lo_u32 v13, s45, v13
  v_add_u32 v15, v12, v13
  v_lshrrev_b32 v12, 4, v1
  v_bfe_u32 v13, v1, 2, 2
  v_lshl_add_u32 v14, v12, 3, v13
  v_lshlrev_b32 v14, 6, v14
  v_and_b32 v8, 3, v1
  v_lshl_add_u32 v14, v8, 3, v14
  v_and_b32 v8, 1, v12
  v_lshl_add_u32 v14, v8, 5, v14
  v_add_u32 v8, s50, v14
  v_xor_b32 v9, 32, v8
  v_lshl_add_u32 v14, v12, 2, v13
  v_lshlrev_b32 v14, 6, v14
  v_and_b32 v10, 3, v1
  v_lshl_add_u32 v14, v10, 3, v14
  v_lshrrev_b32 v13, 1, v12
  v_xor_b32 v13, v13, v12
  v_and_b32 v13, 1, v13
  v_lshl_add_u32 v14, v13, 5, v14
  v_add_u32 v10, s50, v14
  v_xor_b32 v11, 32, v10
  s_mov_b32 s8, s24
  s_and_b32 s9, s25, 0xffff
  s_mov_b32 s10, 0x400000
  s_mov_b32 s11, 0x20000
  s_add_u32 s45, s50, 0
  s_mov_b32 m0, s45
  s_add_u32 s46, s51, 0
  buffer_load_dwordx4 v15, s[8:11], s46 offen lds
  s_add_u32 s45, s50, 1024
  s_mov_b32 m0, s45
  s_add_u32 s46, s51, 131072
  buffer_load_dwordx4 v15, s[8:11], s46 offen lds
  s_add_u32 s45, s50, 2048
  s_mov_b32 m0, s45
  s_add_u32 s46, s51, 262144
  buffer_load_dwordx4 v15, s[8:11], s46 offen lds
  s_add_u32 s45, s50, 3072
  s_mov_b32 m0, s45
  s_add_u32 s46, s51, 393216
  buffer_load_dwordx4 v15, s[8:11], s46 offen lds
  s_add_u32 s45, s50, 4096
  s_mov_b32 m0, s45
  s_add_u32 s46, s51, 524288
  buffer_load_dwordx4 v15, s[8:11], s46 offen lds
  s_add_u32 s45, s50, 5120
  s_mov_b32 m0, s45
  s_add_u32 s46, s51, 655360
  buffer_load_dwordx4 v15, s[8:11], s46 offen lds
  s_add_u32 s45, s50, 6144
  s_mov_b32 m0, s45
  s_add_u32 s46, s51, 786432
  buffer_load_dwordx4 v15, s[8:11], s46 offen lds
  s_add_u32 s45, s50, 7168
  s_mov_b32 m0, s45
  s_add_u32 s46, s51, 917504
  buffer_load_dwordx4 v15, s[8:11], s46 offen lds
  s_add_u32 s45, s50, 8192
  s_mov_b32 m0, s45
  s_add_u32 s46, s51, 1048576
  buffer_load_dwordx4 v15, s[8:11], s46 offen lds
  s_add_u32 s45, s50, 9216
  s_mov_b32 m0, s45
  s_add_u32 s46, s51, 1179648
  buffer_load_dwordx4 v15, s[8:11], s46 offen lds
  s_add_u32 s45, s50, 10240
  s_mov_b32 m0, s45
  s_add_u32 s46, s51, 1310720
  buffer_load_dwordx4 v15, s[8:11], s46 offen lds
  s_add_u32 s45, s50, 11264
  s_mov_b32 m0, s45
  s_add_u32 s46, s51, 1441792
  buffer_load_dwordx4 v15, s[8:11], s46 offen lds
  s_add_u32 s45, s50, 12288
  s_mov_b32 m0, s45
  s_add_u32 s46, s51, 1572864
  buffer_load_dwordx4 v15, s[8:11], s46 offen lds
  s_add_u32 s45, s50, 13312
  s_mov_b32 m0, s45
  s_add_u32 s46, s51, 1703936
  buffer_load_dwordx4 v15, s[8:11], s46 offen lds
  s_add_u32 s45, s50, 14336
  s_mov_b32 m0, s45
  s_add_u32 s46, s51, 1835008
  buffer_load_dwordx4 v15, s[8:11], s46 offen lds
  s_add_u32 s45, s50, 15360
  s_mov_b32 m0, s45
  s_add_u32 s46, s51, 1966080
  buffer_load_dwordx4 v15, s[8:11], s46 offen lds
  s_add_u32 s45, s50, 16384
  s_mov_b32 m0, s45
  s_add_u32 s46, s51, 2097152
  buffer_load_dwordx4 v15, s[8:11], s46 offen lds
  s_add_u32 s45, s50, 17408
  s_mov_b32 m0, s45
  s_add_u32 s46, s51, 2228224
  buffer_load_dwordx4 v15, s[8:11], s46 offen lds
  s_add_u32 s45, s50, 18432
  s_mov_b32 m0, s45
  s_add_u32 s46, s51, 2359296
  buffer_load_dwordx4 v15, s[8:11], s46 offen lds
  s_add_u32 s45, s50, 19456
  s_mov_b32 m0, s45
  s_add_u32 s46, s51, 2490368
  buffer_load_dwordx4 v15, s[8:11], s46 offen lds
  s_add_u32 s45, s50, 20480
  s_mov_b32 m0, s45
  s_add_u32 s46, s51, 2621440
  buffer_load_dwordx4 v15, s[8:11], s46 offen lds
  s_add_u32 s45, s50, 21504
  s_mov_b32 m0, s45
  s_add_u32 s46, s51, 2752512
  buffer_load_dwordx4 v15, s[8:11], s46 offen lds
  s_add_u32 s45, s50, 22528
  s_mov_b32 m0, s45
  s_add_u32 s46, s51, 2883584
  buffer_load_dwordx4 v15, s[8:11], s46 offen lds
  s_add_u32 s45, s50, 23552
  s_mov_b32 m0, s45
  s_add_u32 s46, s51, 3014656
  buffer_load_dwordx4 v15, s[8:11], s46 offen lds
  s_add_u32 s45, s50, 24576
  s_mov_b32 m0, s45
  s_add_u32 s46, s51, 3145728
  buffer_load_dwordx4 v15, s[8:11], s46 offen lds
  s_add_u32 s45, s50, 25600
  s_mov_b32 m0, s45
  s_add_u32 s46, s51, 3276800
  buffer_load_dwordx4 v15, s[8:11], s46 offen lds
  s_add_u32 s45, s50, 26624
  s_mov_b32 m0, s45
  s_add_u32 s46, s51, 3407872
  buffer_load_dwordx4 v15, s[8:11], s46 offen lds
  s_add_u32 s45, s50, 27648
  s_mov_b32 m0, s45
  s_add_u32 s46, s51, 3538944
  buffer_load_dwordx4 v15, s[8:11], s46 offen lds
  s_add_u32 s45, s50, 28672
  s_mov_b32 m0, s45
  s_add_u32 s46, s51, 3670016
  buffer_load_dwordx4 v15, s[8:11], s46 offen lds
  s_add_u32 s45, s50, 29696
  s_mov_b32 m0, s45
  s_add_u32 s46, s51, 3801088
  buffer_load_dwordx4 v15, s[8:11], s46 offen lds
  s_add_u32 s45, s50, 30720
  s_mov_b32 m0, s45
  s_add_u32 s46, s51, 3932160
  buffer_load_dwordx4 v15, s[8:11], s46 offen lds
  s_add_u32 s45, s50, 31744
  s_mov_b32 m0, s45
  s_add_u32 s46, s51, 4063232
  buffer_load_dwordx4 v15, s[8:11], s46 offen lds
  s_waitcnt vmcnt(28)
  ds_read_b64_tr_b16 v[128:129], v8 offset:0
  ds_read_b64_tr_b16 v[130:131], v9 offset:256
  ds_read_b64_tr_b16 v[132:133], v8 offset:2048
  ds_read_b64_tr_b16 v[134:135], v9 offset:2304
  ds_read_b64_tr_b16 v[192:193], v9 offset:0
  ds_read_b64_tr_b16 v[194:195], v8 offset:256
  ds_read_b64_tr_b16 v[196:197], v9 offset:2048
  ds_read_b64_tr_b16 v[198:199], v8 offset:2304
  s_waitcnt lgkmcnt(0)
  s_waitcnt vmcnt(24)
  ds_read_b64_tr_b16 v[136:137], v8 offset:4096
  ds_read_b64_tr_b16 v[138:139], v9 offset:4352
  ds_read_b64_tr_b16 v[140:141], v8 offset:6144
  ds_read_b64_tr_b16 v[142:143], v9 offset:6400
  ds_read_b64_tr_b16 v[200:201], v9 offset:4096
  ds_read_b64_tr_b16 v[202:203], v8 offset:4352
  ds_read_b64_tr_b16 v[204:205], v9 offset:6144
  ds_read_b64_tr_b16 v[206:207], v8 offset:6400
  s_waitcnt lgkmcnt(0)
  s_waitcnt vmcnt(20)
  ds_read_b64_tr_b16 v[144:145], v8 offset:8192
  ds_read_b64_tr_b16 v[146:147], v9 offset:8448
  ds_read_b64_tr_b16 v[148:149], v8 offset:10240
  ds_read_b64_tr_b16 v[150:151], v9 offset:10496
  ds_read_b64_tr_b16 v[208:209], v9 offset:8192
  ds_read_b64_tr_b16 v[210:211], v8 offset:8448
  ds_read_b64_tr_b16 v[212:213], v9 offset:10240
  ds_read_b64_tr_b16 v[214:215], v8 offset:10496
  s_waitcnt lgkmcnt(0)
  s_waitcnt vmcnt(16)
  ds_read_b64_tr_b16 v[152:153], v8 offset:12288
  ds_read_b64_tr_b16 v[154:155], v9 offset:12544
  ds_read_b64_tr_b16 v[156:157], v8 offset:14336
  ds_read_b64_tr_b16 v[158:159], v9 offset:14592
  ds_read_b64_tr_b16 v[216:217], v9 offset:12288
  ds_read_b64_tr_b16 v[218:219], v8 offset:12544
  ds_read_b64_tr_b16 v[220:221], v9 offset:14336
  ds_read_b64_tr_b16 v[222:223], v8 offset:14592
  s_waitcnt lgkmcnt(0)
  s_waitcnt vmcnt(12)
  ds_read_b64_tr_b16 v[160:161], v8 offset:16384
  ds_read_b64_tr_b16 v[162:163], v9 offset:16640
  ds_read_b64_tr_b16 v[164:165], v8 offset:18432
  ds_read_b64_tr_b16 v[166:167], v9 offset:18688
  ds_read_b64_tr_b16 v[224:225], v9 offset:16384
  ds_read_b64_tr_b16 v[226:227], v8 offset:16640
  ds_read_b64_tr_b16 v[228:229], v9 offset:18432
  ds_read_b64_tr_b16 v[230:231], v8 offset:18688
  s_waitcnt lgkmcnt(0)
  s_waitcnt vmcnt(8)
  ds_read_b64_tr_b16 v[168:169], v8 offset:20480
  ds_read_b64_tr_b16 v[170:171], v9 offset:20736
  ds_read_b64_tr_b16 v[172:173], v8 offset:22528
  ds_read_b64_tr_b16 v[174:175], v9 offset:22784
  ds_read_b64_tr_b16 v[232:233], v9 offset:20480
  ds_read_b64_tr_b16 v[234:235], v8 offset:20736
  ds_read_b64_tr_b16 v[236:237], v9 offset:22528
  ds_read_b64_tr_b16 v[238:239], v8 offset:22784
  s_waitcnt lgkmcnt(0)
  s_waitcnt vmcnt(4)
  ds_read_b64_tr_b16 v[176:177], v8 offset:24576
  ds_read_b64_tr_b16 v[178:179], v9 offset:24832
  ds_read_b64_tr_b16 v[180:181], v8 offset:26624
  ds_read_b64_tr_b16 v[182:183], v9 offset:26880
  ds_read_b64_tr_b16 v[240:241], v9 offset:24576
  ds_read_b64_tr_b16 v[242:243], v8 offset:24832
  ds_read_b64_tr_b16 v[244:245], v9 offset:26624
  ds_read_b64_tr_b16 v[246:247], v8 offset:26880
  s_waitcnt lgkmcnt(0)
  s_waitcnt vmcnt(0)
  ds_read_b64_tr_b16 v[184:185], v8 offset:28672
  ds_read_b64_tr_b16 v[186:187], v9 offset:28928
  ds_read_b64_tr_b16 v[188:189], v8 offset:30720
  ds_read_b64_tr_b16 v[190:191], v9 offset:30976
  ds_read_b64_tr_b16 v[248:249], v9 offset:28672
  ds_read_b64_tr_b16 v[250:251], v8 offset:28928
  ds_read_b64_tr_b16 v[252:253], v9 offset:30720
  ds_read_b64_tr_b16 v[254:255], v8 offset:30976
  s_waitcnt lgkmcnt(0)
  s_barrier
  s_cmp_eq_u32 s99, 1
  s_cbranch_scc1 L_gs_done_37
  s_cmp_eq_u32 s16, 0
  s_cbranch_scc0 L_gs_w_38
  v_mov_b32 v100, 32
L_gs_p_39:
  s_mov_b64 exec, 1
  global_load_dword v101, v100, s[40:41] sc1
  s_mov_b64 exec, -1
  s_waitcnt vmcnt(0)
  v_readfirstlane_b32 s45, v101
  s_sub_u32 s64, s64, 1
  s_cbranch_scc1 L_abort
  s_cmp_ge_u32 s45, 256
  s_cbranch_scc1 L_gs_q_40
  s_sleep 4
  s_branch L_gs_p_39
L_gs_q_40:
  v_and_b32 v102, 63, v0
  v_lshlrev_b32 v102, 2, v102
  s_mov_b64 exec, 0xff
  global_load_dword v101, v102, s[40:41] sc1
  s_waitcnt vmcnt(0)
  ds_write_b32 v102, v101
  s_mov_b64 exec, -1
  s_waitcnt lgkmcnt(0)
L_gs_w_38:
  s_barrier
  v_mov_b32 v100, 0
  ds_read_b128 v[104:107], v100
  ds_read_b128 v[108:111], v100 offset:16
  s_waitcnt lgkmcnt(0)
  s_mov_b32 s44, 1
  s_mov_b32 s46, 0
  v_readfirstlane_b32 s45, v104
  s_cmp_eq_u32 s45, 32
  s_cselect_b32 s44, s44, 0
  s_cmp_gt_u32 s18, 0
  s_cselect_b32 s45, s45, 0
  s_add_u32 s46, s46, s45
  v_readfirstlane_b32 s45, v105
  s_cmp_eq_u32 s45, 32
  s_cselect_b32 s44, s44, 0
  s_cmp_gt_u32 s18, 1
  s_cselect_b32 s45, s45, 0
  s_add_u32 s46, s46, s45
  v_readfirstlane_b32 s45, v106
  s_cmp_eq_u32 s45, 32
  s_cselect_b32 s44, s44, 0
  s_cmp_gt_u32 s18, 2
  s_cselect_b32 s45, s45, 0
  s_add_u32 s46, s46, s45
  v_readfirstlane_b32 s45, v107
  s_cmp_eq_u32 s45, 32
  s_cselect_b32 s44, s44, 0
  s_cmp_gt_u32 s18, 3
  s_cselect_b32 s45, s45, 0
  s_add_u32 s46, s46, s45
  v_readfirstlane_b32 s45, v108
  s_cmp_eq_u32 s45, 32
  s_cselect_b32 s44, s44, 0
  s_cmp_gt_u32 s18, 4
  s_cselect_b32 s45, s45, 0
  s_add_u32 s46, s46, s45
  v_readfirstlane_b32 s45, v109
  s_cmp_eq_u32 s45, 32
  s_cselect_b32 s44, s44, 0
  s_cmp_gt_u32 s18, 5
  s_cselect_b32 s45, s45, 0
  s_add_u32 s46, s46, s45
  v_readfirstlane_b32 s45, v110
  s_cmp_eq_u32 s45, 32
  s_cselect_b32 s44, s44, 0
  s_cmp_gt_u32 s18, 6
  s_cselect_b32 s45, s45, 0
  s_add_u32 s46, s46, s45
  v_readfirstlane_b32 s45, v111
  s_cmp_eq_u32 s45, 32
  s_cselect_b32 s44, s44, 0
  s_cmp_gt_u32 s18, 7
  s_cselect_b32 s45, s45, 0
  s_add_u32 s46, s46, s45
  s_barrier
  s_mov_b32 s99, 1
  s_cmp_eq_u32 s44, 1
  s_cbranch_scc1 L_gs_done_37
  s_add_u32 s17, s46, s98
  s_branch L_dispatch
L_gs_done_37:
  s_lshl_b32 s45, s16, 10
  v_add_u32 v3, s45, v2
  v_lshrrev_b32 v120, 4, v1
  v_bfe_u32 v121, v1, 2, 2
  v_lshl_add_u32 v121, v120, 2, v121
  v_lshlrev_b32 v122, 5, v121
  v_and_b32 v123, 3, v1
  v_lshl_add_u32 v122, v123, 3, v122
  v_lshrrev_b32 v121, 1, v120
  v_lshlrev_b32 v121, 7, v121
  v_xor_b32 v4, v122, v121
  v_add_u32 v4, 0x18000, v4
  v_add_u32 v17, 0x10000, v2
  v_add_u32 v18, 0x10000, v3
  v_and_b32 v121, 15, v1
  v_lshlrev_b32 v122, 5, v121
  v_lshl_add_u32 v122, v120, 3, v122
  v_bfe_u32 v123, v1, 3, 1
  v_lshlrev_b32 v123, 7, v123
  v_xor_b32 v122, v122, v123
  s_lshr_b32 s45, s16, 1
  s_lshl_b32 s45, s45, 11
  s_add_u32 s45, s45, 0x18004
  v_add_u32 v5, s45, v122
  v_lshlrev_b32 v120, 2, v120
  s_and_b32 s46, s16, 1
  v_add_u32 v122, 0, v120
  v_cmp_gt_u32 vcc, v122, v121
  v_mov_b32 v123, 0
  v_mov_b32 v122, 0xff800000
  v_cndmask_b32 v123, v123, v122, vcc
  s_cmp_eq_u32 s46, 0
  s_cselect_b64 vcc, -1, 0
  v_mov_b32 v6, 0
  s_nop 1
  v_cndmask_b32 v6, v6, v123, vcc
  v_cndmask_b32 v10, v123, v122, vcc
  v_add_u32 v122, 1, v120
  v_cmp_gt_u32 vcc, v122, v121
  v_mov_b32 v123, 0
  v_mov_b32 v122, 0xff800000
  v_cndmask_b32 v123, v123, v122, vcc
  s_cmp_eq_u32 s46, 0
  s_cselect_b64 vcc, -1, 0
  v_mov_b32 v7, 0
  s_nop 1
  v_cndmask_b32 v7, v7, v123, vcc
  v_cndmask_b32 v11, v123, v122, vcc
  v_add_u32 v122, 2, v120
  v_cmp_gt_u32 vcc, v122, v121
  v_mov_b32 v123, 0
  v_mov_b32 v122, 0xff800000
  v_cndmask_b32 v123, v123, v122, vcc
  s_cmp_eq_u32 s46, 0
  s_cselect_b64 vcc, -1, 0
  v_mov_b32 v8, 0
  s_nop 1
  v_cndmask_b32 v8, v8, v123, vcc
  v_cndmask_b32 v12, v123, v122, vcc
  v_add_u32 v122, 3, v120
  v_cmp_gt_u32 vcc, v122, v121
  v_mov_b32 v123, 0
  v_mov_b32 v122, 0xff800000
  v_cndmask_b32 v123, v123, v122, vcc
  s_cmp_eq_u32 s46, 0
  s_cselect_b64 vcc, -1, 0
  v_mov_b32 v9, 0
  s_nop 1
  v_cndmask_b32 v9, v9, v123, vcc
  v_cndmask_b32 v13, v123, v122, vcc
  s_lshl_b32 s75, s16, 10
  s_mul_i32 s45, s19, 0x200000
  s_add_u32 s66, s45, 0x5200000
  s_mul_i32 s45, s19, 0x2000000
  s_add_u32 s45, s45, 0x200000
  s_lshl_b32 s46, s17, 20
  s_add_u32 s67, s45, s46
  s_mul_i32 s45, s19, 0x800000
  s_add_u32 s45, s45, 0x4200000
  s_lshl_b32 s46, s17, 18
  s_add_u32 s68, s45, s46
  s_mul_i32 s45, s19, 0x1000000
  s_add_u32 s45, s45, 0x6000000
  s_lshl_b32 s46, s17, 13
  s_add_u32 s45, s45, s46
  s_lshr_b32 s46, s16, 1
  s_lshl_b32 s46, s46, 12
  s_add_u32 s45, s45, s46
  s_and_b32 s46, s16, 1
  s_lshl_b32 s46, s46, 10
  s_add_u32 s69, s45, s46
  s_lshl_b32 s45, s19, 18
  s_lshl_b32 s46, s17, 7
  s_add_u32 s45, s45, s46
  s_add_u32 s70, s45, 0x0
  s_add_u32 s71, s45, 0x80000
  s_lshl_b32 s45, s19, 15
  s_lshr_b32 s46, s17, 3
  s_lshl_b32 s46, s46, 7
  s_add_u32 s45, s45, s46
  s_and_b32 s46, s17, 7
  s_lshl_b32 s46, s46, 2
  s_add_u32 s45, s45, s46
  s_add_u32 s72, s45, 0x104000
  s_cmp_eq_u32 s16, 0
  s_cselect_b32 s78, 1, 0
  s_mov_b32 s79, 0
  s_mov_b32 s73, 0x3e0293ee
  s_mov_b32 s74, 0x128000
  s_mov_b32 s76, 0
  s_mov_b32 s77, 0
  s_mov_b32 s65, 0
  v_mov_b32 v14, s70
L_wf_41:
  s_mov_b64 exec, 1
  buffer_load_dword v15, v14, s[4:7], 0 offen sc1
  s_mov_b64 exec, -1
  s_waitcnt vmcnt(0)
  v_readfirstlane_b32 s45, v15
  s_sub_u32 s64, s64, 1
  s_cbranch_scc1 L_abort
  s_cmp_ge_u32 s45, 4
  s_cbranch_scc1 L_wfd_42
  s_sleep 16
  s_branch L_wf_41
L_wfd_42:
  s_add_u32 s47, s75, s76
  s_add_u32 s45, s47, 0
  s_mov_b32 m0, s45
  s_add_u32 s46, s66, 0
  buffer_load_dwordx4 v3, s[4:7], s46 offen sc1 lds
  s_add_u32 s45, s47, 4096
  s_mov_b32 m0, s45
  s_add_u32 s46, s66, 4096
  buffer_load_dwordx4 v3, s[4:7], s46 offen sc1 lds
  s_add_u32 s45, s47, 8192
  s_mov_b32 m0, s45
  s_add_u32 s46, s66, 8192
  buffer_load_dwordx4 v3, s[4:7], s46 offen sc1 lds
  s_add_u32 s45, s47, 12288
  s_mov_b32 m0, s45
  s_add_u32 s46, s66, 12288
  buffer_load_dwordx4 v3, s[4:7], s46 offen sc1 lds
  s_add_u32 s45, s47, 16384
  s_mov_b32 m0, s45
  s_add_u32 s46, s66, 16384
  buffer_load_dwordx4 v3, s[4:7], s46 offen sc1 lds
  s_add_u32 s45, s47, 20480
  s_mov_b32 m0, s45
  s_add_u32 s46, s66, 20480
  buffer_load_dwordx4 v3, s[4:7], s46 offen sc1 lds
  s_add_u32 s45, s47, 24576
  s_mov_b32 m0, s45
  s_add_u32 s46, s66, 24576
  buffer_load_dwordx4 v3, s[4:7], s46 offen sc1 lds
  s_add_u32 s45, s47, 28672
  s_mov_b32 m0, s45
  s_add_u32 s46, s66, 28672
  buffer_load_dwordx4 v3, s[4:7], s46 offen sc1 lds
  s_add_u32 s47, s75, s77
  s_add_u32 s45, s47, 65536
  s_mov_b32 m0, s45
  s_add_u32 s46, s67, 0
  buffer_load_dwordx4 v3, s[4:7], s46 offen sc1 lds
  s_add_u32 s45, s47, 69632
  s_mov_b32 m0, s45
  s_add_u32 s46, s67, 4096
  buffer_load_dwordx4 v3, s[4:7], s46 offen sc1 lds
  s_add_u32 s45, s47, 73728
  s_mov_b32 m0, s45
  s_add_u32 s46, s67, 8192
  buffer_load_dwordx4 v3, s[4:7], s46 offen sc1 lds
  s_add_u32 s45, s47, 77824
  s_mov_b32 m0, s45
  s_add_u32 s46, s67, 12288
  buffer_load_dwordx4 v3, s[4:7], s46 offen sc1 lds
  s_add_u32 s66, s66, 32768
  s_add_u32 s67, s67, 16384
  s_add_u32 s70, s70, 4096
  v_mov_b32 v14, s70
L_wf_43:
  s_mov_b64 exec, 1
  buffer_load_dword v15, v14, s[4:7], 0 offen sc1
  s_mov_b64 exec, -1
  s_waitcnt vmcnt(0)
  v_readfirstlane_b32 s45, v15
  s_sub_u32 s64, s64, 1
  s_cbranch_scc1 L_abort
  s_cmp_ge_u32 s45, 4
  s_cbranch_scc1 L_wfd_44
  s_sleep 4
  s_branch L_wf_43
L_wfd_44:
  s_waitcnt vmcnt(0)
  s_barrier
L_qa_loop:
  s_waitcnt vmcnt(2)
  s_barrier
  v_add_u32 v19, s76, v2
  v_add_u32 v124, s77, v17
  s_xor_b32 s76, s76, 0x8000
  s_xor_b32 s77, s77, 0x4000
  v_mov_b32 v14, s71
  s_mov_b64 exec, 1
  buffer_load_dword v16, v14, s[4:7], 0 offen sc1
  s_mov_b64 exec, -1
  s_add_u32 s80, s75, s76
  s_add_u32 s81, s75, s77
  s_add_u32 s81, s81, 0x10000
  ds_read_b128 v[20:23], v19 offset:0
  ds_read_b128 v[24:27], v19 offset:1024
  s_waitcnt lgkmcnt(1)
  v_mfma_f32_16x16x32_bf16 v[32:35], v[128:131], v[20:23], 0
  ds_read_b128 v[28:31], v19 offset:2048
  v_mfma_f32_16x16x32_bf16 v[40:43], v[192:195], v[20:23], 0
  s_waitcnt lgkmcnt(1)
  v_mfma_f32_16x16x32_bf16 v[32:35], v[132:135], v[24:27], v[32:35]
  ds_read_b128 v[20:23], v19 offset:3072
  v_mfma_f32_16x16x32_bf16 v[40:43], v[196:199], v[24:27], v[40:43]
  s_waitcnt lgkmcnt(1)
  v_mfma_f32_16x16x32_bf16 v[32:35], v[136:139], v[28:31], v[32:35]
  ds_read_b128 v[24:27], v19 offset:4096
  v_mfma_f32_16x16x32_bf16 v[40:43], v[200:203], v[28:31], v[40:43]
  s_waitcnt lgkmcnt(1)
  v_mfma_f32_16x16x32_bf16 v[32:35], v[140:143], v[20:23], v[32:35]
  ds_read_b128 v[28:31], v19 offset:5120
  s_add_u32 s45, s80, 0
  s_mov_b32 m0, s45
  v_mfma_f32_16x16x32_bf16 v[40:43], v[204:207], v[20:23], v[40:43]
  s_add_u32 s46, s66, 0
  buffer_load_dwordx4 v3, s[4:7], s46 offen sc1 lds
  s_waitcnt lgkmcnt(1)
  v_mfma_f32_16x16x32_bf16 v[32:35], v[144:147], v[24:27], v[32:35]
  ds_read_b128 v[20:23], v19 offset:6144
  v_mfma_f32_16x16x32_bf16 v[40:43], v[208:211], v[24:27], v[40:43]
  s_waitcnt lgkmcnt(1)
  v_mfma_f32_16x16x32_bf16 v[32:35], v[148:151], v[28:31], v[32:35]
  ds_read_b128 v[24:27], v19 offset:7168
  s_add_u32 s45, s80, 4096
  s_mov_b32 m0, s45
  v_mfma_f32_16x16x32_bf16 v[40:43], v[212:215], v[28:31], v[40:43]
  s_add_u32 s46, s66, 4096
  buffer_load_dwordx4 v3, s[4:7], s46 offen sc1 lds
  s_waitcnt lgkmcnt(1)
  v_mfma_f32_16x16x32_bf16 v[32:35], v[152:155], v[20:23], v[32:35]
  ds_read_b128 v[28:31], v19 offset:8192
  v_mfma_f32_16x16x32_bf16 v[40:43], v[216:219], v[20:23], v[40:43]
  s_waitcnt lgkmcnt(1)
  v_mfma_f32_16x16x32_bf16 v[32:35], v[156:159], v[24:27], v[32:35]
  ds_read_b128 v[20:23], v19 offset:9216
  s_add_u32 s45, s80, 8192
  s_mov_b32 m0, s45
  v_mfma_f32_16x16x32_bf16 v[40:43], v[220:223], v[24:27], v[40:43]
  s_add_u32 s46, s66, 8192
  buffer_load_dwordx4 v3, s[4:7], s46 offen sc1 lds
  s_waitcnt lgkmcnt(1)
  v_mfma_f32_16x16x32_bf16 v[32:35], v[160:163], v[28:31], v[32:35]
  ds_read_b128 v[24:27], v19 offset:10240
  v_mfma_f32_16x16x32_bf16 v[40:43], v[224:227], v[28:31], v[40:43]
  s_waitcnt lgkmcnt(1)
  v_mfma_f32_16x16x32_bf16 v[32:35], v[164:167], v[20:23], v[32:35]
  ds_read_b128 v[28:31], v19 offset:11264
  s_add_u32 s45, s80, 12288
  s_mov_b32 m0, s45
  v_mfma_f32_16x16x32_bf16 v[40:43], v[228:231], v[20:23], v[40:43]
  s_add_u32 s46, s66, 12288
  buffer_load_dwordx4 v3, s[4:7], s46 offen sc1 lds
  s_waitcnt lgkmcnt(1)
  v_mfma_f32_16x16x32_bf16 v[32:35], v[168:171], v[24:27], v[32:35]
  ds_read_b128 v[20:23], v19 offset:12288
  v_mfma_f32_16x16x32_bf16 v[40:43], v[232:235], v[24:27], v[40:43]
  s_waitcnt lgkmcnt(1)
  v_mfma_f32_16x16x32_bf16 v[32:35], v[172:175], v[28:31], v[32:35]
  ds_read_b128 v[24:27], v19 offset:13312
  s_add_u32 s45, s80, 16384
  s_mov_b32 m0, s45
  v_mfma_f32_16x16x32_bf16 v[40:43], v[236:239], v[28:31], v[40:43]
  s_add_u32 s46, s66, 16384
  buffer_load_dwordx4 v3, s[4:7], s46 offen sc1 lds
  s_waitcnt lgkmcnt(1)
  v_mfma_f32_16x16x32_bf16 v[32:35], v[176:179], v[20:23], v[32:35]
  ds_read_b128 v[28:31], v19 offset:14336
  v_mfma_f32_16x16x32_bf16 v[40:43], v[240:243], v[20:23], v[40:43]
  s_waitcnt lgkmcnt(1)
  v_mfma_f32_16x16x32_bf16 v[32:35], v[180:183], v[24:27], v[32:35]
  ds_read_b128 v[20:23], v19 offset:15360
  s_add_u32 s45, s80, 20480
  s_mov_b32 m0, s45
  v_mfma_f32_16x16x32_bf16 v[40:43], v[244:247], v[24:27], v[40:43]
  s_add_u32 s46, s66, 20480
  buffer_load_dwordx4 v3, s[4:7], s46 offen sc1 lds
  s_waitcnt lgkmcnt(1)
  v_mfma_f32_16x16x32_bf16 v[32:35], v[184:187], v[28:31], v[32:35]
  ds_read_b128 v[24:27], v19 offset:16384
  v_mfma_f32_16x16x32_bf16 v[40:43], v[248:251], v[28:31], v[40:43]
  s_waitcnt lgkmcnt(1)
  v_mfma_f32_16x16x32_bf16 v[32:35], v[188:191], v[20:23], v[32:35]
  ds_read_b128 v[28:31], v19 offset:17408
  s_add_u32 s45, s80, 24576
  s_mov_b32 m0, s45
  v_mfma_f32_16x16x32_bf16 v[40:43], v[252:255], v[20:23], v[40:43]
  s_add_u32 s46, s66, 24576
  buffer_load_dwordx4 v3, s[4:7], s46 offen sc1 lds
  s_waitcnt lgkmcnt(1)
  v_mfma_f32_16x16x32_bf16 v[36:39], v[128:131], v[24:27], 0
  ds_read_b128 v[20:23], v19 offset:18432
  v_mfma_f32_16x16x32_bf16 v[44:47], v[192:195], v[24:27], 0
  s_waitcnt lgkmcnt(1)
  v_mfma_f32_16x16x32_bf16 v[36:39], v[132:135], v[28:31], v[36:39]
  ds_read_b128 v[24:27], v19 offset:19456
  s_add_u32 s45, s80, 28672
  s_mov_b32 m0, s45
  v_mfma_f32_16x16x32_bf16 v[44:47], v[196:199], v[28:31], v[44:47]
  s_add_u32 s46, s66, 28672
  buffer_load_dwordx4 v3, s[4:7], s46 offen sc1 lds
  s_waitcnt lgkmcnt(1)
  v_mfma_f32_16x16x32_bf16 v[36:39], v[136:139], v[20:23], v[36:39]
  ds_read_b128 v[28:31], v19 offset:20480
  v_mfma_f32_16x16x32_bf16 v[44:47], v[200:203], v[20:23], v[44:47]
  s_waitcnt lgkmcnt(1)
  v_mfma_f32_16x16x32_bf16 v[36:39], v[140:143], v[24:27], v[36:39]
  ds_read_b128 v[20:23], v19 offset:21504
  s_add_u32 s45, s81, 0
  s_mov_b32 m0, s45
  v_mfma_f32_16x16x32_bf16 v[44:47], v[204:207], v[24:27], v[44:47]
  s_add_u32 s46, s67, 0
  buffer_load_dwordx4 v3, s[4:7], s46 offen sc1 lds
  s_waitcnt lgkmcnt(1)
  v_mfma_f32_16x16x32_bf16 v[36:39], v[144:147], v[28:31], v[36:39]
  ds_read_b128 v[24:27], v19 offset:22528
  v_mfma_f32_16x16x32_bf16 v[44:47], v[208:211], v[28:31], v[44:47]
  s_waitcnt lgkmcnt(1)
  v_mfma_f32_16x16x32_bf16 v[36:39], v[148:151], v[20:23], v[36:39]
  ds_read_b128 v[28:31], v19 offset:23552
  s_add_u32 s45, s81, 4096
  s_mov_b32 m0, s45
  v_mfma_f32_16x16x32_bf16 v[44:47], v[212:215], v[20:23], v[44:47]
  s_add_u32 s46, s67, 4096
  buffer_load_dwordx4 v3, s[4:7], s46 offen sc1 lds
  s_waitcnt lgkmcnt(1)
  v_mfma_f32_16x16x32_bf16 v[36:39], v[152:155], v[24:27], v[36:39]
  ds_read_b128 v[20:23], v19 offset:24576
  v_mfma_f32_16x16x32_bf16 v[44:47], v[216:219], v[24:27], v[44:47]
  s_waitcnt lgkmcnt(1)
  v_mfma_f32_16x16x32_bf16 v[36:39], v[156:159], v[28:31], v[36:39]
  ds_read_b128 v[24:27], v19 offset:25600
  s_add_u32 s45, s81, 8192
  s_mov_b32 m0, s45
  v_mfma_f32_16x16x32_bf16 v[44:47], v[220:223], v[28:31], v[44:47]
  s_add_u32 s46, s67, 8192
  buffer_load_dwordx4 v3, s[4:7], s46 offen sc1 lds
  s_waitcnt lgkmcnt(1)
  v_mfma_f32_16x16x32_bf16 v[36:39], v[160:163], v[20:23], v[36:39]
  ds_read_b128 v[28:31], v19 offset:26624
  v_mfma_f32_16x16x32_bf16 v[44:47], v[224:227], v[20:23], v[44:47]
  s_waitcnt lgkmcnt(1)
  v_mfma_f32_16x16x32_bf16 v[36:39], v[164:167], v[24:27], v[36:39]
  ds_read_b128 v[20:23], v19 offset:27648
  s_add_u32 s45, s81, 12288
  s_mov_b32 m0, s45
  v_mfma_f32_16x16x32_bf16 v[44:47], v[228:231], v[24:27], v[44:47]
  s_add_u32 s46, s67, 12288
  buffer_load_dwordx4 v3, s[4:7], s46 offen sc1 lds
  s_waitcnt lgkmcnt(1)
  v_mfma_f32_16x16x32_bf16 v[36:39], v[168:171], v[28:31], v[36:39]
  ds_read_b128 v[24:27], v19 offset:28672
  v_mfma_f32_16x16x32_bf16 v[44:47], v[232:235], v[28:31], v[44:47]
  s_waitcnt lgkmcnt(1)
  v_mfma_f32_16x16x32_bf16 v[36:39], v[172:175], v[20:23], v[36:39]
  ds_read_b128 v[28:31], v19 offset:29696
  v_mfma_f32_16x16x32_bf16 v[44:47], v[236:239], v[20:23], v[44:47]
  s_waitcnt lgkmcnt(1)
  v_mfma_f32_16x16x32_bf16 v[36:39], v[176:179], v[24:27], v[36:39]
  ds_read_b128 v[20:23], v19 offset:30720
  v_mfma_f32_16x16x32_bf16 v[44:47], v[240:243], v[24:27], v[44:47]
  s_waitcnt lgkmcnt(1)
  v_mfma_f32_16x16x32_bf16 v[36:39], v[180:183], v[28:31], v[36:39]
  ds_read_b128 v[24:27], v19 offset:31744
  v_mfma_f32_16x16x32_bf16 v[44:47], v[244:247], v[28:31], v[44:47]
  s_waitcnt lgkmcnt(1)
  v_mfma_f32_16x16x32_bf16 v[36:39], v[184:187], v[20:23], v[36:39]
  v_mfma_f32_16x16x32_bf16 v[44:47], v[248:251], v[20:23], v[44:47]
  s_waitcnt lgkmcnt(0)
  v_mfma_f32_16x16x32_bf16 v[36:39], v[188:191], v[24:27], v[36:39]
  v_mfma_f32_16x16x32_bf16 v[44:47], v[252:255], v[24:27], v[44:47]
  s_cmp_lt_u32 s65, 62
  s_cselect_b32 s45, 32768, 0
  s_cselect_b32 s46, 16384, 0
  s_add_u32 s66, s66, s45
  s_add_u32 s67, s67, s46
  s_nop 3
  v_cvt_pk_bf16_f32 v64, v32, v33
  v_cvt_pk_bf16_f32 v65, v34, v35
  v_cvt_pk_bf16_f32 v66, v40, v41
  v_cvt_pk_bf16_f32 v67, v42, v43
  ds_write_b128 v18, v[64:67] offset:36864
  v_cvt_pk_bf16_f32 v68, v36, v37
  v_cvt_pk_bf16_f32 v69, v38, v39
  v_cvt_pk_bf16_f32 v70, v44, v45
  v_cvt_pk_bf16_f32 v71, v46, v47
  ds_write_b128 v18, v[68:71] offset:40960
  s_waitcnt vmcnt(12) lgkmcnt(0)
  s_barrier
  v_mov_b32 v14, s74
  v_mov_b32 v15, 1
  s_mov_b64 exec, s[78:79]
  buffer_store_dword v15, v14, s[4:7], 0 offen sc1
  s_mov_b64 exec, -1
  s_and_b32 s45, s16, 1
  s_lshl_b32 s45, s45, 12
  v_add_u32 v120, s45, v17
  ds_read_b128 v[64:67], v120 offset:36864
  ds_read_b128 v[68:71], v120 offset:37888
  ds_read_b128 v[72:75], v120 offset:38912
  ds_read_b128 v[76:79], v120 offset:39936
  v_readfirstlane_b32 s47, v16
  s_cmp_ge_u32 s47, 4
  s_cbranch_scc1 L_kmok_45
  v_mov_b32 v14, s71
L_wf_46:
  s_mov_b64 exec, 1
  buffer_load_dword v15, v14, s[4:7], 0 offen sc1
  s_mov_b64 exec, -1
  s_waitcnt vmcnt(0)
  v_readfirstlane_b32 s45, v15
  s_sub_u32 s64, s64, 1
  s_cbranch_scc1 L_abort
  s_cmp_ge_u32 s45, 4
  s_cbranch_scc1 L_wfd_47
  s_sleep 2
  s_branch L_wf_46
L_wfd_47:
L_kmok_45:
  s_add_u32 s45, s75, 98304
  s_mov_b32 m0, s45
  s_add_u32 s46, s68, 0
  buffer_load_dwordx4 v3, s[4:7], s46 offen sc1 lds
  ds_read_b128 v[104:107], v124 offset:0
  ds_read_b128 v[108:111], v124 offset:4096
  ds_read_b128 v[112:115], v124 offset:1024
  ds_read_b128 v[116:119], v124 offset:5120
  ds_read_b128 v[80:83], v124 offset:2048
  ds_read_b128 v[84:87], v124 offset:6144
  ds_read_b128 v[44:47], v124 offset:3072
  ds_read_b128 v[48:51], v124 offset:7168
  s_waitcnt lgkmcnt(0)
  v_mfma_f32_16x16x32_bf16 v[32:35], v[104:107], v[64:67], v[6:9]
  v_mfma_f32_16x16x32_bf16 v[36:39], v[108:111], v[64:67], v[10:13]
  v_mfma_f32_16x16x32_bf16 v[32:35], v[112:115], v[68:71], v[32:35]
  v_mfma_f32_16x16x32_bf16 v[36:39], v[116:119], v[68:71], v[36:39]
  v_mfma_f32_16x16x32_bf16 v[32:35], v[80:83], v[72:75], v[32:35]
  v_mfma_f32_16x16x32_bf16 v[36:39], v[84:87], v[72:75], v[36:39]
  v_mfma_f32_16x16x32_bf16 v[32:35], v[44:47], v[76:79], v[32:35]
  v_mfma_f32_16x16x32_bf16 v[36:39], v[48:51], v[76:79], v[36:39]
  s_lshr_b32 s45, s16, 1
  s_lshl_b32 s45, s45, 12
  v_add_u32 v120, s45, v124
  ds_read_b128 v[88:91], v120 offset:8192
  ds_read_b128 v[92:95], v120 offset:9216
  ds_read_b128 v[96:99], v120 offset:10240
  ds_read_b128 v[100:103], v120 offset:11264
  s_waitcnt vmcnt(0)
  s_barrier
  ds_read_b64_tr_b16 v[104:105], v4 offset:0
  ds_read_b64_tr_b16 v[106:107], v4 offset:512
  ds_read_b64_tr_b16 v[108:109], v4 offset:1024
  ds_read_b64_tr_b16 v[110:111], v4 offset:1536
  ds_read_b64_tr_b16 v[112:113], v4 offset:2048
  ds_read_b64_tr_b16 v[114:115], v4 offset:2560
  ds_read_b64_tr_b16 v[116:117], v4 offset:3072
  ds_read_b64_tr_b16 v[118:119], v4 offset:3584
  ds_read_b32 v44, v5 offset:0
  ds_read_b32 v46, v5 offset:512
  ds_read_b32 v48, v5 offset:1024
  ds_read_b32 v50, v5 offset:1536
  v_mov_b32 v45, 0
  v_mov_b32 v47, 0
  v_mov_b32 v49, 0
  v_mov_b32 v51, 0
  s_waitcnt lgkmcnt(4)
  v_mfma_f32_16x16x32_bf16 v[40:43], v[104:107], v[64:67], 0
  v_mfma_f32_16x16x32_bf16 v[40:43], v[108:111], v[68:71], v[40:43]
  v_mfma_f32_16x16x32_bf16 v[40:43], v[112:115], v[72:75], v[40:43]
  v_mfma_f32_16x16x32_bf16 v[40:43], v[116:119], v[76:79], v[40:43]
  s_nop 7
  v_max3_f32 v120, v32, v33, v34
  v_max3_f32 v121, v35, v36, v37
  v_max3_f32 v120, v120, v38, v39
  v_max3_f32 v121, v121, v40, v41
  v_max_f32 v120, v120, v121
  v_mov_b32 v121, v120
  s_nop 1
  v_permlane32_swap_b32 v120, v121
  v_max_f32 v120, v120, v121
  v_mov_b32 v121, v120
  s_nop 1
  v_permlane16_swap_b32 v120, v121
  v_max_f32 v120, v120, v121
  v_mul_f32 v120, s73, v120
  v_fma_f32 v32, v32, s73, -v120
  v_fma_f32 v33, v33, s73, -v120
  v_fma_f32 v34, v34, s73, -v120
  v_fma_f32 v35, v35, s73, -v120
  v_fma_f32 v36, v36, s73, -v120
  v_fma_f32 v37, v37, s73, -v120
  v_fma_f32 v38, v38, s73, -v120
  v_fma_f32 v39, v39, s73, -v120
  v_fma_f32 v40, v40, s73, -v120
  v_fma_f32 v41, v41, s73, -v120
  v_exp_f32 v32, v32
  v_exp_f32 v33, v33
  v_exp_f32 v34, v34
  v_exp_f32 v35, v35
  v_exp_f32 v36, v36
  v_exp_f32 v37, v37
  v_exp_f32 v38, v38
  v_exp_f32 v39, v39
  v_exp_f32 v40, v40
  v_exp_f32 v41, v41
  v_mov_b32 v80, 0x3f803f80
  v_mov_b32 v81, 0x3f803f80
  v_mov_b32 v82, 0x3f803f80
  v_mov_b32 v83, 0x3f803f80
  v_cvt_pk_bf16_f32 v112, v32, v33
  v_cvt_pk_bf16_f32 v113, v34, v35
  v_cvt_pk_bf16_f32 v114, v36, v37
  v_cvt_pk_bf16_f32 v115, v38, v39
  v_cvt_pk_bf16_f32 v116, v40, v41
  v_mov_b32 v117, 0
  s_waitcnt lgkmcnt(0)
  s_nop 0
  v_mfma_f32_16x16x32_bf16 v[68:71], v[80:83], v[112:115], 0
  v_mfma_f32_16x16x32_bf16 v[52:55], v[88:91], v[112:115], 0
  v_mfma_f32_16x16x32_bf16 v[56:59], v[92:95], v[112:115], 0
  v_mfma_f32_16x16x32_bf16 v[60:63], v[96:99], v[112:115], 0
  v_mfma_f32_16x16x32_bf16 v[64:67], v[100:103], v[112:115], 0
  v_mfma_f32_16x16x16_bf16 v[68:71], v[80:81], v[116:117], v[68:71]
  v_mfma_f32_16x16x16_bf16 v[52:55], v[44:45], v[116:117], v[52:55]
  v_mfma_f32_16x16x16_bf16 v[56:59], v[46:47], v[116:117], v[56:59]
  v_mfma_f32_16x16x16_bf16 v[60:63], v[48:49], v[116:117], v[60:63]
  v_mfma_f32_16x16x16_bf16 v[64:67], v[50:51], v[116:117], v[64:67]
  s_nop 3
  v_rcp_f32 v120, v68
  s_nop 3
  v_mul_f32 v52, v52, v120
  v_mul_f32 v53, v53, v120
  v_mul_f32 v54, v54, v120
  v_mul_f32 v55, v55, v120
  v_mul_f32 v56, v56, v120
  v_mul_f32 v57, v57, v120
  v_mul_f32 v58, v58, v120
  v_mul_f32 v59, v59, v120
  v_mul_f32 v60, v60, v120
  v_mul_f32 v61, v61, v120
  v_mul_f32 v62, v62, v120
  v_mul_f32 v63, v63, v120
  v_mul_f32 v64, v64, v120
  v_mul_f32 v65, v65, v120
  v_mul_f32 v66, v66, v120
  v_mul_f32 v67, v67, v120
  v_cvt_pk_bf16_f32 v72, v52, v53
  v_cvt_pk_bf16_f32 v73, v54, v55
  v_cvt_pk_bf16_f32 v74, v56, v57
  v_cvt_pk_bf16_f32 v75, v58, v59
  buffer_store_dwordx4 v[72:75], v2, s[4:7], s69 offen offset:0 sc1
  v_cvt_pk_bf16_f32 v76, v60, v61
  v_cvt_pk_bf16_f32 v77, v62, v63
  v_cvt_pk_bf16_f32 v78, v64, v65
  v_cvt_pk_bf16_f32 v79, v66, v67
  buffer_store_dwordx4 v[76:79], v2, s[4:7], s69 offen offset:2048 sc1
  s_mov_b32 s74, s72
  s_add_u32 s72, s72, 512
  s_add_u32 s69, s69, 262144
  s_add_u32 s68, s68, 4096
  s_add_u32 s71, s71, 4096
  s_add_u32 s65, s65, 1
  s_cmp_lt_u32 s65, 64
  s_cbranch_scc1 L_qa_loop
  s_waitcnt vmcnt(0)
  s_barrier
  v_mov_b32 v14, s74
  v_mov_b32 v15, 1
  s_mov_b64 exec, s[78:79]
  buffer_store_dword v15, v14, s[4:7], 0 offen sc1
  s_mov_b64 exec, -1
  s_waitcnt vmcnt(0)
  s_branch L_end
L_role_kv:
  v_and_b32 v1, 63, v0
  v_lshlrev_b32 v2, 4, v1
  s_mul_i32 s50, s16, 40960
  s_lshl_b32 s45, s17, 8
  s_lshl_b32 s46, s16, 6
  s_add_u32 s51, s45, s46
  v_bfe_u32 v12, v1, 4, 1
  v_bfe_u32 v13, v1, 5, 1
  v_xor_b32 v12, v12, v13
  v_lshlrev_b32 v12, 1, v12
  v_and_b32 v13, 3, v1
  v_xor_b32 v12, v12, v13
  v_lshlrev_b32 v12, 4, v12
  v_lshrrev_b32 v13, 2, v1
  s_mov_b32 s45, 8192
  v_mul_lo_u32 v13, s45, v13
  v_add_u32 v15, v12, v13
  v_lshrrev_b32 v12, 4, v1
  v_bfe_u32 v13, v1, 2, 2
  v_lshl_add_u32 v14, v12, 3, v13
  v_lshlrev_b32 v14, 6, v14
  v_and_b32 v8, 3, v1
  v_lshl_add_u32 v14, v8, 3, v14
  v_and_b32 v8, 1, v12
  v_lshl_add_u32 v14, v8, 5, v14
  v_add_u32 v8, s50, v14
  v_xor_b32 v9, 32, v8
  v_lshl_add_u32 v14, v12, 2, v13
  v_lshlrev_b32 v14, 6, v14
  v_and_b32 v10, 3, v1
  v_lshl_add_u32 v14, v10, 3, v14
  v_lshrrev_b32 v13, 1, v12
  v_xor_b32 v13, v13, v12
  v_and_b32 v13, 1, v13
  v_lshl_add_u32 v14, v13, 5, v14
  v_add_u32 v10, s50, v14
  v_xor_b32 v11, 32, v10
  s_mov_b32 s8, s26
  s_and_b32 s9, s27, 0xffff
  s_mov_b32 s10, 0x400000
  s_mov_b32 s11, 0x20000
  s_add_u32 s45, s50, 0
  s_mov_b32 m0, s45
  s_add_u32 s46, s51, 0
  buffer_load_dwordx4 v15, s[8:11], s46 offen lds
  s_add_u32 s45, s50, 1024
  s_mov_b32 m0, s45
  s_add_u32 s46, s51, 131072
  buffer_load_dwordx4 v15, s[8:11], s46 offen lds
  s_add_u32 s45, s50, 2048
  s_mov_b32 m0, s45
  s_add_u32 s46, s51, 262144
  buffer_load_dwordx4 v15, s[8:11], s46 offen lds
  s_add_u32 s45, s50, 3072
  s_mov_b32 m0, s45
  s_add_u32 s46, s51, 393216
  buffer_load_dwordx4 v15, s[8:11], s46 offen lds
  s_add_u32 s45, s50, 4096
  s_mov_b32 m0, s45
  s_add_u32 s46, s51, 524288
  buffer_load_dwordx4 v15, s[8:11], s46 offen lds
  s_add_u32 s45, s50, 5120
  s_mov_b32 m0, s45
  s_add_u32 s46, s51, 655360
  buffer_load_dwordx4 v15, s[8:11], s46 offen lds
  s_add_u32 s45, s50, 6144
  s_mov_b32 m0, s45
  s_add_u32 s46, s51, 786432
  buffer_load_dwordx4 v15, s[8:11], s46 offen lds
  s_add_u32 s45, s50, 7168
  s_mov_b32 m0, s45
  s_add_u32 s46, s51, 917504
  buffer_load_dwordx4 v15, s[8:11], s46 offen lds
  s_add_u32 s45, s50, 8192
  s_mov_b32 m0, s45
  s_add_u32 s46, s51, 1048576
  buffer_load_dwordx4 v15, s[8:11], s46 offen lds
  s_add_u32 s45, s50, 9216
  s_mov_b32 m0, s45
  s_add_u32 s46, s51, 1179648
  buffer_load_dwordx4 v15, s[8:11], s46 offen lds
  s_add_u32 s45, s50, 10240
  s_mov_b32 m0, s45
  s_add_u32 s46, s51, 1310720
  buffer_load_dwordx4 v15, s[8:11], s46 offen lds
  s_add_u32 s45, s50, 11264
  s_mov_b32 m0, s45
  s_add_u32 s46, s51, 1441792
  buffer_load_dwordx4 v15, s[8:11], s46 offen lds
  s_add_u32 s45, s50, 12288
  s_mov_b32 m0, s45
  s_add_u32 s46, s51, 1572864
  buffer_load_dwordx4 v15, s[8:11], s46 offen lds
  s_add_u32 s45, s50, 13312
  s_mov_b32 m0, s45
  s_add_u32 s46, s51, 1703936
  buffer_load_dwordx4 v15, s[8:11], s46 offen lds
  s_add_u32 s45, s50, 14336
  s_mov_b32 m0, s45
  s_add_u32 s46, s51, 1835008
  buffer_load_dwordx4 v15, s[8:11], s46 offen lds
  s_add_u32 s45, s50, 15360
  s_mov_b32 m0, s45
  s_add_u32 s46, s51, 1966080
  buffer_load_dwordx4 v15, s[8:11], s46 offen lds
  s_add_u32 s45, s50, 16384
  s_mov_b32 m0, s45
  s_add_u32 s46, s51, 2097152
  buffer_load_dwordx4 v15, s[8:11], s46 offen lds
  s_add_u32 s45, s50, 17408
  s_mov_b32 m0, s45
  s_add_u32 s46, s51, 2228224
  buffer_load_dwordx4 v15, s[8:11], s46 offen lds
  s_add_u32 s45, s50, 18432
  s_mov_b32 m0, s45
  s_add_u32 s46, s51, 2359296
  buffer_load_dwordx4 v15, s[8:11], s46 offen lds
  s_add_u32 s45, s50, 19456
  s_mov_b32 m0, s45
  s_add_u32 s46, s51, 2490368
  buffer_load_dwordx4 v15, s[8:11], s46 offen lds
  s_add_u32 s45, s50, 20480
  s_mov_b32 m0, s45
  s_add_u32 s46, s51, 2621440
  buffer_load_dwordx4 v15, s[8:11], s46 offen lds
  s_add_u32 s45, s50, 21504
  s_mov_b32 m0, s45
  s_add_u32 s46, s51, 2752512
  buffer_load_dwordx4 v15, s[8:11], s46 offen lds
  s_add_u32 s45, s50, 22528
  s_mov_b32 m0, s45
  s_add_u32 s46, s51, 2883584
  buffer_load_dwordx4 v15, s[8:11], s46 offen lds
  s_add_u32 s45, s50, 23552
  s_mov_b32 m0, s45
  s_add_u32 s46, s51, 3014656
  buffer_load_dwordx4 v15, s[8:11], s46 offen lds
  s_add_u32 s45, s50, 24576
  s_mov_b32 m0, s45
  s_add_u32 s46, s51, 3145728
  buffer_load_dwordx4 v15, s[8:11], s46 offen lds
  s_add_u32 s45, s50, 25600
  s_mov_b32 m0, s45
  s_add_u32 s46, s51, 3276800
  buffer_load_dwordx4 v15, s[8:11], s46 offen lds
  s_add_u32 s45, s50, 26624
  s_mov_b32 m0, s45
  s_add_u32 s46, s51, 3407872
  buffer_load_dwordx4 v15, s[8:11], s46 offen lds
  s_add_u32 s45, s50, 27648
  s_mov_b32 m0, s45
  s_add_u32 s46, s51, 3538944
  buffer_load_dwordx4 v15, s[8:11], s46 offen lds
  s_add_u32 s45, s50, 28672
  s_mov_b32 m0, s45
  s_add_u32 s46, s51, 3670016
  buffer_load_dwordx4 v15, s[8:11], s46 offen lds
  s_add_u32 s45, s50, 29696
  s_mov_b32 m0, s45
  s_add_u32 s46, s51, 3801088
  buffer_load_dwordx4 v15, s[8:11], s46 offen lds
  s_add_u32 s45, s50, 30720
  s_mov_b32 m0, s45
  s_add_u32 s46, s51, 3932160
  buffer_load_dwordx4 v15, s[8:11], s46 offen lds
  s_add_u32 s45, s50, 31744
  s_mov_b32 m0, s45
  s_add_u32 s46, s51, 4063232
  buffer_load_dwordx4 v15, s[8:11], s46 offen lds
  s_waitcnt vmcnt(28)
  ds_read_b64_tr_b16 a[0:1], v8 offset:0
  ds_read_b64_tr_b16 a[2:3], v9 offset:256
  ds_read_b64_tr_b16 a[4:5], v8 offset:2048
  ds_read_b64_tr_b16 a[6:7], v9 offset:2304
  ds_read_b64_tr_b16 a[64:65], v9 offset:0
  ds_read_b64_tr_b16 a[66:67], v8 offset:256
  ds_read_b64_tr_b16 a[68:69], v9 offset:2048
  ds_read_b64_tr_b16 a[70:71], v8 offset:2304
  s_waitcnt lgkmcnt(0)
  s_mov_b32 s8, s28
  s_and_b32 s9, s29, 0xffff
  s_mov_b32 s10, 0x400000
  s_mov_b32 s11, 0x20000
  s_add_u32 s45, s50, 0
  s_mov_b32 m0, s45
  s_add_u32 s46, s51, 0
  buffer_load_dwordx4 v15, s[8:11], s46 offen lds
  s_add_u32 s45, s50, 1024
  s_mov_b32 m0, s45
  s_add_u32 s46, s51, 131072
  buffer_load_dwordx4 v15, s[8:11], s46 offen lds
  s_add_u32 s45, s50, 2048
  s_mov_b32 m0, s45
  s_add_u32 s46, s51, 262144
  buffer_load_dwordx4 v15, s[8:11], s46 offen lds
  s_add_u32 s45, s50, 3072
  s_mov_b32 m0, s45
  s_add_u32 s46, s51, 393216
  buffer_load_dwordx4 v15, s[8:11], s46 offen lds
  s_waitcnt vmcnt(28)
  ds_read_b64_tr_b16 a[8:9], v8 offset:4096
  ds_read_b64_tr_b16 a[10:11], v9 offset:4352
  ds_read_b64_tr_b16 a[12:13], v8 offset:6144
  ds_read_b64_tr_b16 a[14:15], v9 offset:6400
  ds_read_b64_tr_b16 a[72:73], v9 offset:4096
  ds_read_b64_tr_b16 a[74:75], v8 offset:4352
  ds_read_b64_tr_b16 a[76:77], v9 offset:6144
  ds_read_b64_tr_b16 a[78:79], v8 offset:6400
  s_waitcnt lgkmcnt(0)
  s_add_u32 s45, s50, 4096
  s_mov_b32 m0, s45
  s_add_u32 s46, s51, 524288
  buffer_load_dwordx4 v15, s[8:11], s46 offen lds
  s_add_u32 s45, s50, 5120
  s_mov_b32 m0, s45
  s_add_u32 s46, s51, 655360
  buffer_load_dwordx4 v15, s[8:11], s46 offen lds
  s_add_u32 s45, s50, 6144
  s_mov_b32 m0, s45
  s_add_u32 s46, s51, 786432
  buffer_load_dwordx4 v15, s[8:11], s46 offen lds
  s_add_u32 s45, s50, 7168
  s_mov_b32 m0, s45
  s_add_u32 s46, s51, 917504
  buffer_load_dwordx4 v15, s[8:11], s46 offen lds
  s_waitcnt vmcnt(28)
  ds_read_b64_tr_b16 a[16:17], v8 offset:8192
  ds_read_b64_tr_b16 a[18:19], v9 offset:8448
  ds_read_b64_tr_b16 a[20:21], v8 offset:10240
  ds_read_b64_tr_b16 a[22:23], v9 offset:10496
  ds_read_b64_tr_b16 a[80:81], v9 offset:8192
  ds_read_b64_tr_b16 a[82:83], v8 offset:8448
  ds_read_b64_tr_b16 a[84:85], v9 offset:10240
  ds_read_b64_tr_b16 a[86:87], v8 offset:10496
  s_waitcnt lgkmcnt(0)
  s_add_u32 s45, s50, 8192
  s_mov_b32 m0, s45
  s_add_u32 s46, s51, 1048576
  buffer_load_dwordx4 v15, s[8:11], s46 offen lds
  s_add_u32 s45, s50, 9216
  s_mov_b32 m0, s45
  s_add_u32 s46, s51, 1179648
  buffer_load_dwordx4 v15, s[8:11], s46 offen lds
  s_add_u32 s45, s50, 10240
  s_mov_b32 m0, s45
  s_add_u32 s46, s51, 1310720
  buffer_load_dwordx4 v15, s[8:11], s46 offen lds
  s_add_u32 s45, s50, 11264
  s_mov_b32 m0, s45
  s_add_u32 s46, s51, 1441792
  buffer_load_dwordx4 v15, s[8:11], s46 offen lds
  s_waitcnt vmcnt(28)
  ds_read_b64_tr_b16 a[24:25], v8 offset:12288
  ds_read_b64_tr_b16 a[26:27], v9 offset:12544
  ds_read_b64_tr_b16 a[28:29], v8 offset:14336
  ds_read_b64_tr_b16 a[30:31], v9 offset:14592
  ds_read_b64_tr_b16 a[88:89], v9 offset:12288
  ds_read_b64_tr_b16 a[90:91], v8 offset:12544
  ds_read_b64_tr_b16 a[92:93], v9 offset:14336
  ds_read_b64_tr_b16 a[94:95], v8 offset:14592
  s_waitcnt lgkmcnt(0)
  s_add_u32 s45, s50, 12288
  s_mov_b32 m0, s45
  s_add_u32 s46, s51, 1572864
  buffer_load_dwordx4 v15, s[8:11], s46 offen lds
  s_add_u32 s45, s50, 13312
  s_mov_b32 m0, s45
  s_add_u32 s46, s51, 1703936
  buffer_load_dwordx4 v15, s[8:11], s46 offen lds
  s_add_u32 s45, s50, 14336
  s_mov_b32 m0, s45
  s_add_u32 s46, s51, 1835008
  buffer_load_dwordx4 v15, s[8:11], s46 offen lds
  s_add_u32 s45, s50, 15360
  s_mov_b32 m0, s45
  s_add_u32 s46, s51, 1966080
  buffer_load_dwordx4 v15, s[8:11], s46 offen lds
  s_waitcnt vmcnt(28)
  ds_read_b64_tr_b16 a[32:33], v8 offset:16384
  ds_read_b64_tr_b16 a[34:35], v9 offset:16640
  ds_read_b64_tr_b16 a[36:37], v8 offset:18432
  ds_read_b64_tr_b16 a[38:39], v9 offset:18688
  ds_read_b64_tr_b16 a[96:97], v9 offset:16384
  ds_read_b64_tr_b16 a[98:99], v8 offset:16640
  ds_read_b64_tr_b16 a[100:101], v9 offset:18432
  ds_read_b64_tr_b16 a[102:103], v8 offset:18688
  s_waitcnt lgkmcnt(0)
  s_add_u32 s45, s50, 16384
  s_mov_b32 m0, s45
  s_add_u32 s46, s51, 2097152
  buffer_load_dwordx4 v15, s[8:11], s46 offen lds
  s_add_u32 s45, s50, 17408
  s_mov_b32 m0, s45
  s_add_u32 s46, s51, 2228224
  buffer_load_dwordx4 v15, s[8:11], s46 offen lds
  s_add_u32 s45, s50, 18432
  s_mov_b32 m0, s45
  s_add_u32 s46, s51, 2359296
  buffer_load_dwordx4 v15, s[8:11], s46 offen lds
  s_add_u32 s45, s50, 19456
  s_mov_b32 m0, s45
  s_add_u32 s46, s51, 2490368
  buffer_load_dwordx4 v15, s[8:11], s46 offen lds
  s_waitcnt vmcnt(28)
  ds_read_b64_tr_b16 a[40:41], v8 offset:20480
  ds_read_b64_tr_b16 a[42:43], v9 offset:20736
  ds_read_b64_tr_b16 a[44:45], v8 offset:22528
  ds_read_b64_tr_b16 a[46:47], v9 offset:22784
  ds_read_b64_tr_b16 a[104:105], v9 offset:20480
  ds_read_b64_tr_b16 a[106:107], v8 offset:20736
  ds_read_b64_tr_b16 a[108:109], v9 offset:22528
  ds_read_b64_tr_b16 a[110:111], v8 offset:22784
  s_waitcnt lgkmcnt(0)
  s_add_u32 s45, s50, 20480
  s_mov_b32 m0, s45
  s_add_u32 s46, s51, 2621440
  buffer_load_dwordx4 v15, s[8:11], s46 offen lds
  s_add_u32 s45, s50, 21504
  s_mov_b32 m0, s45
  s_add_u32 s46, s51, 2752512
  buffer_load_dwordx4 v15, s[8:11], s46 offen lds
  s_add_u32 s45, s50, 22528
  s_mov_b32 m0, s45
  s_add_u32 s46, s51, 2883584
  buffer_load_dwordx4 v15, s[8:11], s46 offen lds
  s_add_u32 s45, s50, 23552
  s_mov_b32 m0, s45
  s_add_u32 s46, s51, 3014656
  buffer_load_dwordx4 v15, s[8:11], s46 offen lds
  s_waitcnt vmcnt(28)
  ds_read_b64_tr_b16 a[48:49], v8 offset:24576
  ds_read_b64_tr_b16 a[50:51], v9 offset:24832
  ds_read_b64_tr_b16 a[52:53], v8 offset:26624
  ds_read_b64_tr_b16 a[54:55], v9 offset:26880
  ds_read_b64_tr_b16 a[112:113], v9 offset:24576
  ds_read_b64_tr_b16 a[114:115], v8 offset:24832
  ds_read_b64_tr_b16 a[116:117], v9 offset:26624
  ds_read_b64_tr_b16 a[118:119], v8 offset:26880
  s_waitcnt lgkmcnt(0)
  s_add_u32 s45, s50, 24576
  s_mov_b32 m0, s45
  s_add_u32 s46, s51, 3145728
  buffer_load_dwordx4 v15, s[8:11], s46 offen lds
  s_add_u32 s45, s50, 25600
  s_mov_b32 m0, s45
  s_add_u32 s46, s51, 3276800
  buffer_load_dwordx4 v15, s[8:11], s46 offen lds
  s_add_u32 s45, s50, 26624
  s_mov_b32 m0, s45
  s_add_u32 s46, s51, 3407872
  buffer_load_dwordx4 v15, s[8:11], s46 offen lds
  s_add_u32 s45, s50, 27648
  s_mov_b32 m0, s45
  s_add_u32 s46, s51, 3538944
  buffer_load_dwordx4 v15, s[8:11], s46 offen lds
  s_waitcnt vmcnt(28)
  ds_read_b64_tr_b16 a[56:57], v8 offset:28672
  ds_read_b64_tr_b16 a[58:59], v9 offset:28928
  ds_read_b64_tr_b16 a[60:61], v8 offset:30720
  ds_read_b64_tr_b16 a[62:63], v9 offset:30976
  ds_read_b64_tr_b16 a[120:121], v9 offset:28672
  ds_read_b64_tr_b16 a[122:123], v8 offset:28928
  ds_read_b64_tr_b16 a[124:125], v9 offset:30720
  ds_read_b64_tr_b16 a[126:127], v8 offset:30976
  s_waitcnt lgkmcnt(0)
  s_add_u32 s45, s50, 28672
  s_mov_b32 m0, s45
  s_add_u32 s46, s51, 3670016
  buffer_load_dwordx4 v15, s[8:11], s46 offen lds
  s_add_u32 s45, s50, 29696
  s_mov_b32 m0, s45
  s_add_u32 s46, s51, 3801088
  buffer_load_dwordx4 v15, s[8:11], s46 offen lds
  s_add_u32 s45, s50, 30720
  s_mov_b32 m0, s45
  s_add_u32 s46, s51, 3932160
  buffer_load_dwordx4 v15, s[8:11], s46 offen lds
  s_add_u32 s45, s50, 31744
  s_mov_b32 m0, s45
  s_add_u32 s46, s51, 4063232
  buffer_load_dwordx4 v15, s[8:11], s46 offen lds
  s_waitcnt vmcnt(28)
  ds_read_b64_tr_b16 a[128:129], v8 offset:0
  ds_read_b64_tr_b16 a[130:131], v9 offset:256
  ds_read_b64_tr_b16 a[132:133], v8 offset:2048
  ds_read_b64_tr_b16 a[134:135], v9 offset:2304
  ds_read_b64_tr_b16 a[192:193], v9 offset:0
  ds_read_b64_tr_b16 a[194:195], v8 offset:256
  ds_read_b64_tr_b16 a[196:197], v9 offset:2048
  ds_read_b64_tr_b16 a[198:199], v8 offset:2304
  s_waitcnt lgkmcnt(0)
  s_waitcnt vmcnt(24)
  ds_read_b64_tr_b16 a[136:137], v8 offset:4096
  ds_read_b64_tr_b16 a[138:139], v9 offset:4352
  ds_read_b64_tr_b16 a[140:141], v8 offset:6144
  ds_read_b64_tr_b16 a[142:143], v9 offset:6400
  ds_read_b64_tr_b16 a[200:201], v9 offset:4096
  ds_read_b64_tr_b16 a[202:203], v8 offset:4352
  ds_read_b64_tr_b16 a[204:205], v9 offset:6144
  ds_read_b64_tr_b16 a[206:207], v8 offset:6400
  s_waitcnt lgkmcnt(0)
  s_waitcnt vmcnt(20)
  ds_read_b64_tr_b16 a[144:145], v8 offset:8192
  ds_read_b64_tr_b16 a[146:147], v9 offset:8448
  ds_read_b64_tr_b16 a[148:149], v8 offset:10240
  ds_read_b64_tr_b16 a[150:151], v9 offset:10496
  ds_read_b64_tr_b16 a[208:209], v9 offset:8192
  ds_read_b64_tr_b16 a[210:211], v8 offset:8448
  ds_read_b64_tr_b16 a[212:213], v9 offset:10240
  ds_read_b64_tr_b16 a[214:215], v8 offset:10496
  s_waitcnt lgkmcnt(0)
  s_waitcnt vmcnt(16)
  ds_read_b64_tr_b16 a[152:153], v8 offset:12288
  ds_read_b64_tr_b16 a[154:155], v9 offset:12544
  ds_read_b64_tr_b16 a[156:157], v8 offset:14336
  ds_read_b64_tr_b16 a[158:159], v9 offset:14592
  ds_read_b64_tr_b16 a[216:217], v9 offset:12288
  ds_read_b64_tr_b16 a[218:219], v8 offset:12544
  ds_read_b64_tr_b16 a[220:221], v9 offset:14336
  ds_read_b64_tr_b16 a[222:223], v8 offset:14592
  s_waitcnt lgkmcnt(0)
  s_waitcnt vmcnt(12)
  ds_read_b64_tr_b16 a[160:161], v8 offset:16384
  ds_read_b64_tr_b16 a[162:163], v9 offset:16640
  ds_read_b64_tr_b16 a[164:165], v8 offset:18432
  ds_read_b64_tr_b16 a[166:167], v9 offset:18688
  ds_read_b64_tr_b16 a[224:225], v9 offset:16384
  ds_read_b64_tr_b16 a[226:227], v8 offset:16640
  ds_read_b64_tr_b16 a[228:229], v9 offset:18432
  ds_read_b64_tr_b16 a[230:231], v8 offset:18688
  s_waitcnt lgkmcnt(0)
  s_waitcnt vmcnt(8)
  ds_read_b64_tr_b16 a[168:169], v8 offset:20480
  ds_read_b64_tr_b16 a[170:171], v9 offset:20736
  ds_read_b64_tr_b16 a[172:173], v8 offset:22528
  ds_read_b64_tr_b16 a[174:175], v9 offset:22784
  ds_read_b64_tr_b16 a[232:233], v9 offset:20480
  ds_read_b64_tr_b16 a[234:235], v8 offset:20736
  ds_read_b64_tr_b16 a[236:237], v9 offset:22528
  ds_read_b64_tr_b16 a[238:239], v8 offset:22784
  s_waitcnt lgkmcnt(0)
  s_waitcnt vmcnt(4)
  ds_read_b64_tr_b16 a[176:177], v8 offset:24576
  ds_read_b64_tr_b16 a[178:179], v9 offset:24832
  ds_read_b64_tr_b16 a[180:181], v8 offset:26624
  ds_read_b64_tr_b16 a[182:183], v9 offset:26880
  ds_read_b64_tr_b16 a[240:241], v9 offset:24576
  ds_read_b64_tr_b16 a[242:243], v8 offset:24832
  ds_read_b64_tr_b16 a[244:245], v9 offset:26624
  ds_read_b64_tr_b16 a[246:247], v8 offset:26880
  s_waitcnt lgkmcnt(0)
  s_waitcnt vmcnt(0)
  ds_read_b64_tr_b16 a[184:185], v8 offset:28672
  ds_read_b64_tr_b16 a[186:187], v9 offset:28928
  ds_read_b64_tr_b16 a[188:189], v8 offset:30720
  ds_read_b64_tr_b16 a[190:191], v9 offset:30976
  ds_read_b64_tr_b16 a[248:249], v9 offset:28672
  ds_read_b64_tr_b16 a[250:251], v8 offset:28928
  ds_read_b64_tr_b16 a[252:253], v9 offset:30720
  ds_read_b64_tr_b16 a[254:255], v8 offset:30976
  s_waitcnt lgkmcnt(0)
  s_barrier
  s_cmp_eq_u32 s99, 1
  s_cbranch_scc1 L_gs_done_48
  s_cmp_eq_u32 s16, 0
  s_cbranch_scc0 L_gs_w_49
  v_mov_b32 v100, 32
L_gs_p_50:
  s_mov_b64 exec, 1
  global_load_dword v101, v100, s[40:41] sc1
  s_mov_b64 exec, -1
  s_waitcnt vmcnt(0)
  v_readfirstlane_b32 s45, v101
  s_sub_u32 s64, s64, 1
  s_cbranch_scc1 L_abort
  s_cmp_ge_u32 s45, 256
  s_cbranch_scc1 L_gs_q_51
  s_sleep 4
  s_branch L_gs_p_50
L_gs_q_51:
  v_and_b32 v102, 63, v0
  v_lshlrev_b32 v102, 2, v102
  s_mov_b64 exec, 0xff
  global_load_dword v101, v102, s[40:41] sc1
  s_waitcnt vmcnt(0)
  ds_write_b32 v102, v101
  s_mov_b64 exec, -1
  s_waitcnt lgkmcnt(0)
L_gs_w_49:
  s_barrier
  v_mov_b32 v100, 0
  ds_read_b128 v[104:107], v100
  ds_read_b128 v[108:111], v100 offset:16
  s_waitcnt lgkmcnt(0)
  s_mov_b32 s44, 1
  s_mov_b32 s46, 0
  v_readfirstlane_b32 s45, v104
  s_cmp_eq_u32 s45, 32
  s_cselect_b32 s44, s44, 0
  s_cmp_gt_u32 s18, 0
  s_cselect_b32 s45, s45, 0
  s_add_u32 s46, s46, s45
  v_readfirstlane_b32 s45, v105
  s_cmp_eq_u32 s45, 32
  s_cselect_b32 s44, s44, 0
  s_cmp_gt_u32 s18, 1
  s_cselect_b32 s45, s45, 0
  s_add_u32 s46, s46, s45
  v_readfirstlane_b32 s45, v106
  s_cmp_eq_u32 s45, 32
  s_cselect_b32 s44, s44, 0
  s_cmp_gt_u32 s18, 2
  s_cselect_b32 s45, s45, 0
  s_add_u32 s46, s46, s45
  v_readfirstlane_b32 s45, v107
  s_cmp_eq_u32 s45, 32
  s_cselect_b32 s44, s44, 0
  s_cmp_gt_u32 s18, 3
  s_cselect_b32 s45, s45, 0
  s_add_u32 s46, s46, s45
  v_readfirstlane_b32 s45, v108
  s_cmp_eq_u32 s45, 32
  s_cselect_b32 s44, s44, 0
  s_cmp_gt_u32 s18, 4
  s_cselect_b32 s45, s45, 0
  s_add_u32 s46, s46, s45
  v_readfirstlane_b32 s45, v109
  s_cmp_eq_u32 s45, 32
  s_cselect_b32 s44, s44, 0
  s_cmp_gt_u32 s18, 5
  s_cselect_b32 s45, s45, 0
  s_add_u32 s46, s46, s45
  v_readfirstlane_b32 s45, v110
  s_cmp_eq_u32 s45, 32
  s_cselect_b32 s44, s44, 0
  s_cmp_gt_u32 s18, 6
  s_cselect_b32 s45, s45, 0
  s_add_u32 s46, s46, s45
  v_readfirstlane_b32 s45, v111
  s_cmp_eq_u32 s45, 32
  s_cselect_b32 s44, s44, 0
  s_cmp_gt_u32 s18, 7
  s_cselect_b32 s45, s45, 0
  s_add_u32 s46, s46, s45
  s_barrier
  s_mov_b32 s99, 1
  s_cmp_eq_u32 s44, 1
  s_cbranch_scc1 L_gs_done_48
  s_add_u32 s17, s46, s98
  s_branch L_dispatch
L_gs_done_48:
  s_lshl_b32 s75, s16, 10
  v_add_u32 v3, s75, v2
  s_mov_b32 s66, 0x5200000
  s_mov_b32 s67, 0x5400000
  s_lshl_b32 s45, s17, 20
  s_add_u32 s68, s45, 0x200000
  s_add_u32 s69, s68, 0x2000000
  s_lshl_b32 s45, s17, 7
  s_add_u32 s70, s45, 0x0
  s_add_u32 s71, s70, 0x40000
  s_mov_b32 s72, 0
  s_mov_b32 s73, 0
  s_mov_b32 s74, 0x102000
  s_mov_b32 s80, 0xf800000
  s_mov_b32 s81, 0x128000
  s_mov_b32 s77, 0
  s_cmp_eq_u32 s16, 0
  s_cselect_b32 s78, 1, 0
  s_mov_b32 s79, 0
  s_mov_b32 s76, 0
  s_mov_b32 s86, s66
  s_mov_b32 s84, s68
  s_mov_b32 s85, s70
  s_mov_b32 s87, 0
  s_cmp_lt_u32 s72, 64
  s_cselect_b32 s61, 2, 1
  s_add_u32 s72, s72, s61
  s_lshl_b32 s45, s61, 15
  s_add_u32 s66, s66, s45
  s_lshl_b32 s45, s61, 14
  s_add_u32 s68, s68, s45
  s_lshl_b32 s45, s61, 12
  s_add_u32 s70, s70, s45
  s_add_u32 s47, s76, s75
  s_add_u32 s45, s47, 0
  s_mov_b32 m0, s45
  s_add_u32 s46, s86, 0
  buffer_load_dwordx4 v3, s[4:7], s46 offen sc1 lds
  s_add_u32 s45, s47, 4096
  s_mov_b32 m0, s45
  s_add_u32 s46, s86, 4096
  buffer_load_dwordx4 v3, s[4:7], s46 offen sc1 lds
  s_add_u32 s45, s47, 8192
  s_mov_b32 m0, s45
  s_add_u32 s46, s86, 8192
  buffer_load_dwordx4 v3, s[4:7], s46 offen sc1 lds
  s_add_u32 s45, s47, 12288
  s_mov_b32 m0, s45
  s_add_u32 s46, s86, 12288
  buffer_load_dwordx4 v3, s[4:7], s46 offen sc1 lds
  s_add_u32 s45, s47, 16384
  s_mov_b32 m0, s45
  s_add_u32 s46, s86, 16384
  buffer_load_dwordx4 v3, s[4:7], s46 offen sc1 lds
  s_add_u32 s45, s47, 20480
  s_mov_b32 m0, s45
  s_add_u32 s46, s86, 20480
  buffer_load_dwordx4 v3, s[4:7], s46 offen sc1 lds
  s_add_u32 s45, s47, 24576
  s_mov_b32 m0, s45
  s_add_u32 s46, s86, 24576
  buffer_load_dwordx4 v3, s[4:7], s46 offen sc1 lds
  s_add_u32 s45, s47, 28672
  s_mov_b32 m0, s45
  s_add_u32 s46, s86, 28672
  buffer_load_dwordx4 v3, s[4:7], s46 offen sc1 lds
  s_mov_b32 s82, s84
  s_mov_b32 s83, s85
  s_waitcnt vmcnt(0)
  s_barrier
L_kv_top0:
  s_cmp_lt_u32 s73, 64
  s_cbranch_scc0 L_n0_52
  s_cmp_eq_u32 s77, 1
  s_cbranch_scc0 L_n0_52
  s_mov_b32 s86, s67
  s_mov_b32 s84, s69
  s_mov_b32 s85, s71
  s_mov_b32 s87, 1
  s_add_u32 s67, s67, 32768
  s_add_u32 s73, s73, 1
  s_add_u32 s74, s74, 128
  s_add_u32 s69, s69, 16384
  s_add_u32 s71, s71, 4096
  s_branch L_nn_53
L_n0_52:
  s_cmp_lt_u32 s72, 64
  s_cbranch_scc0 L_nz_54
  s_mov_b32 s86, s66
  s_mov_b32 s84, s68
  s_mov_b32 s85, s70
  s_mov_b32 s87, 0
  s_cmp_lt_u32 s72, 64
  s_cselect_b32 s61, 2, 1
  s_add_u32 s72, s72, s61
  s_lshl_b32 s45, s61, 15
  s_add_u32 s66, s66, s45
  s_lshl_b32 s45, s61, 14
  s_add_u32 s68, s68, s45
  s_lshl_b32 s45, s61, 12
  s_add_u32 s70, s70, s45
  s_branch L_nn_53
L_nz_54:
  s_mov_b32 s87, 2
  s_mov_b32 s86, 0x5200000
L_nn_53:
  v_add_u32 v7, s76, v2
  s_xor_b32 s60, s76, 0x8000
  s_add_u32 s60, s60, s75
  ds_read_b128 v[12:15], v7 offset:0
  ds_read_b128 v[16:19], v7 offset:1024
  s_waitcnt lgkmcnt(1)
  v_mfma_f32_16x16x32_bf16 v[32:35], a[0:3], v[12:15], 0
  ds_read_b128 v[20:23], v7 offset:2048
  v_mfma_f32_16x16x32_bf16 v[40:43], a[64:67], v[12:15], 0
  v_mfma_f32_16x16x32_bf16 v[48:51], v[12:15], a[128:131], 0
  v_mfma_f32_16x16x32_bf16 v[56:59], v[12:15], a[192:195], 0
  s_waitcnt lgkmcnt(1)
  v_mfma_f32_16x16x32_bf16 v[32:35], a[4:7], v[16:19], v[32:35]
  ds_read_b128 v[12:15], v7 offset:3072
  v_mfma_f32_16x16x32_bf16 v[40:43], a[68:71], v[16:19], v[40:43]
  v_mfma_f32_16x16x32_bf16 v[48:51], v[16:19], a[132:135], v[48:51]
  v_mfma_f32_16x16x32_bf16 v[56:59], v[16:19], a[196:199], v[56:59]
  s_waitcnt lgkmcnt(1)
  v_mfma_f32_16x16x32_bf16 v[32:35], a[8:11], v[20:23], v[32:35]
  ds_read_b128 v[16:19], v7 offset:4096
  v_cvt_pk_bf16_f32 v96, v64, v65
  v_mfma_f32_16x16x32_bf16 v[40:43], a[72:75], v[20:23], v[40:43]
  v_cvt_pk_bf16_f32 v97, v66, v67
  v_cvt_pk_bf16_f32 v98, v72, v73
  v_mfma_f32_16x16x32_bf16 v[48:51], v[20:23], a[136:139], v[48:51]
  v_cvt_pk_bf16_f32 v99, v74, v75
  v_mfma_f32_16x16x32_bf16 v[56:59], v[20:23], a[200:203], v[56:59]
  s_waitcnt lgkmcnt(1)
  v_mfma_f32_16x16x32_bf16 v[32:35], a[12:15], v[12:15], v[32:35]
  ds_read_b128 v[20:23], v7 offset:5120
  s_add_u32 s45, s80, 0
  v_mfma_f32_16x16x32_bf16 v[40:43], a[76:79], v[12:15], v[40:43]
  buffer_store_dwordx4 v[96:99], v3, s[4:7], s45 offen sc1
  v_cvt_pk_bf16_f32 v100, v68, v69
  v_mfma_f32_16x16x32_bf16 v[48:51], v[12:15], a[140:143], v[48:51]
  v_cvt_pk_bf16_f32 v101, v70, v71
  v_mfma_f32_16x16x32_bf16 v[56:59], v[12:15], a[204:207], v[56:59]
  s_waitcnt lgkmcnt(1)
  v_mfma_f32_16x16x32_bf16 v[32:35], a[16:19], v[16:19], v[32:35]
  ds_read_b128 v[12:15], v7 offset:6144
  v_cvt_pk_bf16_f32 v102, v76, v77
  v_mfma_f32_16x16x32_bf16 v[40:43], a[80:83], v[16:19], v[40:43]
  v_cvt_pk_bf16_f32 v103, v78, v79
  s_add_u32 s45, s80, 4096
  v_mfma_f32_16x16x32_bf16 v[48:51], v[16:19], a[144:147], v[48:51]
  buffer_store_dwordx4 v[100:103], v3, s[4:7], s45 offen sc1
  v_mfma_f32_16x16x32_bf16 v[56:59], v[16:19], a[208:211], v[56:59]
  s_waitcnt lgkmcnt(1)
  v_mfma_f32_16x16x32_bf16 v[32:35], a[20:23], v[20:23], v[32:35]
  ds_read_b128 v[16:19], v7 offset:7168
  v_cvt_pk_bf16_f32 v104, v80, v81
  v_mfma_f32_16x16x32_bf16 v[40:43], a[84:87], v[20:23], v[40:43]
  v_cvt_pk_bf16_f32 v105, v82, v83
  v_cvt_pk_bf16_f32 v106, v84, v85
  v_mfma_f32_16x16x32_bf16 v[48:51], v[20:23], a[148:151], v[48:51]
  v_cvt_pk_bf16_f32 v107, v86, v87
  v_mfma_f32_16x16x32_bf16 v[56:59], v[20:23], a[212:215], v[56:59]
  s_waitcnt lgkmcnt(1)
  v_mfma_f32_16x16x32_bf16 v[32:35], a[24:27], v[12:15], v[32:35]
  ds_read_b128 v[20:23], v7 offset:8192
  s_add_u32 s45, s75, s80
  v_mfma_f32_16x16x32_bf16 v[40:43], a[88:91], v[12:15], v[40:43]
  s_add_u32 s45, s45, 8192
  buffer_store_dwordx4 v[104:107], v3, s[4:7], s45 offen sc1
  v_mfma_f32_16x16x32_bf16 v[48:51], v[12:15], a[152:155], v[48:51]
  v_cvt_pk_bf16_f32 v108, v88, v89
  v_mfma_f32_16x16x32_bf16 v[56:59], v[12:15], a[216:219], v[56:59]
  s_waitcnt lgkmcnt(1)
  v_mfma_f32_16x16x32_bf16 v[32:35], a[28:31], v[16:19], v[32:35]
  ds_read_b128 v[12:15], v7 offset:9216
  v_cvt_pk_bf16_f32 v109, v90, v91
  v_mfma_f32_16x16x32_bf16 v[40:43], a[92:95], v[16:19], v[40:43]
  v_cvt_pk_bf16_f32 v110, v92, v93
  v_cvt_pk_bf16_f32 v111, v94, v95
  v_mfma_f32_16x16x32_bf16 v[48:51], v[16:19], a[156:159], v[48:51]
  s_add_u32 s45, s75, s80
  v_mfma_f32_16x16x32_bf16 v[56:59], v[16:19], a[220:223], v[56:59]
  s_waitcnt lgkmcnt(1)
  v_mfma_f32_16x16x32_bf16 v[32:35], a[32:35], v[20:23], v[32:35]
  ds_read_b128 v[16:19], v7 offset:10240
  s_add_u32 s45, s45, 9216
  v_mfma_f32_16x16x32_bf16 v[40:43], a[96:99], v[20:23], v[40:43]
  buffer_store_dwordx4 v[108:111], v3, s[4:7], s45 offen sc1
  v_mfma_f32_16x16x32_bf16 v[48:51], v[20:23], a[160:163], v[48:51]
  v_mfma_f32_16x16x32_bf16 v[56:59], v[20:23], a[224:227], v[56:59]
  s_waitcnt lgkmcnt(1)
  v_mfma_f32_16x16x32_bf16 v[32:35], a[36:39], v[12:15], v[32:35]
  ds_read_b128 v[20:23], v7 offset:11264
  v_mfma_f32_16x16x32_bf16 v[40:43], a[100:103], v[12:15], v[40:43]
  v_mfma_f32_16x16x32_bf16 v[48:51], v[12:15], a[164:167], v[48:51]
  v_mfma_f32_16x16x32_bf16 v[56:59], v[12:15], a[228:231], v[56:59]
  s_waitcnt lgkmcnt(1)
  v_mfma_f32_16x16x32_bf16 v[32:35], a[40:43], v[16:19], v[32:35]
  ds_read_b128 v[12:15], v7 offset:12288
  s_add_u32 s47, s60, 0
  v_mfma_f32_16x16x32_bf16 v[40:43], a[104:107], v[16:19], v[40:43]
  s_mov_b32 m0, s47
  s_add_u32 s48, s86, 0
  v_mfma_f32_16x16x32_bf16 v[48:51], v[16:19], a[168:171], v[48:51]
  buffer_load_dwordx4 v3, s[4:7], s48 offen sc1 lds
  v_mfma_f32_16x16x32_bf16 v[56:59], v[16:19], a[232:235], v[56:59]
  s_waitcnt lgkmcnt(1)
  v_mfma_f32_16x16x32_bf16 v[32:35], a[44:47], v[20:23], v[32:35]
  ds_read_b128 v[16:19], v7 offset:13312
  s_add_u32 s47, s60, 4096
  v_mfma_f32_16x16x32_bf16 v[40:43], a[108:111], v[20:23], v[40:43]
  s_mov_b32 m0, s47
  s_add_u32 s48, s86, 4096
  v_mfma_f32_16x16x32_bf16 v[48:51], v[20:23], a[172:175], v[48:51]
  buffer_load_dwordx4 v3, s[4:7], s48 offen sc1 lds
  v_mfma_f32_16x16x32_bf16 v[56:59], v[20:23], a[236:239], v[56:59]
  s_waitcnt lgkmcnt(1)
  v_mfma_f32_16x16x32_bf16 v[32:35], a[48:51], v[12:15], v[32:35]
  ds_read_b128 v[20:23], v7 offset:14336
  s_add_u32 s47, s60, 8192
  v_mfma_f32_16x16x32_bf16 v[40:43], a[112:115], v[12:15], v[40:43]
  s_mov_b32 m0, s47
  s_add_u32 s48, s86, 8192
  v_mfma_f32_16x16x32_bf16 v[48:51], v[12:15], a[176:179], v[48:51]
  buffer_load_dwordx4 v3, s[4:7], s48 offen sc1 lds
  v_mfma_f32_16x16x32_bf16 v[56:59], v[12:15], a[240:243], v[56:59]
  s_waitcnt lgkmcnt(1)
  v_mfma_f32_16x16x32_bf16 v[32:35], a[52:55], v[16:19], v[32:35]
  ds_read_b128 v[12:15], v7 offset:15360
  s_add_u32 s47, s60, 12288
  v_mfma_f32_16x16x32_bf16 v[40:43], a[116:119], v[16:19], v[40:43]
  s_mov_b32 m0, s47
  s_add_u32 s48, s86, 12288
  v_mfma_f32_16x16x32_bf16 v[48:51], v[16:19], a[180:183], v[48:51]
  buffer_load_dwordx4 v3, s[4:7], s48 offen sc1 lds
  v_mfma_f32_16x16x32_bf16 v[56:59], v[16:19], a[244:247], v[56:59]
  s_waitcnt lgkmcnt(1)
  v_mfma_f32_16x16x32_bf16 v[32:35], a[56:59], v[20:23], v[32:35]
  ds_read_b128 v[16:19], v7 offset:16384
  s_add_u32 s47, s60, 16384
  v_mfma_f32_16x16x32_bf16 v[40:43], a[120:123], v[20:23], v[40:43]
  s_mov_b32 m0, s47
  s_add_u32 s48, s86, 16384
  v_mfma_f32_16x16x32_bf16 v[48:51], v[20:23], a[184:187], v[48:51]
  buffer_load_dwordx4 v3, s[4:7], s48 offen sc1 lds
  v_mfma_f32_16x16x32_bf16 v[56:59], v[20:23], a[248:251], v[56:59]
  s_waitcnt lgkmcnt(1)
  v_mfma_f32_16x16x32_bf16 v[32:35], a[60:63], v[12:15], v[32:35]
  ds_read_b128 v[20:23], v7 offset:17408
  s_add_u32 s47, s60, 20480
  v_mfma_f32_16x16x32_bf16 v[40:43], a[124:127], v[12:15], v[40:43]
  s_mov_b32 m0, s47
  s_add_u32 s48, s86, 20480
  v_mfma_f32_16x16x32_bf16 v[48:51], v[12:15], a[188:191], v[48:51]
  buffer_load_dwordx4 v3, s[4:7], s48 offen sc1 lds
  v_mfma_f32_16x16x32_bf16 v[56:59], v[12:15], a[252:255], v[56:59]
  s_waitcnt lgkmcnt(1)
  v_mfma_f32_16x16x32_bf16 v[36:39], a[0:3], v[16:19], 0
  ds_read_b128 v[12:15], v7 offset:18432
  s_add_u32 s47, s60, 24576
  v_mfma_f32_16x16x32_bf16 v[44:47], a[64:67], v[16:19], 0
  s_mov_b32 m0, s47
  s_add_u32 s48, s86, 24576
  v_mfma_f32_16x16x32_bf16 v[52:55], v[16:19], a[128:131], 0
  buffer_load_dwordx4 v3, s[4:7], s48 offen sc1 lds
  v_mfma_f32_16x16x32_bf16 v[60:63], v[16:19], a[192:195], 0
  s_waitcnt lgkmcnt(1)
  v_mfma_f32_16x16x32_bf16 v[36:39], a[4:7], v[20:23], v[36:39]
  ds_read_b128 v[16:19], v7 offset:19456
  s_add_u32 s47, s60, 28672
  v_mfma_f32_16x16x32_bf16 v[44:47], a[68:71], v[20:23], v[44:47]
  s_mov_b32 m0, s47
  s_add_u32 s48, s86, 28672
  v_mfma_f32_16x16x32_bf16 v[52:55], v[20:23], a[132:135], v[52:55]
  buffer_load_dwordx4 v3, s[4:7], s48 offen sc1 lds
  v_mfma_f32_16x16x32_bf16 v[60:63], v[20:23], a[196:199], v[60:63]
  s_waitcnt lgkmcnt(1)
  v_mfma_f32_16x16x32_bf16 v[36:39], a[8:11], v[12:15], v[36:39]
  ds_read_b128 v[20:23], v7 offset:20480
  v_mfma_f32_16x16x32_bf16 v[44:47], a[72:75], v[12:15], v[44:47]
  v_mfma_f32_16x16x32_bf16 v[52:55], v[12:15], a[136:139], v[52:55]
  v_mfma_f32_16x16x32_bf16 v[60:63], v[12:15], a[200:203], v[60:63]
  s_waitcnt lgkmcnt(1)
  v_mfma_f32_16x16x32_bf16 v[36:39], a[12:15], v[16:19], v[36:39]
  ds_read_b128 v[12:15], v7 offset:21504
  v_mfma_f32_16x16x32_bf16 v[44:47], a[76:79], v[16:19], v[44:47]
  v_mfma_f32_16x16x32_bf16 v[52:55], v[16:19], a[140:143], v[52:55]
  v_mfma_f32_16x16x32_bf16 v[60:63], v[16:19], a[204:207], v[60:63]
  s_waitcnt lgkmcnt(1)
  v_mfma_f32_16x16x32_bf16 v[36:39], a[16:19], v[20:23], v[36:39]
  ds_read_b128 v[16:19], v7 offset:22528
  v_mfma_f32_16x16x32_bf16 v[44:47], a[80:83], v[20:23], v[44:47]
  v_mfma_f32_16x16x32_bf16 v[52:55], v[20:23], a[144:147], v[52:55]
  v_mfma_f32_16x16x32_bf16 v[60:63], v[20:23], a[208:211], v[60:63]
  s_waitcnt lgkmcnt(1)
  v_mfma_f32_16x16x32_bf16 v[36:39], a[20:23], v[12:15], v[36:39]
  ds_read_b128 v[20:23], v7 offset:23552
  v_mfma_f32_16x16x32_bf16 v[44:47], a[84:87], v[12:15], v[44:47]
  v_mfma_f32_16x16x32_bf16 v[52:55], v[12:15], a[148:151], v[52:55]
  v_mfma_f32_16x16x32_bf16 v[60:63], v[12:15], a[212:215], v[60:63]
  s_waitcnt lgkmcnt(1)
  v_mfma_f32_16x16x32_bf16 v[36:39], a[24:27], v[16:19], v[36:39]
  ds_read_b128 v[12:15], v7 offset:24576
  v_mfma_f32_16x16x32_bf16 v[44:47], a[88:91], v[16:19], v[44:47]
  v_mfma_f32_16x16x32_bf16 v[52:55], v[16:19], a[152:155], v[52:55]
  v_mfma_f32_16x16x32_bf16 v[60:63], v[16:19], a[216:219], v[60:63]
  s_waitcnt lgkmcnt(1)
  v_mfma_f32_16x16x32_bf16 v[36:39], a[28:31], v[20:23], v[36:39]
  ds_read_b128 v[16:19], v7 offset:25600
  v_mfma_f32_16x16x32_bf16 v[44:47], a[92:95], v[20:23], v[44:47]
  v_mfma_f32_16x16x32_bf16 v[52:55], v[20:23], a[156:159], v[52:55]
  v_mfma_f32_16x16x32_bf16 v[60:63], v[20:23], a[220:223], v[60:63]
  s_waitcnt lgkmcnt(1)
  v_mfma_f32_16x16x32_bf16 v[36:39], a[32:35], v[12:15], v[36:39]
  ds_read_b128 v[20:23], v7 offset:26624
  v_mfma_f32_16x16x32_bf16 v[44:47], a[96:99], v[12:15], v[44:47]
  v_mfma_f32_16x16x32_bf16 v[52:55], v[12:15], a[160:163], v[52:55]
  v_mfma_f32_16x16x32_bf16 v[60:63], v[12:15], a[224:227], v[60:63]
  s_waitcnt lgkmcnt(1)
  v_mfma_f32_16x16x32_bf16 v[36:39], a[36:39], v[16:19], v[36:39]
  ds_read_b128 v[12:15], v7 offset:27648
  v_mfma_f32_16x16x32_bf16 v[44:47], a[100:103], v[16:19], v[44:47]
  v_mfma_f32_16x16x32_bf16 v[52:55], v[16:19], a[164:167], v[52:55]
  v_mfma_f32_16x16x32_bf16 v[60:63], v[16:19], a[228:231], v[60:63]
  s_waitcnt vmcnt(8)
  s_barrier
  v_and_b32 v4, 63, v0
  v_lshlrev_b32 v4, 2, v4
  v_add_u32 v4, s74, v4
  s_mov_b64 exec, 0xf
  buffer_load_dword v5, v4, s[4:7], 0 offen sc1
  s_mov_b64 exec, -1
  v_mov_b32 v8, s81
  v_mov_b32 v9, 4
  s_mov_b64 exec, s[78:79]
  buffer_store_dword v9, v8, s[4:7], 0 offen sc1
  s_mov_b64 exec, -1
  s_waitcnt lgkmcnt(1)
  v_mfma_f32_16x16x32_bf16 v[36:39], a[40:43], v[20:23], v[36:39]
  ds_read_b128 v[16:19], v7 offset:28672
  v_mfma_f32_16x16x32_bf16 v[44:47], a[104:107], v[20:23], v[44:47]
  v_mfma_f32_16x16x32_bf16 v[52:55], v[20:23], a[168:171], v[52:55]
  v_mfma_f32_16x16x32_bf16 v[60:63], v[20:23], a[232:235], v[60:63]
  s_waitcnt lgkmcnt(1)
  v_mfma_f32_16x16x32_bf16 v[36:39], a[44:47], v[12:15], v[36:39]
  ds_read_b128 v[20:23], v7 offset:29696
  v_mfma_f32_16x16x32_bf16 v[44:47], a[108:111], v[12:15], v[44:47]
  v_mfma_f32_16x16x32_bf16 v[52:55], v[12:15], a[172:175], v[52:55]
  v_mfma_f32_16x16x32_bf16 v[60:63], v[12:15], a[236:239], v[60:63]
  s_waitcnt lgkmcnt(1)
  v_mfma_f32_16x16x32_bf16 v[36:39], a[48:51], v[16:19], v[36:39]
  ds_read_b128 v[12:15], v7 offset:30720
  v_mfma_f32_16x16x32_bf16 v[44:47], a[112:115], v[16:19], v[44:47]
  v_mfma_f32_16x16x32_bf16 v[52:55], v[16:19], a[176:179], v[52:55]
  v_mfma_f32_16x16x32_bf16 v[60:63], v[16:19], a[240:243], v[60:63]
  s_waitcnt lgkmcnt(1)
  v_mfma_f32_16x16x32_bf16 v[36:39], a[52:55], v[20:23], v[36:39]
  ds_read_b128 v[16:19], v7 offset:31744
  v_mfma_f32_16x16x32_bf16 v[44:47], a[116:119], v[20:23], v[44:47]
  v_mfma_f32_16x16x32_bf16 v[52:55], v[20:23], a[180:183], v[52:55]
  v_mfma_f32_16x16x32_bf16 v[60:63], v[20:23], a[244:247], v[60:63]
  s_waitcnt lgkmcnt(1)
  v_mfma_f32_16x16x32_bf16 v[36:39], a[56:59], v[12:15], v[36:39]
  v_mfma_f32_16x16x32_bf16 v[44:47], a[120:123], v[12:15], v[44:47]
  v_mfma_f32_16x16x32_bf16 v[52:55], v[12:15], a[184:187], v[52:55]
  v_mfma_f32_16x16x32_bf16 v[60:63], v[12:15], a[248:251], v[60:63]
  s_waitcnt lgkmcnt(0)
  v_mfma_f32_16x16x32_bf16 v[36:39], a[60:63], v[16:19], v[36:39]
  v_mfma_f32_16x16x32_bf16 v[44:47], a[124:127], v[16:19], v[44:47]
  v_mfma_f32_16x16x32_bf16 v[52:55], v[16:19], a[188:191], v[52:55]
  v_mfma_f32_16x16x32_bf16 v[60:63], v[16:19], a[252:255], v[60:63]
  s_waitcnt vmcnt(1)
  v_cmp_ne_u32 vcc, 0, v5
  s_and_b32 s77, vcc_lo, 0xf
  s_cmp_eq_u32 s77, 0xf
  s_cselect_b32 s77, 1, 0
  v_mov_b32 v5, s77
  v_mov_b32 v6, 0x10000
  s_cmp_eq_u32 s16, 0
  s_cbranch_scc0 L_sh_55
  s_mov_b64 exec, 1
  ds_write_b32 v6, v5
  s_mov_b64 exec, -1
  s_waitcnt lgkmcnt(0)
L_sh_55:
  s_barrier
  ds_read_b32 v8, v6
  s_waitcnt lgkmcnt(0)
  v_readfirstlane_b32 s77, v8
  s_mov_b32 s80, s82
  s_mov_b32 s81, s83
  s_mov_b32 s82, s84
  s_mov_b32 s83, s85
  s_xor_b32 s76, s76, 0x8000
  s_cmp_eq_u32 s87, 2
  s_cbranch_scc0 L_kv_top1
  s_nop 7
  v_cvt_pk_bf16_f32 v96, v32, v33
  v_cvt_pk_bf16_f32 v97, v34, v35
  v_cvt_pk_bf16_f32 v98, v40, v41
  v_cvt_pk_bf16_f32 v99, v42, v43
  s_add_u32 s45, s80, 0
  buffer_store_dwordx4 v[96:99], v3, s[4:7], s45 offen sc1
  v_cvt_pk_bf16_f32 v100, v36, v37
  v_cvt_pk_bf16_f32 v101, v38, v39
  v_cvt_pk_bf16_f32 v102, v44, v45
  v_cvt_pk_bf16_f32 v103, v46, v47
  s_add_u32 s45, s80, 4096
  buffer_store_dwordx4 v[100:103], v3, s[4:7], s45 offen sc1
  v_cvt_pk_bf16_f32 v104, v48, v49
  v_cvt_pk_bf16_f32 v105, v50, v51
  v_cvt_pk_bf16_f32 v106, v52, v53
  v_cvt_pk_bf16_f32 v107, v54, v55
  s_add_u32 s45, s75, s80
  s_add_u32 s45, s45, 8192
  buffer_store_dwordx4 v[104:107], v3, s[4:7], s45 offen sc1
  v_cvt_pk_bf16_f32 v108, v56, v57
  v_cvt_pk_bf16_f32 v109, v58, v59
  v_cvt_pk_bf16_f32 v110, v60, v61
  v_cvt_pk_bf16_f32 v111, v62, v63
  s_add_u32 s45, s75, s80
  s_add_u32 s45, s45, 9216
  buffer_store_dwordx4 v[108:111], v3, s[4:7], s45 offen sc1
  s_waitcnt vmcnt(0)
  s_barrier
  v_mov_b32 v8, s81
  v_mov_b32 v9, 4
  s_mov_b64 exec, s[78:79]
  buffer_store_dword v9, v8, s[4:7], 0 offen sc1
  s_mov_b64 exec, -1
  s_mov_b32 s80, 0xf800000
  s_mov_b32 s81, 0x128000
  s_cmp_lt_u32 s73, 64
  s_cbranch_scc0 L_kv_fin
L_wn_56:
  v_and_b32 v4, 63, v0
  v_lshlrev_b32 v4, 2, v4
  v_add_u32 v4, s74, v4
  s_mov_b64 exec, 0xf
  buffer_load_dword v5, v4, s[4:7], 0 offen sc1
  s_mov_b64 exec, -1
  s_waitcnt vmcnt(0)
  v_cmp_ne_u32 vcc, 0, v5
  s_and_b32 s45, vcc_lo, 0xf
  s_cmp_eq_u32 s45, 0xf
  s_cselect_b32 s45, 1, 0
  s_cmp_eq_u32 s45, 1
  s_cbranch_scc1 L_wnd_57
  s_sub_u32 s64, s64, 1
  s_cbranch_scc1 L_abort
  s_sleep 4
  s_branch L_wn_56
L_wnd_57:
  s_mov_b32 s86, s67
  s_mov_b32 s84, s69
  s_mov_b32 s85, s71
  s_mov_b32 s87, 1
  s_add_u32 s67, s67, 32768
  s_add_u32 s73, s73, 1
  s_add_u32 s74, s74, 128
  s_add_u32 s69, s69, 16384
  s_add_u32 s71, s71, 4096
  v_and_b32 v4, 63, v0
  v_lshlrev_b32 v4, 2, v4
  v_add_u32 v4, s74, v4
  s_mov_b64 exec, 0xf
  buffer_load_dword v5, v4, s[4:7], 0 offen sc1
  s_mov_b64 exec, -1
  s_add_u32 s47, s76, s75
  s_add_u32 s45, s47, 0
  s_mov_b32 m0, s45
  s_add_u32 s46, s86, 0
  buffer_load_dwordx4 v3, s[4:7], s46 offen sc1 lds
  s_add_u32 s45, s47, 4096
  s_mov_b32 m0, s45
  s_add_u32 s46, s86, 4096
  buffer_load_dwordx4 v3, s[4:7], s46 offen sc1 lds
  s_add_u32 s45, s47, 8192
  s_mov_b32 m0, s45
  s_add_u32 s46, s86, 8192
  buffer_load_dwordx4 v3, s[4:7], s46 offen sc1 lds
  s_add_u32 s45, s47, 12288
  s_mov_b32 m0, s45
  s_add_u32 s46, s86, 12288
  buffer_load_dwordx4 v3, s[4:7], s46 offen sc1 lds
  s_add_u32 s45, s47, 16384
  s_mov_b32 m0, s45
  s_add_u32 s46, s86, 16384
  buffer_load_dwordx4 v3, s[4:7], s46 offen sc1 lds
  s_add_u32 s45, s47, 20480
  s_mov_b32 m0, s45
  s_add_u32 s46, s86, 20480
  buffer_load_dwordx4 v3, s[4:7], s46 offen sc1 lds
  s_add_u32 s45, s47, 24576
  s_mov_b32 m0, s45
  s_add_u32 s46, s86, 24576
  buffer_load_dwordx4 v3, s[4:7], s46 offen sc1 lds
  s_add_u32 s45, s47, 28672
  s_mov_b32 m0, s45
  s_add_u32 s46, s86, 28672
  buffer_load_dwordx4 v3, s[4:7], s46 offen sc1 lds
  s_mov_b32 s82, s84
  s_mov_b32 s83, s85
  s_waitcnt vmcnt(0)
  s_barrier
  v_cmp_ne_u32 vcc, 0, v5
  s_and_b32 s77, vcc_lo, 0xf
  s_cmp_eq_u32 s77, 0xf
  s_cselect_b32 s77, 1, 0
  v_mov_b32 v5, s77
  v_mov_b32 v6, 0x10000
  s_cmp_eq_u32 s16, 0
  s_cbranch_scc0 L_sh_58
  s_mov_b64 exec, 1
  ds_write_b32 v6, v5
  s_mov_b64 exec, -1
  s_waitcnt lgkmcnt(0)
L_sh_58:
  s_barrier
  ds_read_b32 v8, v6
  s_waitcnt lgkmcnt(0)
  v_readfirstlane_b32 s77, v8
  s_branch L_kv_top1
L_kv_top1:
  s_cmp_lt_u32 s73, 64
  s_cbranch_scc0 L_n0_59
  s_cmp_eq_u32 s77, 1
  s_cbranch_scc0 L_n0_59
  s_mov_b32 s86, s67
  s_mov_b32 s84, s69
  s_mov_b32 s85, s71
  s_mov_b32 s87, 1
  s_add_u32 s67, s67, 32768
  s_add_u32 s73, s73, 1
  s_add_u32 s74, s74, 128
  s_add_u32 s69, s69, 16384
  s_add_u32 s71, s71, 4096
  s_branch L_nn_60
L_n0_59:
  s_cmp_lt_u32 s72, 64
  s_cbranch_scc0 L_nz_61
  s_mov_b32 s86, s66
  s_mov_b32 s84, s68
  s_mov_b32 s85, s70
  s_mov_b32 s87, 0
  s_cmp_lt_u32 s72, 64
  s_cselect_b32 s61, 2, 1
  s_add_u32 s72, s72, s61
  s_lshl_b32 s45, s61, 15
  s_add_u32 s66, s66, s45
  s_lshl_b32 s45, s61, 14
  s_add_u32 s68, s68, s45
  s_lshl_b32 s45, s61, 12
  s_add_u32 s70, s70, s45
  s_branch L_nn_60
L_nz_61:
  s_mov_b32 s87, 2
  s_mov_b32 s86, 0x5200000
L_nn_60:
  v_add_u32 v7, s76, v2
  s_xor_b32 s60, s76, 0x8000
  s_add_u32 s60, s60, s75
  ds_read_b128 v[12:15], v7 offset:0
  ds_read_b128 v[16:19], v7 offset:1024
  s_waitcnt lgkmcnt(1)
  v_mfma_f32_16x16x32_bf16 v[64:67], a[0:3], v[12:15], 0
  ds_read_b128 v[20:23], v7 offset:2048
  v_mfma_f32_16x16x32_bf16 v[72:75], a[64:67], v[12:15], 0
  v_mfma_f32_16x16x32_bf16 v[80:83], v[12:15], a[128:131], 0
  v_mfma_f32_16x16x32_bf16 v[88:91], v[12:15], a[192:195], 0
  s_waitcnt lgkmcnt(1)
  v_mfma_f32_16x16x32_bf16 v[64:67], a[4:7], v[16:19], v[64:67]
  ds_read_b128 v[12:15], v7 offset:3072
  v_mfma_f32_16x16x32_bf16 v[72:75], a[68:71], v[16:19], v[72:75]
  v_mfma_f32_16x16x32_bf16 v[80:83], v[16:19], a[132:135], v[80:83]
  v_mfma_f32_16x16x32_bf16 v[88:91], v[16:19], a[196:199], v[88:91]
  s_waitcnt lgkmcnt(1)
  v_mfma_f32_16x16x32_bf16 v[64:67], a[8:11], v[20:23], v[64:67]
  ds_read_b128 v[16:19], v7 offset:4096
  v_cvt_pk_bf16_f32 v96, v32, v33
  v_mfma_f32_16x16x32_bf16 v[72:75], a[72:75], v[20:23], v[72:75]
  v_cvt_pk_bf16_f32 v97, v34, v35
  v_cvt_pk_bf16_f32 v98, v40, v41
  v_mfma_f32_16x16x32_bf16 v[80:83], v[20:23], a[136:139], v[80:83]
  v_cvt_pk_bf16_f32 v99, v42, v43
  v_mfma_f32_16x16x32_bf16 v[88:91], v[20:23], a[200:203], v[88:91]
  s_waitcnt lgkmcnt(1)
  v_mfma_f32_16x16x32_bf16 v[64:67], a[12:15], v[12:15], v[64:67]
  ds_read_b128 v[20:23], v7 offset:5120
  s_add_u32 s45, s80, 0
  v_mfma_f32_16x16x32_bf16 v[72:75], a[76:79], v[12:15], v[72:75]
  buffer_store_dwordx4 v[96:99], v3, s[4:7], s45 offen sc1
  v_cvt_pk_bf16_f32 v100, v36, v37
  v_mfma_f32_16x16x32_bf16 v[80:83], v[12:15], a[140:143], v[80:83]
  v_cvt_pk_bf16_f32 v101, v38, v39
  v_mfma_f32_16x16x32_bf16 v[88:91], v[12:15], a[204:207], v[88:91]
  s_waitcnt lgkmcnt(1)
  v_mfma_f32_16x16x32_bf16 v[64:67], a[16:19], v[16:19], v[64:67]
  ds_read_b128 v[12:15], v7 offset:6144
  v_cvt_pk_bf16_f32 v102, v44, v45
  v_mfma_f32_16x16x32_bf16 v[72:75], a[80:83], v[16:19], v[72:75]
  v_cvt_pk_bf16_f32 v103, v46, v47
  s_add_u32 s45, s80, 4096
  v_mfma_f32_16x16x32_bf16 v[80:83], v[16:19], a[144:147], v[80:83]
  buffer_store_dwordx4 v[100:103], v3, s[4:7], s45 offen sc1
  v_mfma_f32_16x16x32_bf16 v[88:91], v[16:19], a[208:211], v[88:91]
  s_waitcnt lgkmcnt(1)
  v_mfma_f32_16x16x32_bf16 v[64:67], a[20:23], v[20:23], v[64:67]
  ds_read_b128 v[16:19], v7 offset:7168
  v_cvt_pk_bf16_f32 v104, v48, v49
  v_mfma_f32_16x16x32_bf16 v[72:75], a[84:87], v[20:23], v[72:75]
  v_cvt_pk_bf16_f32 v105, v50, v51
  v_cvt_pk_bf16_f32 v106, v52, v53
  v_mfma_f32_16x16x32_bf16 v[80:83], v[20:23], a[148:151], v[80:83]
  v_cvt_pk_bf16_f32 v107, v54, v55
  v_mfma_f32_16x16x32_bf16 v[88:91], v[20:23], a[212:215], v[88:91]
  s_waitcnt lgkmcnt(1)
  v_mfma_f32_16x16x32_bf16 v[64:67], a[24:27], v[12:15], v[64:67]
  ds_read_b128 v[20:23], v7 offset:8192
  s_add_u32 s45, s75, s80
  v_mfma_f32_16x16x32_bf16 v[72:75], a[88:91], v[12:15], v[72:75]
  s_add_u32 s45, s45, 8192
  buffer_store_dwordx4 v[104:107], v3, s[4:7], s45 offen sc1
  v_mfma_f32_16x16x32_bf16 v[80:83], v[12:15], a[152:155], v[80:83]
  v_cvt_pk_bf16_f32 v108, v56, v57
  v_mfma_f32_16x16x32_bf16 v[88:91], v[12:15], a[216:219], v[88:91]
  s_waitcnt lgkmcnt(1)
  v_mfma_f32_16x16x32_bf16 v[64:67], a[28:31], v[16:19], v[64:67]
  ds_read_b128 v[12:15], v7 offset:9216
  v_cvt_pk_bf16_f32 v109, v58, v59
  v_mfma_f32_16x16x32_bf16 v[72:75], a[92:95], v[16:19], v[72:75]
  v_cvt_pk_bf16_f32 v110, v60, v61
  v_cvt_pk_bf16_f32 v111, v62, v63
  v_mfma_f32_16x16x32_bf16 v[80:83], v[16:19], a[156:159], v[80:83]
  s_add_u32 s45, s75, s80
  v_mfma_f32_16x16x32_bf16 v[88:91], v[16:19], a[220:223], v[88:91]
  s_waitcnt lgkmcnt(1)
  v_mfma_f32_16x16x32_bf16 v[64:67], a[32:35], v[20:23], v[64:67]
  ds_read_b128 v[16:19], v7 offset:10240
  s_add_u32 s45, s45, 9216
  v_mfma_f32_16x16x32_bf16 v[72:75], a[96:99], v[20:23], v[72:75]
  buffer_store_dwordx4 v[108:111], v3, s[4:7], s45 offen sc1
  v_mfma_f32_16x16x32_bf16 v[80:83], v[20:23], a[160:163], v[80:83]
  v_mfma_f32_16x16x32_bf16 v[88:91], v[20:23], a[224:227], v[88:91]
  s_waitcnt lgkmcnt(1)
  v_mfma_f32_16x16x32_bf16 v[64:67], a[36:39], v[12:15], v[64:67]
  ds_read_b128 v[20:23], v7 offset:11264
  v_mfma_f32_16x16x32_bf16 v[72:75], a[100:103], v[12:15], v[72:75]
  v_mfma_f32_16x16x32_bf16 v[80:83], v[12:15], a[164:167], v[80:83]
  v_mfma_f32_16x16x32_bf16 v[88:91], v[12:15], a[228:231], v[88:91]
  s_waitcnt lgkmcnt(1)
  v_mfma_f32_16x16x32_bf16 v[64:67], a[40:43], v[16:19], v[64:67]
  ds_read_b128 v[12:15], v7 offset:12288
  s_add_u32 s47, s60, 0
  v_mfma_f32_16x16x32_bf16 v[72:75], a[104:107], v[16:19], v[72:75]
  s_mov_b32 m0, s47
  s_add_u32 s48, s86, 0
  v_mfma_f32_16x16x32_bf16 v[80:83], v[16:19], a[168:171], v[80:83]
  buffer_load_dwordx4 v3, s[4:7], s48 offen sc1 lds
  v_mfma_f32_16x16x32_bf16 v[88:91], v[16:19], a[232:235], v[88:91]
  s_waitcnt lgkmcnt(1)
  v_mfma_f32_16x16x32_bf16 v[64:67], a[44:47], v[20:23], v[64:67]
  ds_read_b128 v[16:19], v7 offset:13312
  s_add_u32 s47, s60, 4096
  v_mfma_f32_16x16x32_bf16 v[72:75], a[108:111], v[20:23], v[72:75]
  s_mov_b32 m0, s47
  s_add_u32 s48, s86, 4096
  v_mfma_f32_16x16x32_bf16 v[80:83], v[20:23], a[172:175], v[80:83]
  buffer_load_dwordx4 v3, s[4:7], s48 offen sc1 lds
  v_mfma_f32_16x16x32_bf16 v[88:91], v[20:23], a[236:239], v[88:91]
  s_waitcnt lgkmcnt(1)
  v_mfma_f32_16x16x32_bf16 v[64:67], a[48:51], v[12:15], v[64:67]
  ds_read_b128 v[20:23], v7 offset:14336
  s_add_u32 s47, s60, 8192
  v_mfma_f32_16x16x32_bf16 v[72:75], a[112:115], v[12:15], v[72:75]
  s_mov_b32 m0, s47
  s_add_u32 s48, s86, 8192
  v_mfma_f32_16x16x32_bf16 v[80:83], v[12:15], a[176:179], v[80:83]
  buffer_load_dwordx4 v3, s[4:7], s48 offen sc1 lds
  v_mfma_f32_16x16x32_bf16 v[88:91], v[12:15], a[240:243], v[88:91]
  s_waitcnt lgkmcnt(1)
  v_mfma_f32_16x16x32_bf16 v[64:67], a[52:55], v[16:19], v[64:67]
  ds_read_b128 v[12:15], v7 offset:15360
  s_add_u32 s47, s60, 12288
  v_mfma_f32_16x16x32_bf16 v[72:75], a[116:119], v[16:19], v[72:75]
  s_mov_b32 m0, s47
  s_add_u32 s48, s86, 12288
  v_mfma_f32_16x16x32_bf16 v[80:83], v[16:19], a[180:183], v[80:83]
  buffer_load_dwordx4 v3, s[4:7], s48 offen sc1 lds
  v_mfma_f32_16x16x32_bf16 v[88:91], v[16:19], a[244:247], v[88:91]
  s_waitcnt lgkmcnt(1)
  v_mfma_f32_16x16x32_bf16 v[64:67], a[56:59], v[20:23], v[64:67]
  ds_read_b128 v[16:19], v7 offset:16384
  s_add_u32 s47, s60, 16384
  v_mfma_f32_16x16x32_bf16 v[72:75], a[120:123], v[20:23], v[72:75]
  s_mov_b32 m0, s47
  s_add_u32 s48, s86, 16384
  v_mfma_f32_16x16x32_bf16 v[80:83], v[20:23], a[184:187], v[80:83]
  buffer_load_dwordx4 v3, s[4:7], s48 offen sc1 lds
  v_mfma_f32_16x16x32_bf16 v[88:91], v[20:23], a[248:251], v[88:91]
  s_waitcnt lgkmcnt(1)
  v_mfma_f32_16x16x32_bf16 v[64:67], a[60:63], v[12:15], v[64:67]
  ds_read_b128 v[20:23], v7 offset:17408
  s_add_u32 s47, s60, 20480
  v_mfma_f32_16x16x32_bf16 v[72:75], a[124:127], v[12:15], v[72:75]
  s_mov_b32 m0, s47
  s_add_u32 s48, s86, 20480
  v_mfma_f32_16x16x32_bf16 v[80:83], v[12:15], a[188:191], v[80:83]
  buffer_load_dwordx4 v3, s[4:7], s48 offen sc1 lds
  v_mfma_f32_16x16x32_bf16 v[88:91], v[12:15], a[252:255], v[88:91]
  s_waitcnt lgkmcnt(1)
  v_mfma_f32_16x16x32_bf16 v[68:71], a[0:3], v[16:19], 0
  ds_read_b128 v[12:15], v7 offset:18432
  s_add_u32 s47, s60, 24576
  v_mfma_f32_16x16x32_bf16 v[76:79], a[64:67], v[16:19], 0
  s_mov_b32 m0, s47
  s_add_u32 s48, s86, 24576
  v_mfma_f32_16x16x32_bf16 v[84:87], v[16:19], a[128:131], 0
  buffer_load_dwordx4 v3, s[4:7], s48 offen sc1 lds
  v_mfma_f32_16x16x32_bf16 v[92:95], v[16:19], a[192:195], 0
  s_waitcnt lgkmcnt(1)
  v_mfma_f32_16x16x32_bf16 v[68:71], a[4:7], v[20:23], v[68:71]
  ds_read_b128 v[16:19], v7 offset:19456
  s_add_u32 s47, s60, 28672
  v_mfma_f32_16x16x32_bf16 v[76:79], a[68:71], v[20:23], v[76:79]
  s_mov_b32 m0, s47
  s_add_u32 s48, s86, 28672
  v_mfma_f32_16x16x32_bf16 v[84:87], v[20:23], a[132:135], v[84:87]
  buffer_load_dwordx4 v3, s[4:7], s48 offen sc1 lds
  v_mfma_f32_16x16x32_bf16 v[92:95], v[20:23], a[196:199], v[92:95]
  s_waitcnt lgkmcnt(1)
  v_mfma_f32_16x16x32_bf16 v[68:71], a[8:11], v[12:15], v[68:71]
  ds_read_b128 v[20:23], v7 offset:20480
  v_mfma_f32_16x16x32_bf16 v[76:79], a[72:75], v[12:15], v[76:79]
  v_mfma_f32_16x16x32_bf16 v[84:87], v[12:15], a[136:139], v[84:87]
  v_mfma_f32_16x16x32_bf16 v[92:95], v[12:15], a[200:203], v[92:95]
  s_waitcnt lgkmcnt(1)
  v_mfma_f32_16x16x32_bf16 v[68:71], a[12:15], v[16:19], v[68:71]
  ds_read_b128 v[12:15], v7 offset:21504
  v_mfma_f32_16x16x32_bf16 v[76:79], a[76:79], v[16:19], v[76:79]
  v_mfma_f32_16x16x32_bf16 v[84:87], v[16:19], a[140:143], v[84:87]
  v_mfma_f32_16x16x32_bf16 v[92:95], v[16:19], a[204:207], v[92:95]
  s_waitcnt lgkmcnt(1)
  v_mfma_f32_16x16x32_bf16 v[68:71], a[16:19], v[20:23], v[68:71]
  ds_read_b128 v[16:19], v7 offset:22528
  v_mfma_f32_16x16x32_bf16 v[76:79], a[80:83], v[20:23], v[76:79]
  v_mfma_f32_16x16x32_bf16 v[84:87], v[20:23], a[144:147], v[84:87]
  v_mfma_f32_16x16x32_bf16 v[92:95], v[20:23], a[208:211], v[92:95]
  s_waitcnt lgkmcnt(1)
  v_mfma_f32_16x16x32_bf16 v[68:71], a[20:23], v[12:15], v[68:71]
  ds_read_b128 v[20:23], v7 offset:23552
  v_mfma_f32_16x16x32_bf16 v[76:79], a[84:87], v[12:15], v[76:79]
  v_mfma_f32_16x16x32_bf16 v[84:87], v[12:15], a[148:151], v[84:87]
  v_mfma_f32_16x16x32_bf16 v[92:95], v[12:15], a[212:215], v[92:95]
  s_waitcnt lgkmcnt(1)
  v_mfma_f32_16x16x32_bf16 v[68:71], a[24:27], v[16:19], v[68:71]
  ds_read_b128 v[12:15], v7 offset:24576
  v_mfma_f32_16x16x32_bf16 v[76:79], a[88:91], v[16:19], v[76:79]
  v_mfma_f32_16x16x32_bf16 v[84:87], v[16:19], a[152:155], v[84:87]
  v_mfma_f32_16x16x32_bf16 v[92:95], v[16:19], a[216:219], v[92:95]
  s_waitcnt lgkmcnt(1)
  v_mfma_f32_16x16x32_bf16 v[68:71], a[28:31], v[20:23], v[68:71]
  ds_read_b128 v[16:19], v7 offset:25600
  v_mfma_f32_16x16x32_bf16 v[76:79], a[92:95], v[20:23], v[76:79]
  v_mfma_f32_16x16x32_bf16 v[84:87], v[20:23], a[156:159], v[84:87]
  v_mfma_f32_16x16x32_bf16 v[92:95], v[20:23], a[220:223], v[92:95]
  s_waitcnt lgkmcnt(1)
  v_mfma_f32_16x16x32_bf16 v[68:71], a[32:35], v[12:15], v[68:71]
  ds_read_b128 v[20:23], v7 offset:26624
  v_mfma_f32_16x16x32_bf16 v[76:79], a[96:99], v[12:15], v[76:79]
  v_mfma_f32_16x16x32_bf16 v[84:87], v[12:15], a[160:163], v[84:87]
  v_mfma_f32_16x16x32_bf16 v[92:95], v[12:15], a[224:227], v[92:95]
  s_waitcnt lgkmcnt(1)
  v_mfma_f32_16x16x32_bf16 v[68:71], a[36:39], v[16:19], v[68:71]
  ds_read_b128 v[12:15], v7 offset:27648
  v_mfma_f32_16x16x32_bf16 v[76:79], a[100:103], v[16:19], v[76:79]
  v_mfma_f32_16x16x32_bf16 v[84:87], v[16:19], a[164:167], v[84:87]
  v_mfma_f32_16x16x32_bf16 v[92:95], v[16:19], a[228:231], v[92:95]
  s_waitcnt vmcnt(8)
  s_barrier
  v_and_b32 v4, 63, v0
  v_lshlrev_b32 v4, 2, v4
  v_add_u32 v4, s74, v4
  s_mov_b64 exec, 0xf
  buffer_load_dword v5, v4, s[4:7], 0 offen sc1
  s_mov_b64 exec, -1
  v_mov_b32 v8, s81
  v_mov_b32 v9, 4
  s_mov_b64 exec, s[78:79]
  buffer_store_dword v9, v8, s[4:7], 0 offen sc1
  s_mov_b64 exec, -1
  s_waitcnt lgkmcnt(1)
  v_mfma_f32_16x16x32_bf16 v[68:71], a[40:43], v[20:23], v[68:71]
  ds_read_b128 v[16:19], v7 offset:28672
  v_mfma_f32_16x16x32_bf16 v[76:79], a[104:107], v[20:23], v[76:79]
  v_mfma_f32_16x16x32_bf16 v[84:87], v[20:23], a[168:171], v[84:87]
  v_mfma_f32_16x16x32_bf16 v[92:95], v[20:23], a[232:235], v[92:95]
  s_waitcnt lgkmcnt(1)
  v_mfma_f32_16x16x32_bf16 v[68:71], a[44:47], v[12:15], v[68:71]
  ds_read_b128 v[20:23], v7 offset:29696
  v_mfma_f32_16x16x32_bf16 v[76:79], a[108:111], v[12:15], v[76:79]
  v_mfma_f32_16x16x32_bf16 v[84:87], v[12:15], a[172:175], v[84:87]
  v_mfma_f32_16x16x32_bf16 v[92:95], v[12:15], a[236:239], v[92:95]
  s_waitcnt lgkmcnt(1)
  v_mfma_f32_16x16x32_bf16 v[68:71], a[48:51], v[16:19], v[68:71]
  ds_read_b128 v[12:15], v7 offset:30720
  v_mfma_f32_16x16x32_bf16 v[76:79], a[112:115], v[16:19], v[76:79]
  v_mfma_f32_16x16x32_bf16 v[84:87], v[16:19], a[176:179], v[84:87]
  v_mfma_f32_16x16x32_bf16 v[92:95], v[16:19], a[240:243], v[92:95]
  s_waitcnt lgkmcnt(1)
  v_mfma_f32_16x16x32_bf16 v[68:71], a[52:55], v[20:23], v[68:71]
  ds_read_b128 v[16:19], v7 offset:31744
  v_mfma_f32_16x16x32_bf16 v[76:79], a[116:119], v[20:23], v[76:79]
  v_mfma_f32_16x16x32_bf16 v[84:87], v[20:23], a[180:183], v[84:87]
  v_mfma_f32_16x16x32_bf16 v[92:95], v[20:23], a[244:247], v[92:95]
  s_waitcnt lgkmcnt(1)
  v_mfma_f32_16x16x32_bf16 v[68:71], a[56:59], v[12:15], v[68:71]
  v_mfma_f32_16x16x32_bf16 v[76:79], a[120:123], v[12:15], v[76:79]
  v_mfma_f32_16x16x32_bf16 v[84:87], v[12:15], a[184:187], v[84:87]
  v_mfma_f32_16x16x32_bf16 v[92:95], v[12:15], a[248:251], v[92:95]
  s_waitcnt lgkmcnt(0)
  v_mfma_f32_16x16x32_bf16 v[68:71], a[60:63], v[16:19], v[68:71]
  v_mfma_f32_16x16x32_bf16 v[76:79], a[124:127], v[16:19], v[76:79]
  v_mfma_f32_16x16x32_bf16 v[84:87], v[16:19], a[188:191], v[84:87]
  v_mfma_f32_16x16x32_bf16 v[92:95], v[16:19], a[252:255], v[92:95]
  s_waitcnt vmcnt(1)
  v_cmp_ne_u32 vcc, 0, v5
  s_and_b32 s77, vcc_lo, 0xf
  s_cmp_eq_u32 s77, 0xf
  s_cselect_b32 s77, 1, 0
  v_mov_b32 v5, s77
  v_mov_b32 v6, 0x10000
  s_cmp_eq_u32 s16, 0
  s_cbranch_scc0 L_sh_62
  s_mov_b64 exec, 1
  ds_write_b32 v6, v5
  s_mov_b64 exec, -1
  s_waitcnt lgkmcnt(0)
L_sh_62:
  s_barrier
  ds_read_b32 v8, v6
  s_waitcnt lgkmcnt(0)
  v_readfirstlane_b32 s77, v8
  s_mov_b32 s80, s82
  s_mov_b32 s81, s83
  s_mov_b32 s82, s84
  s_mov_b32 s83, s85
  s_xor_b32 s76, s76, 0x8000
  s_cmp_eq_u32 s87, 2
  s_cbranch_scc0 L_kv_top0
  s_nop 7
  v_cvt_pk_bf16_f32 v96, v64, v65
  v_cvt_pk_bf16_f32 v97, v66, v67
  v_cvt_pk_bf16_f32 v98, v72, v73
  v_cvt_pk_bf16_f32 v99, v74, v75
  s_add_u32 s45, s80, 0
  buffer_store_dwordx4 v[96:99], v3, s[4:7], s45 offen sc1
  v_cvt_pk_bf16_f32 v100, v68, v69
  v_cvt_pk_bf16_f32 v101, v70, v71
  v_cvt_pk_bf16_f32 v102, v76, v77
  v_cvt_pk_bf16_f32 v103, v78, v79
  s_add_u32 s45, s80, 4096
  buffer_store_dwordx4 v[100:103], v3, s[4:7], s45 offen sc1
  v_cvt_pk_bf16_f32 v104, v80, v81
  v_cvt_pk_bf16_f32 v105, v82, v83
  v_cvt_pk_bf16_f32 v106, v84, v85
  v_cvt_pk_bf16_f32 v107, v86, v87
  s_add_u32 s45, s75, s80
  s_add_u32 s45, s45, 8192
  buffer_store_dwordx4 v[104:107], v3, s[4:7], s45 offen sc1
  v_cvt_pk_bf16_f32 v108, v88, v89
  v_cvt_pk_bf16_f32 v109, v90, v91
  v_cvt_pk_bf16_f32 v110, v92, v93
  v_cvt_pk_bf16_f32 v111, v94, v95
  s_add_u32 s45, s75, s80
  s_add_u32 s45, s45, 9216
  buffer_store_dwordx4 v[108:111], v3, s[4:7], s45 offen sc1
  s_waitcnt vmcnt(0)
  s_barrier
  v_mov_b32 v8, s81
  v_mov_b32 v9, 4
  s_mov_b64 exec, s[78:79]
  buffer_store_dword v9, v8, s[4:7], 0 offen sc1
  s_mov_b64 exec, -1
  s_mov_b32 s80, 0xf800000
  s_mov_b32 s81, 0x128000
  s_cmp_lt_u32 s73, 64
  s_cbranch_scc0 L_kv_fin
L_wn_63:
  v_and_b32 v4, 63, v0
  v_lshlrev_b32 v4, 2, v4
  v_add_u32 v4, s74, v4
  s_mov_b64 exec, 0xf
  buffer_load_dword v5, v4, s[4:7], 0 offen sc1
  s_mov_b64 exec, -1
  s_waitcnt vmcnt(0)
  v_cmp_ne_u32 vcc, 0, v5
  s_and_b32 s45, vcc_lo, 0xf
  s_cmp_eq_u32 s45, 0xf
  s_cselect_b32 s45, 1, 0
  s_cmp_eq_u32 s45, 1
  s_cbranch_scc1 L_wnd_64
  s_sub_u32 s64, s64, 1
  s_cbranch_scc1 L_abort
  s_sleep 4
  s_branch L_wn_63
L_wnd_64:
  s_mov_b32 s86, s67
  s_mov_b32 s84, s69
  s_mov_b32 s85, s71
  s_mov_b32 s87, 1
  s_add_u32 s67, s67, 32768
  s_add_u32 s73, s73, 1
  s_add_u32 s74, s74, 128
  s_add_u32 s69, s69, 16384
  s_add_u32 s71, s71, 4096
  v_and_b32 v4, 63, v0
  v_lshlrev_b32 v4, 2, v4
  v_add_u32 v4, s74, v4
  s_mov_b64 exec, 0xf
  buffer_load_dword v5, v4, s[4:7], 0 offen sc1
  s_mov_b64 exec, -1
  s_add_u32 s47, s76, s75
  s_add_u32 s45, s47, 0
  s_mov_b32 m0, s45
  s_add_u32 s46, s86, 0
  buffer_load_dwordx4 v3, s[4:7], s46 offen sc1 lds
  s_add_u32 s45, s47, 4096
  s_mov_b32 m0, s45
  s_add_u32 s46, s86, 4096
  buffer_load_dwordx4 v3, s[4:7], s46 offen sc1 lds
  s_add_u32 s45, s47, 8192
  s_mov_b32 m0, s45
  s_add_u32 s46, s86, 8192
  buffer_load_dwordx4 v3, s[4:7], s46 offen sc1 lds
  s_add_u32 s45, s47, 12288
  s_mov_b32 m0, s45
  s_add_u32 s46, s86, 12288
  buffer_load_dwordx4 v3, s[4:7], s46 offen sc1 lds
  s_add_u32 s45, s47, 16384
  s_mov_b32 m0, s45
  s_add_u32 s46, s86, 16384
  buffer_load_dwordx4 v3, s[4:7], s46 offen sc1 lds
  s_add_u32 s45, s47, 20480
  s_mov_b32 m0, s45
  s_add_u32 s46, s86, 20480
  buffer_load_dwordx4 v3, s[4:7], s46 offen sc1 lds
  s_add_u32 s45, s47, 24576
  s_mov_b32 m0, s45
  s_add_u32 s46, s86, 24576
  buffer_load_dwordx4 v3, s[4:7], s46 offen sc1 lds
  s_add_u32 s45, s47, 28672
  s_mov_b32 m0, s45
  s_add_u32 s46, s86, 28672
  buffer_load_dwordx4 v3, s[4:7], s46 offen sc1 lds
  s_mov_b32 s82, s84
  s_mov_b32 s83, s85
  s_waitcnt vmcnt(0)
  s_barrier
  v_cmp_ne_u32 vcc, 0, v5
  s_and_b32 s77, vcc_lo, 0xf
  s_cmp_eq_u32 s77, 0xf
  s_cselect_b32 s77, 1, 0
  v_mov_b32 v5, s77
  v_mov_b32 v6, 0x10000
  s_cmp_eq_u32 s16, 0
  s_cbranch_scc0 L_sh_65
  s_mov_b64 exec, 1
  ds_write_b32 v6, v5
  s_mov_b64 exec, -1
  s_waitcnt lgkmcnt(0)
L_sh_65:
  s_barrier
  ds_read_b32 v8, v6
  s_waitcnt lgkmcnt(0)
  v_readfirstlane_b32 s77, v8
  s_branch L_kv_top0
L_kv_fin:
  s_waitcnt vmcnt(0)
  s_branch L_end
L_role_g3:
  v_and_b32 v1, 63, v0
  v_lshlrev_b32 v2, 4, v1
  s_cmp_eq_u32 s99, 1
  s_cbranch_scc1 L_gs_done_66
  s_cmp_eq_u32 s16, 0
  s_cbranch_scc0 L_gs_w_67
  v_mov_b32 v100, 32
L_gs_p_68:
  s_mov_b64 exec, 1
  global_load_dword v101, v100, s[40:41] sc1
  s_mov_b64 exec, -1
  s_waitcnt vmcnt(0)
  v_readfirstlane_b32 s45, v101
  s_sub_u32 s64, s64, 1
  s_cbranch_scc1 L_abort
  s_cmp_ge_u32 s45, 256
  s_cbranch_scc1 L_gs_q_69
  s_sleep 4
  s_branch L_gs_p_68
L_gs_q_69:
  v_and_b32 v102, 63, v0
  v_lshlrev_b32 v102, 2, v102
  s_mov_b64 exec, 0xff
  global_load_dword v101, v102, s[40:41] sc1
  s_waitcnt vmcnt(0)
  ds_write_b32 v102, v101
  s_mov_b64 exec, -1
  s_waitcnt lgkmcnt(0)
L_gs_w_67:
  s_barrier
  v_mov_b32 v100, 0
  ds_read_b128 v[104:107], v100
  ds_read_b128 v[108:111], v100 offset:16
  s_waitcnt lgkmcnt(0)
  s_mov_b32 s44, 1
  s_mov_b32 s46, 0
  v_readfirstlane_b32 s45, v104
  s_cmp_eq_u32 s45, 32
  s_cselect_b32 s44, s44, 0
  s_cmp_gt_u32 s18, 0
  s_cselect_b32 s45, s45, 0
  s_add_u32 s46, s46, s45
  v_readfirstlane_b32 s45, v105
  s_cmp_eq_u32 s45, 32
  s_cselect_b32 s44, s44, 0
  s_cmp_gt_u32 s18, 1
  s_cselect_b32 s45, s45, 0
  s_add_u32 s46, s46, s45
  v_readfirstlane_b32 s45, v106
  s_cmp_eq_u32 s45, 32
  s_cselect_b32 s44, s44, 0
  s_cmp_gt_u32 s18, 2
  s_cselect_b32 s45, s45, 0
  s_add_u32 s46, s46, s45
  v_readfirstlane_b32 s45, v107
  s_cmp_eq_u32 s45, 32
  s_cselect_b32 s44, s44, 0
  s_cmp_gt_u32 s18, 3
  s_cselect_b32 s45, s45, 0
  s_add_u32 s46, s46, s45
  v_readfirstlane_b32 s45, v108
  s_cmp_eq_u32 s45, 32
  s_cselect_b32 s44, s44, 0
  s_cmp_gt_u32 s18, 4
  s_cselect_b32 s45, s45, 0
  s_add_u32 s46, s46, s45
  v_readfirstlane_b32 s45, v109
  s_cmp_eq_u32 s45, 32
  s_cselect_b32 s44, s44, 0
  s_cmp_gt_u32 s18, 5
  s_cselect_b32 s45, s45, 0
  s_add_u32 s46, s46, s45
  v_readfirstlane_b32 s45, v110
  s_cmp_eq_u32 s45, 32
  s_cselect_b32 s44, s44, 0
  s_cmp_gt_u32 s18, 6
  s_cselect_b32 s45, s45, 0
  s_add_u32 s46, s46, s45
  v_readfirstlane_b32 s45, v111
  s_cmp_eq_u32 s45, 32
  s_cselect_b32 s44, s44, 0
  s_cmp_gt_u32 s18, 7
  s_cselect_b32 s45, s45, 0
  s_add_u32 s46, s46, s45
  s_barrier
  s_mov_b32 s99, 1
  s_cmp_eq_u32 s44, 1
  s_cbranch_scc1 L_gs_done_66
  s_add_u32 s17, s46, s98
  s_branch L_dispatch
L_gs_done_66:
  s_mul_i32 s50, s16, 40960
  s_and_b32 s45, s17, 3
  s_lshl_b32 s45, s45, 8
  s_lshl_b32 s46, s16, 6
  s_add_u32 s51, s45, s46
  s_lshr_b32 s45, s17, 2
  s_lshl_b32 s45, s45, 20
  s_add_u32 s51, s51, s45
  v_bfe_u32 v12, v1, 4, 1
  v_bfe_u32 v13, v1, 5, 1
  v_xor_b32 v12, v12, v13
  v_lshlrev_b32 v12, 1, v12
  v_and_b32 v13, 3, v1
  v_xor_b32 v12, v12, v13
  v_lshlrev_b32 v12, 4, v12
  v_lshrrev_b32 v13, 2, v1
  s_mov_b32 s45, 1024
  v_mul_lo_u32 v13, s45, v13
  v_add_u32 v15, v12, v13
  v_lshrrev_b32 v12, 4, v1
  v_bfe_u32 v13, v1, 2, 2
  v_lshl_add_u32 v14, v12, 3, v13
  v_lshlrev_b32 v14, 6, v14
  v_and_b32 v8, 3, v1
  v_lshl_add_u32 v14, v8, 3, v14
  v_and_b32 v8, 1, v12
  v_lshl_add_u32 v14, v8, 5, v14
  v_add_u32 v8, s50, v14
  v_xor_b32 v9, 32, v8
  v_lshl_add_u32 v14, v12, 2, v13
  v_lshlrev_b32 v14, 6, v14
  v_and_b32 v10, 3, v1
  v_lshl_add_u32 v14, v10, 3, v14
  v_lshrrev_b32 v13, 1, v12
  v_xor_b32 v13, v13, v12
  v_and_b32 v13, 1, v13
  v_lshl_add_u32 v14, v13, 5, v14
  v_add_u32 v10, s50, v14
  v_xor_b32 v11, 32, v10
  s_mov_b32 s8, s30
  s_and_b32 s9, s31, 0xffff
  s_mov_b32 s10, 0x400000
  s_mov_b32 s11, 0x20000
  s_add_u32 s45, s50, 0
  s_mov_b32 m0, s45
  s_add_u32 s46, s51, 0
  buffer_load_dwordx4 v15, s[8:11], s46 offen lds
  s_add_u32 s45, s50, 1024
  s_mov_b32 m0, s45
  s_add_u32 s46, s51, 16384
  buffer_load_dwordx4 v15, s[8:11], s46 offen lds
  s_add_u32 s45, s50, 2048
  s_mov_b32 m0, s45
  s_add_u32 s46, s51, 32768
  buffer_load_dwordx4 v15, s[8:11], s46 offen lds
  s_add_u32 s45, s50, 3072
  s_mov_b32 m0, s45
  s_add_u32 s46, s51, 49152
  buffer_load_dwordx4 v15, s[8:11], s46 offen lds
  s_add_u32 s45, s50, 4096
  s_mov_b32 m0, s45
  s_add_u32 s46, s51, 65536
  buffer_load_dwordx4 v15, s[8:11], s46 offen lds
  s_add_u32 s45, s50, 5120
  s_mov_b32 m0, s45
  s_add_u32 s46, s51, 81920
  buffer_load_dwordx4 v15, s[8:11], s46 offen lds
  s_add_u32 s45, s50, 6144
  s_mov_b32 m0, s45
  s_add_u32 s46, s51, 98304
  buffer_load_dwordx4 v15, s[8:11], s46 offen lds
  s_add_u32 s45, s50, 7168
  s_mov_b32 m0, s45
  s_add_u32 s46, s51, 114688
  buffer_load_dwordx4 v15, s[8:11], s46 offen lds
  s_add_u32 s45, s50, 8192
  s_mov_b32 m0, s45
  s_add_u32 s46, s51, 131072
  buffer_load_dwordx4 v15, s[8:11], s46 offen lds
  s_add_u32 s45, s50, 9216
  s_mov_b32 m0, s45
  s_add_u32 s46, s51, 147456
  buffer_load_dwordx4 v15, s[8:11], s46 offen lds
  s_add_u32 s45, s50, 10240
  s_mov_b32 m0, s45
  s_add_u32 s46, s51, 163840
  buffer_load_dwordx4 v15, s[8:11], s46 offen lds
  s_add_u32 s45, s50, 11264
  s_mov_b32 m0, s45
  s_add_u32 s46, s51, 180224
  buffer_load_dwordx4 v15, s[8:11], s46 offen lds
  s_add_u32 s45, s50, 12288
  s_mov_b32 m0, s45
  s_add_u32 s46, s51, 196608
  buffer_load_dwordx4 v15, s[8:11], s46 offen lds
  s_add_u32 s45, s50, 13312
  s_mov_b32 m0, s45
  s_add_u32 s46, s51, 212992
  buffer_load_dwordx4 v15, s[8:11], s46 offen lds
  s_add_u32 s45, s50, 14336
  s_mov_b32 m0, s45
  s_add_u32 s46, s51, 229376
  buffer_load_dwordx4 v15, s[8:11], s46 offen lds
  s_add_u32 s45, s50, 15360
  s_mov_b32 m0, s45
  s_add_u32 s46, s51, 245760
  buffer_load_dwordx4 v15, s[8:11], s46 offen lds
  s_add_u32 s45, s50, 16384
  s_mov_b32 m0, s45
  s_add_u32 s46, s51, 262144
  buffer_load_dwordx4 v15, s[8:11], s46 offen lds
  s_add_u32 s45, s50, 17408
  s_mov_b32 m0, s45
  s_add_u32 s46, s51, 278528
  buffer_load_dwordx4 v15, s[8:11], s46 offen lds
  s_add_u32 s45, s50, 18432
  s_mov_b32 m0, s45
  s_add_u32 s46, s51, 294912
  buffer_load_dwordx4 v15, s[8:11], s46 offen lds
  s_add_u32 s45, s50, 19456
  s_mov_b32 m0, s45
  s_add_u32 s46, s51, 311296
  buffer_load_dwordx4 v15, s[8:11], s46 offen lds
  s_add_u32 s45, s50, 20480
  s_mov_b32 m0, s45
  s_add_u32 s46, s51, 327680
  buffer_load_dwordx4 v15, s[8:11], s46 offen lds
  s_add_u32 s45, s50, 21504
  s_mov_b32 m0, s45
  s_add_u32 s46, s51, 344064
  buffer_load_dwordx4 v15, s[8:11], s46 offen lds
  s_add_u32 s45, s50, 22528
  s_mov_b32 m0, s45
  s_add_u32 s46, s51, 360448
  buffer_load_dwordx4 v15, s[8:11], s46 offen lds
  s_add_u32 s45, s50, 23552
  s_mov_b32 m0, s45
  s_add_u32 s46, s51, 376832
  buffer_load_dwordx4 v15, s[8:11], s46 offen lds
  s_add_u32 s45, s50, 24576
  s_mov_b32 m0, s45
  s_add_u32 s46, s51, 393216
  buffer_load_dwordx4 v15, s[8:11], s46 offen lds
  s_add_u32 s45, s50, 25600
  s_mov_b32 m0, s45
  s_add_u32 s46, s51, 409600
  buffer_load_dwordx4 v15, s[8:11], s46 offen lds
  s_add_u32 s45, s50, 26624
  s_mov_b32 m0, s45
  s_add_u32 s46, s51, 425984
  buffer_load_dwordx4 v15, s[8:11], s46 offen lds
  s_add_u32 s45, s50, 27648
  s_mov_b32 m0, s45
  s_add_u32 s46, s51, 442368
  buffer_load_dwordx4 v15, s[8:11], s46 offen lds
  s_add_u32 s45, s50, 28672
  s_mov_b32 m0, s45
  s_add_u32 s46, s51, 458752
  buffer_load_dwordx4 v15, s[8:11], s46 offen lds
  s_add_u32 s45, s50, 29696
  s_mov_b32 m0, s45
  s_add_u32 s46, s51, 475136
  buffer_load_dwordx4 v15, s[8:11], s46 offen lds
  s_add_u32 s45, s50, 30720
  s_mov_b32 m0, s45
  s_add_u32 s46, s51, 491520
  buffer_load_dwordx4 v15, s[8:11], s46 offen lds
  s_add_u32 s45, s50, 31744
  s_mov_b32 m0, s45
  s_add_u32 s46, s51, 507904
  buffer_load_dwordx4 v15, s[8:11], s46 offen lds
  s_waitcnt vmcnt(28)
  ds_read_b64_tr_b16 a[0:1], v10 offset:0
  ds_read_b64_tr_b16 a[2:3], v10 offset:1024
  ds_read_b64_tr_b16 a[4:5], v10 offset:2048
  ds_read_b64_tr_b16 a[6:7], v10 offset:3072
  ds_read_b64_tr_b16 a[128:129], v11 offset:0
  ds_read_b64_tr_b16 a[130:131], v11 offset:1024
  ds_read_b64_tr_b16 a[132:133], v11 offset:2048
  ds_read_b64_tr_b16 a[134:135], v11 offset:3072
  s_waitcnt lgkmcnt(0)
  s_add_u32 s45, s50, 0
  s_mov_b32 m0, s45
  s_add_u32 s46, s51, 524288
  buffer_load_dwordx4 v15, s[8:11], s46 offen lds
  s_add_u32 s45, s50, 1024
  s_mov_b32 m0, s45
  s_add_u32 s46, s51, 540672
  buffer_load_dwordx4 v15, s[8:11], s46 offen lds
  s_add_u32 s45, s50, 2048
  s_mov_b32 m0, s45
  s_add_u32 s46, s51, 557056
  buffer_load_dwordx4 v15, s[8:11], s46 offen lds
  s_add_u32 s45, s50, 3072
  s_mov_b32 m0, s45
  s_add_u32 s46, s51, 573440
  buffer_load_dwordx4 v15, s[8:11], s46 offen lds
  s_waitcnt vmcnt(28)
  ds_read_b64_tr_b16 a[8:9], v10 offset:4096
  ds_read_b64_tr_b16 a[10:11], v10 offset:5120
  ds_read_b64_tr_b16 a[12:13], v10 offset:6144
  ds_read_b64_tr_b16 a[14:15], v10 offset:7168
  ds_read_b64_tr_b16 a[136:137], v11 offset:4096
  ds_read_b64_tr_b16 a[138:139], v11 offset:5120
  ds_read_b64_tr_b16 a[140:141], v11 offset:6144
  ds_read_b64_tr_b16 a[142:143], v11 offset:7168
  s_waitcnt lgkmcnt(0)
  s_add_u32 s45, s50, 4096
  s_mov_b32 m0, s45
  s_add_u32 s46, s51, 589824
  buffer_load_dwordx4 v15, s[8:11], s46 offen lds
  s_add_u32 s45, s50, 5120
  s_mov_b32 m0, s45
  s_add_u32 s46, s51, 606208
  buffer_load_dwordx4 v15, s[8:11], s46 offen lds
  s_add_u32 s45, s50, 6144
  s_mov_b32 m0, s45
  s_add_u32 s46, s51, 622592
  buffer_load_dwordx4 v15, s[8:11], s46 offen lds
  s_add_u32 s45, s50, 7168
  s_mov_b32 m0, s45
  s_add_u32 s46, s51, 638976
  buffer_load_dwordx4 v15, s[8:11], s46 offen lds
  s_waitcnt vmcnt(28)
  ds_read_b64_tr_b16 a[16:17], v10 offset:8192
  ds_read_b64_tr_b16 a[18:19], v10 offset:9216
  ds_read_b64_tr_b16 a[20:21], v10 offset:10240
  ds_read_b64_tr_b16 a[22:23], v10 offset:11264
  ds_read_b64_tr_b16 a[144:145], v11 offset:8192
  ds_read_b64_tr_b16 a[146:147], v11 offset:9216
  ds_read_b64_tr_b16 a[148:149], v11 offset:10240
  ds_read_b64_tr_b16 a[150:151], v11 offset:11264
  s_waitcnt lgkmcnt(0)
  s_add_u32 s45, s50, 8192
  s_mov_b32 m0, s45
  s_add_u32 s46, s51, 655360
  buffer_load_dwordx4 v15, s[8:11], s46 offen lds
  s_add_u32 s45, s50, 9216
  s_mov_b32 m0, s45
  s_add_u32 s46, s51, 671744
  buffer_load_dwordx4 v15, s[8:11], s46 offen lds
  s_add_u32 s45, s50, 10240
  s_mov_b32 m0, s45
  s_add_u32 s46, s51, 688128
  buffer_load_dwordx4 v15, s[8:11], s46 offen lds
  s_add_u32 s45, s50, 11264
  s_mov_b32 m0, s45
  s_add_u32 s46, s51, 704512
  buffer_load_dwordx4 v15, s[8:11], s46 offen lds
  s_waitcnt vmcnt(28)
  ds_read_b64_tr_b16 a[24:25], v10 offset:12288
  ds_read_b64_tr_b16 a[26:27], v10 offset:13312
  ds_read_b64_tr_b16 a[28:29], v10 offset:14336
  ds_read_b64_tr_b16 a[30:31], v10 offset:15360
  ds_read_b64_tr_b16 a[152:153], v11 offset:12288
  ds_read_b64_tr_b16 a[154:155], v11 offset:13312
  ds_read_b64_tr_b16 a[156:157], v11 offset:14336
  ds_read_b64_tr_b16 a[158:159], v11 offset:15360
  s_waitcnt lgkmcnt(0)
  s_add_u32 s45, s50, 12288
  s_mov_b32 m0, s45
  s_add_u32 s46, s51, 720896
  buffer_load_dwordx4 v15, s[8:11], s46 offen lds
  s_add_u32 s45, s50, 13312
  s_mov_b32 m0, s45
  s_add_u32 s46, s51, 737280
  buffer_load_dwordx4 v15, s[8:11], s46 offen lds
  s_add_u32 s45, s50, 14336
  s_mov_b32 m0, s45
  s_add_u32 s46, s51, 753664
  buffer_load_dwordx4 v15, s[8:11], s46 offen lds
  s_add_u32 s45, s50, 15360
  s_mov_b32 m0, s45
  s_add_u32 s46, s51, 770048
  buffer_load_dwordx4 v15, s[8:11], s46 offen lds
  s_waitcnt vmcnt(28)
  ds_read_b64_tr_b16 a[32:33], v10 offset:16384
  ds_read_b64_tr_b16 a[34:35], v10 offset:17408
  ds_read_b64_tr_b16 a[36:37], v10 offset:18432
  ds_read_b64_tr_b16 a[38:39], v10 offset:19456
  ds_read_b64_tr_b16 a[160:161], v11 offset:16384
  ds_read_b64_tr_b16 a[162:163], v11 offset:17408
  ds_read_b64_tr_b16 a[164:165], v11 offset:18432
  ds_read_b64_tr_b16 a[166:167], v11 offset:19456
  s_waitcnt lgkmcnt(0)
  s_add_u32 s45, s50, 16384
  s_mov_b32 m0, s45
  s_add_u32 s46, s51, 786432
  buffer_load_dwordx4 v15, s[8:11], s46 offen lds
  s_add_u32 s45, s50, 17408
  s_mov_b32 m0, s45
  s_add_u32 s46, s51, 802816
  buffer_load_dwordx4 v15, s[8:11], s46 offen lds
  s_add_u32 s45, s50, 18432
  s_mov_b32 m0, s45
  s_add_u32 s46, s51, 819200
  buffer_load_dwordx4 v15, s[8:11], s46 offen lds
  s_add_u32 s45, s50, 19456
  s_mov_b32 m0, s45
  s_add_u32 s46, s51, 835584
  buffer_load_dwordx4 v15, s[8:11], s46 offen lds
  s_waitcnt vmcnt(28)
  ds_read_b64_tr_b16 a[40:41], v10 offset:20480
  ds_read_b64_tr_b16 a[42:43], v10 offset:21504
  ds_read_b64_tr_b16 a[44:45], v10 offset:22528
  ds_read_b64_tr_b16 a[46:47], v10 offset:23552
  ds_read_b64_tr_b16 a[168:169], v11 offset:20480
  ds_read_b64_tr_b16 a[170:171], v11 offset:21504
  ds_read_b64_tr_b16 a[172:173], v11 offset:22528
  ds_read_b64_tr_b16 a[174:175], v11 offset:23552
  s_waitcnt lgkmcnt(0)
  s_add_u32 s45, s50, 20480
  s_mov_b32 m0, s45
  s_add_u32 s46, s51, 851968
  buffer_load_dwordx4 v15, s[8:11], s46 offen lds
  s_add_u32 s45, s50, 21504
  s_mov_b32 m0, s45
  s_add_u32 s46, s51, 868352
  buffer_load_dwordx4 v15, s[8:11], s46 offen lds
  s_add_u32 s45, s50, 22528
  s_mov_b32 m0, s45
  s_add_u32 s46, s51, 884736
  buffer_load_dwordx4 v15, s[8:11], s46 offen lds
  s_add_u32 s45, s50, 23552
  s_mov_b32 m0, s45
  s_add_u32 s46, s51, 901120
  buffer_load_dwordx4 v15, s[8:11], s46 offen lds
  s_waitcnt vmcnt(28)
  ds_read_b64_tr_b16 a[48:49], v10 offset:24576
  ds_read_b64_tr_b16 a[50:51], v10 offset:25600
  ds_read_b64_tr_b16 a[52:53], v10 offset:26624
  ds_read_b64_tr_b16 a[54:55], v10 offset:27648
  ds_read_b64_tr_b16 a[176:177], v11 offset:24576
  ds_read_b64_tr_b16 a[178:179], v11 offset:25600
  ds_read_b64_tr_b16 a[180:181], v11 offset:26624
  ds_read_b64_tr_b16 a[182:183], v11 offset:27648
  s_waitcnt lgkmcnt(0)
  s_add_u32 s45, s50, 24576
  s_mov_b32 m0, s45
  s_add_u32 s46, s51, 917504
  buffer_load_dwordx4 v15, s[8:11], s46 offen lds
  s_add_u32 s45, s50, 25600
  s_mov_b32 m0, s45
  s_add_u32 s46, s51, 933888
  buffer_load_dwordx4 v15, s[8:11], s46 offen lds
  s_add_u32 s45, s50, 26624
  s_mov_b32 m0, s45
  s_add_u32 s46, s51, 950272
  buffer_load_dwordx4 v15, s[8:11], s46 offen lds
  s_add_u32 s45, s50, 27648
  s_mov_b32 m0, s45
  s_add_u32 s46, s51, 966656
  buffer_load_dwordx4 v15, s[8:11], s46 offen lds
  s_waitcnt vmcnt(28)
  ds_read_b64_tr_b16 a[56:57], v10 offset:28672
  ds_read_b64_tr_b16 a[58:59], v10 offset:29696
  ds_read_b64_tr_b16 a[60:61], v10 offset:30720
  ds_read_b64_tr_b16 a[62:63], v10 offset:31744
  ds_read_b64_tr_b16 a[184:185], v11 offset:28672
  ds_read_b64_tr_b16 a[186:187], v11 offset:29696
  ds_read_b64_tr_b16 a[188:189], v11 offset:30720
  ds_read_b64_tr_b16 a[190:191], v11 offset:31744
  s_waitcnt lgkmcnt(0)
  s_add_u32 s45, s50, 28672
  s_mov_b32 m0, s45
  s_add_u32 s46, s51, 983040
  buffer_load_dwordx4 v15, s[8:11], s46 offen lds
  s_add_u32 s45, s50, 29696
  s_mov_b32 m0, s45
  s_add_u32 s46, s51, 999424
  buffer_load_dwordx4 v15, s[8:11], s46 offen lds
  s_add_u32 s45, s50, 30720
  s_mov_b32 m0, s45
  s_add_u32 s46, s51, 1015808
  buffer_load_dwordx4 v15, s[8:11], s46 offen lds
  s_add_u32 s45, s50, 31744
  s_mov_b32 m0, s45
  s_add_u32 s46, s51, 1032192
  buffer_load_dwordx4 v15, s[8:11], s46 offen lds
  s_waitcnt vmcnt(28)
  ds_read_b64_tr_b16 a[64:65], v10 offset:0
  ds_read_b64_tr_b16 a[66:67], v10 offset:1024
  ds_read_b64_tr_b16 a[68:69], v10 offset:2048
  ds_read_b64_tr_b16 a[70:71], v10 offset:3072
  ds_read_b64_tr_b16 a[192:193], v11 offset:0
  ds_read_b64_tr_b16 a[194:195], v11 offset:1024
  ds_read_b64_tr_b16 a[196:197], v11 offset:2048
  ds_read_b64_tr_b16 a[198:199], v11 offset:3072
  s_waitcnt lgkmcnt(0)
  s_waitcnt vmcnt(24)
  ds_read_b64_tr_b16 a[72:73], v10 offset:4096
  ds_read_b64_tr_b16 a[74:75], v10 offset:5120
  ds_read_b64_tr_b16 a[76:77], v10 offset:6144
  ds_read_b64_tr_b16 a[78:79], v10 offset:7168
  ds_read_b64_tr_b16 a[200:201], v11 offset:4096
  ds_read_b64_tr_b16 a[202:203], v11 offset:5120
  ds_read_b64_tr_b16 a[204:205], v11 offset:6144
  ds_read_b64_tr_b16 a[206:207], v11 offset:7168
  s_waitcnt lgkmcnt(0)
  s_waitcnt vmcnt(20)
  ds_read_b64_tr_b16 a[80:81], v10 offset:8192
  ds_read_b64_tr_b16 a[82:83], v10 offset:9216
  ds_read_b64_tr_b16 a[84:85], v10 offset:10240
  ds_read_b64_tr_b16 a[86:87], v10 offset:11264
  ds_read_b64_tr_b16 a[208:209], v11 offset:8192
  ds_read_b64_tr_b16 a[210:211], v11 offset:9216
  ds_read_b64_tr_b16 a[212:213], v11 offset:10240
  ds_read_b64_tr_b16 a[214:215], v11 offset:11264
  s_waitcnt lgkmcnt(0)
  s_waitcnt vmcnt(16)
  ds_read_b64_tr_b16 a[88:89], v10 offset:12288
  ds_read_b64_tr_b16 a[90:91], v10 offset:13312
  ds_read_b64_tr_b16 a[92:93], v10 offset:14336
  ds_read_b64_tr_b16 a[94:95], v10 offset:15360
  ds_read_b64_tr_b16 a[216:217], v11 offset:12288
  ds_read_b64_tr_b16 a[218:219], v11 offset:13312
  ds_read_b64_tr_b16 a[220:221], v11 offset:14336
  ds_read_b64_tr_b16 a[222:223], v11 offset:15360
  s_waitcnt lgkmcnt(0)
  s_waitcnt vmcnt(12)
  ds_read_b64_tr_b16 a[96:97], v10 offset:16384
  ds_read_b64_tr_b16 a[98:99], v10 offset:17408
  ds_read_b64_tr_b16 a[100:101], v10 offset:18432
  ds_read_b64_tr_b16 a[102:103], v10 offset:19456
  ds_read_b64_tr_b16 a[224:225], v11 offset:16384
  ds_read_b64_tr_b16 a[226:227], v11 offset:17408
  ds_read_b64_tr_b16 a[228:229], v11 offset:18432
  ds_read_b64_tr_b16 a[230:231], v11 offset:19456
  s_waitcnt lgkmcnt(0)
  s_waitcnt vmcnt(8)
  ds_read_b64_tr_b16 a[104:105], v10 offset:20480
  ds_read_b64_tr_b16 a[106:107], v10 offset:21504
  ds_read_b64_tr_b16 a[108:109], v10 offset:22528
  ds_read_b64_tr_b16 a[110:111], v10 offset:23552
  ds_read_b64_tr_b16 a[232:233], v11 offset:20480
  ds_read_b64_tr_b16 a[234:235], v11 offset:21504
  ds_read_b64_tr_b16 a[236:237], v11 offset:22528
  ds_read_b64_tr_b16 a[238:239], v11 offset:23552
  s_waitcnt lgkmcnt(0)
  s_waitcnt vmcnt(4)
  ds_read_b64_tr_b16 a[112:113], v10 offset:24576
  ds_read_b64_tr_b16 a[114:115], v10 offset:25600
  ds_read_b64_tr_b16 a[116:117], v10 offset:26624
  ds_read_b64_tr_b16 a[118:119], v10 offset:27648
  ds_read_b64_tr_b16 a[240:241], v11 offset:24576
  ds_read_b64_tr_b16 a[242:243], v11 offset:25600
  ds_read_b64_tr_b16 a[244:245], v11 offset:26624
  ds_read_b64_tr_b16 a[246:247], v11 offset:27648
  s_waitcnt lgkmcnt(0)
  s_waitcnt vmcnt(0)
  ds_read_b64_tr_b16 a[120:121], v10 offset:28672
  ds_read_b64_tr_b16 a[122:123], v10 offset:29696
  ds_read_b64_tr_b16 a[124:125], v10 offset:30720
  ds_read_b64_tr_b16 a[126:127], v10 offset:31744
  ds_read_b64_tr_b16 a[248:249], v11 offset:28672
  ds_read_b64_tr_b16 a[250:251], v11 offset:29696
  ds_read_b64_tr_b16 a[252:253], v11 offset:30720
  ds_read_b64_tr_b16 a[254:255], v11 offset:31744
  s_waitcnt lgkmcnt(0)
  s_barrier
  s_mul_i32 s66, s19, 0x1000000
  s_add_u32 s66, s66, 0x6000000
  s_lshr_b32 s45, s17, 2
  s_lshl_b32 s45, s45, 16
  s_add_u32 s66, s66, s45
  s_lshl_b32 s45, s19, 15
  s_lshr_b32 s46, s17, 2
  s_lshl_b32 s46, s46, 7
  s_add_u32 s45, s45, s46
  s_add_u32 s67, s45, 0x104000
  s_lshl_b32 s45, s19, 13
  s_lshl_b32 s46, s17, 2
  s_add_u32 s45, s45, s46
  s_add_u32 s68, s45, 0x114000
  s_lshl_b32 s73, s16, 10
  s_lshl_b32 s74, s16, 10
  s_mov_b32 s84, 0
  s_mov_b32 s65, 0
  s_mov_b32 s69, 0
  s_mov_b32 s76, 0
  s_mov_b32 s77, 0x128000
  s_mov_b32 s83, 0x128000
  s_cmp_eq_u32 s16, 0
  s_cselect_b32 s78, 1, 0
  s_mov_b32 s79, 0
  s_mul_i32 s72, s19, 0x1000000
  s_add_u32 s72, s72, 0x8000000
  s_lshr_b32 s45, s17, 2
  s_lshl_b32 s45, s45, 16
  s_add_u32 s72, s72, s45
  s_and_b32 s45, s17, 3
  s_lshl_b32 s45, s45, 14
  s_add_u32 s72, s72, s45
  s_lshl_b32 s45, s16, 12
  s_add_u32 s72, s72, s45
L_wn_70:
  v_and_b32 v3, 63, v0
  v_lshlrev_b32 v3, 2, v3
  v_add_u32 v3, s67, v3
  s_mov_b64 exec, 0xff
  buffer_load_dword v4, v3, s[4:7], 0 offen sc1
  s_mov_b64 exec, -1
  s_waitcnt vmcnt(0)
  v_cmp_ne_u32 vcc, 0, v4
  s_and_b32 s45, vcc_lo, 0xff
  s_cmp_eq_u32 s45, 0xff
  s_cselect_b32 s45, 1, 0
  s_cmp_eq_u32 s45, 1
  s_cbranch_scc1 L_wnd_71
  s_sub_u32 s64, s64, 1
  s_cbranch_scc1 L_abort
  s_sleep 16
  s_branch L_wn_70
L_wnd_71:
  s_add_u32 s47, s66, s74
  s_add_u32 s48, s69, s73
  s_mov_b32 s81, s47
  s_mov_b32 s82, s48
  s_add_u32 s45, s48, 0
  s_mov_b32 m0, s45
  s_add_u32 s46, s47, 0
  buffer_load_dwordx4 v2, s[4:7], s46 offen sc1 lds
  s_add_u32 s45, s48, 4096
  s_mov_b32 m0, s45
  s_add_u32 s46, s47, 4096
  buffer_load_dwordx4 v2, s[4:7], s46 offen sc1 lds
  s_add_u32 s45, s48, 8192
  s_mov_b32 m0, s45
  s_add_u32 s46, s47, 8192
  buffer_load_dwordx4 v2, s[4:7], s46 offen sc1 lds
  s_add_u32 s45, s48, 12288
  s_mov_b32 m0, s45
  s_add_u32 s46, s47, 12288
  buffer_load_dwordx4 v2, s[4:7], s46 offen sc1 lds
  s_add_u32 s45, s48, 16384
  s_mov_b32 m0, s45
  s_add_u32 s46, s47, 16384
  buffer_load_dwordx4 v2, s[4:7], s46 offen sc1 lds
  s_add_u32 s45, s48, 20480
  s_mov_b32 m0, s45
  s_add_u32 s46, s47, 20480
  buffer_load_dwordx4 v2, s[4:7], s46 offen sc1 lds
  s_add_u32 s45, s48, 24576
  s_mov_b32 m0, s45
  s_add_u32 s46, s47, 24576
  buffer_load_dwordx4 v2, s[4:7], s46 offen sc1 lds
  s_add_u32 s45, s48, 28672
  s_mov_b32 m0, s45
  s_add_u32 s46, s47, 28672
  buffer_load_dwordx4 v2, s[4:7], s46 offen sc1 lds
  s_add_u32 s45, s48, 32768
  s_mov_b32 m0, s45
  s_add_u32 s46, s47, 32768
  buffer_load_dwordx4 v2, s[4:7], s46 offen sc1 lds
  s_add_u32 s45, s48, 36864
  s_mov_b32 m0, s45
  s_add_u32 s46, s47, 36864
  buffer_load_dwordx4 v2, s[4:7], s46 offen sc1 lds
  s_add_u32 s45, s48, 40960
  s_mov_b32 m0, s45
  s_add_u32 s46, s47, 40960
  buffer_load_dwordx4 v2, s[4:7], s46 offen sc1 lds
  s_add_u32 s45, s48, 45056
  s_mov_b32 m0, s45
  s_add_u32 s46, s47, 45056
  buffer_load_dwordx4 v2, s[4:7], s46 offen sc1 lds
  s_add_u32 s45, s48, 49152
  s_mov_b32 m0, s45
  s_add_u32 s46, s47, 49152
  buffer_load_dwordx4 v2, s[4:7], s46 offen sc1 lds
  s_add_u32 s45, s48, 53248
  s_mov_b32 m0, s45
  s_add_u32 s46, s47, 53248
  buffer_load_dwordx4 v2, s[4:7], s46 offen sc1 lds
  s_add_u32 s45, s48, 57344
  s_mov_b32 m0, s45
  s_add_u32 s46, s47, 57344
  buffer_load_dwordx4 v2, s[4:7], s46 offen sc1 lds
  s_add_u32 s45, s48, 61440
  s_mov_b32 m0, s45
  s_add_u32 s46, s47, 61440
  buffer_load_dwordx4 v2, s[4:7], s46 offen sc1 lds
  s_mov_b32 s70, 0
L_g3_loop:
  v_add_u32 v5, s69, v2
  s_add_u32 s66, s66, 262144
  s_add_u32 s67, s67, 512
  v_and_b32 v3, 63, v0
  v_lshlrev_b32 v3, 2, v3
  v_add_u32 v3, s67, v3
  s_mov_b64 exec, 0xff
  buffer_load_dword v4, v3, s[4:7], 0 offen sc1
  s_mov_b64 exec, -1
  s_waitcnt vmcnt(13)
  s_barrier
  s_cmp_eq_u32 s77, 0x128000
  s_cbranch_scc1 L_ps_76
  v_mov_b32 v6, s77
  v_mov_b32 v7, 1
  s_mov_b64 exec, s[78:79]
  buffer_store_dword v7, v6, s[4:7], 0 offen sc1
  s_mov_b64 exec, -1
  s_mov_b32 s77, 0x128000
L_ps_76:
  ds_read_b128 v[8:11], v5 offset:0
  ds_read_b128 v[12:15], v5 offset:1024
  ds_read_b128 v[16:19], v5 offset:2048
  ds_read_b128 v[20:23], v5 offset:3072
  s_waitcnt lgkmcnt(2)
  v_mfma_f32_16x16x32_bf16 v[32:35], a[0:3], v[8:11], 0
  ds_read_b128 v[24:27], v5 offset:4096
  v_mfma_f32_16x16x32_bf16 v[36:39], a[0:3], v[12:15], 0
  ds_read_b128 v[28:31], v5 offset:5120
  v_mfma_f32_16x16x32_bf16 v[40:43], a[128:131], v[8:11], 0
  v_mfma_f32_16x16x32_bf16 v[44:47], a[128:131], v[12:15], 0
  s_waitcnt lgkmcnt(2)
  v_mfma_f32_16x16x32_bf16 v[32:35], a[4:7], v[16:19], v[32:35]
  ds_read_b128 v[8:11], v5 offset:6144
  v_mfma_f32_16x16x32_bf16 v[36:39], a[4:7], v[20:23], v[36:39]
  ds_read_b128 v[12:15], v5 offset:7168
  v_mfma_f32_16x16x32_bf16 v[40:43], a[132:135], v[16:19], v[40:43]
  v_mfma_f32_16x16x32_bf16 v[44:47], a[132:135], v[20:23], v[44:47]
  s_waitcnt lgkmcnt(2)
  v_mfma_f32_16x16x32_bf16 v[32:35], a[8:11], v[24:27], v[32:35]
  ds_read_b128 v[16:19], v5 offset:8192
  v_mfma_f32_16x16x32_bf16 v[36:39], a[8:11], v[28:31], v[36:39]
  ds_read_b128 v[20:23], v5 offset:9216
  v_mfma_f32_16x16x32_bf16 v[40:43], a[136:139], v[24:27], v[40:43]
  v_mfma_f32_16x16x32_bf16 v[44:47], a[136:139], v[28:31], v[44:47]
  s_waitcnt lgkmcnt(2)
  v_mfma_f32_16x16x32_bf16 v[32:35], a[12:15], v[8:11], v[32:35]
  ds_read_b128 v[24:27], v5 offset:10240
  v_mfma_f32_16x16x32_bf16 v[36:39], a[12:15], v[12:15], v[36:39]
  ds_read_b128 v[28:31], v5 offset:11264
  v_mfma_f32_16x16x32_bf16 v[40:43], a[140:143], v[8:11], v[40:43]
  v_mfma_f32_16x16x32_bf16 v[44:47], a[140:143], v[12:15], v[44:47]
  s_waitcnt lgkmcnt(2)
  v_mfma_f32_16x16x32_bf16 v[32:35], a[16:19], v[16:19], v[32:35]
  ds_read_b128 v[8:11], v5 offset:12288
  v_mfma_f32_16x16x32_bf16 v[36:39], a[16:19], v[20:23], v[36:39]
  ds_read_b128 v[12:15], v5 offset:13312
  v_mfma_f32_16x16x32_bf16 v[40:43], a[144:147], v[16:19], v[40:43]
  v_mfma_f32_16x16x32_bf16 v[44:47], a[144:147], v[20:23], v[44:47]
  s_waitcnt lgkmcnt(2)
  v_mfma_f32_16x16x32_bf16 v[32:35], a[20:23], v[24:27], v[32:35]
  ds_read_b128 v[16:19], v5 offset:14336
  v_mfma_f32_16x16x32_bf16 v[36:39], a[20:23], v[28:31], v[36:39]
  ds_read_b128 v[20:23], v5 offset:15360
  v_mfma_f32_16x16x32_bf16 v[40:43], a[148:151], v[24:27], v[40:43]
  v_mfma_f32_16x16x32_bf16 v[44:47], a[148:151], v[28:31], v[44:47]
  s_waitcnt lgkmcnt(2)
  v_mfma_f32_16x16x32_bf16 v[32:35], a[24:27], v[8:11], v[32:35]
  v_mfma_f32_16x16x32_bf16 v[36:39], a[24:27], v[12:15], v[36:39]
  v_mfma_f32_16x16x32_bf16 v[40:43], a[152:155], v[8:11], v[40:43]
  v_mfma_f32_16x16x32_bf16 v[44:47], a[152:155], v[12:15], v[44:47]
  s_waitcnt lgkmcnt(0)
  v_mfma_f32_16x16x32_bf16 v[32:35], a[28:31], v[16:19], v[32:35]
  v_mfma_f32_16x16x32_bf16 v[36:39], a[28:31], v[20:23], v[36:39]
  v_mfma_f32_16x16x32_bf16 v[40:43], a[156:159], v[16:19], v[40:43]
  v_mfma_f32_16x16x32_bf16 v[44:47], a[156:159], v[20:23], v[44:47]
  s_waitcnt vmcnt(9)
  s_barrier
  ds_read_b128 v[24:27], v5 offset:16384
  ds_read_b128 v[28:31], v5 offset:17408
  ds_read_b128 v[8:11], v5 offset:18432
  ds_read_b128 v[12:15], v5 offset:19456
  s_waitcnt lgkmcnt(2)
  v_mfma_f32_16x16x32_bf16 v[32:35], a[32:35], v[24:27], v[32:35]
  ds_read_b128 v[16:19], v5 offset:20480
  v_mfma_f32_16x16x32_bf16 v[36:39], a[32:35], v[28:31], v[36:39]
  ds_read_b128 v[20:23], v5 offset:21504
  v_mfma_f32_16x16x32_bf16 v[40:43], a[160:163], v[24:27], v[40:43]
  v_mfma_f32_16x16x32_bf16 v[44:47], a[160:163], v[28:31], v[44:47]
  s_waitcnt lgkmcnt(2)
  v_mfma_f32_16x16x32_bf16 v[32:35], a[36:39], v[8:11], v[32:35]
  ds_read_b128 v[24:27], v5 offset:22528
  v_mfma_f32_16x16x32_bf16 v[36:39], a[36:39], v[12:15], v[36:39]
  ds_read_b128 v[28:31], v5 offset:23552
  v_mfma_f32_16x16x32_bf16 v[40:43], a[164:167], v[8:11], v[40:43]
  v_mfma_f32_16x16x32_bf16 v[44:47], a[164:167], v[12:15], v[44:47]
  s_waitcnt lgkmcnt(2)
  v_mfma_f32_16x16x32_bf16 v[32:35], a[40:43], v[16:19], v[32:35]
  ds_read_b128 v[8:11], v5 offset:24576
  v_mfma_f32_16x16x32_bf16 v[36:39], a[40:43], v[20:23], v[36:39]
  ds_read_b128 v[12:15], v5 offset:25600
  v_mfma_f32_16x16x32_bf16 v[40:43], a[168:171], v[16:19], v[40:43]
  v_mfma_f32_16x16x32_bf16 v[44:47], a[168:171], v[20:23], v[44:47]
  s_waitcnt lgkmcnt(2)
  v_mfma_f32_16x16x32_bf16 v[32:35], a[44:47], v[24:27], v[32:35]
  ds_read_b128 v[16:19], v5 offset:26624
  v_mfma_f32_16x16x32_bf16 v[36:39], a[44:47], v[28:31], v[36:39]
  ds_read_b128 v[20:23], v5 offset:27648
  v_mfma_f32_16x16x32_bf16 v[40:43], a[172:175], v[24:27], v[40:43]
  v_mfma_f32_16x16x32_bf16 v[44:47], a[172:175], v[28:31], v[44:47]
  s_waitcnt lgkmcnt(2)
  v_mfma_f32_16x16x32_bf16 v[32:35], a[48:51], v[8:11], v[32:35]
  ds_read_b128 v[24:27], v5 offset:28672
  v_mfma_f32_16x16x32_bf16 v[36:39], a[48:51], v[12:15], v[36:39]
  ds_read_b128 v[28:31], v5 offset:29696
  v_mfma_f32_16x16x32_bf16 v[40:43], a[176:179], v[8:11], v[40:43]
  v_mfma_f32_16x16x32_bf16 v[44:47], a[176:179], v[12:15], v[44:47]
  s_waitcnt lgkmcnt(2)
  v_mfma_f32_16x16x32_bf16 v[32:35], a[52:55], v[16:19], v[32:35]
  ds_read_b128 v[8:11], v5 offset:30720
  v_mfma_f32_16x16x32_bf16 v[36:39], a[52:55], v[20:23], v[36:39]
  ds_read_b128 v[12:15], v5 offset:31744
  v_mfma_f32_16x16x32_bf16 v[40:43], a[180:183], v[16:19], v[40:43]
  v_mfma_f32_16x16x32_bf16 v[44:47], a[180:183], v[20:23], v[44:47]
  s_waitcnt lgkmcnt(2)
  v_mfma_f32_16x16x32_bf16 v[32:35], a[56:59], v[24:27], v[32:35]
  v_mfma_f32_16x16x32_bf16 v[36:39], a[56:59], v[28:31], v[36:39]
  v_mfma_f32_16x16x32_bf16 v[40:43], a[184:187], v[24:27], v[40:43]
  v_mfma_f32_16x16x32_bf16 v[44:47], a[184:187], v[28:31], v[44:47]
  s_waitcnt lgkmcnt(0)
  v_mfma_f32_16x16x32_bf16 v[32:35], a[60:63], v[8:11], v[32:35]
  v_mfma_f32_16x16x32_bf16 v[36:39], a[60:63], v[12:15], v[36:39]
  v_mfma_f32_16x16x32_bf16 v[40:43], a[188:191], v[8:11], v[40:43]
  v_mfma_f32_16x16x32_bf16 v[44:47], a[188:191], v[12:15], v[44:47]
  s_waitcnt vmcnt(0)
  v_cmp_ne_u32 vcc, 0, v4
  s_and_b32 s71, vcc_lo, 0xff
  s_cmp_eq_u32 s71, 0xff
  s_cselect_b32 s71, 1, 0
  v_mov_b32 v4, s71
  v_mov_b32 v6, 0x20000
  s_cmp_eq_u32 s16, 0
  s_cbranch_scc0 L_dec_77
  s_mov_b64 exec, 1
  ds_write_b32 v6, v4
  s_mov_b64 exec, -1
  s_waitcnt lgkmcnt(0)
L_dec_77:
  s_barrier
  s_cmp_eq_u32 s83, 0x128000
  s_cbranch_scc1 L_ps_78
  v_mov_b32 v6, s83
  v_mov_b32 v7, 1
  s_mov_b64 exec, s[78:79]
  buffer_store_dword v7, v6, s[4:7], 0 offen sc1
  s_mov_b64 exec, -1
  s_mov_b32 s83, 0x128000
L_ps_78:
  ds_read_b32 v4, v6
  s_waitcnt lgkmcnt(0)
  v_readfirstlane_b32 s71, v4
  s_cmp_ge_u32 s65, 63
  s_cbranch_scc1 L_varB_72
  s_cmp_eq_u32 s71, 1
  s_cbranch_scc0 L_varB_72
  s_add_u32 s81, s66, s74
  s_xor_b32 s82, s69, 65536
  s_add_u32 s82, s82, s73
  ds_read_b128 v[16:19], v5 offset:32768
  ds_read_b128 v[20:23], v5 offset:33792
  ds_read_b128 v[24:27], v5 offset:34816
  ds_read_b128 v[28:31], v5 offset:35840
  s_waitcnt lgkmcnt(2)
  v_mfma_f32_16x16x32_bf16 v[32:35], a[64:67], v[16:19], v[32:35]
  ds_read_b128 v[8:11], v5 offset:36864
  ds_read_b128 v[12:15], v5 offset:37888
  v_mfma_f32_16x16x32_bf16 v[36:39], a[64:67], v[20:23], v[36:39]
  s_add_u32 s45, s82, 0
  s_mov_b32 m0, s45
  v_mfma_f32_16x16x32_bf16 v[40:43], a[192:195], v[16:19], v[40:43]
  s_add_u32 s46, s81, 0
  buffer_load_dwordx4 v2, s[4:7], s46 offen sc1 lds
  v_mfma_f32_16x16x32_bf16 v[44:47], a[192:195], v[20:23], v[44:47]
  s_waitcnt lgkmcnt(2)
  v_mfma_f32_16x16x32_bf16 v[32:35], a[68:71], v[24:27], v[32:35]
  ds_read_b128 v[16:19], v5 offset:38912
  ds_read_b128 v[20:23], v5 offset:39936
  v_mfma_f32_16x16x32_bf16 v[36:39], a[68:71], v[28:31], v[36:39]
  s_add_u32 s45, s82, 4096
  s_mov_b32 m0, s45
  v_mfma_f32_16x16x32_bf16 v[40:43], a[196:199], v[24:27], v[40:43]
  s_add_u32 s46, s81, 4096
  buffer_load_dwordx4 v2, s[4:7], s46 offen sc1 lds
  v_mfma_f32_16x16x32_bf16 v[44:47], a[196:199], v[28:31], v[44:47]
  s_waitcnt lgkmcnt(2)
  v_mfma_f32_16x16x32_bf16 v[32:35], a[72:75], v[8:11], v[32:35]
  ds_read_b128 v[24:27], v5 offset:40960
  ds_read_b128 v[28:31], v5 offset:41984
  v_mfma_f32_16x16x32_bf16 v[36:39], a[72:75], v[12:15], v[36:39]
  s_add_u32 s45, s82, 8192
  s_mov_b32 m0, s45
  v_mfma_f32_16x16x32_bf16 v[40:43], a[200:203], v[8:11], v[40:43]
  s_add_u32 s46, s81, 8192
  buffer_load_dwordx4 v2, s[4:7], s46 offen sc1 lds
  v_mfma_f32_16x16x32_bf16 v[44:47], a[200:203], v[12:15], v[44:47]
  s_waitcnt lgkmcnt(2)
  v_mfma_f32_16x16x32_bf16 v[32:35], a[76:79], v[16:19], v[32:35]
  ds_read_b128 v[8:11], v5 offset:43008
  ds_read_b128 v[12:15], v5 offset:44032
  v_mfma_f32_16x16x32_bf16 v[36:39], a[76:79], v[20:23], v[36:39]
  s_add_u32 s45, s82, 12288
  s_mov_b32 m0, s45
  v_mfma_f32_16x16x32_bf16 v[40:43], a[204:207], v[16:19], v[40:43]
  s_add_u32 s46, s81, 12288
  buffer_load_dwordx4 v2, s[4:7], s46 offen sc1 lds
  v_mfma_f32_16x16x32_bf16 v[44:47], a[204:207], v[20:23], v[44:47]
  s_waitcnt lgkmcnt(2)
  v_mfma_f32_16x16x32_bf16 v[32:35], a[80:83], v[24:27], v[32:35]
  ds_read_b128 v[16:19], v5 offset:45056
  ds_read_b128 v[20:23], v5 offset:46080
  v_mfma_f32_16x16x32_bf16 v[36:39], a[80:83], v[28:31], v[36:39]
  s_add_u32 s45, s82, 16384
  s_mov_b32 m0, s45
  v_mfma_f32_16x16x32_bf16 v[40:43], a[208:211], v[24:27], v[40:43]
  s_add_u32 s46, s81, 16384
  buffer_load_dwordx4 v2, s[4:7], s46 offen sc1 lds
  v_mfma_f32_16x16x32_bf16 v[44:47], a[208:211], v[28:31], v[44:47]
  s_waitcnt lgkmcnt(2)
  v_mfma_f32_16x16x32_bf16 v[32:35], a[84:87], v[8:11], v[32:35]
  ds_read_b128 v[24:27], v5 offset:47104
  ds_read_b128 v[28:31], v5 offset:48128
  v_mfma_f32_16x16x32_bf16 v[36:39], a[84:87], v[12:15], v[36:39]
  s_add_u32 s45, s82, 20480
  s_mov_b32 m0, s45
  v_mfma_f32_16x16x32_bf16 v[40:43], a[212:215], v[8:11], v[40:43]
  s_add_u32 s46, s81, 20480
  buffer_load_dwordx4 v2, s[4:7], s46 offen sc1 lds
  v_mfma_f32_16x16x32_bf16 v[44:47], a[212:215], v[12:15], v[44:47]
  s_waitcnt lgkmcnt(2)
  v_mfma_f32_16x16x32_bf16 v[32:35], a[88:91], v[16:19], v[32:35]
  s_add_u32 s45, s82, 24576
  s_mov_b32 m0, s45
  v_mfma_f32_16x16x32_bf16 v[36:39], a[88:91], v[20:23], v[36:39]
  s_add_u32 s46, s81, 24576
  buffer_load_dwordx4 v2, s[4:7], s46 offen sc1 lds
  v_mfma_f32_16x16x32_bf16 v[40:43], a[216:219], v[16:19], v[40:43]
  v_mfma_f32_16x16x32_bf16 v[44:47], a[216:219], v[20:23], v[44:47]
  s_waitcnt lgkmcnt(0)
  v_mfma_f32_16x16x32_bf16 v[32:35], a[92:95], v[24:27], v[32:35]
  s_add_u32 s45, s82, 28672
  s_mov_b32 m0, s45
  v_mfma_f32_16x16x32_bf16 v[36:39], a[92:95], v[28:31], v[36:39]
  s_add_u32 s46, s81, 28672
  buffer_load_dwordx4 v2, s[4:7], s46 offen sc1 lds
  v_mfma_f32_16x16x32_bf16 v[40:43], a[220:223], v[24:27], v[40:43]
  v_mfma_f32_16x16x32_bf16 v[44:47], a[220:223], v[28:31], v[44:47]
  ds_read_b128 v[8:11], v5 offset:49152
  ds_read_b128 v[12:15], v5 offset:50176
  ds_read_b128 v[16:19], v5 offset:51200
  ds_read_b128 v[20:23], v5 offset:52224
  s_waitcnt lgkmcnt(2)
  v_mfma_f32_16x16x32_bf16 v[32:35], a[96:99], v[8:11], v[32:35]
  ds_read_b128 v[24:27], v5 offset:53248
  ds_read_b128 v[28:31], v5 offset:54272
  v_mfma_f32_16x16x32_bf16 v[36:39], a[96:99], v[12:15], v[36:39]
  s_add_u32 s45, s82, 32768
  s_mov_b32 m0, s45
  v_mfma_f32_16x16x32_bf16 v[40:43], a[224:227], v[8:11], v[40:43]
  s_add_u32 s46, s81, 32768
  buffer_load_dwordx4 v2, s[4:7], s46 offen sc1 lds
  v_mfma_f32_16x16x32_bf16 v[44:47], a[224:227], v[12:15], v[44:47]
  s_waitcnt lgkmcnt(2)
  v_mfma_f32_16x16x32_bf16 v[32:35], a[100:103], v[16:19], v[32:35]
  ds_read_b128 v[8:11], v5 offset:55296
  ds_read_b128 v[12:15], v5 offset:56320
  v_mfma_f32_16x16x32_bf16 v[36:39], a[100:103], v[20:23], v[36:39]
  s_add_u32 s45, s82, 36864
  s_mov_b32 m0, s45
  v_mfma_f32_16x16x32_bf16 v[40:43], a[228:231], v[16:19], v[40:43]
  s_add_u32 s46, s81, 36864
  buffer_load_dwordx4 v2, s[4:7], s46 offen sc1 lds
  v_mfma_f32_16x16x32_bf16 v[44:47], a[228:231], v[20:23], v[44:47]
  s_waitcnt lgkmcnt(2)
  v_mfma_f32_16x16x32_bf16 v[32:35], a[104:107], v[24:27], v[32:35]
  ds_read_b128 v[16:19], v5 offset:57344
  ds_read_b128 v[20:23], v5 offset:58368
  v_mfma_f32_16x16x32_bf16 v[36:39], a[104:107], v[28:31], v[36:39]
  s_add_u32 s45, s82, 40960
  s_mov_b32 m0, s45
  v_mfma_f32_16x16x32_bf16 v[40:43], a[232:235], v[24:27], v[40:43]
  s_add_u32 s46, s81, 40960
  buffer_load_dwordx4 v2, s[4:7], s46 offen sc1 lds
  v_mfma_f32_16x16x32_bf16 v[44:47], a[232:235], v[28:31], v[44:47]
  s_waitcnt lgkmcnt(2)
  v_mfma_f32_16x16x32_bf16 v[32:35], a[108:111], v[8:11], v[32:35]
  ds_read_b128 v[24:27], v5 offset:59392
  ds_read_b128 v[28:31], v5 offset:60416
  v_mfma_f32_16x16x32_bf16 v[36:39], a[108:111], v[12:15], v[36:39]
  s_add_u32 s45, s82, 45056
  s_mov_b32 m0, s45
  v_mfma_f32_16x16x32_bf16 v[40:43], a[236:239], v[8:11], v[40:43]
  s_add_u32 s46, s81, 45056
  buffer_load_dwordx4 v2, s[4:7], s46 offen sc1 lds
  v_mfma_f32_16x16x32_bf16 v[44:47], a[236:239], v[12:15], v[44:47]
  s_waitcnt lgkmcnt(2)
  v_mfma_f32_16x16x32_bf16 v[32:35], a[112:115], v[16:19], v[32:35]
  ds_read_b128 v[8:11], v5 offset:61440
  ds_read_b128 v[12:15], v5 offset:62464
  v_mfma_f32_16x16x32_bf16 v[36:39], a[112:115], v[20:23], v[36:39]
  s_add_u32 s45, s82, 49152
  s_mov_b32 m0, s45
  v_mfma_f32_16x16x32_bf16 v[40:43], a[240:243], v[16:19], v[40:43]
  s_add_u32 s46, s81, 49152
  buffer_load_dwordx4 v2, s[4:7], s46 offen sc1 lds
  v_mfma_f32_16x16x32_bf16 v[44:47], a[240:243], v[20:23], v[44:47]
  s_waitcnt lgkmcnt(2)
  v_mfma_f32_16x16x32_bf16 v[32:35], a[116:119], v[24:27], v[32:35]
  ds_read_b128 v[16:19], v5 offset:63488
  ds_read_b128 v[20:23], v5 offset:64512
  v_mfma_f32_16x16x32_bf16 v[36:39], a[116:119], v[28:31], v[36:39]
  s_add_u32 s45, s82, 53248
  s_mov_b32 m0, s45
  v_mfma_f32_16x16x32_bf16 v[40:43], a[244:247], v[24:27], v[40:43]
  s_add_u32 s46, s81, 53248
  buffer_load_dwordx4 v2, s[4:7], s46 offen sc1 lds
  v_mfma_f32_16x16x32_bf16 v[44:47], a[244:247], v[28:31], v[44:47]
  s_waitcnt lgkmcnt(2)
  v_mfma_f32_16x16x32_bf16 v[32:35], a[120:123], v[8:11], v[32:35]
  s_add_u32 s45, s82, 57344
  s_mov_b32 m0, s45
  v_mfma_f32_16x16x32_bf16 v[36:39], a[120:123], v[12:15], v[36:39]
  s_add_u32 s46, s81, 57344
  buffer_load_dwordx4 v2, s[4:7], s46 offen sc1 lds
  v_mfma_f32_16x16x32_bf16 v[40:43], a[248:251], v[8:11], v[40:43]
  v_mfma_f32_16x16x32_bf16 v[44:47], a[248:251], v[12:15], v[44:47]
  s_waitcnt lgkmcnt(0)
  v_mfma_f32_16x16x32_bf16 v[32:35], a[124:127], v[16:19], v[32:35]
  s_add_u32 s45, s82, 61440
  s_mov_b32 m0, s45
  v_mfma_f32_16x16x32_bf16 v[36:39], a[124:127], v[20:23], v[36:39]
  s_add_u32 s46, s81, 61440
  buffer_load_dwordx4 v2, s[4:7], s46 offen sc1 lds
  v_mfma_f32_16x16x32_bf16 v[40:43], a[252:255], v[16:19], v[40:43]
  v_mfma_f32_16x16x32_bf16 v[44:47], a[252:255], v[20:23], v[44:47]
  s_nop 7
  buffer_store_dwordx4 v[32:35], v2, s[4:7], s72 offen offset:0 sc1
  buffer_store_dwordx4 v[36:39], v2, s[4:7], s72 offen offset:1024 sc1
  buffer_store_dwordx4 v[40:43], v2, s[4:7], s72 offen offset:2048 sc1
  buffer_store_dwordx4 v[44:47], v2, s[4:7], s72 offen offset:3072 sc1
  s_add_u32 s72, s72, 262144
  s_xor_b32 s69, s69, 65536
  s_add_u32 s65, s65, 1
  s_mov_b32 s83, s68
  s_add_u32 s68, s68, 128
  s_mov_b32 s84, 1
  s_branch L_g3_loop
L_varB_72:
  s_mov_b32 s84, 0
  ds_read_b128 v[16:19], v5 offset:32768
  ds_read_b128 v[20:23], v5 offset:33792
  ds_read_b128 v[24:27], v5 offset:34816
  ds_read_b128 v[28:31], v5 offset:35840
  s_waitcnt lgkmcnt(2)
  v_mfma_f32_16x16x32_bf16 v[32:35], a[64:67], v[16:19], v[32:35]
  ds_read_b128 v[8:11], v5 offset:36864
  v_mfma_f32_16x16x32_bf16 v[36:39], a[64:67], v[20:23], v[36:39]
  ds_read_b128 v[12:15], v5 offset:37888
  v_mfma_f32_16x16x32_bf16 v[40:43], a[192:195], v[16:19], v[40:43]
  v_mfma_f32_16x16x32_bf16 v[44:47], a[192:195], v[20:23], v[44:47]
  s_waitcnt lgkmcnt(2)
  v_mfma_f32_16x16x32_bf16 v[32:35], a[68:71], v[24:27], v[32:35]
  ds_read_b128 v[16:19], v5 offset:38912
  v_mfma_f32_16x16x32_bf16 v[36:39], a[68:71], v[28:31], v[36:39]
  ds_read_b128 v[20:23], v5 offset:39936
  v_mfma_f32_16x16x32_bf16 v[40:43], a[196:199], v[24:27], v[40:43]
  v_mfma_f32_16x16x32_bf16 v[44:47], a[196:199], v[28:31], v[44:47]
  s_waitcnt lgkmcnt(2)
  v_mfma_f32_16x16x32_bf16 v[32:35], a[72:75], v[8:11], v[32:35]
  ds_read_b128 v[24:27], v5 offset:40960
  v_mfma_f32_16x16x32_bf16 v[36:39], a[72:75], v[12:15], v[36:39]
  ds_read_b128 v[28:31], v5 offset:41984
  v_mfma_f32_16x16x32_bf16 v[40:43], a[200:203], v[8:11], v[40:43]
  v_mfma_f32_16x16x32_bf16 v[44:47], a[200:203], v[12:15], v[44:47]
  s_waitcnt lgkmcnt(2)
  v_mfma_f32_16x16x32_bf16 v[32:35], a[76:79], v[16:19], v[32:35]
  ds_read_b128 v[8:11], v5 offset:43008
  v_mfma_f32_16x16x32_bf16 v[36:39], a[76:79], v[20:23], v[36:39]
  ds_read_b128 v[12:15], v5 offset:44032
  v_mfma_f32_16x16x32_bf16 v[40:43], a[204:207], v[16:19], v[40:43]
  v_mfma_f32_16x16x32_bf16 v[44:47], a[204:207], v[20:23], v[44:47]
  s_waitcnt lgkmcnt(2)
  v_mfma_f32_16x16x32_bf16 v[32:35], a[80:83], v[24:27], v[32:35]
  ds_read_b128 v[16:19], v5 offset:45056
  v_mfma_f32_16x16x32_bf16 v[36:39], a[80:83], v[28:31], v[36:39]
  ds_read_b128 v[20:23], v5 offset:46080
  v_mfma_f32_16x16x32_bf16 v[40:43], a[208:211], v[24:27], v[40:43]
  v_mfma_f32_16x16x32_bf16 v[44:47], a[208:211], v[28:31], v[44:47]
  s_waitcnt lgkmcnt(2)
  v_mfma_f32_16x16x32_bf16 v[32:35], a[84:87], v[8:11], v[32:35]
  ds_read_b128 v[24:27], v5 offset:47104
  v_mfma_f32_16x16x32_bf16 v[36:39], a[84:87], v[12:15], v[36:39]
  ds_read_b128 v[28:31], v5 offset:48128
  v_mfma_f32_16x16x32_bf16 v[40:43], a[212:215], v[8:11], v[40:43]
  v_mfma_f32_16x16x32_bf16 v[44:47], a[212:215], v[12:15], v[44:47]
  s_waitcnt lgkmcnt(2)
  v_mfma_f32_16x16x32_bf16 v[32:35], a[88:91], v[16:19], v[32:35]
  v_mfma_f32_16x16x32_bf16 v[36:39], a[88:91], v[20:23], v[36:39]
  v_mfma_f32_16x16x32_bf16 v[40:43], a[216:219], v[16:19], v[40:43]
  v_mfma_f32_16x16x32_bf16 v[44:47], a[216:219], v[20:23], v[44:47]
  s_waitcnt lgkmcnt(0)
  v_mfma_f32_16x16x32_bf16 v[32:35], a[92:95], v[24:27], v[32:35]
  v_mfma_f32_16x16x32_bf16 v[36:39], a[92:95], v[28:31], v[36:39]
  v_mfma_f32_16x16x32_bf16 v[40:43], a[220:223], v[24:27], v[40:43]
  v_mfma_f32_16x16x32_bf16 v[44:47], a[220:223], v[28:31], v[44:47]
  v_and_b32 v3, 63, v0
  v_lshlrev_b32 v3, 2, v3
  v_add_u32 v3, s67, v3
  s_mov_b64 exec, 0xff
  buffer_load_dword v4, v3, s[4:7], 0 offen sc1
  s_mov_b64 exec, -1
  ds_read_b128 v[8:11], v5 offset:49152
  ds_read_b128 v[12:15], v5 offset:50176
  ds_read_b128 v[16:19], v5 offset:51200
  ds_read_b128 v[20:23], v5 offset:52224
  s_waitcnt lgkmcnt(2)
  v_mfma_f32_16x16x32_bf16 v[32:35], a[96:99], v[8:11], v[32:35]
  ds_read_b128 v[24:27], v5 offset:53248
  v_mfma_f32_16x16x32_bf16 v[36:39], a[96:99], v[12:15], v[36:39]
  ds_read_b128 v[28:31], v5 offset:54272
  v_mfma_f32_16x16x32_bf16 v[40:43], a[224:227], v[8:11], v[40:43]
  v_mfma_f32_16x16x32_bf16 v[44:47], a[224:227], v[12:15], v[44:47]
  s_waitcnt lgkmcnt(2)
  v_mfma_f32_16x16x32_bf16 v[32:35], a[100:103], v[16:19], v[32:35]
  ds_read_b128 v[8:11], v5 offset:55296
  v_mfma_f32_16x16x32_bf16 v[36:39], a[100:103], v[20:23], v[36:39]
  ds_read_b128 v[12:15], v5 offset:56320
  v_mfma_f32_16x16x32_bf16 v[40:43], a[228:231], v[16:19], v[40:43]
  v_mfma_f32_16x16x32_bf16 v[44:47], a[228:231], v[20:23], v[44:47]
  s_waitcnt lgkmcnt(2)
  v_mfma_f32_16x16x32_bf16 v[32:35], a[104:107], v[24:27], v[32:35]
  ds_read_b128 v[16:19], v5 offset:57344
  v_mfma_f32_16x16x32_bf16 v[36:39], a[104:107], v[28:31], v[36:39]
  ds_read_b128 v[20:23], v5 offset:58368
  v_mfma_f32_16x16x32_bf16 v[40:43], a[232:235], v[24:27], v[40:43]
  v_mfma_f32_16x16x32_bf16 v[44:47], a[232:235], v[28:31], v[44:47]
  s_waitcnt lgkmcnt(2)
  v_mfma_f32_16x16x32_bf16 v[32:35], a[108:111], v[8:11], v[32:35]
  ds_read_b128 v[24:27], v5 offset:59392
  v_mfma_f32_16x16x32_bf16 v[36:39], a[108:111], v[12:15], v[36:39]
  ds_read_b128 v[28:31], v5 offset:60416
  v_mfma_f32_16x16x32_bf16 v[40:43], a[236:239], v[8:11], v[40:43]
  v_mfma_f32_16x16x32_bf16 v[44:47], a[236:239], v[12:15], v[44:47]
  s_waitcnt lgkmcnt(2)
  v_mfma_f32_16x16x32_bf16 v[32:35], a[112:115], v[16:19], v[32:35]
  ds_read_b128 v[8:11], v5 offset:61440
  v_mfma_f32_16x16x32_bf16 v[36:39], a[112:115], v[20:23], v[36:39]
  ds_read_b128 v[12:15], v5 offset:62464
  v_mfma_f32_16x16x32_bf16 v[40:43], a[240:243], v[16:19], v[40:43]
  v_mfma_f32_16x16x32_bf16 v[44:47], a[240:243], v[20:23], v[44:47]
  s_waitcnt lgkmcnt(2)
  v_mfma_f32_16x16x32_bf16 v[32:35], a[116:119], v[24:27], v[32:35]
  ds_read_b128 v[16:19], v5 offset:63488
  v_mfma_f32_16x16x32_bf16 v[36:39], a[116:119], v[28:31], v[36:39]
  ds_read_b128 v[20:23], v5 offset:64512
  v_mfma_f32_16x16x32_bf16 v[40:43], a[244:247], v[24:27], v[40:43]
  v_mfma_f32_16x16x32_bf16 v[44:47], a[244:247], v[28:31], v[44:47]
  s_waitcnt lgkmcnt(2)
  v_mfma_f32_16x16x32_bf16 v[32:35], a[120:123], v[8:11], v[32:35]
  v_mfma_f32_16x16x32_bf16 v[36:39], a[120:123], v[12:15], v[36:39]
  v_mfma_f32_16x16x32_bf16 v[40:43], a[248:251], v[8:11], v[40:43]
  v_mfma_f32_16x16x32_bf16 v[44:47], a[248:251], v[12:15], v[44:47]
  s_waitcnt lgkmcnt(0)
  v_mfma_f32_16x16x32_bf16 v[32:35], a[124:127], v[16:19], v[32:35]
  v_mfma_f32_16x16x32_bf16 v[36:39], a[124:127], v[20:23], v[36:39]
  v_mfma_f32_16x16x32_bf16 v[40:43], a[252:255], v[16:19], v[40:43]
  v_mfma_f32_16x16x32_bf16 v[44:47], a[252:255], v[20:23], v[44:47]
  s_nop 7
  buffer_store_dwordx4 v[32:35], v2, s[4:7], s72 offen offset:0 sc1
  buffer_store_dwordx4 v[36:39], v2, s[4:7], s72 offen offset:1024 sc1
  buffer_store_dwordx4 v[40:43], v2, s[4:7], s72 offen offset:2048 sc1
  buffer_store_dwordx4 v[44:47], v2, s[4:7], s72 offen offset:3072 sc1
  s_add_u32 s72, s72, 262144
  s_xor_b32 s69, s69, 65536
  s_add_u32 s65, s65, 1
  s_waitcnt vmcnt(4)
  v_cmp_ne_u32 vcc, 0, v4
  s_and_b32 s71, vcc_lo, 0xff
  s_cmp_eq_u32 s71, 0xff
  s_cselect_b32 s71, 1, 0
  v_mov_b32 v4, s71
  v_mov_b32 v6, 0x20004
  s_cmp_eq_u32 s16, 0
  s_cbranch_scc0 L_dec_79
  s_mov_b64 exec, 1
  ds_write_b32 v6, v4
  s_mov_b64 exec, -1
  s_waitcnt lgkmcnt(0)
L_dec_79:
  s_barrier
  ds_read_b32 v4, v6
  s_waitcnt lgkmcnt(0)
  v_readfirstlane_b32 s71, v4
  s_cmp_ge_u32 s65, 64
  s_cbranch_scc1 L_ni_73
  s_cmp_eq_u32 s71, 1
  s_cbranch_scc0 L_ni_73
  s_add_u32 s47, s66, s74
  s_add_u32 s48, s69, s73
  s_mov_b32 s81, s47
  s_mov_b32 s82, s48
  s_add_u32 s45, s48, 0
  s_mov_b32 m0, s45
  s_add_u32 s46, s47, 0
  buffer_load_dwordx4 v2, s[4:7], s46 offen sc1 lds
  s_add_u32 s45, s48, 4096
  s_mov_b32 m0, s45
  s_add_u32 s46, s47, 4096
  buffer_load_dwordx4 v2, s[4:7], s46 offen sc1 lds
  s_add_u32 s45, s48, 8192
  s_mov_b32 m0, s45
  s_add_u32 s46, s47, 8192
  buffer_load_dwordx4 v2, s[4:7], s46 offen sc1 lds
  s_add_u32 s45, s48, 12288
  s_mov_b32 m0, s45
  s_add_u32 s46, s47, 12288
  buffer_load_dwordx4 v2, s[4:7], s46 offen sc1 lds
  s_add_u32 s45, s48, 16384
  s_mov_b32 m0, s45
  s_add_u32 s46, s47, 16384
  buffer_load_dwordx4 v2, s[4:7], s46 offen sc1 lds
  s_add_u32 s45, s48, 20480
  s_mov_b32 m0, s45
  s_add_u32 s46, s47, 20480
  buffer_load_dwordx4 v2, s[4:7], s46 offen sc1 lds
  s_add_u32 s45, s48, 24576
  s_mov_b32 m0, s45
  s_add_u32 s46, s47, 24576
  buffer_load_dwordx4 v2, s[4:7], s46 offen sc1 lds
  s_add_u32 s45, s48, 28672
  s_mov_b32 m0, s45
  s_add_u32 s46, s47, 28672
  buffer_load_dwordx4 v2, s[4:7], s46 offen sc1 lds
  s_add_u32 s45, s48, 32768
  s_mov_b32 m0, s45
  s_add_u32 s46, s47, 32768
  buffer_load_dwordx4 v2, s[4:7], s46 offen sc1 lds
  s_add_u32 s45, s48, 36864
  s_mov_b32 m0, s45
  s_add_u32 s46, s47, 36864
  buffer_load_dwordx4 v2, s[4:7], s46 offen sc1 lds
  s_add_u32 s45, s48, 40960
  s_mov_b32 m0, s45
  s_add_u32 s46, s47, 40960
  buffer_load_dwordx4 v2, s[4:7], s46 offen sc1 lds
  s_add_u32 s45, s48, 45056
  s_mov_b32 m0, s45
  s_add_u32 s46, s47, 45056
  buffer_load_dwordx4 v2, s[4:7], s46 offen sc1 lds
  s_add_u32 s45, s48, 49152
  s_mov_b32 m0, s45
  s_add_u32 s46, s47, 49152
  buffer_load_dwordx4 v2, s[4:7], s46 offen sc1 lds
  s_add_u32 s45, s48, 53248
  s_mov_b32 m0, s45
  s_add_u32 s46, s47, 53248
  buffer_load_dwordx4 v2, s[4:7], s46 offen sc1 lds
  s_add_u32 s45, s48, 57344
  s_mov_b32 m0, s45
  s_add_u32 s46, s47, 57344
  buffer_load_dwordx4 v2, s[4:7], s46 offen sc1 lds
  s_add_u32 s45, s48, 61440
  s_mov_b32 m0, s45
  s_add_u32 s46, s47, 61440
  buffer_load_dwordx4 v2, s[4:7], s46 offen sc1 lds
  s_mov_b32 s77, s68
  s_add_u32 s68, s68, 128
  s_branch L_g3_loop
L_ni_73:
  s_waitcnt vmcnt(0)
  s_barrier
  v_mov_b32 v6, s68
  v_mov_b32 v7, 1
  s_mov_b64 exec, s[78:79]
  buffer_store_dword v7, v6, s[4:7], 0 offen sc1
  s_mov_b64 exec, -1
  s_add_u32 s68, s68, 128
  s_cmp_ge_u32 s65, 64
  s_cbranch_scc1 L_gfin_80
L_wn_81:
  v_and_b32 v3, 63, v0
  v_lshlrev_b32 v3, 2, v3
  v_add_u32 v3, s67, v3
  s_mov_b64 exec, 0xff
  buffer_load_dword v4, v3, s[4:7], 0 offen sc1
  s_mov_b64 exec, -1
  s_waitcnt vmcnt(0)
  v_cmp_ne_u32 vcc, 0, v4
  s_and_b32 s45, vcc_lo, 0xff
  s_cmp_eq_u32 s45, 0xff
  s_cselect_b32 s45, 1, 0
  s_cmp_eq_u32 s45, 1
  s_cbranch_scc1 L_wnd_82
  s_sub_u32 s64, s64, 1
  s_cbranch_scc1 L_abort
  s_sleep 4
  s_branch L_wn_81
L_wnd_82:
  s_add_u32 s47, s66, s74
  s_add_u32 s48, s69, s73
  s_mov_b32 s81, s47
  s_mov_b32 s82, s48
  s_add_u32 s45, s48, 0
  s_mov_b32 m0, s45
  s_add_u32 s46, s47, 0
  buffer_load_dwordx4 v2, s[4:7], s46 offen sc1 lds
  s_add_u32 s45, s48, 4096
  s_mov_b32 m0, s45
  s_add_u32 s46, s47, 4096
  buffer_load_dwordx4 v2, s[4:7], s46 offen sc1 lds
  s_add_u32 s45, s48, 8192
  s_mov_b32 m0, s45
  s_add_u32 s46, s47, 8192
  buffer_load_dwordx4 v2, s[4:7], s46 offen sc1 lds
  s_add_u32 s45, s48, 12288
  s_mov_b32 m0, s45
  s_add_u32 s46, s47, 12288
  buffer_load_dwordx4 v2, s[4:7], s46 offen sc1 lds
  s_add_u32 s45, s48, 16384
  s_mov_b32 m0, s45
  s_add_u32 s46, s47, 16384
  buffer_load_dwordx4 v2, s[4:7], s46 offen sc1 lds
  s_add_u32 s45, s48, 20480
  s_mov_b32 m0, s45
  s_add_u32 s46, s47, 20480
  buffer_load_dwordx4 v2, s[4:7], s46 offen sc1 lds
  s_add_u32 s45, s48, 24576
  s_mov_b32 m0, s45
  s_add_u32 s46, s47, 24576
  buffer_load_dwordx4 v2, s[4:7], s46 offen sc1 lds
  s_add_u32 s45, s48, 28672
  s_mov_b32 m0, s45
  s_add_u32 s46, s47, 28672
  buffer_load_dwordx4 v2, s[4:7], s46 offen sc1 lds
  s_add_u32 s45, s48, 32768
  s_mov_b32 m0, s45
  s_add_u32 s46, s47, 32768
  buffer_load_dwordx4 v2, s[4:7], s46 offen sc1 lds
  s_add_u32 s45, s48, 36864
  s_mov_b32 m0, s45
  s_add_u32 s46, s47, 36864
  buffer_load_dwordx4 v2, s[4:7], s46 offen sc1 lds
  s_add_u32 s45, s48, 40960
  s_mov_b32 m0, s45
  s_add_u32 s46, s47, 40960
  buffer_load_dwordx4 v2, s[4:7], s46 offen sc1 lds
  s_add_u32 s45, s48, 45056
  s_mov_b32 m0, s45
  s_add_u32 s46, s47, 45056
  buffer_load_dwordx4 v2, s[4:7], s46 offen sc1 lds
  s_add_u32 s45, s48, 49152
  s_mov_b32 m0, s45
  s_add_u32 s46, s47, 49152
  buffer_load_dwordx4 v2, s[4:7], s46 offen sc1 lds
  s_add_u32 s45, s48, 53248
  s_mov_b32 m0, s45
  s_add_u32 s46, s47, 53248
  buffer_load_dwordx4 v2, s[4:7], s46 offen sc1 lds
  s_add_u32 s45, s48, 57344
  s_mov_b32 m0, s45
  s_add_u32 s46, s47, 57344
  buffer_load_dwordx4 v2, s[4:7], s46 offen sc1 lds
  s_add_u32 s45, s48, 61440
  s_mov_b32 m0, s45
  s_add_u32 s46, s47, 61440
  buffer_load_dwordx4 v2, s[4:7], s46 offen sc1 lds
  s_branch L_g3_loop
L_gfin_80:
  s_waitcnt vmcnt(0)
  s_branch L_end
L_role_g4:
  v_and_b32 v1, 63, v0
  v_lshlrev_b32 v2, 4, v1
  s_cmp_eq_u32 s99, 1
  s_cbranch_scc1 L_gs_done_83
  s_cmp_eq_u32 s16, 0
  s_cbranch_scc0 L_gs_w_84
  v_mov_b32 v100, 32
L_gs_p_85:
  s_mov_b64 exec, 1
  global_load_dword v101, v100, s[40:41] sc1
  s_mov_b64 exec, -1
  s_waitcnt vmcnt(0)
  v_readfirstlane_b32 s45, v101
  s_sub_u32 s64, s64, 1
  s_cbranch_scc1 L_abort
  s_cmp_ge_u32 s45, 256
  s_cbranch_scc1 L_gs_q_86
  s_sleep 4
  s_branch L_gs_p_85
L_gs_q_86:
  v_and_b32 v102, 63, v0
  v_lshlrev_b32 v102, 2, v102
  s_mov_b64 exec, 0xff
  global_load_dword v101, v102, s[40:41] sc1
  s_waitcnt vmcnt(0)
  ds_write_b32 v102, v101
  s_mov_b64 exec, -1
  s_waitcnt lgkmcnt(0)
L_gs_w_84:
  s_barrier
  v_mov_b32 v100, 0
  ds_read_b128 v[104:107], v100
  ds_read_b128 v[108:111], v100 offset:16
  s_waitcnt lgkmcnt(0)
  s_mov_b32 s44, 1
  s_mov_b32 s46, 0
  v_readfirstlane_b32 s45, v104
  s_cmp_eq_u32 s45, 32
  s_cselect_b32 s44, s44, 0
  s_cmp_gt_u32 s18, 0
  s_cselect_b32 s45, s45, 0
  s_add_u32 s46, s46, s45
  v_readfirstlane_b32 s45, v105
  s_cmp_eq_u32 s45, 32
  s_cselect_b32 s44, s44, 0
  s_cmp_gt_u32 s18, 1
  s_cselect_b32 s45, s45, 0
  s_add_u32 s46, s46, s45
  v_readfirstlane_b32 s45, v106
  s_cmp_eq_u32 s45, 32
  s_cselect_b32 s44, s44, 0
  s_cmp_gt_u32 s18, 2
  s_cselect_b32 s45, s45, 0
  s_add_u32 s46, s46, s45
  v_readfirstlane_b32 s45, v107
  s_cmp_eq_u32 s45, 32
  s_cselect_b32 s44, s44, 0
  s_cmp_gt_u32 s18, 3
  s_cselect_b32 s45, s45, 0
  s_add_u32 s46, s46, s45
  v_readfirstlane_b32 s45, v108
  s_cmp_eq_u32 s45, 32
  s_cselect_b32 s44, s44, 0
  s_cmp_gt_u32 s18, 4
  s_cselect_b32 s45, s45, 0
  s_add_u32 s46, s46, s45
  v_readfirstlane_b32 s45, v109
  s_cmp_eq_u32 s45, 32
  s_cselect_b32 s44, s44, 0
  s_cmp_gt_u32 s18, 5
  s_cselect_b32 s45, s45, 0
  s_add_u32 s46, s46, s45
  v_readfirstlane_b32 s45, v110
  s_cmp_eq_u32 s45, 32
  s_cselect_b32 s44, s44, 0
  s_cmp_gt_u32 s18, 6
  s_cselect_b32 s45, s45, 0
  s_add_u32 s46, s46, s45
  v_readfirstlane_b32 s45, v111
  s_cmp_eq_u32 s45, 32
  s_cselect_b32 s44, s44, 0
  s_cmp_gt_u32 s18, 7
  s_cselect_b32 s45, s45, 0
  s_add_u32 s46, s46, s45
  s_barrier
  s_mov_b32 s99, 1
  s_cmp_eq_u32 s44, 1
  s_cbranch_scc1 L_gs_done_83
  s_add_u32 s17, s46, s98
  s_branch L_dispatch
L_gs_done_83:
  s_mul_i32 s50, s16, 40960
  s_lshl_b32 s45, s17, 8
  s_lshl_b32 s46, s16, 6
  s_add_u32 s51, s45, s46
  v_bfe_u32 v12, v1, 4, 1
  v_bfe_u32 v13, v1, 5, 1
  v_xor_b32 v12, v12, v13
  v_lshlrev_b32 v12, 1, v12
  v_and_b32 v13, 3, v1
  v_xor_b32 v12, v12, v13
  v_lshlrev_b32 v12, 4, v12
  v_lshrrev_b32 v13, 2, v1
  s_mov_b32 s45, 3584
  v_mul_lo_u32 v13, s45, v13
  v_add_u32 v15, v12, v13
  v_lshrrev_b32 v12, 4, v1
  v_bfe_u32 v13, v1, 2, 2
  v_lshl_add_u32 v14, v12, 3, v13
  v_lshlrev_b32 v14, 6, v14
  v_and_b32 v8, 3, v1
  v_lshl_add_u32 v14, v8, 3, v14
  v_and_b32 v8, 1, v12
  v_lshl_add_u32 v14, v8, 5, v14
  v_add_u32 v8, s50, v14
  v_xor_b32 v9, 32, v8
  v_lshl_add_u32 v14, v12, 2, v13
  v_lshlrev_b32 v14, 6, v14
  v_and_b32 v10, 3, v1
  v_lshl_add_u32 v14, v10, 3, v14
  v_lshrrev_b32 v13, 1, v12
  v_xor_b32 v13, v13, v12
  v_and_b32 v13, 1, v13
  v_lshl_add_u32 v14, v13, 5, v14
  v_add_u32 v10, s50, v14
  v_xor_b32 v11, 32, v10
  s_mov_b32 s8, s32
  s_and_b32 s9, s33, 0xffff
  s_mov_b32 s10, 0x1c0000
  s_mov_b32 s11, 0x20000
  s_add_u32 s45, s50, 0
  s_mov_b32 m0, s45
  s_add_u32 s46, s51, 0
  buffer_load_dwordx4 v15, s[8:11], s46 offen lds
  s_add_u32 s45, s50, 1024
  s_mov_b32 m0, s45
  s_add_u32 s46, s51, 57344
  buffer_load_dwordx4 v15, s[8:11], s46 offen lds
  s_add_u32 s45, s50, 2048
  s_mov_b32 m0, s45
  s_add_u32 s46, s51, 114688
  buffer_load_dwordx4 v15, s[8:11], s46 offen lds
  s_add_u32 s45, s50, 3072
  s_mov_b32 m0, s45
  s_add_u32 s46, s51, 172032
  buffer_load_dwordx4 v15, s[8:11], s46 offen lds
  s_add_u32 s45, s50, 4096
  s_mov_b32 m0, s45
  s_add_u32 s46, s51, 229376
  buffer_load_dwordx4 v15, s[8:11], s46 offen lds
  s_add_u32 s45, s50, 5120
  s_mov_b32 m0, s45
  s_add_u32 s46, s51, 286720
  buffer_load_dwordx4 v15, s[8:11], s46 offen lds
  s_add_u32 s45, s50, 6144
  s_mov_b32 m0, s45
  s_add_u32 s46, s51, 344064
  buffer_load_dwordx4 v15, s[8:11], s46 offen lds
  s_add_u32 s45, s50, 7168
  s_mov_b32 m0, s45
  s_add_u32 s46, s51, 401408
  buffer_load_dwordx4 v15, s[8:11], s46 offen lds
  s_add_u32 s45, s50, 8192
  s_mov_b32 m0, s45
  s_add_u32 s46, s51, 458752
  buffer_load_dwordx4 v15, s[8:11], s46 offen lds
  s_add_u32 s45, s50, 9216
  s_mov_b32 m0, s45
  s_add_u32 s46, s51, 516096
  buffer_load_dwordx4 v15, s[8:11], s46 offen lds
  s_add_u32 s45, s50, 10240
  s_mov_b32 m0, s45
  s_add_u32 s46, s51, 573440
  buffer_load_dwordx4 v15, s[8:11], s46 offen lds
  s_add_u32 s45, s50, 11264
  s_mov_b32 m0, s45
  s_add_u32 s46, s51, 630784
  buffer_load_dwordx4 v15, s[8:11], s46 offen lds
  s_add_u32 s45, s50, 12288
  s_mov_b32 m0, s45
  s_add_u32 s46, s51, 688128
  buffer_load_dwordx4 v15, s[8:11], s46 offen lds
  s_add_u32 s45, s50, 13312
  s_mov_b32 m0, s45
  s_add_u32 s46, s51, 745472
  buffer_load_dwordx4 v15, s[8:11], s46 offen lds
  s_add_u32 s45, s50, 14336
  s_mov_b32 m0, s45
  s_add_u32 s46, s51, 802816
  buffer_load_dwordx4 v15, s[8:11], s46 offen lds
  s_add_u32 s45, s50, 15360
  s_mov_b32 m0, s45
  s_add_u32 s46, s51, 860160
  buffer_load_dwordx4 v15, s[8:11], s46 offen lds
  s_add_u32 s45, s50, 16384
  s_mov_b32 m0, s45
  s_add_u32 s46, s51, 917504
  buffer_load_dwordx4 v15, s[8:11], s46 offen lds
  s_add_u32 s45, s50, 17408
  s_mov_b32 m0, s45
  s_add_u32 s46, s51, 974848
  buffer_load_dwordx4 v15, s[8:11], s46 offen lds
  s_add_u32 s45, s50, 18432
  s_mov_b32 m0, s45
  s_add_u32 s46, s51, 1032192
  buffer_load_dwordx4 v15, s[8:11], s46 offen lds
  s_add_u32 s45, s50, 19456
  s_mov_b32 m0, s45
  s_add_u32 s46, s51, 1089536
  buffer_load_dwordx4 v15, s[8:11], s46 offen lds
  s_add_u32 s45, s50, 20480
  s_mov_b32 m0, s45
  s_add_u32 s46, s51, 1146880
  buffer_load_dwordx4 v15, s[8:11], s46 offen lds
  s_add_u32 s45, s50, 21504
  s_mov_b32 m0, s45
  s_add_u32 s46, s51, 1204224
  buffer_load_dwordx4 v15, s[8:11], s46 offen lds
  s_add_u32 s45, s50, 22528
  s_mov_b32 m0, s45
  s_add_u32 s46, s51, 1261568
  buffer_load_dwordx4 v15, s[8:11], s46 offen lds
  s_add_u32 s45, s50, 23552
  s_mov_b32 m0, s45
  s_add_u32 s46, s51, 1318912
  buffer_load_dwordx4 v15, s[8:11], s46 offen lds
  s_add_u32 s45, s50, 24576
  s_mov_b32 m0, s45
  s_add_u32 s46, s51, 1376256
  buffer_load_dwordx4 v15, s[8:11], s46 offen lds
  s_add_u32 s45, s50, 25600
  s_mov_b32 m0, s45
  s_add_u32 s46, s51, 1433600
  buffer_load_dwordx4 v15, s[8:11], s46 offen lds
  s_add_u32 s45, s50, 26624
  s_mov_b32 m0, s45
  s_add_u32 s46, s51, 1490944
  buffer_load_dwordx4 v15, s[8:11], s46 offen lds
  s_add_u32 s45, s50, 27648
  s_mov_b32 m0, s45
  s_add_u32 s46, s51, 1548288
  buffer_load_dwordx4 v15, s[8:11], s46 offen lds
  s_add_u32 s45, s50, 28672
  s_mov_b32 m0, s45
  s_add_u32 s46, s51, 1605632
  buffer_load_dwordx4 v15, s[8:11], s46 offen lds
  s_add_u32 s45, s50, 29696
  s_mov_b32 m0, s45
  s_add_u32 s46, s51, 1662976
  buffer_load_dwordx4 v15, s[8:11], s46 offen lds
  s_add_u32 s45, s50, 30720
  s_mov_b32 m0, s45
  s_add_u32 s46, s51, 1720320
  buffer_load_dwordx4 v15, s[8:11], s46 offen lds
  s_add_u32 s45, s50, 31744
  s_mov_b32 m0, s45
  s_add_u32 s46, s51, 1777664
  buffer_load_dwordx4 v15, s[8:11], s46 offen lds
  s_waitcnt vmcnt(28)
  ds_read_b64_tr_b16 a[0:1], v8 offset:0
  ds_read_b64_tr_b16 a[2:3], v9 offset:256
  ds_read_b64_tr_b16 a[4:5], v8 offset:2048
  ds_read_b64_tr_b16 a[6:7], v9 offset:2304
  ds_read_b64_tr_b16 a[64:65], v9 offset:0
  ds_read_b64_tr_b16 a[66:67], v8 offset:256
  ds_read_b64_tr_b16 a[68:69], v9 offset:2048
  ds_read_b64_tr_b16 a[70:71], v8 offset:2304
  s_waitcnt lgkmcnt(0)
  s_mov_b32 s8, s34
  s_and_b32 s9, s35, 0xffff
  s_mov_b32 s10, 0x1c0000
  s_mov_b32 s11, 0x20000
  s_add_u32 s45, s50, 0
  s_mov_b32 m0, s45
  s_add_u32 s46, s51, 0
  buffer_load_dwordx4 v15, s[8:11], s46 offen lds
  s_add_u32 s45, s50, 1024
  s_mov_b32 m0, s45
  s_add_u32 s46, s51, 57344
  buffer_load_dwordx4 v15, s[8:11], s46 offen lds
  s_add_u32 s45, s50, 2048
  s_mov_b32 m0, s45
  s_add_u32 s46, s51, 114688
  buffer_load_dwordx4 v15, s[8:11], s46 offen lds
  s_add_u32 s45, s50, 3072
  s_mov_b32 m0, s45
  s_add_u32 s46, s51, 172032
  buffer_load_dwordx4 v15, s[8:11], s46 offen lds
  s_waitcnt vmcnt(28)
  ds_read_b64_tr_b16 a[8:9], v8 offset:4096
  ds_read_b64_tr_b16 a[10:11], v9 offset:4352
  ds_read_b64_tr_b16 a[12:13], v8 offset:6144
  ds_read_b64_tr_b16 a[14:15], v9 offset:6400
  ds_read_b64_tr_b16 a[72:73], v9 offset:4096
  ds_read_b64_tr_b16 a[74:75], v8 offset:4352
  ds_read_b64_tr_b16 a[76:77], v9 offset:6144
  ds_read_b64_tr_b16 a[78:79], v8 offset:6400
  s_waitcnt lgkmcnt(0)
  s_add_u32 s45, s50, 4096
  s_mov_b32 m0, s45
  s_add_u32 s46, s51, 229376
  buffer_load_dwordx4 v15, s[8:11], s46 offen lds
  s_add_u32 s45, s50, 5120
  s_mov_b32 m0, s45
  s_add_u32 s46, s51, 286720
  buffer_load_dwordx4 v15, s[8:11], s46 offen lds
  s_add_u32 s45, s50, 6144
  s_mov_b32 m0, s45
  s_add_u32 s46, s51, 344064
  buffer_load_dwordx4 v15, s[8:11], s46 offen lds
  s_add_u32 s45, s50, 7168
  s_mov_b32 m0, s45
  s_add_u32 s46, s51, 401408
  buffer_load_dwordx4 v15, s[8:11], s46 offen lds
  s_waitcnt vmcnt(28)
  ds_read_b64_tr_b16 a[16:17], v8 offset:8192
  ds_read_b64_tr_b16 a[18:19], v9 offset:8448
  ds_read_b64_tr_b16 a[20:21], v8 offset:10240
  ds_read_b64_tr_b16 a[22:23], v9 offset:10496
  ds_read_b64_tr_b16 a[80:81], v9 offset:8192
  ds_read_b64_tr_b16 a[82:83], v8 offset:8448
  ds_read_b64_tr_b16 a[84:85], v9 offset:10240
  ds_read_b64_tr_b16 a[86:87], v8 offset:10496
  s_waitcnt lgkmcnt(0)
  s_add_u32 s45, s50, 8192
  s_mov_b32 m0, s45
  s_add_u32 s46, s51, 458752
  buffer_load_dwordx4 v15, s[8:11], s46 offen lds
  s_add_u32 s45, s50, 9216
  s_mov_b32 m0, s45
  s_add_u32 s46, s51, 516096
  buffer_load_dwordx4 v15, s[8:11], s46 offen lds
  s_add_u32 s45, s50, 10240
  s_mov_b32 m0, s45
  s_add_u32 s46, s51, 573440
  buffer_load_dwordx4 v15, s[8:11], s46 offen lds
  s_add_u32 s45, s50, 11264
  s_mov_b32 m0, s45
  s_add_u32 s46, s51, 630784
  buffer_load_dwordx4 v15, s[8:11], s46 offen lds
  s_waitcnt vmcnt(28)
  ds_read_b64_tr_b16 a[24:25], v8 offset:12288
  ds_read_b64_tr_b16 a[26:27], v9 offset:12544
  ds_read_b64_tr_b16 a[28:29], v8 offset:14336
  ds_read_b64_tr_b16 a[30:31], v9 offset:14592
  ds_read_b64_tr_b16 a[88:89], v9 offset:12288
  ds_read_b64_tr_b16 a[90:91], v8 offset:12544
  ds_read_b64_tr_b16 a[92:93], v9 offset:14336
  ds_read_b64_tr_b16 a[94:95], v8 offset:14592
  s_waitcnt lgkmcnt(0)
  s_add_u32 s45, s50, 12288
  s_mov_b32 m0, s45
  s_add_u32 s46, s51, 688128
  buffer_load_dwordx4 v15, s[8:11], s46 offen lds
  s_add_u32 s45, s50, 13312
  s_mov_b32 m0, s45
  s_add_u32 s46, s51, 745472
  buffer_load_dwordx4 v15, s[8:11], s46 offen lds
  s_add_u32 s45, s50, 14336
  s_mov_b32 m0, s45
  s_add_u32 s46, s51, 802816
  buffer_load_dwordx4 v15, s[8:11], s46 offen lds
  s_add_u32 s45, s50, 15360
  s_mov_b32 m0, s45
  s_add_u32 s46, s51, 860160
  buffer_load_dwordx4 v15, s[8:11], s46 offen lds
  s_waitcnt vmcnt(28)
  ds_read_b64_tr_b16 a[32:33], v8 offset:16384
  ds_read_b64_tr_b16 a[34:35], v9 offset:16640
  ds_read_b64_tr_b16 a[36:37], v8 offset:18432
  ds_read_b64_tr_b16 a[38:39], v9 offset:18688
  ds_read_b64_tr_b16 a[96:97], v9 offset:16384
  ds_read_b64_tr_b16 a[98:99], v8 offset:16640
  ds_read_b64_tr_b16 a[100:101], v9 offset:18432
  ds_read_b64_tr_b16 a[102:103], v8 offset:18688
  s_waitcnt lgkmcnt(0)
  s_add_u32 s45, s50, 16384
  s_mov_b32 m0, s45
  s_add_u32 s46, s51, 917504
  buffer_load_dwordx4 v15, s[8:11], s46 offen lds
  s_add_u32 s45, s50, 17408
  s_mov_b32 m0, s45
  s_add_u32 s46, s51, 974848
  buffer_load_dwordx4 v15, s[8:11], s46 offen lds
  s_add_u32 s45, s50, 18432
  s_mov_b32 m0, s45
  s_add_u32 s46, s51, 1032192
  buffer_load_dwordx4 v15, s[8:11], s46 offen lds
  s_add_u32 s45, s50, 19456
  s_mov_b32 m0, s45
  s_add_u32 s46, s51, 1089536
  buffer_load_dwordx4 v15, s[8:11], s46 offen lds
  s_waitcnt vmcnt(28)
  ds_read_b64_tr_b16 a[40:41], v8 offset:20480
  ds_read_b64_tr_b16 a[42:43], v9 offset:20736
  ds_read_b64_tr_b16 a[44:45], v8 offset:22528
  ds_read_b64_tr_b16 a[46:47], v9 offset:22784
  ds_read_b64_tr_b16 a[104:105], v9 offset:20480
  ds_read_b64_tr_b16 a[106:107], v8 offset:20736
  ds_read_b64_tr_b16 a[108:109], v9 offset:22528
  ds_read_b64_tr_b16 a[110:111], v8 offset:22784
  s_waitcnt lgkmcnt(0)
  s_add_u32 s45, s50, 20480
  s_mov_b32 m0, s45
  s_add_u32 s46, s51, 1146880
  buffer_load_dwordx4 v15, s[8:11], s46 offen lds
  s_add_u32 s45, s50, 21504
  s_mov_b32 m0, s45
  s_add_u32 s46, s51, 1204224
  buffer_load_dwordx4 v15, s[8:11], s46 offen lds
  s_add_u32 s45, s50, 22528
  s_mov_b32 m0, s45
  s_add_u32 s46, s51, 1261568
  buffer_load_dwordx4 v15, s[8:11], s46 offen lds
  s_add_u32 s45, s50, 23552
  s_mov_b32 m0, s45
  s_add_u32 s46, s51, 1318912
  buffer_load_dwordx4 v15, s[8:11], s46 offen lds
  s_waitcnt vmcnt(28)
  ds_read_b64_tr_b16 a[48:49], v8 offset:24576
  ds_read_b64_tr_b16 a[50:51], v9 offset:24832
  ds_read_b64_tr_b16 a[52:53], v8 offset:26624
  ds_read_b64_tr_b16 a[54:55], v9 offset:26880
  ds_read_b64_tr_b16 a[112:113], v9 offset:24576
  ds_read_b64_tr_b16 a[114:115], v8 offset:24832
  ds_read_b64_tr_b16 a[116:117], v9 offset:26624
  ds_read_b64_tr_b16 a[118:119], v8 offset:26880
  s_waitcnt lgkmcnt(0)
  s_add_u32 s45, s50, 24576
  s_mov_b32 m0, s45
  s_add_u32 s46, s51, 1376256
  buffer_load_dwordx4 v15, s[8:11], s46 offen lds
  s_add_u32 s45, s50, 25600
  s_mov_b32 m0, s45
  s_add_u32 s46, s51, 1433600
  buffer_load_dwordx4 v15, s[8:11], s46 offen lds
  s_add_u32 s45, s50, 26624
  s_mov_b32 m0, s45
  s_add_u32 s46, s51, 1490944
  buffer_load_dwordx4 v15, s[8:11], s46 offen lds
  s_add_u32 s45, s50, 27648
  s_mov_b32 m0, s45
  s_add_u32 s46, s51, 1548288
  buffer_load_dwordx4 v15, s[8:11], s46 offen lds
  s_waitcnt vmcnt(28)
  ds_read_b64_tr_b16 a[56:57], v8 offset:28672
  ds_read_b64_tr_b16 a[58:59], v9 offset:28928
  ds_read_b64_tr_b16 a[60:61], v8 offset:30720
  ds_read_b64_tr_b16 a[62:63], v9 offset:30976
  ds_read_b64_tr_b16 a[120:121], v9 offset:28672
  ds_read_b64_tr_b16 a[122:123], v8 offset:28928
  ds_read_b64_tr_b16 a[124:125], v9 offset:30720
  ds_read_b64_tr_b16 a[126:127], v8 offset:30976
  s_waitcnt lgkmcnt(0)
  s_add_u32 s45, s50, 28672
  s_mov_b32 m0, s45
  s_add_u32 s46, s51, 1605632
  buffer_load_dwordx4 v15, s[8:11], s46 offen lds
  s_add_u32 s45, s50, 29696
  s_mov_b32 m0, s45
  s_add_u32 s46, s51, 1662976
  buffer_load_dwordx4 v15, s[8:11], s46 offen lds
  s_add_u32 s45, s50, 30720
  s_mov_b32 m0, s45
  s_add_u32 s46, s51, 1720320
  buffer_load_dwordx4 v15, s[8:11], s46 offen lds
  s_add_u32 s45, s50, 31744
  s_mov_b32 m0, s45
  s_add_u32 s46, s51, 1777664
  buffer_load_dwordx4 v15, s[8:11], s46 offen lds
  s_waitcnt vmcnt(28)
  ds_read_b64_tr_b16 a[128:129], v8 offset:0
  ds_read_b64_tr_b16 a[130:131], v9 offset:256
  ds_read_b64_tr_b16 a[132:133], v8 offset:2048
  ds_read_b64_tr_b16 a[134:135], v9 offset:2304
  ds_read_b64_tr_b16 a[192:193], v9 offset:0
  ds_read_b64_tr_b16 a[194:195], v8 offset:256
  ds_read_b64_tr_b16 a[196:197], v9 offset:2048
  ds_read_b64_tr_b16 a[198:199], v8 offset:2304
  s_waitcnt lgkmcnt(0)
  s_waitcnt vmcnt(24)
  ds_read_b64_tr_b16 a[136:137], v8 offset:4096
  ds_read_b64_tr_b16 a[138:139], v9 offset:4352
  ds_read_b64_tr_b16 a[140:141], v8 offset:6144
  ds_read_b64_tr_b16 a[142:143], v9 offset:6400
  ds_read_b64_tr_b16 a[200:201], v9 offset:4096
  ds_read_b64_tr_b16 a[202:203], v8 offset:4352
  ds_read_b64_tr_b16 a[204:205], v9 offset:6144
  ds_read_b64_tr_b16 a[206:207], v8 offset:6400
  s_waitcnt lgkmcnt(0)
  s_waitcnt vmcnt(20)
  ds_read_b64_tr_b16 a[144:145], v8 offset:8192
  ds_read_b64_tr_b16 a[146:147], v9 offset:8448
  ds_read_b64_tr_b16 a[148:149], v8 offset:10240
  ds_read_b64_tr_b16 a[150:151], v9 offset:10496
  ds_read_b64_tr_b16 a[208:209], v9 offset:8192
  ds_read_b64_tr_b16 a[210:211], v8 offset:8448
  ds_read_b64_tr_b16 a[212:213], v9 offset:10240
  ds_read_b64_tr_b16 a[214:215], v8 offset:10496
  s_waitcnt lgkmcnt(0)
  s_waitcnt vmcnt(16)
  ds_read_b64_tr_b16 a[152:153], v8 offset:12288
  ds_read_b64_tr_b16 a[154:155], v9 offset:12544
  ds_read_b64_tr_b16 a[156:157], v8 offset:14336
  ds_read_b64_tr_b16 a[158:159], v9 offset:14592
  ds_read_b64_tr_b16 a[216:217], v9 offset:12288
  ds_read_b64_tr_b16 a[218:219], v8 offset:12544
  ds_read_b64_tr_b16 a[220:221], v9 offset:14336
  ds_read_b64_tr_b16 a[222:223], v8 offset:14592
  s_waitcnt lgkmcnt(0)
  s_waitcnt vmcnt(12)
  ds_read_b64_tr_b16 a[160:161], v8 offset:16384
  ds_read_b64_tr_b16 a[162:163], v9 offset:16640
  ds_read_b64_tr_b16 a[164:165], v8 offset:18432
  ds_read_b64_tr_b16 a[166:167], v9 offset:18688
  ds_read_b64_tr_b16 a[224:225], v9 offset:16384
  ds_read_b64_tr_b16 a[226:227], v8 offset:16640
  ds_read_b64_tr_b16 a[228:229], v9 offset:18432
  ds_read_b64_tr_b16 a[230:231], v8 offset:18688
  s_waitcnt lgkmcnt(0)
  s_waitcnt vmcnt(8)
  ds_read_b64_tr_b16 a[168:169], v8 offset:20480
  ds_read_b64_tr_b16 a[170:171], v9 offset:20736
  ds_read_b64_tr_b16 a[172:173], v8 offset:22528
  ds_read_b64_tr_b16 a[174:175], v9 offset:22784
  ds_read_b64_tr_b16 a[232:233], v9 offset:20480
  ds_read_b64_tr_b16 a[234:235], v8 offset:20736
  ds_read_b64_tr_b16 a[236:237], v9 offset:22528
  ds_read_b64_tr_b16 a[238:239], v8 offset:22784
  s_waitcnt lgkmcnt(0)
  s_waitcnt vmcnt(4)
  ds_read_b64_tr_b16 a[176:177], v8 offset:24576
  ds_read_b64_tr_b16 a[178:179], v9 offset:24832
  ds_read_b64_tr_b16 a[180:181], v8 offset:26624
  ds_read_b64_tr_b16 a[182:183], v9 offset:26880
  ds_read_b64_tr_b16 a[240:241], v9 offset:24576
  ds_read_b64_tr_b16 a[242:243], v8 offset:24832
  ds_read_b64_tr_b16 a[244:245], v9 offset:26624
  ds_read_b64_tr_b16 a[246:247], v8 offset:26880
  s_waitcnt lgkmcnt(0)
  s_waitcnt vmcnt(0)
  ds_read_b64_tr_b16 a[184:185], v8 offset:28672
  ds_read_b64_tr_b16 a[186:187], v9 offset:28928
  ds_read_b64_tr_b16 a[188:189], v8 offset:30720
  ds_read_b64_tr_b16 a[190:191], v9 offset:30976
  ds_read_b64_tr_b16 a[248:249], v9 offset:28672
  ds_read_b64_tr_b16 a[250:251], v8 offset:28928
  ds_read_b64_tr_b16 a[252:253], v9 offset:30720
  ds_read_b64_tr_b16 a[254:255], v8 offset:30976
  s_waitcnt lgkmcnt(0)
  s_barrier
  s_mul_i32 s66, s19, 0x200000
  s_add_u32 s66, s66, 0x5600000
  s_lshl_b32 s45, s19, 13
  s_add_u32 s67, s45, 0x118000
  s_lshl_b32 s45, s19, 14
  s_cmp_ge_u32 s17, 7
  s_cselect_b32 s46, 100, 0
  s_add_u32 s45, s45, s46
  s_lshl_b32 s46, s17, 2
  s_add_u32 s45, s45, s46
  s_add_u32 s68, s45, 0x11c000
  s_lshl_b32 s73, s16, 10
  s_and_b32 s45, s16, 1
  s_lshl_b32 s45, s45, 14
  s_lshr_b32 s46, s16, 1
  s_lshl_b32 s46, s46, 10
  s_add_u32 s74, s45, s46
  s_mov_b32 s84, 0
  s_mov_b32 s65, 0
  s_mov_b32 s69, 0
  s_mov_b32 s76, 0
  s_mov_b32 s77, 0x128000
  s_mov_b32 s83, 0x128000
  s_cmp_eq_u32 s16, 0
  s_cselect_b32 s78, 1, 0
  s_mov_b32 s79, 0
  s_mul_i32 s72, s19, 0x700000
  s_add_u32 s72, s72, 0xa000000
  s_lshl_b32 s45, s17, 2
  s_add_u32 s45, s45, s16
  s_lshl_b32 s45, s45, 11
  s_add_u32 s72, s72, s45
L_wn_87:
  v_and_b32 v3, 63, v0
  v_lshlrev_b32 v3, 2, v3
  v_add_u32 v3, s67, v3
  s_mov_b64 exec, 0xf
  buffer_load_dword v4, v3, s[4:7], 0 offen sc1
  s_mov_b64 exec, -1
  s_waitcnt vmcnt(0)
  v_cmp_ne_u32 vcc, 0, v4
  s_and_b32 s45, vcc_lo, 0xf
  s_cmp_eq_u32 s45, 0xf
  s_cselect_b32 s45, 1, 0
  s_cmp_eq_u32 s45, 1
  s_cbranch_scc1 L_wnd_88
  s_sub_u32 s64, s64, 1
  s_cbranch_scc1 L_abort
  s_sleep 16
  s_branch L_wn_87
L_wnd_88:
  s_add_u32 s47, s66, s74
  s_add_u32 s48, s69, s73
  s_mov_b32 s81, s47
  s_mov_b32 s82, s48
  s_add_u32 s45, s48, 0
  s_mov_b32 m0, s45
  s_add_u32 s46, s47, 0
  buffer_load_dwordx4 v2, s[4:7], s46 offen sc1 lds
  s_add_u32 s45, s48, 4096
  s_mov_b32 m0, s45
  s_add_u32 s46, s47, 2048
  buffer_load_dwordx4 v2, s[4:7], s46 offen sc1 lds
  s_add_u32 s45, s48, 8192
  s_mov_b32 m0, s45
  s_add_u32 s46, s47, 4096
  buffer_load_dwordx4 v2, s[4:7], s46 offen sc1 lds
  s_add_u32 s45, s48, 12288
  s_mov_b32 m0, s45
  s_add_u32 s46, s47, 6144
  buffer_load_dwordx4 v2, s[4:7], s46 offen sc1 lds
  s_add_u32 s45, s48, 16384
  s_mov_b32 m0, s45
  s_add_u32 s46, s47, 8192
  buffer_load_dwordx4 v2, s[4:7], s46 offen sc1 lds
  s_add_u32 s45, s48, 20480
  s_mov_b32 m0, s45
  s_add_u32 s46, s47, 10240
  buffer_load_dwordx4 v2, s[4:7], s46 offen sc1 lds
  s_add_u32 s45, s48, 24576
  s_mov_b32 m0, s45
  s_add_u32 s46, s47, 12288
  buffer_load_dwordx4 v2, s[4:7], s46 offen sc1 lds
  s_add_u32 s45, s48, 28672
  s_mov_b32 m0, s45
  s_add_u32 s46, s47, 14336
  buffer_load_dwordx4 v2, s[4:7], s46 offen sc1 lds
  s_mov_b32 s70, 0
L_g4_loop:
  v_add_u32 v5, s69, v2
  s_add_u32 s66, s66, 32768
  s_add_u32 s67, s67, 128
  v_and_b32 v3, 63, v0
  v_lshlrev_b32 v3, 2, v3
  v_add_u32 v3, s67, v3
  s_mov_b64 exec, 0xf
  buffer_load_dword v4, v3, s[4:7], 0 offen sc1
  s_mov_b64 exec, -1
  s_waitcnt vmcnt(7)
  s_barrier
  s_cmp_eq_u32 s77, 0x128000
  s_cbranch_scc1 L_ps_93
  v_mov_b32 v6, s77
  v_mov_b32 v7, 1
  s_mov_b64 exec, s[78:79]
  buffer_store_dword v7, v6, s[4:7], 0 offen sc1
  s_mov_b64 exec, -1
  s_mov_b32 s77, 0x128000
L_ps_93:
  ds_read_b128 v[8:11], v5 offset:0
  ds_read_b128 v[12:15], v5 offset:1024
  ds_read_b128 v[16:19], v5 offset:2048
  ds_read_b128 v[20:23], v5 offset:3072
  s_waitcnt lgkmcnt(2)
  v_mfma_f32_16x16x32_bf16 v[32:35], a[0:3], v[8:11], 0
  ds_read_b128 v[24:27], v5 offset:4096
  v_mfma_f32_16x16x32_bf16 v[36:39], a[0:3], v[12:15], 0
  ds_read_b128 v[28:31], v5 offset:5120
  v_mfma_f32_16x16x32_bf16 v[40:43], a[64:67], v[8:11], 0
  v_mfma_f32_16x16x32_bf16 v[44:47], a[64:67], v[12:15], 0
  v_mfma_f32_16x16x32_bf16 v[48:51], a[128:131], v[8:11], 0
  v_mfma_f32_16x16x32_bf16 v[52:55], a[128:131], v[12:15], 0
  v_mfma_f32_16x16x32_bf16 v[56:59], a[192:195], v[8:11], 0
  v_mfma_f32_16x16x32_bf16 v[60:63], a[192:195], v[12:15], 0
  s_waitcnt lgkmcnt(2)
  v_mfma_f32_16x16x32_bf16 v[32:35], a[4:7], v[16:19], v[32:35]
  ds_read_b128 v[8:11], v5 offset:6144
  v_mfma_f32_16x16x32_bf16 v[36:39], a[4:7], v[20:23], v[36:39]
  ds_read_b128 v[12:15], v5 offset:7168
  v_mfma_f32_16x16x32_bf16 v[40:43], a[68:71], v[16:19], v[40:43]
  v_mfma_f32_16x16x32_bf16 v[44:47], a[68:71], v[20:23], v[44:47]
  v_mfma_f32_16x16x32_bf16 v[48:51], a[132:135], v[16:19], v[48:51]
  v_mfma_f32_16x16x32_bf16 v[52:55], a[132:135], v[20:23], v[52:55]
  v_mfma_f32_16x16x32_bf16 v[56:59], a[196:199], v[16:19], v[56:59]
  v_mfma_f32_16x16x32_bf16 v[60:63], a[196:199], v[20:23], v[60:63]
  s_waitcnt lgkmcnt(2)
  v_mfma_f32_16x16x32_bf16 v[32:35], a[8:11], v[24:27], v[32:35]
  v_mfma_f32_16x16x32_bf16 v[36:39], a[8:11], v[28:31], v[36:39]
  v_mfma_f32_16x16x32_bf16 v[40:43], a[72:75], v[24:27], v[40:43]
  v_mfma_f32_16x16x32_bf16 v[44:47], a[72:75], v[28:31], v[44:47]
  v_mfma_f32_16x16x32_bf16 v[48:51], a[136:139], v[24:27], v[48:51]
  v_mfma_f32_16x16x32_bf16 v[52:55], a[136:139], v[28:31], v[52:55]
  v_mfma_f32_16x16x32_bf16 v[56:59], a[200:203], v[24:27], v[56:59]
  v_mfma_f32_16x16x32_bf16 v[60:63], a[200:203], v[28:31], v[60:63]
  s_waitcnt lgkmcnt(0)
  v_mfma_f32_16x16x32_bf16 v[32:35], a[12:15], v[8:11], v[32:35]
  v_mfma_f32_16x16x32_bf16 v[36:39], a[12:15], v[12:15], v[36:39]
  v_mfma_f32_16x16x32_bf16 v[40:43], a[76:79], v[8:11], v[40:43]
  v_mfma_f32_16x16x32_bf16 v[44:47], a[76:79], v[12:15], v[44:47]
  v_mfma_f32_16x16x32_bf16 v[48:51], a[140:143], v[8:11], v[48:51]
  v_mfma_f32_16x16x32_bf16 v[52:55], a[140:143], v[12:15], v[52:55]
  v_mfma_f32_16x16x32_bf16 v[56:59], a[204:207], v[8:11], v[56:59]
  v_mfma_f32_16x16x32_bf16 v[60:63], a[204:207], v[12:15], v[60:63]
  s_waitcnt vmcnt(5)
  s_barrier
  ds_read_b128 v[16:19], v5 offset:8192
  ds_read_b128 v[20:23], v5 offset:9216
  ds_read_b128 v[24:27], v5 offset:10240
  ds_read_b128 v[28:31], v5 offset:11264
  s_waitcnt lgkmcnt(2)
  v_mfma_f32_16x16x32_bf16 v[32:35], a[16:19], v[16:19], v[32:35]
  ds_read_b128 v[8:11], v5 offset:12288
  v_mfma_f32_16x16x32_bf16 v[36:39], a[16:19], v[20:23], v[36:39]
  ds_read_b128 v[12:15], v5 offset:13312
  v_mfma_f32_16x16x32_bf16 v[40:43], a[80:83], v[16:19], v[40:43]
  v_mfma_f32_16x16x32_bf16 v[44:47], a[80:83], v[20:23], v[44:47]
  v_mfma_f32_16x16x32_bf16 v[48:51], a[144:147], v[16:19], v[48:51]
  v_mfma_f32_16x16x32_bf16 v[52:55], a[144:147], v[20:23], v[52:55]
  v_mfma_f32_16x16x32_bf16 v[56:59], a[208:211], v[16:19], v[56:59]
  v_mfma_f32_16x16x32_bf16 v[60:63], a[208:211], v[20:23], v[60:63]
  s_waitcnt lgkmcnt(2)
  v_mfma_f32_16x16x32_bf16 v[32:35], a[20:23], v[24:27], v[32:35]
  ds_read_b128 v[16:19], v5 offset:14336
  v_mfma_f32_16x16x32_bf16 v[36:39], a[20:23], v[28:31], v[36:39]
  ds_read_b128 v[20:23], v5 offset:15360
  v_mfma_f32_16x16x32_bf16 v[40:43], a[84:87], v[24:27], v[40:43]
  v_mfma_f32_16x16x32_bf16 v[44:47], a[84:87], v[28:31], v[44:47]
  v_mfma_f32_16x16x32_bf16 v[48:51], a[148:151], v[24:27], v[48:51]
  v_mfma_f32_16x16x32_bf16 v[52:55], a[148:151], v[28:31], v[52:55]
  v_mfma_f32_16x16x32_bf16 v[56:59], a[212:215], v[24:27], v[56:59]
  v_mfma_f32_16x16x32_bf16 v[60:63], a[212:215], v[28:31], v[60:63]
  s_waitcnt lgkmcnt(2)
  v_mfma_f32_16x16x32_bf16 v[32:35], a[24:27], v[8:11], v[32:35]
  v_mfma_f32_16x16x32_bf16 v[36:39], a[24:27], v[12:15], v[36:39]
  v_mfma_f32_16x16x32_bf16 v[40:43], a[88:91], v[8:11], v[40:43]
  v_mfma_f32_16x16x32_bf16 v[44:47], a[88:91], v[12:15], v[44:47]
  v_mfma_f32_16x16x32_bf16 v[48:51], a[152:155], v[8:11], v[48:51]
  v_mfma_f32_16x16x32_bf16 v[52:55], a[152:155], v[12:15], v[52:55]
  v_mfma_f32_16x16x32_bf16 v[56:59], a[216:219], v[8:11], v[56:59]
  v_mfma_f32_16x16x32_bf16 v[60:63], a[216:219], v[12:15], v[60:63]
  s_waitcnt lgkmcnt(0)
  v_mfma_f32_16x16x32_bf16 v[32:35], a[28:31], v[16:19], v[32:35]
  v_mfma_f32_16x16x32_bf16 v[36:39], a[28:31], v[20:23], v[36:39]
  v_mfma_f32_16x16x32_bf16 v[40:43], a[92:95], v[16:19], v[40:43]
  v_mfma_f32_16x16x32_bf16 v[44:47], a[92:95], v[20:23], v[44:47]
  v_mfma_f32_16x16x32_bf16 v[48:51], a[156:159], v[16:19], v[48:51]
  v_mfma_f32_16x16x32_bf16 v[52:55], a[156:159], v[20:23], v[52:55]
  v_mfma_f32_16x16x32_bf16 v[56:59], a[220:223], v[16:19], v[56:59]
  v_mfma_f32_16x16x32_bf16 v[60:63], a[220:223], v[20:23], v[60:63]
  s_waitcnt vmcnt(0)
  v_cmp_ne_u32 vcc, 0, v4
  s_and_b32 s71, vcc_lo, 0xf
  s_cmp_eq_u32 s71, 0xf
  s_cselect_b32 s71, 1, 0
  v_mov_b32 v4, s71
  v_mov_b32 v6, 0x20000
  s_cmp_eq_u32 s16, 0
  s_cbranch_scc0 L_dec_94
  s_mov_b64 exec, 1
  ds_write_b32 v6, v4
  s_mov_b64 exec, -1
  s_waitcnt lgkmcnt(0)
L_dec_94:
  s_barrier
  s_cmp_eq_u32 s83, 0x128000
  s_cbranch_scc1 L_ps_95
  v_mov_b32 v6, s83
  v_mov_b32 v7, 1
  s_mov_b64 exec, s[78:79]
  buffer_store_dword v7, v6, s[4:7], 0 offen sc1
  s_mov_b64 exec, -1
  s_mov_b32 s83, 0x128000
L_ps_95:
  ds_read_b32 v4, v6
  s_waitcnt lgkmcnt(0)
  v_readfirstlane_b32 s71, v4
  s_cmp_ge_u32 s65, 63
  s_cbranch_scc1 L_varB_89
  s_cmp_eq_u32 s71, 1
  s_cbranch_scc0 L_varB_89
  s_add_u32 s81, s66, s74
  s_xor_b32 s82, s69, 32768
  s_add_u32 s82, s82, s73
  ds_read_b128 v[24:27], v5 offset:16384
  ds_read_b128 v[28:31], v5 offset:17408
  ds_read_b128 v[8:11], v5 offset:18432
  ds_read_b128 v[12:15], v5 offset:19456
  s_waitcnt lgkmcnt(2)
  v_mfma_f32_16x16x32_bf16 v[32:35], a[32:35], v[24:27], v[32:35]
  ds_read_b128 v[16:19], v5 offset:20480
  ds_read_b128 v[20:23], v5 offset:21504
  v_mfma_f32_16x16x32_bf16 v[36:39], a[32:35], v[28:31], v[36:39]
  s_add_u32 s45, s82, 0
  s_mov_b32 m0, s45
  v_mfma_f32_16x16x32_bf16 v[40:43], a[96:99], v[24:27], v[40:43]
  s_add_u32 s46, s81, 0
  buffer_load_dwordx4 v2, s[4:7], s46 offen sc1 lds
  v_mfma_f32_16x16x32_bf16 v[44:47], a[96:99], v[28:31], v[44:47]
  v_mfma_f32_16x16x32_bf16 v[48:51], a[160:163], v[24:27], v[48:51]
  v_mfma_f32_16x16x32_bf16 v[52:55], a[160:163], v[28:31], v[52:55]
  v_mfma_f32_16x16x32_bf16 v[56:59], a[224:227], v[24:27], v[56:59]
  v_mfma_f32_16x16x32_bf16 v[60:63], a[224:227], v[28:31], v[60:63]
  s_waitcnt lgkmcnt(2)
  v_mfma_f32_16x16x32_bf16 v[32:35], a[36:39], v[8:11], v[32:35]
  ds_read_b128 v[24:27], v5 offset:22528
  ds_read_b128 v[28:31], v5 offset:23552
  v_mfma_f32_16x16x32_bf16 v[36:39], a[36:39], v[12:15], v[36:39]
  s_add_u32 s45, s82, 4096
  s_mov_b32 m0, s45
  v_mfma_f32_16x16x32_bf16 v[40:43], a[100:103], v[8:11], v[40:43]
  s_add_u32 s46, s81, 2048
  buffer_load_dwordx4 v2, s[4:7], s46 offen sc1 lds
  v_mfma_f32_16x16x32_bf16 v[44:47], a[100:103], v[12:15], v[44:47]
  v_mfma_f32_16x16x32_bf16 v[48:51], a[164:167], v[8:11], v[48:51]
  v_mfma_f32_16x16x32_bf16 v[52:55], a[164:167], v[12:15], v[52:55]
  v_mfma_f32_16x16x32_bf16 v[56:59], a[228:231], v[8:11], v[56:59]
  v_mfma_f32_16x16x32_bf16 v[60:63], a[228:231], v[12:15], v[60:63]
  s_waitcnt lgkmcnt(2)
  v_mfma_f32_16x16x32_bf16 v[32:35], a[40:43], v[16:19], v[32:35]
  s_add_u32 s45, s82, 8192
  s_mov_b32 m0, s45
  v_mfma_f32_16x16x32_bf16 v[36:39], a[40:43], v[20:23], v[36:39]
  s_add_u32 s46, s81, 4096
  buffer_load_dwordx4 v2, s[4:7], s46 offen sc1 lds
  v_mfma_f32_16x16x32_bf16 v[40:43], a[104:107], v[16:19], v[40:43]
  v_mfma_f32_16x16x32_bf16 v[44:47], a[104:107], v[20:23], v[44:47]
  v_mfma_f32_16x16x32_bf16 v[48:51], a[168:171], v[16:19], v[48:51]
  v_mfma_f32_16x16x32_bf16 v[52:55], a[168:171], v[20:23], v[52:55]
  v_mfma_f32_16x16x32_bf16 v[56:59], a[232:235], v[16:19], v[56:59]
  v_mfma_f32_16x16x32_bf16 v[60:63], a[232:235], v[20:23], v[60:63]
  s_waitcnt lgkmcnt(0)
  v_mfma_f32_16x16x32_bf16 v[32:35], a[44:47], v[24:27], v[32:35]
  s_add_u32 s45, s82, 12288
  s_mov_b32 m0, s45
  v_mfma_f32_16x16x32_bf16 v[36:39], a[44:47], v[28:31], v[36:39]
  s_add_u32 s46, s81, 6144
  buffer_load_dwordx4 v2, s[4:7], s46 offen sc1 lds
  v_mfma_f32_16x16x32_bf16 v[40:43], a[108:111], v[24:27], v[40:43]
  v_mfma_f32_16x16x32_bf16 v[44:47], a[108:111], v[28:31], v[44:47]
  v_mfma_f32_16x16x32_bf16 v[48:51], a[172:175], v[24:27], v[48:51]
  v_mfma_f32_16x16x32_bf16 v[52:55], a[172:175], v[28:31], v[52:55]
  v_mfma_f32_16x16x32_bf16 v[56:59], a[236:239], v[24:27], v[56:59]
  v_mfma_f32_16x16x32_bf16 v[60:63], a[236:239], v[28:31], v[60:63]
  ds_read_b128 v[8:11], v5 offset:24576
  ds_read_b128 v[12:15], v5 offset:25600
  ds_read_b128 v[16:19], v5 offset:26624
  ds_read_b128 v[20:23], v5 offset:27648
  s_waitcnt lgkmcnt(2)
  v_mfma_f32_16x16x32_bf16 v[32:35], a[48:51], v[8:11], v[32:35]
  ds_read_b128 v[24:27], v5 offset:28672
  ds_read_b128 v[28:31], v5 offset:29696
  v_mfma_f32_16x16x32_bf16 v[36:39], a[48:51], v[12:15], v[36:39]
  s_add_u32 s45, s82, 16384
  s_mov_b32 m0, s45
  v_mfma_f32_16x16x32_bf16 v[40:43], a[112:115], v[8:11], v[40:43]
  s_add_u32 s46, s81, 8192
  buffer_load_dwordx4 v2, s[4:7], s46 offen sc1 lds
  v_mfma_f32_16x16x32_bf16 v[44:47], a[112:115], v[12:15], v[44:47]
  v_mfma_f32_16x16x32_bf16 v[48:51], a[176:179], v[8:11], v[48:51]
  v_mfma_f32_16x16x32_bf16 v[52:55], a[176:179], v[12:15], v[52:55]
  v_mfma_f32_16x16x32_bf16 v[56:59], a[240:243], v[8:11], v[56:59]
  v_mfma_f32_16x16x32_bf16 v[60:63], a[240:243], v[12:15], v[60:63]
  s_waitcnt lgkmcnt(2)
  v_mfma_f32_16x16x32_bf16 v[32:35], a[52:55], v[16:19], v[32:35]
  ds_read_b128 v[8:11], v5 offset:30720
  ds_read_b128 v[12:15], v5 offset:31744
  v_mfma_f32_16x16x32_bf16 v[36:39], a[52:55], v[20:23], v[36:39]
  s_add_u32 s45, s82, 20480
  s_mov_b32 m0, s45
  v_mfma_f32_16x16x32_bf16 v[40:43], a[116:119], v[16:19], v[40:43]
  s_add_u32 s46, s81, 10240
  buffer_load_dwordx4 v2, s[4:7], s46 offen sc1 lds
  v_mfma_f32_16x16x32_bf16 v[44:47], a[116:119], v[20:23], v[44:47]
  v_mfma_f32_16x16x32_bf16 v[48:51], a[180:183], v[16:19], v[48:51]
  v_mfma_f32_16x16x32_bf16 v[52:55], a[180:183], v[20:23], v[52:55]
  v_mfma_f32_16x16x32_bf16 v[56:59], a[244:247], v[16:19], v[56:59]
  v_mfma_f32_16x16x32_bf16 v[60:63], a[244:247], v[20:23], v[60:63]
  s_waitcnt lgkmcnt(2)
  v_mfma_f32_16x16x32_bf16 v[32:35], a[56:59], v[24:27], v[32:35]
  s_add_u32 s45, s82, 24576
  s_mov_b32 m0, s45
  v_mfma_f32_16x16x32_bf16 v[36:39], a[56:59], v[28:31], v[36:39]
  s_add_u32 s46, s81, 12288
  buffer_load_dwordx4 v2, s[4:7], s46 offen sc1 lds
  v_mfma_f32_16x16x32_bf16 v[40:43], a[120:123], v[24:27], v[40:43]
  v_mfma_f32_16x16x32_bf16 v[44:47], a[120:123], v[28:31], v[44:47]
  v_mfma_f32_16x16x32_bf16 v[48:51], a[184:187], v[24:27], v[48:51]
  v_mfma_f32_16x16x32_bf16 v[52:55], a[184:187], v[28:31], v[52:55]
  v_mfma_f32_16x16x32_bf16 v[56:59], a[248:251], v[24:27], v[56:59]
  v_mfma_f32_16x16x32_bf16 v[60:63], a[248:251], v[28:31], v[60:63]
  s_waitcnt lgkmcnt(0)
  v_mfma_f32_16x16x32_bf16 v[32:35], a[60:63], v[8:11], v[32:35]
  s_add_u32 s45, s82, 28672
  s_mov_b32 m0, s45
  v_mfma_f32_16x16x32_bf16 v[36:39], a[60:63], v[12:15], v[36:39]
  s_add_u32 s46, s81, 14336
  buffer_load_dwordx4 v2, s[4:7], s46 offen sc1 lds
  v_mfma_f32_16x16x32_bf16 v[40:43], a[124:127], v[8:11], v[40:43]
  v_mfma_f32_16x16x32_bf16 v[44:47], a[124:127], v[12:15], v[44:47]
  v_mfma_f32_16x16x32_bf16 v[48:51], a[188:191], v[8:11], v[48:51]
  v_mfma_f32_16x16x32_bf16 v[52:55], a[188:191], v[12:15], v[52:55]
  v_mfma_f32_16x16x32_bf16 v[56:59], a[252:255], v[8:11], v[56:59]
  v_mfma_f32_16x16x32_bf16 v[60:63], a[252:255], v[12:15], v[60:63]
  s_nop 7
  v_mul_f32 v32, v32, v48
  v_mul_f32 v40, v40, v56
  v_mul_f32 v33, v33, v49
  v_mul_f32 v41, v41, v57
  v_mul_f32 v34, v34, v50
  v_mul_f32 v42, v42, v58
  v_mul_f32 v35, v35, v51
  v_mul_f32 v43, v43, v59
  v_cvt_pk_bf16_f32 v48, v32, v33
  v_cvt_pk_bf16_f32 v49, v34, v35
  v_cvt_pk_bf16_f32 v50, v40, v41
  v_cvt_pk_bf16_f32 v51, v42, v43
  buffer_store_dwordx4 v[48:51], v2, s[4:7], s72 offen offset:0 sc1
  v_mul_f32 v36, v36, v52
  v_mul_f32 v44, v44, v60
  v_mul_f32 v37, v37, v53
  v_mul_f32 v45, v45, v61
  v_mul_f32 v38, v38, v54
  v_mul_f32 v46, v46, v62
  v_mul_f32 v39, v39, v55
  v_mul_f32 v47, v47, v63
  v_cvt_pk_bf16_f32 v52, v36, v37
  v_cvt_pk_bf16_f32 v53, v38, v39
  v_cvt_pk_bf16_f32 v54, v44, v45
  v_cvt_pk_bf16_f32 v55, v46, v47
  buffer_store_dwordx4 v[52:55], v2, s[4:7], s72 offen offset:1024 sc1
  s_add_u32 s72, s72, 114688
  s_xor_b32 s69, s69, 32768
  s_add_u32 s65, s65, 1
  s_mov_b32 s83, s68
  s_add_u32 s68, s68, 256
  s_mov_b32 s84, 1
  s_branch L_g4_loop
L_varB_89:
  s_mov_b32 s84, 0
  ds_read_b128 v[24:27], v5 offset:16384
  ds_read_b128 v[28:31], v5 offset:17408
  ds_read_b128 v[8:11], v5 offset:18432
  ds_read_b128 v[12:15], v5 offset:19456
  s_waitcnt lgkmcnt(2)
  v_mfma_f32_16x16x32_bf16 v[32:35], a[32:35], v[24:27], v[32:35]
  ds_read_b128 v[16:19], v5 offset:20480
  v_mfma_f32_16x16x32_bf16 v[36:39], a[32:35], v[28:31], v[36:39]
  ds_read_b128 v[20:23], v5 offset:21504
  v_mfma_f32_16x16x32_bf16 v[40:43], a[96:99], v[24:27], v[40:43]
  v_mfma_f32_16x16x32_bf16 v[44:47], a[96:99], v[28:31], v[44:47]
  v_mfma_f32_16x16x32_bf16 v[48:51], a[160:163], v[24:27], v[48:51]
  v_mfma_f32_16x16x32_bf16 v[52:55], a[160:163], v[28:31], v[52:55]
  v_mfma_f32_16x16x32_bf16 v[56:59], a[224:227], v[24:27], v[56:59]
  v_mfma_f32_16x16x32_bf16 v[60:63], a[224:227], v[28:31], v[60:63]
  s_waitcnt lgkmcnt(2)
  v_mfma_f32_16x16x32_bf16 v[32:35], a[36:39], v[8:11], v[32:35]
  ds_read_b128 v[24:27], v5 offset:22528
  v_mfma_f32_16x16x32_bf16 v[36:39], a[36:39], v[12:15], v[36:39]
  ds_read_b128 v[28:31], v5 offset:23552
  v_mfma_f32_16x16x32_bf16 v[40:43], a[100:103], v[8:11], v[40:43]
  v_mfma_f32_16x16x32_bf16 v[44:47], a[100:103], v[12:15], v[44:47]
  v_mfma_f32_16x16x32_bf16 v[48:51], a[164:167], v[8:11], v[48:51]
  v_mfma_f32_16x16x32_bf16 v[52:55], a[164:167], v[12:15], v[52:55]
  v_mfma_f32_16x16x32_bf16 v[56:59], a[228:231], v[8:11], v[56:59]
  v_mfma_f32_16x16x32_bf16 v[60:63], a[228:231], v[12:15], v[60:63]
  s_waitcnt lgkmcnt(2)
  v_mfma_f32_16x16x32_bf16 v[32:35], a[40:43], v[16:19], v[32:35]
  v_mfma_f32_16x16x32_bf16 v[36:39], a[40:43], v[20:23], v[36:39]
  v_mfma_f32_16x16x32_bf16 v[40:43], a[104:107], v[16:19], v[40:43]
  v_mfma_f32_16x16x32_bf16 v[44:47], a[104:107], v[20:23], v[44:47]
  v_mfma_f32_16x16x32_bf16 v[48:51], a[168:171], v[16:19], v[48:51]
  v_mfma_f32_16x16x32_bf16 v[52:55], a[168:171], v[20:23], v[52:55]
  v_mfma_f32_16x16x32_bf16 v[56:59], a[232:235], v[16:19], v[56:59]
  v_mfma_f32_16x16x32_bf16 v[60:63], a[232:235], v[20:23], v[60:63]
  s_waitcnt lgkmcnt(0)
  v_mfma_f32_16x16x32_bf16 v[32:35], a[44:47], v[24:27], v[32:35]
  v_mfma_f32_16x16x32_bf16 v[36:39], a[44:47], v[28:31], v[36:39]
  v_mfma_f32_16x16x32_bf16 v[40:43], a[108:111], v[24:27], v[40:43]
  v_mfma_f32_16x16x32_bf16 v[44:47], a[108:111], v[28:31], v[44:47]
  v_mfma_f32_16x16x32_bf16 v[48:51], a[172:175], v[24:27], v[48:51]
  v_mfma_f32_16x16x32_bf16 v[52:55], a[172:175], v[28:31], v[52:55]
  v_mfma_f32_16x16x32_bf16 v[56:59], a[236:239], v[24:27], v[56:59]
  v_mfma_f32_16x16x32_bf16 v[60:63], a[236:239], v[28:31], v[60:63]
  v_and_b32 v3, 63, v0
  v_lshlrev_b32 v3, 2, v3
  v_add_u32 v3, s67, v3
  s_mov_b64 exec, 0xf
  buffer_load_dword v4, v3, s[4:7], 0 offen sc1
  s_mov_b64 exec, -1
  ds_read_b128 v[8:11], v5 offset:24576
  ds_read_b128 v[12:15], v5 offset:25600
  ds_read_b128 v[16:19], v5 offset:26624
  ds_read_b128 v[20:23], v5 offset:27648
  s_waitcnt lgkmcnt(2)
  v_mfma_f32_16x16x32_bf16 v[32:35], a[48:51], v[8:11], v[32:35]
  ds_read_b128 v[24:27], v5 offset:28672
  v_mfma_f32_16x16x32_bf16 v[36:39], a[48:51], v[12:15], v[36:39]
  ds_read_b128 v[28:31], v5 offset:29696
  v_mfma_f32_16x16x32_bf16 v[40:43], a[112:115], v[8:11], v[40:43]
  v_mfma_f32_16x16x32_bf16 v[44:47], a[112:115], v[12:15], v[44:47]
  v_mfma_f32_16x16x32_bf16 v[48:51], a[176:179], v[8:11], v[48:51]
  v_mfma_f32_16x16x32_bf16 v[52:55], a[176:179], v[12:15], v[52:55]
  v_mfma_f32_16x16x32_bf16 v[56:59], a[240:243], v[8:11], v[56:59]
  v_mfma_f32_16x16x32_bf16 v[60:63], a[240:243], v[12:15], v[60:63]
  s_waitcnt lgkmcnt(2)
  v_mfma_f32_16x16x32_bf16 v[32:35], a[52:55], v[16:19], v[32:35]
  ds_read_b128 v[8:11], v5 offset:30720
  v_mfma_f32_16x16x32_bf16 v[36:39], a[52:55], v[20:23], v[36:39]
  ds_read_b128 v[12:15], v5 offset:31744
  v_mfma_f32_16x16x32_bf16 v[40:43], a[116:119], v[16:19], v[40:43]
  v_mfma_f32_16x16x32_bf16 v[44:47], a[116:119], v[20:23], v[44:47]
  v_mfma_f32_16x16x32_bf16 v[48:51], a[180:183], v[16:19], v[48:51]
  v_mfma_f32_16x16x32_bf16 v[52:55], a[180:183], v[20:23], v[52:55]
  v_mfma_f32_16x16x32_bf16 v[56:59], a[244:247], v[16:19], v[56:59]
  v_mfma_f32_16x16x32_bf16 v[60:63], a[244:247], v[20:23], v[60:63]
  s_waitcnt lgkmcnt(2)
  v_mfma_f32_16x16x32_bf16 v[32:35], a[56:59], v[24:27], v[32:35]
  v_mfma_f32_16x16x32_bf16 v[36:39], a[56:59], v[28:31], v[36:39]
  v_mfma_f32_16x16x32_bf16 v[40:43], a[120:123], v[24:27], v[40:43]
  v_mfma_f32_16x16x32_bf16 v[44:47], a[120:123], v[28:31], v[44:47]
  v_mfma_f32_16x16x32_bf16 v[48:51], a[184:187], v[24:27], v[48:51]
  v_mfma_f32_16x16x32_bf16 v[52:55], a[184:187], v[28:31], v[52:55]
  v_mfma_f32_16x16x32_bf16 v[56:59], a[248:251], v[24:27], v[56:59]
  v_mfma_f32_16x16x32_bf16 v[60:63], a[248:251], v[28:31], v[60:63]
  s_waitcnt lgkmcnt(0)
  v_mfma_f32_16x16x32_bf16 v[32:35], a[60:63], v[8:11], v[32:35]
  v_mfma_f32_16x16x32_bf16 v[36:39], a[60:63], v[12:15], v[36:39]
  v_mfma_f32_16x16x32_bf16 v[40:43], a[124:127], v[8:11], v[40:43]
  v_mfma_f32_16x16x32_bf16 v[44:47], a[124:127], v[12:15], v[44:47]
  v_mfma_f32_16x16x32_bf16 v[48:51], a[188:191], v[8:11], v[48:51]
  v_mfma_f32_16x16x32_bf16 v[52:55], a[188:191], v[12:15], v[52:55]
  v_mfma_f32_16x16x32_bf16 v[56:59], a[252:255], v[8:11], v[56:59]
  v_mfma_f32_16x16x32_bf16 v[60:63], a[252:255], v[12:15], v[60:63]
  s_nop 7
  v_mul_f32 v32, v32, v48
  v_mul_f32 v40, v40, v56
  v_mul_f32 v33, v33, v49
  v_mul_f32 v41, v41, v57
  v_mul_f32 v34, v34, v50
  v_mul_f32 v42, v42, v58
  v_mul_f32 v35, v35, v51
  v_mul_f32 v43, v43, v59
  v_cvt_pk_bf16_f32 v48, v32, v33
  v_cvt_pk_bf16_f32 v49, v34, v35
  v_cvt_pk_bf16_f32 v50, v40, v41
  v_cvt_pk_bf16_f32 v51, v42, v43
  buffer_store_dwordx4 v[48:51], v2, s[4:7], s72 offen offset:0 sc1
  v_mul_f32 v36, v36, v52
  v_mul_f32 v44, v44, v60
  v_mul_f32 v37, v37, v53
  v_mul_f32 v45, v45, v61
  v_mul_f32 v38, v38, v54
  v_mul_f32 v46, v46, v62
  v_mul_f32 v39, v39, v55
  v_mul_f32 v47, v47, v63
  v_cvt_pk_bf16_f32 v52, v36, v37
  v_cvt_pk_bf16_f32 v53, v38, v39
  v_cvt_pk_bf16_f32 v54, v44, v45
  v_cvt_pk_bf16_f32 v55, v46, v47
  buffer_store_dwordx4 v[52:55], v2, s[4:7], s72 offen offset:1024 sc1
  s_add_u32 s72, s72, 114688
  s_xor_b32 s69, s69, 32768
  s_add_u32 s65, s65, 1
  s_waitcnt vmcnt(2)
  v_cmp_ne_u32 vcc, 0, v4
  s_and_b32 s71, vcc_lo, 0xf
  s_cmp_eq_u32 s71, 0xf
  s_cselect_b32 s71, 1, 0
  v_mov_b32 v4, s71
  v_mov_b32 v6, 0x20004
  s_cmp_eq_u32 s16, 0
  s_cbranch_scc0 L_dec_96
  s_mov_b64 exec, 1
  ds_write_b32 v6, v4
  s_mov_b64 exec, -1
  s_waitcnt lgkmcnt(0)
L_dec_96:
  s_barrier
  ds_read_b32 v4, v6
  s_waitcnt lgkmcnt(0)
  v_readfirstlane_b32 s71, v4
  s_cmp_ge_u32 s65, 64
  s_cbranch_scc1 L_ni_90
  s_cmp_eq_u32 s71, 1
  s_cbranch_scc0 L_ni_90
  s_add_u32 s47, s66, s74
  s_add_u32 s48, s69, s73
  s_mov_b32 s81, s47
  s_mov_b32 s82, s48
  s_add_u32 s45, s48, 0
  s_mov_b32 m0, s45
  s_add_u32 s46, s47, 0
  buffer_load_dwordx4 v2, s[4:7], s46 offen sc1 lds
  s_add_u32 s45, s48, 4096
  s_mov_b32 m0, s45
  s_add_u32 s46, s47, 2048
  buffer_load_dwordx4 v2, s[4:7], s46 offen sc1 lds
  s_add_u32 s45, s48, 8192
  s_mov_b32 m0, s45
  s_add_u32 s46, s47, 4096
  buffer_load_dwordx4 v2, s[4:7], s46 offen sc1 lds
  s_add_u32 s45, s48, 12288
  s_mov_b32 m0, s45
  s_add_u32 s46, s47, 6144
  buffer_load_dwordx4 v2, s[4:7], s46 offen sc1 lds
  s_add_u32 s45, s48, 16384
  s_mov_b32 m0, s45
  s_add_u32 s46, s47, 8192
  buffer_load_dwordx4 v2, s[4:7], s46 offen sc1 lds
  s_add_u32 s45, s48, 20480
  s_mov_b32 m0, s45
  s_add_u32 s46, s47, 10240
  buffer_load_dwordx4 v2, s[4:7], s46 offen sc1 lds
  s_add_u32 s45, s48, 24576
  s_mov_b32 m0, s45
  s_add_u32 s46, s47, 12288
  buffer_load_dwordx4 v2, s[4:7], s46 offen sc1 lds
  s_add_u32 s45, s48, 28672
  s_mov_b32 m0, s45
  s_add_u32 s46, s47, 14336
  buffer_load_dwordx4 v2, s[4:7], s46 offen sc1 lds
  s_mov_b32 s77, s68
  s_add_u32 s68, s68, 256
  s_branch L_g4_loop
L_ni_90:
  s_waitcnt vmcnt(0)
  s_barrier
  v_mov_b32 v6, s68
  v_mov_b32 v7, 1
  s_mov_b64 exec, s[78:79]
  buffer_store_dword v7, v6, s[4:7], 0 offen sc1
  s_mov_b64 exec, -1
  s_add_u32 s68, s68, 256
  s_cmp_ge_u32 s65, 64
  s_cbranch_scc1 L_gfin_97
L_wn_98:
  v_and_b32 v3, 63, v0
  v_lshlrev_b32 v3, 2, v3
  v_add_u32 v3, s67, v3
  s_mov_b64 exec, 0xf
  buffer_load_dword v4, v3, s[4:7], 0 offen sc1
  s_mov_b64 exec, -1
  s_waitcnt vmcnt(0)
  v_cmp_ne_u32 vcc, 0, v4
  s_and_b32 s45, vcc_lo, 0xf
  s_cmp_eq_u32 s45, 0xf
  s_cselect_b32 s45, 1, 0
  s_cmp_eq_u32 s45, 1
  s_cbranch_scc1 L_wnd_99
  s_sub_u32 s64, s64, 1
  s_cbranch_scc1 L_abort
  s_sleep 4
  s_branch L_wn_98
L_wnd_99:
  s_add_u32 s47, s66, s74
  s_add_u32 s48, s69, s73
  s_mov_b32 s81, s47
  s_mov_b32 s82, s48
  s_add_u32 s45, s48, 0
  s_mov_b32 m0, s45
  s_add_u32 s46, s47, 0
  buffer_load_dwordx4 v2, s[4:7], s46 offen sc1 lds
  s_add_u32 s45, s48, 4096
  s_mov_b32 m0, s45
  s_add_u32 s46, s47, 2048
  buffer_load_dwordx4 v2, s[4:7], s46 offen sc1 lds
  s_add_u32 s45, s48, 8192
  s_mov_b32 m0, s45
  s_add_u32 s46, s47, 4096
  buffer_load_dwordx4 v2, s[4:7], s46 offen sc1 lds
  s_add_u32 s45, s48, 12288
  s_mov_b32 m0, s45
  s_add_u32 s46, s47, 6144
  buffer_load_dwordx4 v2, s[4:7], s46 offen sc1 lds
  s_add_u32 s45, s48, 16384
  s_mov_b32 m0, s45
  s_add_u32 s46, s47, 8192
  buffer_load_dwordx4 v2, s[4:7], s46 offen sc1 lds
  s_add_u32 s45, s48, 20480
  s_mov_b32 m0, s45
  s_add_u32 s46, s47, 10240
  buffer_load_dwordx4 v2, s[4:7], s46 offen sc1 lds
  s_add_u32 s45, s48, 24576
  s_mov_b32 m0, s45
  s_add_u32 s46, s47, 12288
  buffer_load_dwordx4 v2, s[4:7], s46 offen sc1 lds
  s_add_u32 s45, s48, 28672
  s_mov_b32 m0, s45
  s_add_u32 s46, s47, 14336
  buffer_load_dwordx4 v2, s[4:7], s46 offen sc1 lds
  s_branch L_g4_loop
L_gfin_97:
  s_waitcnt vmcnt(0)
  s_branch L_end
L_role_g5:
  v_and_b32 v1, 63, v0
  v_lshlrev_b32 v2, 4, v1
  s_cmp_eq_u32 s99, 1
  s_cbranch_scc1 L_gs_done_100
  s_cmp_eq_u32 s16, 0
  s_cbranch_scc0 L_gs_w_101
  v_mov_b32 v100, 32
L_gs_p_102:
  s_mov_b64 exec, 1
  global_load_dword v101, v100, s[40:41] sc1
  s_mov_b64 exec, -1
  s_waitcnt vmcnt(0)
  v_readfirstlane_b32 s45, v101
  s_sub_u32 s64, s64, 1
  s_cbranch_scc1 L_abort
  s_cmp_ge_u32 s45, 256
  s_cbranch_scc1 L_gs_q_103
  s_sleep 4
  s_branch L_gs_p_102
L_gs_q_103:
  v_and_b32 v102, 63, v0
  v_lshlrev_b32 v102, 2, v102
  s_mov_b64 exec, 0xff
  global_load_dword v101, v102, s[40:41] sc1
  s_waitcnt vmcnt(0)
  ds_write_b32 v102, v101
  s_mov_b64 exec, -1
  s_waitcnt lgkmcnt(0)
L_gs_w_101:
  s_barrier
  v_mov_b32 v100, 0
  ds_read_b128 v[104:107], v100
  ds_read_b128 v[108:111], v100 offset:16
  s_waitcnt lgkmcnt(0)
  s_mov_b32 s44, 1
  s_mov_b32 s46, 0
  v_readfirstlane_b32 s45, v104
  s_cmp_eq_u32 s45, 32
  s_cselect_b32 s44, s44, 0
  s_cmp_gt_u32 s18, 0
  s_cselect_b32 s45, s45, 0
  s_add_u32 s46, s46, s45
  v_readfirstlane_b32 s45, v105
  s_cmp_eq_u32 s45, 32
  s_cselect_b32 s44, s44, 0
  s_cmp_gt_u32 s18, 1
  s_cselect_b32 s45, s45, 0
  s_add_u32 s46, s46, s45
  v_readfirstlane_b32 s45, v106
  s_cmp_eq_u32 s45, 32
  s_cselect_b32 s44, s44, 0
  s_cmp_gt_u32 s18, 2
  s_cselect_b32 s45, s45, 0
  s_add_u32 s46, s46, s45
  v_readfirstlane_b32 s45, v107
  s_cmp_eq_u32 s45, 32
  s_cselect_b32 s44, s44, 0
  s_cmp_gt_u32 s18, 3
  s_cselect_b32 s45, s45, 0
  s_add_u32 s46, s46, s45
  v_readfirstlane_b32 s45, v108
  s_cmp_eq_u32 s45, 32
  s_cselect_b32 s44, s44, 0
  s_cmp_gt_u32 s18, 4
  s_cselect_b32 s45, s45, 0
  s_add_u32 s46, s46, s45
  v_readfirstlane_b32 s45, v109
  s_cmp_eq_u32 s45, 32
  s_cselect_b32 s44, s44, 0
  s_cmp_gt_u32 s18, 5
  s_cselect_b32 s45, s45, 0
  s_add_u32 s46, s46, s45
  v_readfirstlane_b32 s45, v110
  s_cmp_eq_u32 s45, 32
  s_cselect_b32 s44, s44, 0
  s_cmp_gt_u32 s18, 6
  s_cselect_b32 s45, s45, 0
  s_add_u32 s46, s46, s45
  v_readfirstlane_b32 s45, v111
  s_cmp_eq_u32 s45, 32
  s_cselect_b32 s44, s44, 0
  s_cmp_gt_u32 s18, 7
  s_cselect_b32 s45, s45, 0
  s_add_u32 s46, s46, s45
  s_barrier
  s_mov_b32 s99, 1
  s_cmp_eq_u32 s44, 1
  s_cbranch_scc1 L_gs_done_100
  s_add_u32 s17, s46, s98
  s_branch L_dispatch
L_gs_done_100:
  s_mul_i32 s50, s16, 40960
  s_and_b32 s45, s17, 3
  s_lshl_b32 s45, s45, 8
  s_lshl_b32 s46, s16, 6
  s_add_u32 s51, s45, s46
  s_lshr_b32 s45, s17, 2
  s_mul_i32 s45, s45, 917504
  s_add_u32 s51, s51, s45
  v_bfe_u32 v12, v1, 4, 1
  v_bfe_u32 v13, v1, 5, 1
  v_xor_b32 v12, v12, v13
  v_lshlrev_b32 v12, 1, v12
  v_and_b32 v13, 3, v1
  v_xor_b32 v12, v12, v13
  v_lshlrev_b32 v12, 4, v12
  v_lshrrev_b32 v13, 2, v1
  s_mov_b32 s45, 1024
  v_mul_lo_u32 v13, s45, v13
  v_add_u32 v15, v12, v13
  v_lshrrev_b32 v12, 4, v1
  v_bfe_u32 v13, v1, 2, 2
  v_lshl_add_u32 v14, v12, 3, v13
  v_lshlrev_b32 v14, 6, v14
  v_and_b32 v8, 3, v1
  v_lshl_add_u32 v14, v8, 3, v14
  v_and_b32 v8, 1, v12
  v_lshl_add_u32 v14, v8, 5, v14
  v_add_u32 v8, s50, v14
  v_xor_b32 v9, 32, v8
  v_lshl_add_u32 v14, v12, 2, v13
  v_lshlrev_b32 v14, 6, v14
  v_and_b32 v10, 3, v1
  v_lshl_add_u32 v14, v10, 3, v14
  v_lshrrev_b32 v13, 1, v12
  v_xor_b32 v13, v13, v12
  v_and_b32 v13, 1, v13
  v_lshl_add_u32 v14, v13, 5, v14
  v_add_u32 v10, s50, v14
  v_xor_b32 v11, 32, v10
  s_mov_b32 s8, s36
  s_and_b32 s9, s37, 0xffff
  s_mov_b32 s10, 0x1c0000
  s_mov_b32 s11, 0x20000
  s_add_u32 s45, s50, 0
  s_mov_b32 m0, s45
  s_add_u32 s46, s51, 0
  buffer_load_dwordx4 v15, s[8:11], s46 offen lds
  s_add_u32 s45, s50, 1024
  s_mov_b32 m0, s45
  s_add_u32 s46, s51, 16384
  buffer_load_dwordx4 v15, s[8:11], s46 offen lds
  s_add_u32 s45, s50, 2048
  s_mov_b32 m0, s45
  s_add_u32 s46, s51, 32768
  buffer_load_dwordx4 v15, s[8:11], s46 offen lds
  s_add_u32 s45, s50, 3072
  s_mov_b32 m0, s45
  s_add_u32 s46, s51, 49152
  buffer_load_dwordx4 v15, s[8:11], s46 offen lds
  s_add_u32 s45, s50, 4096
  s_mov_b32 m0, s45
  s_add_u32 s46, s51, 65536
  buffer_load_dwordx4 v15, s[8:11], s46 offen lds
  s_add_u32 s45, s50, 5120
  s_mov_b32 m0, s45
  s_add_u32 s46, s51, 81920
  buffer_load_dwordx4 v15, s[8:11], s46 offen lds
  s_add_u32 s45, s50, 6144
  s_mov_b32 m0, s45
  s_add_u32 s46, s51, 98304
  buffer_load_dwordx4 v15, s[8:11], s46 offen lds
  s_add_u32 s45, s50, 7168
  s_mov_b32 m0, s45
  s_add_u32 s46, s51, 114688
  buffer_load_dwordx4 v15, s[8:11], s46 offen lds
  s_add_u32 s45, s50, 8192
  s_mov_b32 m0, s45
  s_add_u32 s46, s51, 131072
  buffer_load_dwordx4 v15, s[8:11], s46 offen lds
  s_add_u32 s45, s50, 9216
  s_mov_b32 m0, s45
  s_add_u32 s46, s51, 147456
  buffer_load_dwordx4 v15, s[8:11], s46 offen lds
  s_add_u32 s45, s50, 10240
  s_mov_b32 m0, s45
  s_add_u32 s46, s51, 163840
  buffer_load_dwordx4 v15, s[8:11], s46 offen lds
  s_add_u32 s45, s50, 11264
  s_mov_b32 m0, s45
  s_add_u32 s46, s51, 180224
  buffer_load_dwordx4 v15, s[8:11], s46 offen lds
  s_add_u32 s45, s50, 12288
  s_mov_b32 m0, s45
  s_add_u32 s46, s51, 196608
  buffer_load_dwordx4 v15, s[8:11], s46 offen lds
  s_add_u32 s45, s50, 13312
  s_mov_b32 m0, s45
  s_add_u32 s46, s51, 212992
  buffer_load_dwordx4 v15, s[8:11], s46 offen lds
  s_add_u32 s45, s50, 14336
  s_mov_b32 m0, s45
  s_add_u32 s46, s51, 229376
  buffer_load_dwordx4 v15, s[8:11], s46 offen lds
  s_add_u32 s45, s50, 15360
  s_mov_b32 m0, s45
  s_add_u32 s46, s51, 245760
  buffer_load_dwordx4 v15, s[8:11], s46 offen lds
  s_add_u32 s45, s50, 16384
  s_mov_b32 m0, s45
  s_add_u32 s46, s51, 262144
  buffer_load_dwordx4 v15, s[8:11], s46 offen lds
  s_add_u32 s45, s50, 17408
  s_mov_b32 m0, s45
  s_add_u32 s46, s51, 278528
  buffer_load_dwordx4 v15, s[8:11], s46 offen lds
  s_add_u32 s45, s50, 18432
  s_mov_b32 m0, s45
  s_add_u32 s46, s51, 294912
  buffer_load_dwordx4 v15, s[8:11], s46 offen lds
  s_add_u32 s45, s50, 19456
  s_mov_b32 m0, s45
  s_add_u32 s46, s51, 311296
  buffer_load_dwordx4 v15, s[8:11], s46 offen lds
  s_add_u32 s45, s50, 20480
  s_mov_b32 m0, s45
  s_add_u32 s46, s51, 327680
  buffer_load_dwordx4 v15, s[8:11], s46 offen lds
  s_add_u32 s45, s50, 21504
  s_mov_b32 m0, s45
  s_add_u32 s46, s51, 344064
  buffer_load_dwordx4 v15, s[8:11], s46 offen lds
  s_add_u32 s45, s50, 22528
  s_mov_b32 m0, s45
  s_add_u32 s46, s51, 360448
  buffer_load_dwordx4 v15, s[8:11], s46 offen lds
  s_add_u32 s45, s50, 23552
  s_mov_b32 m0, s45
  s_add_u32 s46, s51, 376832
  buffer_load_dwordx4 v15, s[8:11], s46 offen lds
  s_add_u32 s45, s50, 24576
  s_mov_b32 m0, s45
  s_add_u32 s46, s51, 393216
  buffer_load_dwordx4 v15, s[8:11], s46 offen lds
  s_add_u32 s45, s50, 25600
  s_mov_b32 m0, s45
  s_add_u32 s46, s51, 409600
  buffer_load_dwordx4 v15, s[8:11], s46 offen lds
  s_add_u32 s45, s50, 26624
  s_mov_b32 m0, s45
  s_add_u32 s46, s51, 425984
  buffer_load_dwordx4 v15, s[8:11], s46 offen lds
  s_add_u32 s45, s50, 27648
  s_mov_b32 m0, s45
  s_add_u32 s46, s51, 442368
  buffer_load_dwordx4 v15, s[8:11], s46 offen lds
  s_add_u32 s45, s50, 28672
  s_mov_b32 m0, s45
  s_add_u32 s46, s51, 458752
  buffer_load_dwordx4 v15, s[8:11], s46 offen lds
  s_add_u32 s45, s50, 29696
  s_mov_b32 m0, s45
  s_add_u32 s46, s51, 475136
  buffer_load_dwordx4 v15, s[8:11], s46 offen lds
  s_add_u32 s45, s50, 30720
  s_mov_b32 m0, s45
  s_add_u32 s46, s51, 491520
  buffer_load_dwordx4 v15, s[8:11], s46 offen lds
  s_add_u32 s45, s50, 31744
  s_mov_b32 m0, s45
  s_add_u32 s46, s51, 507904
  buffer_load_dwordx4 v15, s[8:11], s46 offen lds
  s_waitcnt vmcnt(28)
  ds_read_b64_tr_b16 a[0:1], v10 offset:0
  ds_read_b64_tr_b16 a[2:3], v10 offset:1024
  ds_read_b64_tr_b16 a[4:5], v10 offset:2048
  ds_read_b64_tr_b16 a[6:7], v10 offset:3072
  ds_read_b64_tr_b16 a[112:113], v11 offset:0
  ds_read_b64_tr_b16 a[114:115], v11 offset:1024
  ds_read_b64_tr_b16 a[116:117], v11 offset:2048
  ds_read_b64_tr_b16 a[118:119], v11 offset:3072
  s_waitcnt lgkmcnt(0)
  s_add_u32 s45, s50, 0
  s_mov_b32 m0, s45
  s_add_u32 s46, s51, 524288
  buffer_load_dwordx4 v15, s[8:11], s46 offen lds
  s_add_u32 s45, s50, 1024
  s_mov_b32 m0, s45
  s_add_u32 s46, s51, 540672
  buffer_load_dwordx4 v15, s[8:11], s46 offen lds
  s_add_u32 s45, s50, 2048
  s_mov_b32 m0, s45
  s_add_u32 s46, s51, 557056
  buffer_load_dwordx4 v15, s[8:11], s46 offen lds
  s_add_u32 s45, s50, 3072
  s_mov_b32 m0, s45
  s_add_u32 s46, s51, 573440
  buffer_load_dwordx4 v15, s[8:11], s46 offen lds
  s_waitcnt vmcnt(28)
  ds_read_b64_tr_b16 a[8:9], v10 offset:4096
  ds_read_b64_tr_b16 a[10:11], v10 offset:5120
  ds_read_b64_tr_b16 a[12:13], v10 offset:6144
  ds_read_b64_tr_b16 a[14:15], v10 offset:7168
  ds_read_b64_tr_b16 a[120:121], v11 offset:4096
  ds_read_b64_tr_b16 a[122:123], v11 offset:5120
  ds_read_b64_tr_b16 a[124:125], v11 offset:6144
  ds_read_b64_tr_b16 a[126:127], v11 offset:7168
  s_waitcnt lgkmcnt(0)
  s_add_u32 s45, s50, 4096
  s_mov_b32 m0, s45
  s_add_u32 s46, s51, 589824
  buffer_load_dwordx4 v15, s[8:11], s46 offen lds
  s_add_u32 s45, s50, 5120
  s_mov_b32 m0, s45
  s_add_u32 s46, s51, 606208
  buffer_load_dwordx4 v15, s[8:11], s46 offen lds
  s_add_u32 s45, s50, 6144
  s_mov_b32 m0, s45
  s_add_u32 s46, s51, 622592
  buffer_load_dwordx4 v15, s[8:11], s46 offen lds
  s_add_u32 s45, s50, 7168
  s_mov_b32 m0, s45
  s_add_u32 s46, s51, 638976
  buffer_load_dwordx4 v15, s[8:11], s46 offen lds
  s_waitcnt vmcnt(28)
  ds_read_b64_tr_b16 a[16:17], v10 offset:8192
  ds_read_b64_tr_b16 a[18:19], v10 offset:9216
  ds_read_b64_tr_b16 a[20:21], v10 offset:10240
  ds_read_b64_tr_b16 a[22:23], v10 offset:11264
  ds_read_b64_tr_b16 a[128:129], v11 offset:8192
  ds_read_b64_tr_b16 a[130:131], v11 offset:9216
  ds_read_b64_tr_b16 a[132:133], v11 offset:10240
  ds_read_b64_tr_b16 a[134:135], v11 offset:11264
  s_waitcnt lgkmcnt(0)
  s_add_u32 s45, s50, 8192
  s_mov_b32 m0, s45
  s_add_u32 s46, s51, 655360
  buffer_load_dwordx4 v15, s[8:11], s46 offen lds
  s_add_u32 s45, s50, 9216
  s_mov_b32 m0, s45
  s_add_u32 s46, s51, 671744
  buffer_load_dwordx4 v15, s[8:11], s46 offen lds
  s_add_u32 s45, s50, 10240
  s_mov_b32 m0, s45
  s_add_u32 s46, s51, 688128
  buffer_load_dwordx4 v15, s[8:11], s46 offen lds
  s_add_u32 s45, s50, 11264
  s_mov_b32 m0, s45
  s_add_u32 s46, s51, 704512
  buffer_load_dwordx4 v15, s[8:11], s46 offen lds
  s_waitcnt vmcnt(28)
  ds_read_b64_tr_b16 a[24:25], v10 offset:12288
  ds_read_b64_tr_b16 a[26:27], v10 offset:13312
  ds_read_b64_tr_b16 a[28:29], v10 offset:14336
  ds_read_b64_tr_b16 a[30:31], v10 offset:15360
  ds_read_b64_tr_b16 a[136:137], v11 offset:12288
  ds_read_b64_tr_b16 a[138:139], v11 offset:13312
  ds_read_b64_tr_b16 a[140:141], v11 offset:14336
  ds_read_b64_tr_b16 a[142:143], v11 offset:15360
  s_waitcnt lgkmcnt(0)
  s_add_u32 s45, s50, 12288
  s_mov_b32 m0, s45
  s_add_u32 s46, s51, 720896
  buffer_load_dwordx4 v15, s[8:11], s46 offen lds
  s_add_u32 s45, s50, 13312
  s_mov_b32 m0, s45
  s_add_u32 s46, s51, 737280
  buffer_load_dwordx4 v15, s[8:11], s46 offen lds
  s_add_u32 s45, s50, 14336
  s_mov_b32 m0, s45
  s_add_u32 s46, s51, 753664
  buffer_load_dwordx4 v15, s[8:11], s46 offen lds
  s_add_u32 s45, s50, 15360
  s_mov_b32 m0, s45
  s_add_u32 s46, s51, 770048
  buffer_load_dwordx4 v15, s[8:11], s46 offen lds
  s_waitcnt vmcnt(28)
  ds_read_b64_tr_b16 a[32:33], v10 offset:16384
  ds_read_b64_tr_b16 a[34:35], v10 offset:17408
  ds_read_b64_tr_b16 a[36:37], v10 offset:18432
  ds_read_b64_tr_b16 a[38:39], v10 offset:19456
  ds_read_b64_tr_b16 a[144:145], v11 offset:16384
  ds_read_b64_tr_b16 a[146:147], v11 offset:17408
  ds_read_b64_tr_b16 a[148:149], v11 offset:18432
  ds_read_b64_tr_b16 a[150:151], v11 offset:19456
  s_waitcnt lgkmcnt(0)
  s_add_u32 s45, s50, 16384
  s_mov_b32 m0, s45
  s_add_u32 s46, s51, 786432
  buffer_load_dwordx4 v15, s[8:11], s46 offen lds
  s_add_u32 s45, s50, 17408
  s_mov_b32 m0, s45
  s_add_u32 s46, s51, 802816
  buffer_load_dwordx4 v15, s[8:11], s46 offen lds
  s_add_u32 s45, s50, 18432
  s_mov_b32 m0, s45
  s_add_u32 s46, s51, 819200
  buffer_load_dwordx4 v15, s[8:11], s46 offen lds
  s_add_u32 s45, s50, 19456
  s_mov_b32 m0, s45
  s_add_u32 s46, s51, 835584
  buffer_load_dwordx4 v15, s[8:11], s46 offen lds
  s_waitcnt vmcnt(28)
  ds_read_b64_tr_b16 a[40:41], v10 offset:20480
  ds_read_b64_tr_b16 a[42:43], v10 offset:21504
  ds_read_b64_tr_b16 a[44:45], v10 offset:22528
  ds_read_b64_tr_b16 a[46:47], v10 offset:23552
  ds_read_b64_tr_b16 a[152:153], v11 offset:20480
  ds_read_b64_tr_b16 a[154:155], v11 offset:21504
  ds_read_b64_tr_b16 a[156:157], v11 offset:22528
  ds_read_b64_tr_b16 a[158:159], v11 offset:23552
  s_waitcnt lgkmcnt(0)
  s_add_u32 s45, s50, 20480
  s_mov_b32 m0, s45
  s_add_u32 s46, s51, 851968
  buffer_load_dwordx4 v15, s[8:11], s46 offen lds
  s_add_u32 s45, s50, 21504
  s_mov_b32 m0, s45
  s_add_u32 s46, s51, 868352
  buffer_load_dwordx4 v15, s[8:11], s46 offen lds
  s_add_u32 s45, s50, 22528
  s_mov_b32 m0, s45
  s_add_u32 s46, s51, 884736
  buffer_load_dwordx4 v15, s[8:11], s46 offen lds
  s_add_u32 s45, s50, 23552
  s_mov_b32 m0, s45
  s_add_u32 s46, s51, 901120
  buffer_load_dwordx4 v15, s[8:11], s46 offen lds
  s_waitcnt vmcnt(28)
  ds_read_b64_tr_b16 a[48:49], v10 offset:24576
  ds_read_b64_tr_b16 a[50:51], v10 offset:25600
  ds_read_b64_tr_b16 a[52:53], v10 offset:26624
  ds_read_b64_tr_b16 a[54:55], v10 offset:27648
  ds_read_b64_tr_b16 a[160:161], v11 offset:24576
  ds_read_b64_tr_b16 a[162:163], v11 offset:25600
  ds_read_b64_tr_b16 a[164:165], v11 offset:26624
  ds_read_b64_tr_b16 a[166:167], v11 offset:27648
  s_waitcnt lgkmcnt(0)
  s_waitcnt vmcnt(24)
  ds_read_b64_tr_b16 a[56:57], v10 offset:28672
  ds_read_b64_tr_b16 a[58:59], v10 offset:29696
  ds_read_b64_tr_b16 a[60:61], v10 offset:30720
  ds_read_b64_tr_b16 a[62:63], v10 offset:31744
  ds_read_b64_tr_b16 a[168:169], v11 offset:28672
  ds_read_b64_tr_b16 a[170:171], v11 offset:29696
  ds_read_b64_tr_b16 a[172:173], v11 offset:30720
  ds_read_b64_tr_b16 a[174:175], v11 offset:31744
  s_waitcnt lgkmcnt(0)
  s_waitcnt vmcnt(20)
  ds_read_b64_tr_b16 a[64:65], v10 offset:0
  ds_read_b64_tr_b16 a[66:67], v10 offset:1024
  ds_read_b64_tr_b16 a[68:69], v10 offset:2048
  ds_read_b64_tr_b16 a[70:71], v10 offset:3072
  ds_read_b64_tr_b16 a[176:177], v11 offset:0
  ds_read_b64_tr_b16 a[178:179], v11 offset:1024
  ds_read_b64_tr_b16 a[180:181], v11 offset:2048
  ds_read_b64_tr_b16 a[182:183], v11 offset:3072
  s_waitcnt lgkmcnt(0)
  s_waitcnt vmcnt(16)
  ds_read_b64_tr_b16 a[72:73], v10 offset:4096
  ds_read_b64_tr_b16 a[74:75], v10 offset:5120
  ds_read_b64_tr_b16 a[76:77], v10 offset:6144
  ds_read_b64_tr_b16 a[78:79], v10 offset:7168
  ds_read_b64_tr_b16 a[184:185], v11 offset:4096
  ds_read_b64_tr_b16 a[186:187], v11 offset:5120
  ds_read_b64_tr_b16 a[188:189], v11 offset:6144
  ds_read_b64_tr_b16 a[190:191], v11 offset:7168
  s_waitcnt lgkmcnt(0)
  s_waitcnt vmcnt(12)
  ds_read_b64_tr_b16 a[80:81], v10 offset:8192
  ds_read_b64_tr_b16 a[82:83], v10 offset:9216
  ds_read_b64_tr_b16 a[84:85], v10 offset:10240
  ds_read_b64_tr_b16 a[86:87], v10 offset:11264
  ds_read_b64_tr_b16 a[192:193], v11 offset:8192
  ds_read_b64_tr_b16 a[194:195], v11 offset:9216
  ds_read_b64_tr_b16 a[196:197], v11 offset:10240
  ds_read_b64_tr_b16 a[198:199], v11 offset:11264
  s_waitcnt lgkmcnt(0)
  s_waitcnt vmcnt(8)
  ds_read_b64_tr_b16 a[88:89], v10 offset:12288
  ds_read_b64_tr_b16 a[90:91], v10 offset:13312
  ds_read_b64_tr_b16 a[92:93], v10 offset:14336
  ds_read_b64_tr_b16 a[94:95], v10 offset:15360
  ds_read_b64_tr_b16 a[200:201], v11 offset:12288
  ds_read_b64_tr_b16 a[202:203], v11 offset:13312
  ds_read_b64_tr_b16 a[204:205], v11 offset:14336
  ds_read_b64_tr_b16 a[206:207], v11 offset:15360
  s_waitcnt lgkmcnt(0)
  s_waitcnt vmcnt(4)
  ds_read_b64_tr_b16 a[96:97], v10 offset:16384
  ds_read_b64_tr_b16 a[98:99], v10 offset:17408
  ds_read_b64_tr_b16 a[100:101], v10 offset:18432
  ds_read_b64_tr_b16 a[102:103], v10 offset:19456
  ds_read_b64_tr_b16 a[208:209], v11 offset:16384
  ds_read_b64_tr_b16 a[210:211], v11 offset:17408
  ds_read_b64_tr_b16 a[212:213], v11 offset:18432
  ds_read_b64_tr_b16 a[214:215], v11 offset:19456
  s_waitcnt lgkmcnt(0)
  s_waitcnt vmcnt(0)
  ds_read_b64_tr_b16 a[104:105], v10 offset:20480
  ds_read_b64_tr_b16 a[106:107], v10 offset:21504
  ds_read_b64_tr_b16 a[108:109], v10 offset:22528
  ds_read_b64_tr_b16 a[110:111], v10 offset:23552
  ds_read_b64_tr_b16 a[216:217], v11 offset:20480
  ds_read_b64_tr_b16 a[218:219], v11 offset:21504
  ds_read_b64_tr_b16 a[220:221], v11 offset:22528
  ds_read_b64_tr_b16 a[222:223], v11 offset:23552
  s_waitcnt lgkmcnt(0)
  s_barrier
  s_mul_i32 s66, s19, 0x700000
  s_add_u32 s66, s66, 0xa000000
  s_lshr_b32 s45, s17, 2
  s_mul_i32 s45, s45, 57344
  s_add_u32 s66, s66, s45
  s_lshl_b32 s45, s19, 14
  s_lshr_b32 s46, s17, 2
  s_lshl_b32 s46, s46, 7
  s_add_u32 s45, s45, s46
  s_add_u32 s67, s45, 0x11c000
  s_lshl_b32 s45, s19, 13
  s_lshl_b32 s46, s17, 2
  s_add_u32 s45, s45, s46
  s_add_u32 s68, s45, 0x124000
  s_lshl_b32 s73, s16, 10
  s_lshl_b32 s74, s16, 10
  s_mov_b32 s84, 0
  s_mov_b32 s65, 0
  s_mov_b32 s69, 0
  s_mov_b32 s76, 0
  s_mov_b32 s77, 0x128000
  s_mov_b32 s83, 0x128000
  s_cmp_eq_u32 s16, 0
  s_cselect_b32 s78, 1, 0
  s_mov_b32 s79, 0
  s_mul_i32 s72, s19, 0x800000
  s_add_u32 s72, s72, 0xae00000
  s_lshr_b32 s45, s17, 2
  s_lshl_b32 s45, s45, 16
  s_add_u32 s72, s72, s45
  s_and_b32 s45, s17, 3
  s_lshl_b32 s45, s45, 14
  s_add_u32 s72, s72, s45
  s_lshl_b32 s45, s16, 12
  s_add_u32 s72, s72, s45
L_wn_104:
  v_and_b32 v3, 63, v0
  v_lshlrev_b32 v3, 2, v3
  v_add_u32 v3, s67, v3
  s_mov_b64 exec, 0x7f
  buffer_load_dword v4, v3, s[4:7], 0 offen sc1
  s_mov_b64 exec, -1
  s_waitcnt vmcnt(0)
  v_cmp_ne_u32 vcc, 0, v4
  s_and_b32 s45, vcc_lo, 0x7f
  s_cmp_eq_u32 s45, 0x7f
  s_cselect_b32 s45, 1, 0
  s_cmp_eq_u32 s45, 1
  s_cbranch_scc1 L_wnd_105
  s_sub_u32 s64, s64, 1
  s_cbranch_scc1 L_abort
  s_sleep 16
  s_branch L_wn_104
L_wnd_105:
  s_add_u32 s47, s66, s74
  s_add_u32 s48, s69, s73
  s_mov_b32 s81, s47
  s_mov_b32 s82, s48
  s_add_u32 s45, s48, 0
  s_mov_b32 m0, s45
  s_add_u32 s46, s47, 0
  buffer_load_dwordx4 v2, s[4:7], s46 offen sc1 lds
  s_add_u32 s45, s48, 4096
  s_mov_b32 m0, s45
  s_add_u32 s46, s47, 4096
  buffer_load_dwordx4 v2, s[4:7], s46 offen sc1 lds
  s_add_u32 s45, s48, 8192
  s_mov_b32 m0, s45
  s_add_u32 s46, s47, 8192
  buffer_load_dwordx4 v2, s[4:7], s46 offen sc1 lds
  s_add_u32 s45, s48, 12288
  s_mov_b32 m0, s45
  s_add_u32 s46, s47, 12288
  buffer_load_dwordx4 v2, s[4:7], s46 offen sc1 lds
  s_add_u32 s45, s48, 16384
  s_mov_b32 m0, s45
  s_add_u32 s46, s47, 16384
  buffer_load_dwordx4 v2, s[4:7], s46 offen sc1 lds
  s_add_u32 s45, s48, 20480
  s_mov_b32 m0, s45
  s_add_u32 s46, s47, 20480
  buffer_load_dwordx4 v2, s[4:7], s46 offen sc1 lds
  s_add_u32 s45, s48, 24576
  s_mov_b32 m0, s45
  s_add_u32 s46, s47, 24576
  buffer_load_dwordx4 v2, s[4:7], s46 offen sc1 lds
  s_add_u32 s45, s48, 28672
  s_mov_b32 m0, s45
  s_add_u32 s46, s47, 28672
  buffer_load_dwordx4 v2, s[4:7], s46 offen sc1 lds
  s_add_u32 s45, s48, 32768
  s_mov_b32 m0, s45
  s_add_u32 s46, s47, 32768
  buffer_load_dwordx4 v2, s[4:7], s46 offen sc1 lds
  s_add_u32 s45, s48, 36864
  s_mov_b32 m0, s45
  s_add_u32 s46, s47, 36864
  buffer_load_dwordx4 v2, s[4:7], s46 offen sc1 lds
  s_add_u32 s45, s48, 40960
  s_mov_b32 m0, s45
  s_add_u32 s46, s47, 40960
  buffer_load_dwordx4 v2, s[4:7], s46 offen sc1 lds
  s_add_u32 s45, s48, 45056
  s_mov_b32 m0, s45
  s_add_u32 s46, s47, 45056
  buffer_load_dwordx4 v2, s[4:7], s46 offen sc1 lds
  s_add_u32 s45, s48, 49152
  s_mov_b32 m0, s45
  s_add_u32 s46, s47, 49152
  buffer_load_dwordx4 v2, s[4:7], s46 offen sc1 lds
  s_add_u32 s45, s48, 53248
  s_mov_b32 m0, s45
  s_add_u32 s46, s47, 53248
  buffer_load_dwordx4 v2, s[4:7], s46 offen sc1 lds
  s_mov_b32 s70, 0
L_g5_loop:
  v_add_u32 v5, s69, v2
  s_add_u32 s66, s66, 114688
  s_add_u32 s67, s67, 256
  v_and_b32 v3, 63, v0
  v_lshlrev_b32 v3, 2, v3
  v_add_u32 v3, s67, v3
  s_mov_b64 exec, 0x7f
  buffer_load_dword v4, v3, s[4:7], 0 offen sc1
  s_mov_b64 exec, -1
  s_waitcnt vmcnt(11)
  s_barrier
  s_cmp_eq_u32 s77, 0x128000
  s_cbranch_scc1 L_ps_110
  v_mov_b32 v6, s77
  v_mov_b32 v7, 1
  s_mov_b64 exec, s[78:79]
  buffer_store_dword v7, v6, s[4:7], 0 offen sc1
  s_mov_b64 exec, -1
  s_mov_b32 s77, 0x128000
L_ps_110:
  ds_read_b128 v[8:11], v5 offset:0
  ds_read_b128 v[12:15], v5 offset:1024
  ds_read_b128 v[16:19], v5 offset:2048
  ds_read_b128 v[20:23], v5 offset:3072
  s_waitcnt lgkmcnt(2)
  v_mfma_f32_16x16x32_bf16 v[32:35], a[0:3], v[8:11], 0
  ds_read_b128 v[24:27], v5 offset:4096
  v_mfma_f32_16x16x32_bf16 v[36:39], a[0:3], v[12:15], 0
  ds_read_b128 v[28:31], v5 offset:5120
  v_mfma_f32_16x16x32_bf16 v[40:43], a[112:115], v[8:11], 0
  v_mfma_f32_16x16x32_bf16 v[44:47], a[112:115], v[12:15], 0
  s_waitcnt lgkmcnt(2)
  v_mfma_f32_16x16x32_bf16 v[32:35], a[4:7], v[16:19], v[32:35]
  ds_read_b128 v[8:11], v5 offset:6144
  v_mfma_f32_16x16x32_bf16 v[36:39], a[4:7], v[20:23], v[36:39]
  ds_read_b128 v[12:15], v5 offset:7168
  v_mfma_f32_16x16x32_bf16 v[40:43], a[116:119], v[16:19], v[40:43]
  v_mfma_f32_16x16x32_bf16 v[44:47], a[116:119], v[20:23], v[44:47]
  s_waitcnt lgkmcnt(2)
  v_mfma_f32_16x16x32_bf16 v[32:35], a[8:11], v[24:27], v[32:35]
  ds_read_b128 v[16:19], v5 offset:8192
  v_mfma_f32_16x16x32_bf16 v[36:39], a[8:11], v[28:31], v[36:39]
  ds_read_b128 v[20:23], v5 offset:9216
  v_mfma_f32_16x16x32_bf16 v[40:43], a[120:123], v[24:27], v[40:43]
  v_mfma_f32_16x16x32_bf16 v[44:47], a[120:123], v[28:31], v[44:47]
  s_waitcnt lgkmcnt(2)
  v_mfma_f32_16x16x32_bf16 v[32:35], a[12:15], v[8:11], v[32:35]
  ds_read_b128 v[24:27], v5 offset:10240
  v_mfma_f32_16x16x32_bf16 v[36:39], a[12:15], v[12:15], v[36:39]
  ds_read_b128 v[28:31], v5 offset:11264
  v_mfma_f32_16x16x32_bf16 v[40:43], a[124:127], v[8:11], v[40:43]
  v_mfma_f32_16x16x32_bf16 v[44:47], a[124:127], v[12:15], v[44:47]
  s_waitcnt lgkmcnt(2)
  v_mfma_f32_16x16x32_bf16 v[32:35], a[16:19], v[16:19], v[32:35]
  ds_read_b128 v[8:11], v5 offset:12288
  v_mfma_f32_16x16x32_bf16 v[36:39], a[16:19], v[20:23], v[36:39]
  ds_read_b128 v[12:15], v5 offset:13312
  v_mfma_f32_16x16x32_bf16 v[40:43], a[128:131], v[16:19], v[40:43]
  v_mfma_f32_16x16x32_bf16 v[44:47], a[128:131], v[20:23], v[44:47]
  s_waitcnt lgkmcnt(2)
  v_mfma_f32_16x16x32_bf16 v[32:35], a[20:23], v[24:27], v[32:35]
  v_mfma_f32_16x16x32_bf16 v[36:39], a[20:23], v[28:31], v[36:39]
  v_mfma_f32_16x16x32_bf16 v[40:43], a[132:135], v[24:27], v[40:43]
  v_mfma_f32_16x16x32_bf16 v[44:47], a[132:135], v[28:31], v[44:47]
  s_waitcnt lgkmcnt(0)
  v_mfma_f32_16x16x32_bf16 v[32:35], a[24:27], v[8:11], v[32:35]
  v_mfma_f32_16x16x32_bf16 v[36:39], a[24:27], v[12:15], v[36:39]
  v_mfma_f32_16x16x32_bf16 v[40:43], a[136:139], v[8:11], v[40:43]
  v_mfma_f32_16x16x32_bf16 v[44:47], a[136:139], v[12:15], v[44:47]
  s_waitcnt vmcnt(8)
  s_barrier
  ds_read_b128 v[16:19], v5 offset:14336
  ds_read_b128 v[20:23], v5 offset:15360
  ds_read_b128 v[24:27], v5 offset:16384
  ds_read_b128 v[28:31], v5 offset:17408
  s_waitcnt lgkmcnt(2)
  v_mfma_f32_16x16x32_bf16 v[32:35], a[28:31], v[16:19], v[32:35]
  ds_read_b128 v[8:11], v5 offset:18432
  v_mfma_f32_16x16x32_bf16 v[36:39], a[28:31], v[20:23], v[36:39]
  ds_read_b128 v[12:15], v5 offset:19456
  v_mfma_f32_16x16x32_bf16 v[40:43], a[140:143], v[16:19], v[40:43]
  v_mfma_f32_16x16x32_bf16 v[44:47], a[140:143], v[20:23], v[44:47]
  s_waitcnt lgkmcnt(2)
  v_mfma_f32_16x16x32_bf16 v[32:35], a[32:35], v[24:27], v[32:35]
  ds_read_b128 v[16:19], v5 offset:20480
  v_mfma_f32_16x16x32_bf16 v[36:39], a[32:35], v[28:31], v[36:39]
  ds_read_b128 v[20:23], v5 offset:21504
  v_mfma_f32_16x16x32_bf16 v[40:43], a[144:147], v[24:27], v[40:43]
  v_mfma_f32_16x16x32_bf16 v[44:47], a[144:147], v[28:31], v[44:47]
  s_waitcnt lgkmcnt(2)
  v_mfma_f32_16x16x32_bf16 v[32:35], a[36:39], v[8:11], v[32:35]
  ds_read_b128 v[24:27], v5 offset:22528
  v_mfma_f32_16x16x32_bf16 v[36:39], a[36:39], v[12:15], v[36:39]
  ds_read_b128 v[28:31], v5 offset:23552
  v_mfma_f32_16x16x32_bf16 v[40:43], a[148:151], v[8:11], v[40:43]
  v_mfma_f32_16x16x32_bf16 v[44:47], a[148:151], v[12:15], v[44:47]
  s_waitcnt lgkmcnt(2)
  v_mfma_f32_16x16x32_bf16 v[32:35], a[40:43], v[16:19], v[32:35]
  ds_read_b128 v[8:11], v5 offset:24576
  v_mfma_f32_16x16x32_bf16 v[36:39], a[40:43], v[20:23], v[36:39]
  ds_read_b128 v[12:15], v5 offset:25600
  v_mfma_f32_16x16x32_bf16 v[40:43], a[152:155], v[16:19], v[40:43]
  v_mfma_f32_16x16x32_bf16 v[44:47], a[152:155], v[20:23], v[44:47]
  s_waitcnt lgkmcnt(2)
  v_mfma_f32_16x16x32_bf16 v[32:35], a[44:47], v[24:27], v[32:35]
  ds_read_b128 v[16:19], v5 offset:26624
  v_mfma_f32_16x16x32_bf16 v[36:39], a[44:47], v[28:31], v[36:39]
  ds_read_b128 v[20:23], v5 offset:27648
  v_mfma_f32_16x16x32_bf16 v[40:43], a[156:159], v[24:27], v[40:43]
  v_mfma_f32_16x16x32_bf16 v[44:47], a[156:159], v[28:31], v[44:47]
  s_waitcnt lgkmcnt(2)
  v_mfma_f32_16x16x32_bf16 v[32:35], a[48:51], v[8:11], v[32:35]
  v_mfma_f32_16x16x32_bf16 v[36:39], a[48:51], v[12:15], v[36:39]
  v_mfma_f32_16x16x32_bf16 v[40:43], a[160:163], v[8:11], v[40:43]
  v_mfma_f32_16x16x32_bf16 v[44:47], a[160:163], v[12:15], v[44:47]
  s_waitcnt lgkmcnt(0)
  v_mfma_f32_16x16x32_bf16 v[32:35], a[52:55], v[16:19], v[32:35]
  v_mfma_f32_16x16x32_bf16 v[36:39], a[52:55], v[20:23], v[36:39]
  v_mfma_f32_16x16x32_bf16 v[40:43], a[164:167], v[16:19], v[40:43]
  v_mfma_f32_16x16x32_bf16 v[44:47], a[164:167], v[20:23], v[44:47]
  s_waitcnt vmcnt(0)
  v_cmp_ne_u32 vcc, 0, v4
  s_and_b32 s71, vcc_lo, 0x7f
  s_cmp_eq_u32 s71, 0x7f
  s_cselect_b32 s71, 1, 0
  v_mov_b32 v4, s71
  v_mov_b32 v6, 0x20000
  s_cmp_eq_u32 s16, 0
  s_cbranch_scc0 L_dec_111
  s_mov_b64 exec, 1
  ds_write_b32 v6, v4
  s_mov_b64 exec, -1
  s_waitcnt lgkmcnt(0)
L_dec_111:
  s_barrier
  s_cmp_eq_u32 s83, 0x128000
  s_cbranch_scc1 L_ps_112
  v_mov_b32 v6, s83
  v_mov_b32 v7, 1
  s_mov_b64 exec, s[78:79]
  buffer_store_dword v7, v6, s[4:7], 0 offen sc1
  s_mov_b64 exec, -1
  s_mov_b32 s83, 0x128000
L_ps_112:
  ds_read_b32 v4, v6
  s_waitcnt lgkmcnt(0)
  v_readfirstlane_b32 s71, v4
  s_cmp_ge_u32 s65, 63
  s_cbranch_scc1 L_varB_106
  s_cmp_eq_u32 s71, 1
  s_cbranch_scc0 L_varB_106
  s_add_u32 s81, s66, s74
  s_xor_b32 s82, s69, 57344
  s_add_u32 s82, s82, s73
  ds_read_b128 v[24:27], v5 offset:28672
  ds_read_b128 v[28:31], v5 offset:29696
  ds_read_b128 v[8:11], v5 offset:30720
  ds_read_b128 v[12:15], v5 offset:31744
  s_waitcnt lgkmcnt(2)
  v_mfma_f32_16x16x32_bf16 v[32:35], a[56:59], v[24:27], v[32:35]
  ds_read_b128 v[16:19], v5 offset:32768
  ds_read_b128 v[20:23], v5 offset:33792
  v_mfma_f32_16x16x32_bf16 v[36:39], a[56:59], v[28:31], v[36:39]
  s_add_u32 s45, s82, 0
  s_mov_b32 m0, s45
  v_mfma_f32_16x16x32_bf16 v[40:43], a[168:171], v[24:27], v[40:43]
  s_add_u32 s46, s81, 0
  buffer_load_dwordx4 v2, s[4:7], s46 offen sc1 lds
  v_mfma_f32_16x16x32_bf16 v[44:47], a[168:171], v[28:31], v[44:47]
  s_waitcnt lgkmcnt(2)
  v_mfma_f32_16x16x32_bf16 v[32:35], a[60:63], v[8:11], v[32:35]
  ds_read_b128 v[24:27], v5 offset:34816
  ds_read_b128 v[28:31], v5 offset:35840
  v_mfma_f32_16x16x32_bf16 v[36:39], a[60:63], v[12:15], v[36:39]
  s_add_u32 s45, s82, 4096
  s_mov_b32 m0, s45
  v_mfma_f32_16x16x32_bf16 v[40:43], a[172:175], v[8:11], v[40:43]
  s_add_u32 s46, s81, 4096
  buffer_load_dwordx4 v2, s[4:7], s46 offen sc1 lds
  v_mfma_f32_16x16x32_bf16 v[44:47], a[172:175], v[12:15], v[44:47]
  s_waitcnt lgkmcnt(2)
  v_mfma_f32_16x16x32_bf16 v[32:35], a[64:67], v[16:19], v[32:35]
  ds_read_b128 v[8:11], v5 offset:36864
  ds_read_b128 v[12:15], v5 offset:37888
  v_mfma_f32_16x16x32_bf16 v[36:39], a[64:67], v[20:23], v[36:39]
  s_add_u32 s45, s82, 8192
  s_mov_b32 m0, s45
  v_mfma_f32_16x16x32_bf16 v[40:43], a[176:179], v[16:19], v[40:43]
  s_add_u32 s46, s81, 8192
  buffer_load_dwordx4 v2, s[4:7], s46 offen sc1 lds
  v_mfma_f32_16x16x32_bf16 v[44:47], a[176:179], v[20:23], v[44:47]
  s_waitcnt lgkmcnt(2)
  v_mfma_f32_16x16x32_bf16 v[32:35], a[68:71], v[24:27], v[32:35]
  ds_read_b128 v[16:19], v5 offset:38912
  ds_read_b128 v[20:23], v5 offset:39936
  v_mfma_f32_16x16x32_bf16 v[36:39], a[68:71], v[28:31], v[36:39]
  s_add_u32 s45, s82, 12288
  s_mov_b32 m0, s45
  v_mfma_f32_16x16x32_bf16 v[40:43], a[180:183], v[24:27], v[40:43]
  s_add_u32 s46, s81, 12288
  buffer_load_dwordx4 v2, s[4:7], s46 offen sc1 lds
  v_mfma_f32_16x16x32_bf16 v[44:47], a[180:183], v[28:31], v[44:47]
  s_waitcnt lgkmcnt(2)
  v_mfma_f32_16x16x32_bf16 v[32:35], a[72:75], v[8:11], v[32:35]
  ds_read_b128 v[24:27], v5 offset:40960
  ds_read_b128 v[28:31], v5 offset:41984
  v_mfma_f32_16x16x32_bf16 v[36:39], a[72:75], v[12:15], v[36:39]
  s_add_u32 s45, s82, 16384
  s_mov_b32 m0, s45
  v_mfma_f32_16x16x32_bf16 v[40:43], a[184:187], v[8:11], v[40:43]
  s_add_u32 s46, s81, 16384
  buffer_load_dwordx4 v2, s[4:7], s46 offen sc1 lds
  v_mfma_f32_16x16x32_bf16 v[44:47], a[184:187], v[12:15], v[44:47]
  s_waitcnt lgkmcnt(2)
  v_mfma_f32_16x16x32_bf16 v[32:35], a[76:79], v[16:19], v[32:35]
  s_add_u32 s45, s82, 20480
  s_mov_b32 m0, s45
  v_mfma_f32_16x16x32_bf16 v[36:39], a[76:79], v[20:23], v[36:39]
  s_add_u32 s46, s81, 20480
  buffer_load_dwordx4 v2, s[4:7], s46 offen sc1 lds
  v_mfma_f32_16x16x32_bf16 v[40:43], a[188:191], v[16:19], v[40:43]
  v_mfma_f32_16x16x32_bf16 v[44:47], a[188:191], v[20:23], v[44:47]
  s_waitcnt lgkmcnt(0)
  v_mfma_f32_16x16x32_bf16 v[32:35], a[80:83], v[24:27], v[32:35]
  s_add_u32 s45, s82, 24576
  s_mov_b32 m0, s45
  v_mfma_f32_16x16x32_bf16 v[36:39], a[80:83], v[28:31], v[36:39]
  s_add_u32 s46, s81, 24576
  buffer_load_dwordx4 v2, s[4:7], s46 offen sc1 lds
  v_mfma_f32_16x16x32_bf16 v[40:43], a[192:195], v[24:27], v[40:43]
  v_mfma_f32_16x16x32_bf16 v[44:47], a[192:195], v[28:31], v[44:47]
  ds_read_b128 v[8:11], v5 offset:43008
  ds_read_b128 v[12:15], v5 offset:44032
  ds_read_b128 v[16:19], v5 offset:45056
  ds_read_b128 v[20:23], v5 offset:46080
  s_waitcnt lgkmcnt(2)
  v_mfma_f32_16x16x32_bf16 v[32:35], a[84:87], v[8:11], v[32:35]
  ds_read_b128 v[24:27], v5 offset:47104
  ds_read_b128 v[28:31], v5 offset:48128
  v_mfma_f32_16x16x32_bf16 v[36:39], a[84:87], v[12:15], v[36:39]
  s_add_u32 s45, s82, 28672
  s_mov_b32 m0, s45
  v_mfma_f32_16x16x32_bf16 v[40:43], a[196:199], v[8:11], v[40:43]
  s_add_u32 s46, s81, 28672
  buffer_load_dwordx4 v2, s[4:7], s46 offen sc1 lds
  v_mfma_f32_16x16x32_bf16 v[44:47], a[196:199], v[12:15], v[44:47]
  s_waitcnt lgkmcnt(2)
  v_mfma_f32_16x16x32_bf16 v[32:35], a[88:91], v[16:19], v[32:35]
  ds_read_b128 v[8:11], v5 offset:49152
  ds_read_b128 v[12:15], v5 offset:50176
  v_mfma_f32_16x16x32_bf16 v[36:39], a[88:91], v[20:23], v[36:39]
  s_add_u32 s45, s82, 32768
  s_mov_b32 m0, s45
  v_mfma_f32_16x16x32_bf16 v[40:43], a[200:203], v[16:19], v[40:43]
  s_add_u32 s46, s81, 32768
  buffer_load_dwordx4 v2, s[4:7], s46 offen sc1 lds
  v_mfma_f32_16x16x32_bf16 v[44:47], a[200:203], v[20:23], v[44:47]
  s_waitcnt lgkmcnt(2)
  v_mfma_f32_16x16x32_bf16 v[32:35], a[92:95], v[24:27], v[32:35]
  ds_read_b128 v[16:19], v5 offset:51200
  ds_read_b128 v[20:23], v5 offset:52224
  v_mfma_f32_16x16x32_bf16 v[36:39], a[92:95], v[28:31], v[36:39]
  s_add_u32 s45, s82, 36864
  s_mov_b32 m0, s45
  v_mfma_f32_16x16x32_bf16 v[40:43], a[204:207], v[24:27], v[40:43]
  s_add_u32 s46, s81, 36864
  buffer_load_dwordx4 v2, s[4:7], s46 offen sc1 lds
  v_mfma_f32_16x16x32_bf16 v[44:47], a[204:207], v[28:31], v[44:47]
  s_waitcnt lgkmcnt(2)
  v_mfma_f32_16x16x32_bf16 v[32:35], a[96:99], v[8:11], v[32:35]
  ds_read_b128 v[24:27], v5 offset:53248
  ds_read_b128 v[28:31], v5 offset:54272
  v_mfma_f32_16x16x32_bf16 v[36:39], a[96:99], v[12:15], v[36:39]
  s_add_u32 s45, s82, 40960
  s_mov_b32 m0, s45
  v_mfma_f32_16x16x32_bf16 v[40:43], a[208:211], v[8:11], v[40:43]
  s_add_u32 s46, s81, 40960
  buffer_load_dwordx4 v2, s[4:7], s46 offen sc1 lds
  v_mfma_f32_16x16x32_bf16 v[44:47], a[208:211], v[12:15], v[44:47]
  s_waitcnt lgkmcnt(2)
  v_mfma_f32_16x16x32_bf16 v[32:35], a[100:103], v[16:19], v[32:35]
  ds_read_b128 v[8:11], v5 offset:55296
  ds_read_b128 v[12:15], v5 offset:56320
  v_mfma_f32_16x16x32_bf16 v[36:39], a[100:103], v[20:23], v[36:39]
  s_add_u32 s45, s82, 45056
  s_mov_b32 m0, s45
  v_mfma_f32_16x16x32_bf16 v[40:43], a[212:215], v[16:19], v[40:43]
  s_add_u32 s46, s81, 45056
  buffer_load_dwordx4 v2, s[4:7], s46 offen sc1 lds
  v_mfma_f32_16x16x32_bf16 v[44:47], a[212:215], v[20:23], v[44:47]
  s_waitcnt lgkmcnt(2)
  v_mfma_f32_16x16x32_bf16 v[32:35], a[104:107], v[24:27], v[32:35]
  s_add_u32 s45, s82, 49152
  s_mov_b32 m0, s45
  v_mfma_f32_16x16x32_bf16 v[36:39], a[104:107], v[28:31], v[36:39]
  s_add_u32 s46, s81, 49152
  buffer_load_dwordx4 v2, s[4:7], s46 offen sc1 lds
  v_mfma_f32_16x16x32_bf16 v[40:43], a[216:219], v[24:27], v[40:43]
  v_mfma_f32_16x16x32_bf16 v[44:47], a[216:219], v[28:31], v[44:47]
  s_waitcnt lgkmcnt(0)
  v_mfma_f32_16x16x32_bf16 v[32:35], a[108:111], v[8:11], v[32:35]
  s_add_u32 s45, s82, 53248
  s_mov_b32 m0, s45
  v_mfma_f32_16x16x32_bf16 v[36:39], a[108:111], v[12:15], v[36:39]
  s_add_u32 s46, s81, 53248
  buffer_load_dwordx4 v2, s[4:7], s46 offen sc1 lds
  v_mfma_f32_16x16x32_bf16 v[40:43], a[220:223], v[8:11], v[40:43]
  v_mfma_f32_16x16x32_bf16 v[44:47], a[220:223], v[12:15], v[44:47]
  s_nop 7
  buffer_store_dwordx4 v[32:35], v2, s[4:7], s72 offen offset:0 sc1
  buffer_store_dwordx4 v[36:39], v2, s[4:7], s72 offen offset:1024 sc1
  buffer_store_dwordx4 v[40:43], v2, s[4:7], s72 offen offset:2048 sc1
  buffer_store_dwordx4 v[44:47], v2, s[4:7], s72 offen offset:3072 sc1
  s_add_u32 s72, s72, 131072
  s_xor_b32 s69, s69, 57344
  s_add_u32 s65, s65, 1
  s_mov_b32 s83, s68
  s_add_u32 s68, s68, 128
  s_mov_b32 s84, 1
  s_branch L_g5_loop
L_varB_106:
  s_mov_b32 s84, 0
  ds_read_b128 v[24:27], v5 offset:28672
  ds_read_b128 v[28:31], v5 offset:29696
  ds_read_b128 v[8:11], v5 offset:30720
  ds_read_b128 v[12:15], v5 offset:31744
  s_waitcnt lgkmcnt(2)
  v_mfma_f32_16x16x32_bf16 v[32:35], a[56:59], v[24:27], v[32:35]
  ds_read_b128 v[16:19], v5 offset:32768
  v_mfma_f32_16x16x32_bf16 v[36:39], a[56:59], v[28:31], v[36:39]
  ds_read_b128 v[20:23], v5 offset:33792
  v_mfma_f32_16x16x32_bf16 v[40:43], a[168:171], v[24:27], v[40:43]
  v_mfma_f32_16x16x32_bf16 v[44:47], a[168:171], v[28:31], v[44:47]
  s_waitcnt lgkmcnt(2)
  v_mfma_f32_16x16x32_bf16 v[32:35], a[60:63], v[8:11], v[32:35]
  ds_read_b128 v[24:27], v5 offset:34816
  v_mfma_f32_16x16x32_bf16 v[36:39], a[60:63], v[12:15], v[36:39]
  ds_read_b128 v[28:31], v5 offset:35840
  v_mfma_f32_16x16x32_bf16 v[40:43], a[172:175], v[8:11], v[40:43]
  v_mfma_f32_16x16x32_bf16 v[44:47], a[172:175], v[12:15], v[44:47]
  s_waitcnt lgkmcnt(2)
  v_mfma_f32_16x16x32_bf16 v[32:35], a[64:67], v[16:19], v[32:35]
  ds_read_b128 v[8:11], v5 offset:36864
  v_mfma_f32_16x16x32_bf16 v[36:39], a[64:67], v[20:23], v[36:39]
  ds_read_b128 v[12:15], v5 offset:37888
  v_mfma_f32_16x16x32_bf16 v[40:43], a[176:179], v[16:19], v[40:43]
  v_mfma_f32_16x16x32_bf16 v[44:47], a[176:179], v[20:23], v[44:47]
  s_waitcnt lgkmcnt(2)
  v_mfma_f32_16x16x32_bf16 v[32:35], a[68:71], v[24:27], v[32:35]
  ds_read_b128 v[16:19], v5 offset:38912
  v_mfma_f32_16x16x32_bf16 v[36:39], a[68:71], v[28:31], v[36:39]
  ds_read_b128 v[20:23], v5 offset:39936
  v_mfma_f32_16x16x32_bf16 v[40:43], a[180:183], v[24:27], v[40:43]
  v_mfma_f32_16x16x32_bf16 v[44:47], a[180:183], v[28:31], v[44:47]
  s_waitcnt lgkmcnt(2)
  v_mfma_f32_16x16x32_bf16 v[32:35], a[72:75], v[8:11], v[32:35]
  ds_read_b128 v[24:27], v5 offset:40960
  v_mfma_f32_16x16x32_bf16 v[36:39], a[72:75], v[12:15], v[36:39]
  ds_read_b128 v[28:31], v5 offset:41984
  v_mfma_f32_16x16x32_bf16 v[40:43], a[184:187], v[8:11], v[40:43]
  v_mfma_f32_16x16x32_bf16 v[44:47], a[184:187], v[12:15], v[44:47]
  s_waitcnt lgkmcnt(2)
  v_mfma_f32_16x16x32_bf16 v[32:35], a[76:79], v[16:19], v[32:35]
  v_mfma_f32_16x16x32_bf16 v[36:39], a[76:79], v[20:23], v[36:39]
  v_mfma_f32_16x16x32_bf16 v[40:43], a[188:191], v[16:19], v[40:43]
  v_mfma_f32_16x16x32_bf16 v[44:47], a[188:191], v[20:23], v[44:47]
  s_waitcnt lgkmcnt(0)
  v_mfma_f32_16x16x32_bf16 v[32:35], a[80:83], v[24:27], v[32:35]
  v_mfma_f32_16x16x32_bf16 v[36:39], a[80:83], v[28:31], v[36:39]
  v_mfma_f32_16x16x32_bf16 v[40:43], a[192:195], v[24:27], v[40:43]
  v_mfma_f32_16x16x32_bf16 v[44:47], a[192:195], v[28:31], v[44:47]
  v_and_b32 v3, 63, v0
  v_lshlrev_b32 v3, 2, v3
  v_add_u32 v3, s67, v3
  s_mov_b64 exec, 0x7f
  buffer_load_dword v4, v3, s[4:7], 0 offen sc1
  s_mov_b64 exec, -1
  ds_read_b128 v[8:11], v5 offset:43008
  ds_read_b128 v[12:15], v5 offset:44032
  ds_read_b128 v[16:19], v5 offset:45056
  ds_read_b128 v[20:23], v5 offset:46080
  s_waitcnt lgkmcnt(2)
  v_mfma_f32_16x16x32_bf16 v[32:35], a[84:87], v[8:11], v[32:35]
  ds_read_b128 v[24:27], v5 offset:47104
  v_mfma_f32_16x16x32_bf16 v[36:39], a[84:87], v[12:15], v[36:39]
  ds_read_b128 v[28:31], v5 offset:48128
  v_mfma_f32_16x16x32_bf16 v[40:43], a[196:199], v[8:11], v[40:43]
  v_mfma_f32_16x16x32_bf16 v[44:47], a[196:199], v[12:15], v[44:47]
  s_waitcnt lgkmcnt(2)
  v_mfma_f32_16x16x32_bf16 v[32:35], a[88:91], v[16:19], v[32:35]
  ds_read_b128 v[8:11], v5 offset:49152
  v_mfma_f32_16x16x32_bf16 v[36:39], a[88:91], v[20:23], v[36:39]
  ds_read_b128 v[12:15], v5 offset:50176
  v_mfma_f32_16x16x32_bf16 v[40:43], a[200:203], v[16:19], v[40:43]
  v_mfma_f32_16x16x32_bf16 v[44:47], a[200:203], v[20:23], v[44:47]
  s_waitcnt lgkmcnt(2)
  v_mfma_f32_16x16x32_bf16 v[32:35], a[92:95], v[24:27], v[32:35]
  ds_read_b128 v[16:19], v5 offset:51200
  v_mfma_f32_16x16x32_bf16 v[36:39], a[92:95], v[28:31], v[36:39]
  ds_read_b128 v[20:23], v5 offset:52224
  v_mfma_f32_16x16x32_bf16 v[40:43], a[204:207], v[24:27], v[40:43]
  v_mfma_f32_16x16x32_bf16 v[44:47], a[204:207], v[28:31], v[44:47]
  s_waitcnt lgkmcnt(2)
  v_mfma_f32_16x16x32_bf16 v[32:35], a[96:99], v[8:11], v[32:35]
  ds_read_b128 v[24:27], v5 offset:53248
  v_mfma_f32_16x16x32_bf16 v[36:39], a[96:99], v[12:15], v[36:39]
  ds_read_b128 v[28:31], v5 offset:54272
  v_mfma_f32_16x16x32_bf16 v[40:43], a[208:211], v[8:11], v[40:43]
  v_mfma_f32_16x16x32_bf16 v[44:47], a[208:211], v[12:15], v[44:47]
  s_waitcnt lgkmcnt(2)
  v_mfma_f32_16x16x32_bf16 v[32:35], a[100:103], v[16:19], v[32:35]
  ds_read_b128 v[8:11], v5 offset:55296
  v_mfma_f32_16x16x32_bf16 v[36:39], a[100:103], v[20:23], v[36:39]
  ds_read_b128 v[12:15], v5 offset:56320
  v_mfma_f32_16x16x32_bf16 v[40:43], a[212:215], v[16:19], v[40:43]
  v_mfma_f32_16x16x32_bf16 v[44:47], a[212:215], v[20:23], v[44:47]
  s_waitcnt lgkmcnt(2)
  v_mfma_f32_16x16x32_bf16 v[32:35], a[104:107], v[24:27], v[32:35]
  v_mfma_f32_16x16x32_bf16 v[36:39], a[104:107], v[28:31], v[36:39]
  v_mfma_f32_16x16x32_bf16 v[40:43], a[216:219], v[24:27], v[40:43]
  v_mfma_f32_16x16x32_bf16 v[44:47], a[216:219], v[28:31], v[44:47]
  s_waitcnt lgkmcnt(0)
  v_mfma_f32_16x16x32_bf16 v[32:35], a[108:111], v[8:11], v[32:35]
  v_mfma_f32_16x16x32_bf16 v[36:39], a[108:111], v[12:15], v[36:39]
  v_mfma_f32_16x16x32_bf16 v[40:43], a[220:223], v[8:11], v[40:43]
  v_mfma_f32_16x16x32_bf16 v[44:47], a[220:223], v[12:15], v[44:47]
  s_nop 7
  buffer_store_dwordx4 v[32:35], v2, s[4:7], s72 offen offset:0 sc1
  buffer_store_dwordx4 v[36:39], v2, s[4:7], s72 offen offset:1024 sc1
  buffer_store_dwordx4 v[40:43], v2, s[4:7], s72 offen offset:2048 sc1
  buffer_store_dwordx4 v[44:47], v2, s[4:7], s72 offen offset:3072 sc1
  s_add_u32 s72, s72, 131072
  s_xor_b32 s69, s69, 57344
  s_add_u32 s65, s65, 1
  s_waitcnt vmcnt(4)
  v_cmp_ne_u32 vcc, 0, v4
  s_and_b32 s71, vcc_lo, 0x7f
  s_cmp_eq_u32 s71, 0x7f
  s_cselect_b32 s71, 1, 0
  v_mov_b32 v4, s71
  v_mov_b32 v6, 0x20004
  s_cmp_eq_u32 s16, 0
  s_cbranch_scc0 L_dec_113
  s_mov_b64 exec, 1
  ds_write_b32 v6, v4
  s_mov_b64 exec, -1
  s_waitcnt lgkmcnt(0)
L_dec_113:
  s_barrier
  ds_read_b32 v4, v6
  s_waitcnt lgkmcnt(0)
  v_readfirstlane_b32 s71, v4
  s_cmp_ge_u32 s65, 64
  s_cbranch_scc1 L_ni_107
  s_cmp_eq_u32 s71, 1
  s_cbranch_scc0 L_ni_107
  s_add_u32 s47, s66, s74
  s_add_u32 s48, s69, s73
  s_mov_b32 s81, s47
  s_mov_b32 s82, s48
  s_add_u32 s45, s48, 0
  s_mov_b32 m0, s45
  s_add_u32 s46, s47, 0
  buffer_load_dwordx4 v2, s[4:7], s46 offen sc1 lds
  s_add_u32 s45, s48, 4096
  s_mov_b32 m0, s45
  s_add_u32 s46, s47, 4096
  buffer_load_dwordx4 v2, s[4:7], s46 offen sc1 lds
  s_add_u32 s45, s48, 8192
  s_mov_b32 m0, s45
  s_add_u32 s46, s47, 8192
  buffer_load_dwordx4 v2, s[4:7], s46 offen sc1 lds
  s_add_u32 s45, s48, 12288
  s_mov_b32 m0, s45
  s_add_u32 s46, s47, 12288
  buffer_load_dwordx4 v2, s[4:7], s46 offen sc1 lds
  s_add_u32 s45, s48, 16384
  s_mov_b32 m0, s45
  s_add_u32 s46, s47, 16384
  buffer_load_dwordx4 v2, s[4:7], s46 offen sc1 lds
  s_add_u32 s45, s48, 20480
  s_mov_b32 m0, s45
  s_add_u32 s46, s47, 20480
  buffer_load_dwordx4 v2, s[4:7], s46 offen sc1 lds
  s_add_u32 s45, s48, 24576
  s_mov_b32 m0, s45
  s_add_u32 s46, s47, 24576
  buffer_load_dwordx4 v2, s[4:7], s46 offen sc1 lds
  s_add_u32 s45, s48, 28672
  s_mov_b32 m0, s45
  s_add_u32 s46, s47, 28672
  buffer_load_dwordx4 v2, s[4:7], s46 offen sc1 lds
  s_add_u32 s45, s48, 32768
  s_mov_b32 m0, s45
  s_add_u32 s46, s47, 32768
  buffer_load_dwordx4 v2, s[4:7], s46 offen sc1 lds
  s_add_u32 s45, s48, 36864
  s_mov_b32 m0, s45
  s_add_u32 s46, s47, 36864
  buffer_load_dwordx4 v2, s[4:7], s46 offen sc1 lds
  s_add_u32 s45, s48, 40960
  s_mov_b32 m0, s45
  s_add_u32 s46, s47, 40960
  buffer_load_dwordx4 v2, s[4:7], s46 offen sc1 lds
  s_add_u32 s45, s48, 45056
  s_mov_b32 m0, s45
  s_add_u32 s46, s47, 45056
  buffer_load_dwordx4 v2, s[4:7], s46 offen sc1 lds
  s_add_u32 s45, s48, 49152
  s_mov_b32 m0, s45
  s_add_u32 s46, s47, 49152
  buffer_load_dwordx4 v2, s[4:7], s46 offen sc1 lds
  s_add_u32 s45, s48, 53248
  s_mov_b32 m0, s45
  s_add_u32 s46, s47, 53248
  buffer_load_dwordx4 v2, s[4:7], s46 offen sc1 lds
  s_mov_b32 s77, s68
  s_add_u32 s68, s68, 128
  s_branch L_g5_loop
L_ni_107:
  s_waitcnt vmcnt(0)
  s_barrier
  v_mov_b32 v6, s68
  v_mov_b32 v7, 1
  s_mov_b64 exec, s[78:79]
  buffer_store_dword v7, v6, s[4:7], 0 offen sc1
  s_mov_b64 exec, -1
  s_add_u32 s68, s68, 128
  s_cmp_ge_u32 s65, 64
  s_cbranch_scc1 L_gfin_114
L_wn_115:
  v_and_b32 v3, 63, v0
  v_lshlrev_b32 v3, 2, v3
  v_add_u32 v3, s67, v3
  s_mov_b64 exec, 0x7f
  buffer_load_dword v4, v3, s[4:7], 0 offen sc1
  s_mov_b64 exec, -1
  s_waitcnt vmcnt(0)
  v_cmp_ne_u32 vcc, 0, v4
  s_and_b32 s45, vcc_lo, 0x7f
  s_cmp_eq_u32 s45, 0x7f
  s_cselect_b32 s45, 1, 0
  s_cmp_eq_u32 s45, 1
  s_cbranch_scc1 L_wnd_116
  s_sub_u32 s64, s64, 1
  s_cbranch_scc1 L_abort
  s_sleep 4
  s_branch L_wn_115
L_wnd_116:
  s_add_u32 s47, s66, s74
  s_add_u32 s48, s69, s73
  s_mov_b32 s81, s47
  s_mov_b32 s82, s48
  s_add_u32 s45, s48, 0
  s_mov_b32 m0, s45
  s_add_u32 s46, s47, 0
  buffer_load_dwordx4 v2, s[4:7], s46 offen sc1 lds
  s_add_u32 s45, s48, 4096
  s_mov_b32 m0, s45
  s_add_u32 s46, s47, 4096
  buffer_load_dwordx4 v2, s[4:7], s46 offen sc1 lds
  s_add_u32 s45, s48, 8192
  s_mov_b32 m0, s45
  s_add_u32 s46, s47, 8192
  buffer_load_dwordx4 v2, s[4:7], s46 offen sc1 lds
  s_add_u32 s45, s48, 12288
  s_mov_b32 m0, s45
  s_add_u32 s46, s47, 12288
  buffer_load_dwordx4 v2, s[4:7], s46 offen sc1 lds
  s_add_u32 s45, s48, 16384
  s_mov_b32 m0, s45
  s_add_u32 s46, s47, 16384
  buffer_load_dwordx4 v2, s[4:7], s46 offen sc1 lds
  s_add_u32 s45, s48, 20480
  s_mov_b32 m0, s45
  s_add_u32 s46, s47, 20480
  buffer_load_dwordx4 v2, s[4:7], s46 offen sc1 lds
  s_add_u32 s45, s48, 24576
  s_mov_b32 m0, s45
  s_add_u32 s46, s47, 24576
  buffer_load_dwordx4 v2, s[4:7], s46 offen sc1 lds
  s_add_u32 s45, s48, 28672
  s_mov_b32 m0, s45
  s_add_u32 s46, s47, 28672
  buffer_load_dwordx4 v2, s[4:7], s46 offen sc1 lds
  s_add_u32 s45, s48, 32768
  s_mov_b32 m0, s45
  s_add_u32 s46, s47, 32768
  buffer_load_dwordx4 v2, s[4:7], s46 offen sc1 lds
  s_add_u32 s45, s48, 36864
  s_mov_b32 m0, s45
  s_add_u32 s46, s47, 36864
  buffer_load_dwordx4 v2, s[4:7], s46 offen sc1 lds
  s_add_u32 s45, s48, 40960
  s_mov_b32 m0, s45
  s_add_u32 s46, s47, 40960
  buffer_load_dwordx4 v2, s[4:7], s46 offen sc1 lds
  s_add_u32 s45, s48, 45056
  s_mov_b32 m0, s45
  s_add_u32 s46, s47, 45056
  buffer_load_dwordx4 v2, s[4:7], s46 offen sc1 lds
  s_add_u32 s45, s48, 49152
  s_mov_b32 m0, s45
  s_add_u32 s46, s47, 49152
  buffer_load_dwordx4 v2, s[4:7], s46 offen sc1 lds
  s_add_u32 s45, s48, 53248
  s_mov_b32 m0, s45
  s_add_u32 s46, s47, 53248
  buffer_load_dwordx4 v2, s[4:7], s46 offen sc1 lds
  s_branch L_g5_loop
L_gfin_114:
  s_waitcnt vmcnt(0)
  s_branch L_end
L_role_f3:
  s_cmp_eq_u32 s99, 1
  s_cbranch_scc1 L_gs_done_117
  s_cmp_eq_u32 s16, 0
  s_cbranch_scc0 L_gs_w_118
  v_mov_b32 v100, 32
L_gs_p_119:
  s_mov_b64 exec, 1
  global_load_dword v101, v100, s[40:41] sc1
  s_mov_b64 exec, -1
  s_waitcnt vmcnt(0)
  v_readfirstlane_b32 s45, v101
  s_sub_u32 s64, s64, 1
  s_cbranch_scc1 L_abort
  s_cmp_ge_u32 s45, 256
  s_cbranch_scc1 L_gs_q_120
  s_sleep 4
  s_branch L_gs_p_119
L_gs_q_120:
  v_and_b32 v102, 63, v0
  v_lshlrev_b32 v102, 2, v102
  s_mov_b64 exec, 0xff
  global_load_dword v101, v102, s[40:41] sc1
  s_waitcnt vmcnt(0)
  ds_write_b32 v102, v101
  s_mov_b64 exec, -1
  s_waitcnt lgkmcnt(0)
L_gs_w_118:
  s_barrier
  v_mov_b32 v100, 0
  ds_read_b128 v[104:107], v100
  ds_read_b128 v[108:111], v100 offset:16
  s_waitcnt lgkmcnt(0)
  s_mov_b32 s44, 1
  s_mov_b32 s46, 0
  v_readfirstlane_b32 s45, v104
  s_cmp_eq_u32 s45, 32
  s_cselect_b32 s44, s44, 0
  s_cmp_gt_u32 s18, 0
  s_cselect_b32 s45, s45, 0
  s_add_u32 s46, s46, s45
  v_readfirstlane_b32 s45, v105
  s_cmp_eq_u32 s45, 32
  s_cselect_b32 s44, s44, 0
  s_cmp_gt_u32 s18, 1
  s_cselect_b32 s45, s45, 0
  s_add_u32 s46, s46, s45
  v_readfirstlane_b32 s45, v106
  s_cmp_eq_u32 s45, 32
  s_cselect_b32 s44, s44, 0
  s_cmp_gt_u32 s18, 2
  s_cselect_b32 s45, s45, 0
  s_add_u32 s46, s46, s45
  v_readfirstlane_b32 s45, v107
  s_cmp_eq_u32 s45, 32
  s_cselect_b32 s44, s44, 0
  s_cmp_gt_u32 s18, 3
  s_cselect_b32 s45, s45, 0
  s_add_u32 s46, s46, s45
  v_readfirstlane_b32 s45, v108
  s_cmp_eq_u32 s45, 32
  s_cselect_b32 s44, s44, 0
  s_cmp_gt_u32 s18, 4
  s_cselect_b32 s45, s45, 0
  s_add_u32 s46, s46, s45
  v_readfirstlane_b32 s45, v109
  s_cmp_eq_u32 s45, 32
  s_cselect_b32 s44, s44, 0
  s_cmp_gt_u32 s18, 5
  s_cselect_b32 s45, s45, 0
  s_add_u32 s46, s46, s45
  v_readfirstlane_b32 s45, v110
  s_cmp_eq_u32 s45, 32
  s_cselect_b32 s44, s44, 0
  s_cmp_gt_u32 s18, 6
  s_cselect_b32 s45, s45, 0
  s_add_u32 s46, s46, s45
  v_readfirstlane_b32 s45, v111
  s_cmp_eq_u32 s45, 32
  s_cselect_b32 s44, s44, 0
  s_cmp_gt_u32 s18, 7
  s_cselect_b32 s45, s45, 0
  s_add_u32 s46, s46, s45
  s_barrier
  s_mov_b32 s99, 1
  s_cmp_eq_u32 s44, 1
  s_cbranch_scc1 L_gs_done_117
  s_add_u32 s17, s46, s98
  s_branch L_dispatch
L_gs_done_117:
  v_and_b32 v6, 7, v0
  v_lshrrev_b32 v7, 3, v0
  v_lshlrev_b32 v5, 4, v6
  v_lshl_add_u32 v1, v7, 11, v5
  v_lshlrev_b32 v2, 10, v6
  v_lshl_add_u32 v2, v7, 5, v2
  v_lshrrev_b32 v3, 1, v7
  v_lshlrev_b32 v3, 10, v3
  v_and_b32 v4, 1, v7
  v_lshl_add_u32 v3, v4, 9, v3
  v_add_u32 v3, v3, v5
  v_and_b32 v4, 63, v0
  v_lshlrev_b32 v4, 2, v4
  s_lshl_b32 s45, s16, 8
  v_add_u32 v4, s45, v4
  v_lshlrev_b32 v5, 2, v6
  v_lshlrev_b32 v8, 4, v0
  v_add_u32 v9, 0x1000, v8
  s_mov_b32 s8, s20
  s_and_b32 s9, s21, 0xffff
  s_mov_b32 s10, 0x200000
  s_mov_b32 s11, 0x20000
  s_mov_b32 s12, s38
  s_and_b32 s13, s39, 0xffff
  s_mov_b32 s14, 0x200000
  s_mov_b32 s15, 0x20000
  s_cmp_eq_u32 s19, 0
  s_cbranch_scc0 L_f1_122
L_f0_121:
  s_mov_b32 s66, s17
  s_mov_b32 s76, 0x128000
  s_cmp_eq_u32 s16, 0
  s_cselect_b32 s80, 1, 0
  s_mov_b32 s81, 0
  s_mov_b32 s65, 0
  s_lshr_b32 s45, s66, 2
  s_and_b32 s46, s66, 3
  s_mul_i32 s47, s45, 0x40000
  s_lshr_b32 s48, s46, 1
  s_lshl_b32 s49, s48, 10
  s_add_u32 s47, s47, s49
  s_and_b32 s49, s46, 1
  s_lshl_b32 s49, s49, 7
  s_add_u32 s47, s47, s49
  s_add_u32 s67, s47, 0x8000000
  s_lshl_b32 s47, s66, 13
  s_add_u32 s68, s47, 0x0
  s_add_u32 s73, s47, 0x5a00000
  s_lshl_b32 s47, s45, 7
  s_add_u32 s69, s47, 0x114000
  s_lshl_b32 s48, s48, 14
  s_add_u32 s48, s48, s49
  s_lshl_b32 s49, s45, 15
  s_add_u32 s48, s48, s49
  s_add_u32 s74, s48, 0x5600000
  s_lshl_b32 s46, s46, 2
  s_add_u32 s46, s46, s47
  s_add_u32 s75, s46, 0x118000
L_wn_123:
  v_and_b32 v6, 63, v0
  v_lshlrev_b32 v6, 2, v6
  v_add_u32 v6, s69, v6
  s_mov_b64 exec, 0xffff
  buffer_load_dword v7, v6, s[4:7], 0 offen sc1
  s_mov_b64 exec, -1
  s_waitcnt vmcnt(0)
  v_cmp_ne_u32 vcc, 0, v7
  s_and_b32 s45, vcc_lo, 0xffff
  s_cmp_eq_u32 s45, 0xffff
  s_cselect_b32 s45, 1, 0
  s_cmp_eq_u32 s45, 1
  s_cbranch_scc1 L_wnd_124
  s_sub_u32 s64, s64, 1
  s_cbranch_scc1 L_abort
  s_sleep 16
  s_branch L_wn_123
L_wnd_124:
  buffer_load_dwordx4 v[80:83], v2, s[8:11], s68 offen sc1
  buffer_load_dwordx4 v[84:87], v2, s[8:11], s68 offen offset:16 sc1
  buffer_load_dwordx4 v[16:19], v1, s[4:7], s67 offen offset:0 sc1
  buffer_load_dwordx4 v[20:23], v1, s[4:7], s67 offen offset:256 sc1
  buffer_load_dwordx4 v[24:27], v1, s[4:7], s67 offen offset:512 sc1
  buffer_load_dwordx4 v[28:31], v1, s[4:7], s67 offen offset:768 sc1
  s_add_u32 s49, s67, 65536
  buffer_load_dwordx4 v[32:35], v1, s[4:7], s49 offen offset:0 sc1
  buffer_load_dwordx4 v[36:39], v1, s[4:7], s49 offen offset:256 sc1
  buffer_load_dwordx4 v[40:43], v1, s[4:7], s49 offen offset:512 sc1
  buffer_load_dwordx4 v[44:47], v1, s[4:7], s49 offen offset:768 sc1
  s_add_u32 s49, s67, 131072
  buffer_load_dwordx4 v[48:51], v1, s[4:7], s49 offen offset:0 sc1
  buffer_load_dwordx4 v[52:55], v1, s[4:7], s49 offen offset:256 sc1
  buffer_load_dwordx4 v[56:59], v1, s[4:7], s49 offen offset:512 sc1
  buffer_load_dwordx4 v[60:63], v1, s[4:7], s49 offen offset:768 sc1
  s_add_u32 s49, s67, 196608
  buffer_load_dwordx4 v[64:67], v1, s[4:7], s49 offen offset:0 sc1
  buffer_load_dwordx4 v[68:71], v1, s[4:7], s49 offen offset:256 sc1
  buffer_load_dwordx4 v[72:75], v1, s[4:7], s49 offen offset:512 sc1
  buffer_load_dwordx4 v[76:79], v1, s[4:7], s49 offen offset:768 sc1
L_f3_l0:
  s_mov_b32 s70, s73
  s_mov_b32 s71, s74
  s_mov_b32 s72, s75
  s_add_u32 s66, s66, 6
  s_lshr_b32 s45, s66, 2
  s_and_b32 s46, s66, 3
  s_mul_i32 s47, s45, 0x40000
  s_lshr_b32 s48, s46, 1
  s_lshl_b32 s49, s48, 10
  s_add_u32 s47, s47, s49
  s_and_b32 s49, s46, 1
  s_lshl_b32 s49, s49, 7
  s_add_u32 s47, s47, s49
  s_add_u32 s67, s47, 0x8000000
  s_lshl_b32 s47, s66, 13
  s_add_u32 s68, s47, 0x0
  s_add_u32 s73, s47, 0x5a00000
  s_lshl_b32 s47, s45, 7
  s_add_u32 s69, s47, 0x114000
  s_lshl_b32 s48, s48, 14
  s_add_u32 s48, s48, s49
  s_lshl_b32 s49, s45, 15
  s_add_u32 s48, s48, s49
  s_add_u32 s74, s48, 0x5600000
  s_lshl_b32 s46, s46, 2
  s_add_u32 s46, s46, s47
  s_add_u32 s75, s46, 0x118000
  s_waitcnt vmcnt(0)
  v_and_b32 v6, 63, v0
  v_lshlrev_b32 v6, 2, v6
  v_add_u32 v6, s69, v6
  s_mov_b64 exec, 0xffff
  buffer_load_dword v7, v6, s[4:7], 0 offen sc1
  s_mov_b64 exec, -1
  s_barrier
  v_mov_b32 v10, s76
  v_mov_b32 v11, 1
  s_mov_b64 exec, s[80:81]
  buffer_store_dword v11, v10, s[4:7], 0 offen sc1
  s_mov_b64 exec, -1
  s_mov_b32 s76, 0x128000
  s_mov_b32 s49, 0xffff0000
  v_lshlrev_b32 v176, 16, v80
  v_and_b32 v177, s49, v80
  v_lshlrev_b32 v178, 16, v81
  v_and_b32 v179, s49, v81
  v_lshlrev_b32 v180, 16, v82
  v_and_b32 v181, s49, v82
  v_lshlrev_b32 v182, 16, v83
  v_and_b32 v183, s49, v83
  v_lshlrev_b32 v184, 16, v84
  v_and_b32 v185, s49, v84
  v_lshlrev_b32 v186, 16, v85
  v_and_b32 v187, s49, v85
  v_lshlrev_b32 v188, 16, v86
  v_and_b32 v189, s49, v86
  v_lshlrev_b32 v190, 16, v87
  v_and_b32 v191, s49, v87
  v_add_f32 v176, v176, v16
  v_add_f32 v177, v177, v17
  v_add_f32 v178, v178, v18
  v_add_f32 v179, v179, v19
  v_add_f32 v180, v180, v20
  v_add_f32 v181, v181, v21
  v_add_f32 v182, v182, v22
  v_add_f32 v183, v183, v23
  v_add_f32 v184, v184, v24
  v_add_f32 v185, v185, v25
  v_add_f32 v186, v186, v26
  v_add_f32 v187, v187, v27
  v_add_f32 v188, v188, v28
  v_add_f32 v189, v189, v29
  v_add_f32 v190, v190, v30
  v_add_f32 v191, v191, v31
  v_add_f32 v176, v176, v32
  v_add_f32 v177, v177, v33
  v_add_f32 v178, v178, v34
  v_add_f32 v179, v179, v35
  v_add_f32 v180, v180, v36
  v_add_f32 v181, v181, v37
  v_add_f32 v182, v182, v38
  v_add_f32 v183, v183, v39
  v_add_f32 v184, v184, v40
  v_add_f32 v185, v185, v41
  v_add_f32 v186, v186, v42
  v_add_f32 v187, v187, v43
  v_add_f32 v188, v188, v44
  v_add_f32 v189, v189, v45
  v_add_f32 v190, v190, v46
  v_add_f32 v191, v191, v47
  v_add_f32 v176, v176, v48
  v_add_f32 v177, v177, v49
  v_add_f32 v178, v178, v50
  v_add_f32 v179, v179, v51
  v_add_f32 v180, v180, v52
  v_add_f32 v181, v181, v53
  v_add_f32 v182, v182, v54
  v_add_f32 v183, v183, v55
  v_add_f32 v184, v184, v56
  v_add_f32 v185, v185, v57
  v_add_f32 v186, v186, v58
  v_add_f32 v187, v187, v59
  v_add_f32 v188, v188, v60
  v_add_f32 v189, v189, v61
  v_add_f32 v190, v190, v62
  v_add_f32 v191, v191, v63
  v_add_f32 v176, v176, v64
  v_add_f32 v177, v177, v65
  v_add_f32 v178, v178, v66
  v_add_f32 v179, v179, v67
  v_add_f32 v180, v180, v68
  v_add_f32 v181, v181, v69
  v_add_f32 v182, v182, v70
  v_add_f32 v183, v183, v71
  v_add_f32 v184, v184, v72
  v_add_f32 v185, v185, v73
  v_add_f32 v186, v186, v74
  v_add_f32 v187, v187, v75
  v_add_f32 v188, v188, v76
  v_add_f32 v189, v189, v77
  v_add_f32 v190, v190, v78
  v_add_f32 v191, v191, v79
  v_cvt_pk_bf16_f32 v80, v176, v177
  v_cvt_pk_bf16_f32 v81, v178, v179
  v_cvt_pk_bf16_f32 v82, v180, v181
  v_cvt_pk_bf16_f32 v83, v182, v183
  v_cvt_pk_bf16_f32 v84, v184, v185
  v_cvt_pk_bf16_f32 v85, v186, v187
  v_cvt_pk_bf16_f32 v86, v188, v189
  v_cvt_pk_bf16_f32 v87, v190, v191
  buffer_store_dwordx4 v[80:83], v8, s[4:7], s70 offen sc1
  buffer_store_dwordx4 v[84:87], v9, s[4:7], s70 offen sc1
  v_lshlrev_b32 v176, 16, v80
  v_and_b32 v177, s49, v80
  v_lshlrev_b32 v178, 16, v81
  v_and_b32 v179, s49, v81
  v_lshlrev_b32 v180, 16, v82
  v_and_b32 v181, s49, v82
  v_lshlrev_b32 v182, 16, v83
  v_and_b32 v183, s49, v83
  v_lshlrev_b32 v184, 16, v84
  v_and_b32 v185, s49, v84
  v_lshlrev_b32 v186, 16, v85
  v_and_b32 v187, s49, v85
  v_lshlrev_b32 v188, 16, v86
  v_and_b32 v189, s49, v86
  v_lshlrev_b32 v190, 16, v87
  v_and_b32 v191, s49, v87
  v_add_f32 v192, v176, v177
  v_add_f32 v193, v178, v179
  v_add_f32 v192, v192, v180
  v_add_f32 v193, v193, v181
  v_add_f32 v192, v192, v182
  v_add_f32 v193, v193, v183
  v_add_f32 v192, v192, v184
  v_add_f32 v193, v193, v185
  v_add_f32 v192, v192, v186
  v_add_f32 v193, v193, v187
  v_add_f32 v192, v192, v188
  v_add_f32 v193, v193, v189
  v_add_f32 v192, v192, v190
  v_add_f32 v193, v193, v191
  v_add_f32 v192, v192, v193
  s_nop 1
  v_add_f32_dpp v192, v192, v192 row_ror:8 row_mask:0xf bank_mask:0xf
  v_mov_b32 v193, v192
  s_nop 1
  v_permlane16_swap_b32 v192, v193
  v_add_f32 v192, v192, v193
  v_mov_b32 v193, v192
  s_nop 1
  v_permlane32_swap_b32 v192, v193
  v_add_f32 v192, v192, v193
  ds_write_b32 v4, v192 offset:0
  s_waitcnt vmcnt(3)
  v_mov_b32 v10, 0x1000
  v_cmp_ne_u32 vcc, 0, v7
  s_and_b32 s77, vcc_lo, 0xffff
  s_cmp_eq_u32 s77, 0xffff
  s_cselect_b32 s77, 1, 0
  v_mov_b32 v7, s77
  s_cmp_eq_u32 s16, 0
  s_cbranch_scc0 L_fw_125
  s_mov_b64 exec, 1
  ds_write_b32 v10, v7
  s_mov_b64 exec, -1
L_fw_125:
  s_waitcnt lgkmcnt(0)
  s_barrier
  ds_read_b32 v192, v5 offset:0
  ds_read_b32 v193, v5 offset:256
  ds_read_b32 v194, v5 offset:512
  ds_read_b32 v195, v5 offset:768
  s_waitcnt lgkmcnt(0)
  v_add_f32 v192, v192, v193
  v_add_f32 v194, v194, v195
  v_add_f32 v192, v192, v194
  ds_read_b32 v7, v10
  s_waitcnt lgkmcnt(0)
  v_readfirstlane_b32 s77, v7
  s_mov_b32 s78, 0
  s_cmp_lt_u32 s66, 256
  s_cbranch_scc0 L_fn_126
  s_cmp_eq_u32 s77, 1
  s_cbranch_scc0 L_fn_126
  buffer_load_dwordx4 v[160:163], v2, s[8:11], s68 offen sc1
  buffer_load_dwordx4 v[164:167], v2, s[8:11], s68 offen offset:16 sc1
  buffer_load_dwordx4 v[96:99], v1, s[4:7], s67 offen offset:0 sc1
  buffer_load_dwordx4 v[100:103], v1, s[4:7], s67 offen offset:256 sc1
  buffer_load_dwordx4 v[104:107], v1, s[4:7], s67 offen offset:512 sc1
  buffer_load_dwordx4 v[108:111], v1, s[4:7], s67 offen offset:768 sc1
  s_add_u32 s49, s67, 65536
  buffer_load_dwordx4 v[112:115], v1, s[4:7], s49 offen offset:0 sc1
  buffer_load_dwordx4 v[116:119], v1, s[4:7], s49 offen offset:256 sc1
  buffer_load_dwordx4 v[120:123], v1, s[4:7], s49 offen offset:512 sc1
  buffer_load_dwordx4 v[124:127], v1, s[4:7], s49 offen offset:768 sc1
  s_add_u32 s49, s67, 131072
  buffer_load_dwordx4 v[128:131], v1, s[4:7], s49 offen offset:0 sc1
  buffer_load_dwordx4 v[132:135], v1, s[4:7], s49 offen offset:256 sc1
  buffer_load_dwordx4 v[136:139], v1, s[4:7], s49 offen offset:512 sc1
  buffer_load_dwordx4 v[140:143], v1, s[4:7], s49 offen offset:768 sc1
  s_add_u32 s49, s67, 196608
  buffer_load_dwordx4 v[144:147], v1, s[4:7], s49 offen offset:0 sc1
  buffer_load_dwordx4 v[148:151], v1, s[4:7], s49 offen offset:256 sc1
  buffer_load_dwordx4 v[152:155], v1, s[4:7], s49 offen offset:512 sc1
  buffer_load_dwordx4 v[156:159], v1, s[4:7], s49 offen offset:768 sc1
  s_mov_b32 s78, 1
L_fn_126:
  v_mul_f32 v192, 0x3b000000, v192
  v_sub_f32 v176, v176, v192
  v_sub_f32 v177, v177, v192
  v_sub_f32 v178, v178, v192
  v_sub_f32 v179, v179, v192
  v_sub_f32 v180, v180, v192
  v_sub_f32 v181, v181, v192
  v_sub_f32 v182, v182, v192
  v_sub_f32 v183, v183, v192
  v_sub_f32 v184, v184, v192
  v_sub_f32 v185, v185, v192
  v_sub_f32 v186, v186, v192
  v_sub_f32 v187, v187, v192
  v_sub_f32 v188, v188, v192
  v_sub_f32 v189, v189, v192
  v_sub_f32 v190, v190, v192
  v_sub_f32 v191, v191, v192
  v_mul_f32 v192, v176, v176
  v_mul_f32 v193, v177, v177
  v_fmac_f32 v192, v178, v178
  v_fmac_f32 v193, v179, v179
  v_fmac_f32 v192, v180, v180
  v_fmac_f32 v193, v181, v181
  v_fmac_f32 v192, v182, v182
  v_fmac_f32 v193, v183, v183
  v_fmac_f32 v192, v184, v184
  v_fmac_f32 v193, v185, v185
  v_fmac_f32 v192, v186, v186
  v_fmac_f32 v193, v187, v187
  v_fmac_f32 v192, v188, v188
  v_fmac_f32 v193, v189, v189
  v_fmac_f32 v192, v190, v190
  v_fmac_f32 v193, v191, v191
  v_add_f32 v192, v192, v193
  s_nop 1
  v_add_f32_dpp v192, v192, v192 row_ror:8 row_mask:0xf bank_mask:0xf
  v_mov_b32 v193, v192
  s_nop 1
  v_permlane16_swap_b32 v192, v193
  v_add_f32 v192, v192, v193
  v_mov_b32 v193, v192
  s_nop 1
  v_permlane32_swap_b32 v192, v193
  v_add_f32 v192, v192, v193
  ds_write_b32 v4, v192 offset:1024
  s_waitcnt lgkmcnt(0)
  s_barrier
  ds_read_b32 v192, v5 offset:1024
  ds_read_b32 v193, v5 offset:1280
  ds_read_b32 v194, v5 offset:1536
  ds_read_b32 v195, v5 offset:1792
  s_waitcnt lgkmcnt(0)
  v_add_f32 v192, v192, v193
  v_add_f32 v194, v194, v195
  v_add_f32 v192, v192, v194
  v_mov_b32 v193, 0x3727c5ac
  v_fmac_f32 v193, 0x3b000000, v192
  v_rsq_f32 v192, v193
  s_nop 0
  v_mul_f32 v176, v176, v192
  v_mul_f32 v177, v177, v192
  v_mul_f32 v178, v178, v192
  v_mul_f32 v179, v179, v192
  v_mul_f32 v180, v180, v192
  v_mul_f32 v181, v181, v192
  v_mul_f32 v182, v182, v192
  v_mul_f32 v183, v183, v192
  v_mul_f32 v184, v184, v192
  v_mul_f32 v185, v185, v192
  v_mul_f32 v186, v186, v192
  v_mul_f32 v187, v187, v192
  v_mul_f32 v188, v188, v192
  v_mul_f32 v189, v189, v192
  v_mul_f32 v190, v190, v192
  v_mul_f32 v191, v191, v192
  v_cvt_pk_bf16_f32 v80, v176, v177
  v_cvt_pk_bf16_f32 v81, v178, v179
  v_cvt_pk_bf16_f32 v82, v180, v181
  v_cvt_pk_bf16_f32 v83, v182, v183
  v_cvt_pk_bf16_f32 v84, v184, v185
  v_cvt_pk_bf16_f32 v85, v186, v187
  v_cvt_pk_bf16_f32 v86, v188, v189
  v_cvt_pk_bf16_f32 v87, v190, v191
  buffer_store_dwordx4 v[80:83], v3, s[4:7], s71 offen sc1
  buffer_store_dwordx4 v[84:87], v3, s[4:7], s71 offen offset:256 sc1
  s_mov_b32 s76, s72
  s_cmp_eq_u32 s78, 1
  s_cbranch_scc1 L_fgo_128
  s_waitcnt vmcnt(0)
  s_barrier
  v_mov_b32 v10, s76
  v_mov_b32 v11, 1
  s_mov_b64 exec, s[80:81]
  buffer_store_dword v11, v10, s[4:7], 0 offen sc1
  s_mov_b64 exec, -1
  s_mov_b32 s76, 0x128000
  s_cmp_ge_u32 s66, 256
  s_cbranch_scc1 L_f3_l0_fin
L_wn_129:
  v_and_b32 v6, 63, v0
  v_lshlrev_b32 v6, 2, v6
  v_add_u32 v6, s69, v6
  s_mov_b64 exec, 0xffff
  buffer_load_dword v7, v6, s[4:7], 0 offen sc1
  s_mov_b64 exec, -1
  s_waitcnt vmcnt(0)
  v_cmp_ne_u32 vcc, 0, v7
  s_and_b32 s45, vcc_lo, 0xffff
  s_cmp_eq_u32 s45, 0xffff
  s_cselect_b32 s45, 1, 0
  s_cmp_eq_u32 s45, 1
  s_cbranch_scc1 L_wnd_130
  s_sub_u32 s64, s64, 1
  s_cbranch_scc1 L_abort
  s_sleep 4
  s_branch L_wn_129
L_wnd_130:
  buffer_load_dwordx4 v[160:163], v2, s[8:11], s68 offen sc1
  buffer_load_dwordx4 v[164:167], v2, s[8:11], s68 offen offset:16 sc1
  buffer_load_dwordx4 v[96:99], v1, s[4:7], s67 offen offset:0 sc1
  buffer_load_dwordx4 v[100:103], v1, s[4:7], s67 offen offset:256 sc1
  buffer_load_dwordx4 v[104:107], v1, s[4:7], s67 offen offset:512 sc1
  buffer_load_dwordx4 v[108:111], v1, s[4:7], s67 offen offset:768 sc1
  s_add_u32 s49, s67, 65536
  buffer_load_dwordx4 v[112:115], v1, s[4:7], s49 offen offset:0 sc1
  buffer_load_dwordx4 v[116:119], v1, s[4:7], s49 offen offset:256 sc1
  buffer_load_dwordx4 v[120:123], v1, s[4:7], s49 offen offset:512 sc1
  buffer_load_dwordx4 v[124:127], v1, s[4:7], s49 offen offset:768 sc1
  s_add_u32 s49, s67, 131072
  buffer_load_dwordx4 v[128:131], v1, s[4:7], s49 offen offset:0 sc1
  buffer_load_dwordx4 v[132:135], v1, s[4:7], s49 offen offset:256 sc1
  buffer_load_dwordx4 v[136:139], v1, s[4:7], s49 offen offset:512 sc1
  buffer_load_dwordx4 v[140:143], v1, s[4:7], s49 offen offset:768 sc1
  s_add_u32 s49, s67, 196608
  buffer_load_dwordx4 v[144:147], v1, s[4:7], s49 offen offset:0 sc1
  buffer_load_dwordx4 v[148:151], v1, s[4:7], s49 offen offset:256 sc1
  buffer_load_dwordx4 v[152:155], v1, s[4:7], s49 offen offset:512 sc1
  buffer_load_dwordx4 v[156:159], v1, s[4:7], s49 offen offset:768 sc1
L_fgo_128:
  s_mov_b32 s70, s73
  s_mov_b32 s71, s74
  s_mov_b32 s72, s75
  s_add_u32 s66, s66, 6
  s_lshr_b32 s45, s66, 2
  s_and_b32 s46, s66, 3
  s_mul_i32 s47, s45, 0x40000
  s_lshr_b32 s48, s46, 1
  s_lshl_b32 s49, s48, 10
  s_add_u32 s47, s47, s49
  s_and_b32 s49, s46, 1
  s_lshl_b32 s49, s49, 7
  s_add_u32 s47, s47, s49
  s_add_u32 s67, s47, 0x8000000
  s_lshl_b32 s47, s66, 13
  s_add_u32 s68, s47, 0x0
  s_add_u32 s73, s47, 0x5a00000
  s_lshl_b32 s47, s45, 7
  s_add_u32 s69, s47, 0x114000
  s_lshl_b32 s48, s48, 14
  s_add_u32 s48, s48, s49
  s_lshl_b32 s49, s45, 15
  s_add_u32 s48, s48, s49
  s_add_u32 s74, s48, 0x5600000
  s_lshl_b32 s46, s46, 2
  s_add_u32 s46, s46, s47
  s_add_u32 s75, s46, 0x118000
  s_waitcnt vmcnt(0)
  v_and_b32 v6, 63, v0
  v_lshlrev_b32 v6, 2, v6
  v_add_u32 v6, s69, v6
  s_mov_b64 exec, 0xffff
  buffer_load_dword v7, v6, s[4:7], 0 offen sc1
  s_mov_b64 exec, -1
  s_barrier
  v_mov_b32 v10, s76
  v_mov_b32 v11, 1
  s_mov_b64 exec, s[80:81]
  buffer_store_dword v11, v10, s[4:7], 0 offen sc1
  s_mov_b64 exec, -1
  s_mov_b32 s76, 0x128000
  s_mov_b32 s49, 0xffff0000
  v_lshlrev_b32 v176, 16, v160
  v_and_b32 v177, s49, v160
  v_lshlrev_b32 v178, 16, v161
  v_and_b32 v179, s49, v161
  v_lshlrev_b32 v180, 16, v162
  v_and_b32 v181, s49, v162
  v_lshlrev_b32 v182, 16, v163
  v_and_b32 v183, s49, v163
  v_lshlrev_b32 v184, 16, v164
  v_and_b32 v185, s49, v164
  v_lshlrev_b32 v186, 16, v165
  v_and_b32 v187, s49, v165
  v_lshlrev_b32 v188, 16, v166
  v_and_b32 v189, s49, v166
  v_lshlrev_b32 v190, 16, v167
  v_and_b32 v191, s49, v167
  v_add_f32 v176, v176, v96
  v_add_f32 v177, v177, v97
  v_add_f32 v178, v178, v98
  v_add_f32 v179, v179, v99
  v_add_f32 v180, v180, v100
  v_add_f32 v181, v181, v101
  v_add_f32 v182, v182, v102
  v_add_f32 v183, v183, v103
  v_add_f32 v184, v184, v104
  v_add_f32 v185, v185, v105
  v_add_f32 v186, v186, v106
  v_add_f32 v187, v187, v107
  v_add_f32 v188, v188, v108
  v_add_f32 v189, v189, v109
  v_add_f32 v190, v190, v110
  v_add_f32 v191, v191, v111
  v_add_f32 v176, v176, v112
  v_add_f32 v177, v177, v113
  v_add_f32 v178, v178, v114
  v_add_f32 v179, v179, v115
  v_add_f32 v180, v180, v116
  v_add_f32 v181, v181, v117
  v_add_f32 v182, v182, v118
  v_add_f32 v183, v183, v119
  v_add_f32 v184, v184, v120
  v_add_f32 v185, v185, v121
  v_add_f32 v186, v186, v122
  v_add_f32 v187, v187, v123
  v_add_f32 v188, v188, v124
  v_add_f32 v189, v189, v125
  v_add_f32 v190, v190, v126
  v_add_f32 v191, v191, v127
  v_add_f32 v176, v176, v128
  v_add_f32 v177, v177, v129
  v_add_f32 v178, v178, v130
  v_add_f32 v179, v179, v131
  v_add_f32 v180, v180, v132
  v_add_f32 v181, v181, v133
  v_add_f32 v182, v182, v134
  v_add_f32 v183, v183, v135
  v_add_f32 v184, v184, v136
  v_add_f32 v185, v185, v137
  v_add_f32 v186, v186, v138
  v_add_f32 v187, v187, v139
  v_add_f32 v188, v188, v140
  v_add_f32 v189, v189, v141
  v_add_f32 v190, v190, v142
  v_add_f32 v191, v191, v143
  v_add_f32 v176, v176, v144
  v_add_f32 v177, v177, v145
  v_add_f32 v178, v178, v146
  v_add_f32 v179, v179, v147
  v_add_f32 v180, v180, v148
  v_add_f32 v181, v181, v149
  v_add_f32 v182, v182, v150
  v_add_f32 v183, v183, v151
  v_add_f32 v184, v184, v152
  v_add_f32 v185, v185, v153
  v_add_f32 v186, v186, v154
  v_add_f32 v187, v187, v155
  v_add_f32 v188, v188, v156
  v_add_f32 v189, v189, v157
  v_add_f32 v190, v190, v158
  v_add_f32 v191, v191, v159
  v_cvt_pk_bf16_f32 v160, v176, v177
  v_cvt_pk_bf16_f32 v161, v178, v179
  v_cvt_pk_bf16_f32 v162, v180, v181
  v_cvt_pk_bf16_f32 v163, v182, v183
  v_cvt_pk_bf16_f32 v164, v184, v185
  v_cvt_pk_bf16_f32 v165, v186, v187
  v_cvt_pk_bf16_f32 v166, v188, v189
  v_cvt_pk_bf16_f32 v167, v190, v191
  buffer_store_dwordx4 v[160:163], v8, s[4:7], s70 offen sc1
  buffer_store_dwordx4 v[164:167], v9, s[4:7], s70 offen sc1
  v_lshlrev_b32 v176, 16, v160
  v_and_b32 v177, s49, v160
  v_lshlrev_b32 v178, 16, v161
  v_and_b32 v179, s49, v161
  v_lshlrev_b32 v180, 16, v162
  v_and_b32 v181, s49, v162
  v_lshlrev_b32 v182, 16, v163
  v_and_b32 v183, s49, v163
  v_lshlrev_b32 v184, 16, v164
  v_and_b32 v185, s49, v164
  v_lshlrev_b32 v186, 16, v165
  v_and_b32 v187, s49, v165
  v_lshlrev_b32 v188, 16, v166
  v_and_b32 v189, s49, v166
  v_lshlrev_b32 v190, 16, v167
  v_and_b32 v191, s49, v167
  v_add_f32 v192, v176, v177
  v_add_f32 v193, v178, v179
  v_add_f32 v192, v192, v180
  v_add_f32 v193, v193, v181
  v_add_f32 v192, v192, v182
  v_add_f32 v193, v193, v183
  v_add_f32 v192, v192, v184
  v_add_f32 v193, v193, v185
  v_add_f32 v192, v192, v186
  v_add_f32 v193, v193, v187
  v_add_f32 v192, v192, v188
  v_add_f32 v193, v193, v189
  v_add_f32 v192, v192, v190
  v_add_f32 v193, v193, v191
  v_add_f32 v192, v192, v193
  s_nop 1
  v_add_f32_dpp v192, v192, v192 row_ror:8 row_mask:0xf bank_mask:0xf
  v_mov_b32 v193, v192
  s_nop 1
  v_permlane16_swap_b32 v192, v193
  v_add_f32 v192, v192, v193
  v_mov_b32 v193, v192
  s_nop 1
  v_permlane32_swap_b32 v192, v193
  v_add_f32 v192, v192, v193
  ds_write_b32 v4, v192 offset:0
  s_waitcnt vmcnt(3)
  v_mov_b32 v10, 0x1000
  v_cmp_ne_u32 vcc, 0, v7
  s_and_b32 s77, vcc_lo, 0xffff
  s_cmp_eq_u32 s77, 0xffff
  s_cselect_b32 s77, 1, 0
  v_mov_b32 v7, s77
  s_cmp_eq_u32 s16, 0
  s_cbranch_scc0 L_fw_131
  s_mov_b64 exec, 1
  ds_write_b32 v10, v7
  s_mov_b64 exec, -1
L_fw_131:
  s_waitcnt lgkmcnt(0)
  s_barrier
  ds_read_b32 v192, v5 offset:0
  ds_read_b32 v193, v5 offset:256
  ds_read_b32 v194, v5 offset:512
  ds_read_b32 v195, v5 offset:768
  s_waitcnt lgkmcnt(0)
  v_add_f32 v192, v192, v193
  v_add_f32 v194, v194, v195
  v_add_f32 v192, v192, v194
  ds_read_b32 v7, v10
  s_waitcnt lgkmcnt(0)
  v_readfirstlane_b32 s77, v7
  s_mov_b32 s78, 0
  s_cmp_lt_u32 s66, 256
  s_cbranch_scc0 L_fn_132
  s_cmp_eq_u32 s77, 1
  s_cbranch_scc0 L_fn_132
  buffer_load_dwordx4 v[80:83], v2, s[8:11], s68 offen sc1
  buffer_load_dwordx4 v[84:87], v2, s[8:11], s68 offen offset:16 sc1
  buffer_load_dwordx4 v[16:19], v1, s[4:7], s67 offen offset:0 sc1
  buffer_load_dwordx4 v[20:23], v1, s[4:7], s67 offen offset:256 sc1
  buffer_load_dwordx4 v[24:27], v1, s[4:7], s67 offen offset:512 sc1
  buffer_load_dwordx4 v[28:31], v1, s[4:7], s67 offen offset:768 sc1
  s_add_u32 s49, s67, 65536
  buffer_load_dwordx4 v[32:35], v1, s[4:7], s49 offen offset:0 sc1
  buffer_load_dwordx4 v[36:39], v1, s[4:7], s49 offen offset:256 sc1
  buffer_load_dwordx4 v[40:43], v1, s[4:7], s49 offen offset:512 sc1
  buffer_load_dwordx4 v[44:47], v1, s[4:7], s49 offen offset:768 sc1
  s_add_u32 s49, s67, 131072
  buffer_load_dwordx4 v[48:51], v1, s[4:7], s49 offen offset:0 sc1
  buffer_load_dwordx4 v[52:55], v1, s[4:7], s49 offen offset:256 sc1
  buffer_load_dwordx4 v[56:59], v1, s[4:7], s49 offen offset:512 sc1
  buffer_load_dwordx4 v[60:63], v1, s[4:7], s49 offen offset:768 sc1
  s_add_u32 s49, s67, 196608
  buffer_load_dwordx4 v[64:67], v1, s[4:7], s49 offen offset:0 sc1
  buffer_load_dwordx4 v[68:71], v1, s[4:7], s49 offen offset:256 sc1
  buffer_load_dwordx4 v[72:75], v1, s[4:7], s49 offen offset:512 sc1
  buffer_load_dwordx4 v[76:79], v1, s[4:7], s49 offen offset:768 sc1
  s_mov_b32 s78, 1
L_fn_132:
  v_mul_f32 v192, 0x3b000000, v192
  v_sub_f32 v176, v176, v192
  v_sub_f32 v177, v177, v192
  v_sub_f32 v178, v178, v192
  v_sub_f32 v179, v179, v192
  v_sub_f32 v180, v180, v192
  v_sub_f32 v181, v181, v192
  v_sub_f32 v182, v182, v192
  v_sub_f32 v183, v183, v192
  v_sub_f32 v184, v184, v192
  v_sub_f32 v185, v185, v192
  v_sub_f32 v186, v186, v192
  v_sub_f32 v187, v187, v192
  v_sub_f32 v188, v188, v192
  v_sub_f32 v189, v189, v192
  v_sub_f32 v190, v190, v192
  v_sub_f32 v191, v191, v192
  v_mul_f32 v192, v176, v176
  v_mul_f32 v193, v177, v177
  v_fmac_f32 v192, v178, v178
  v_fmac_f32 v193, v179, v179
  v_fmac_f32 v192, v180, v180
  v_fmac_f32 v193, v181, v181
  v_fmac_f32 v192, v182, v182
  v_fmac_f32 v193, v183, v183
  v_fmac_f32 v192, v184, v184
  v_fmac_f32 v193, v185, v185
  v_fmac_f32 v192, v186, v186
  v_fmac_f32 v193, v187, v187
  v_fmac_f32 v192, v188, v188
  v_fmac_f32 v193, v189, v189
  v_fmac_f32 v192, v190, v190
  v_fmac_f32 v193, v191, v191
  v_add_f32 v192, v192, v193
  s_nop 1
  v_add_f32_dpp v192, v192, v192 row_ror:8 row_mask:0xf bank_mask:0xf
  v_mov_b32 v193, v192
  s_nop 1
  v_permlane16_swap_b32 v192, v193
  v_add_f32 v192, v192, v193
  v_mov_b32 v193, v192
  s_nop 1
  v_permlane32_swap_b32 v192, v193
  v_add_f32 v192, v192, v193
  ds_write_b32 v4, v192 offset:1024
  s_waitcnt lgkmcnt(0)
  s_barrier
  ds_read_b32 v192, v5 offset:1024
  ds_read_b32 v193, v5 offset:1280
  ds_read_b32 v194, v5 offset:1536
  ds_read_b32 v195, v5 offset:1792
  s_waitcnt lgkmcnt(0)
  v_add_f32 v192, v192, v193
  v_add_f32 v194, v194, v195
  v_add_f32 v192, v192, v194
  v_mov_b32 v193, 0x3727c5ac
  v_fmac_f32 v193, 0x3b000000, v192
  v_rsq_f32 v192, v193
  s_nop 0
  v_mul_f32 v176, v176, v192
  v_mul_f32 v177, v177, v192
  v_mul_f32 v178, v178, v192
  v_mul_f32 v179, v179, v192
  v_mul_f32 v180, v180, v192
  v_mul_f32 v181, v181, v192
  v_mul_f32 v182, v182, v192
  v_mul_f32 v183, v183, v192
  v_mul_f32 v184, v184, v192
  v_mul_f32 v185, v185, v192
  v_mul_f32 v186, v186, v192
  v_mul_f32 v187, v187, v192
  v_mul_f32 v188, v188, v192
  v_mul_f32 v189, v189, v192
  v_mul_f32 v190, v190, v192
  v_mul_f32 v191, v191, v192
  v_cvt_pk_bf16_f32 v160, v176, v177
  v_cvt_pk_bf16_f32 v161, v178, v179
  v_cvt_pk_bf16_f32 v162, v180, v181
  v_cvt_pk_bf16_f32 v163, v182, v183
  v_cvt_pk_bf16_f32 v164, v184, v185
  v_cvt_pk_bf16_f32 v165, v186, v187
  v_cvt_pk_bf16_f32 v166, v188, v189
  v_cvt_pk_bf16_f32 v167, v190, v191
  buffer_store_dwordx4 v[160:163], v3, s[4:7], s71 offen sc1
  buffer_store_dwordx4 v[164:167], v3, s[4:7], s71 offen offset:256 sc1
  s_mov_b32 s76, s72
  s_cmp_eq_u32 s78, 1
  s_cbranch_scc1 L_fgo_134
  s_waitcnt vmcnt(0)
  s_barrier
  v_mov_b32 v10, s76
  v_mov_b32 v11, 1
  s_mov_b64 exec, s[80:81]
  buffer_store_dword v11, v10, s[4:7], 0 offen sc1
  s_mov_b64 exec, -1
  s_mov_b32 s76, 0x128000
  s_cmp_ge_u32 s66, 256
  s_cbranch_scc1 L_f3_l0_fin
L_wn_135:
  v_and_b32 v6, 63, v0
  v_lshlrev_b32 v6, 2, v6
  v_add_u32 v6, s69, v6
  s_mov_b64 exec, 0xffff
  buffer_load_dword v7, v6, s[4:7], 0 offen sc1
  s_mov_b64 exec, -1
  s_waitcnt vmcnt(0)
  v_cmp_ne_u32 vcc, 0, v7
  s_and_b32 s45, vcc_lo, 0xffff
  s_cmp_eq_u32 s45, 0xffff
  s_cselect_b32 s45, 1, 0
  s_cmp_eq_u32 s45, 1
  s_cbranch_scc1 L_wnd_136
  s_sub_u32 s64, s64, 1
  s_cbranch_scc1 L_abort
  s_sleep 4
  s_branch L_wn_135
L_wnd_136:
  buffer_load_dwordx4 v[80:83], v2, s[8:11], s68 offen sc1
  buffer_load_dwordx4 v[84:87], v2, s[8:11], s68 offen offset:16 sc1
  buffer_load_dwordx4 v[16:19], v1, s[4:7], s67 offen offset:0 sc1
  buffer_load_dwordx4 v[20:23], v1, s[4:7], s67 offen offset:256 sc1
  buffer_load_dwordx4 v[24:27], v1, s[4:7], s67 offen offset:512 sc1
  buffer_load_dwordx4 v[28:31], v1, s[4:7], s67 offen offset:768 sc1
  s_add_u32 s49, s67, 65536
  buffer_load_dwordx4 v[32:35], v1, s[4:7], s49 offen offset:0 sc1
  buffer_load_dwordx4 v[36:39], v1, s[4:7], s49 offen offset:256 sc1
  buffer_load_dwordx4 v[40:43], v1, s[4:7], s49 offen offset:512 sc1
  buffer_load_dwordx4 v[44:47], v1, s[4:7], s49 offen offset:768 sc1
  s_add_u32 s49, s67, 131072
  buffer_load_dwordx4 v[48:51], v1, s[4:7], s49 offen offset:0 sc1
  buffer_load_dwordx4 v[52:55], v1, s[4:7], s49 offen offset:256 sc1
  buffer_load_dwordx4 v[56:59], v1, s[4:7], s49 offen offset:512 sc1
  buffer_load_dwordx4 v[60:63], v1, s[4:7], s49 offen offset:768 sc1
  s_add_u32 s49, s67, 196608
  buffer_load_dwordx4 v[64:67], v1, s[4:7], s49 offen offset:0 sc1
  buffer_load_dwordx4 v[68:71], v1, s[4:7], s49 offen offset:256 sc1
  buffer_load_dwordx4 v[72:75], v1, s[4:7], s49 offen offset:512 sc1
  buffer_load_dwordx4 v[76:79], v1, s[4:7], s49 offen offset:768 sc1
L_fgo_134:
  s_branch L_f3_l0
L_f3_l0_fin:
  s_waitcnt vmcnt(0)
  s_branch L_end
L_f1_122:
  s_mov_b32 s66, s17
  s_mov_b32 s76, 0x128000
  s_cmp_eq_u32 s16, 0
  s_cselect_b32 s80, 1, 0
  s_mov_b32 s81, 0
  s_mov_b32 s65, 0
  s_lshr_b32 s45, s66, 2
  s_and_b32 s46, s66, 3
  s_mul_i32 s47, s45, 0x40000
  s_lshr_b32 s48, s46, 1
  s_lshl_b32 s49, s48, 10
  s_add_u32 s47, s47, s49
  s_and_b32 s49, s46, 1
  s_lshl_b32 s49, s49, 7
  s_add_u32 s47, s47, s49
  s_add_u32 s67, s47, 0x9000000
  s_lshl_b32 s47, s66, 13
  s_add_u32 s68, s47, 0x5e00000
  s_add_u32 s73, s47, 0x5c00000
  s_lshl_b32 s47, s45, 7
  s_add_u32 s69, s47, 0x116000
  s_lshl_b32 s48, s48, 14
  s_add_u32 s48, s48, s49
  s_lshl_b32 s49, s45, 15
  s_add_u32 s48, s48, s49
  s_add_u32 s74, s48, 0x5800000
  s_lshl_b32 s46, s46, 2
  s_add_u32 s46, s46, s47
  s_add_u32 s75, s46, 0x11a000
L_wn_137:
  v_and_b32 v6, 63, v0
  v_lshlrev_b32 v6, 2, v6
  v_add_u32 v6, s69, v6
  s_mov_b64 exec, 0xffff
  buffer_load_dword v7, v6, s[4:7], 0 offen sc1
  s_mov_b64 exec, -1
  s_waitcnt vmcnt(0)
  v_cmp_ne_u32 vcc, 0, v7
  s_and_b32 s45, vcc_lo, 0xffff
  s_cmp_eq_u32 s45, 0xffff
  s_cselect_b32 s45, 1, 0
  s_cmp_eq_u32 s45, 1
  s_cbranch_scc1 L_wnd_138
  s_sub_u32 s64, s64, 1
  s_cbranch_scc1 L_abort
  s_sleep 16
  s_branch L_wn_137
L_wnd_138:
  buffer_load_dwordx4 v[80:83], v8, s[4:7], s68 offen sc1
  buffer_load_dwordx4 v[84:87], v9, s[4:7], s68 offen sc1
  buffer_load_dwordx4 v[16:19], v1, s[4:7], s67 offen offset:0 sc1
  buffer_load_dwordx4 v[20:23], v1, s[4:7], s67 offen offset:256 sc1
  buffer_load_dwordx4 v[24:27], v1, s[4:7], s67 offen offset:512 sc1
  buffer_load_dwordx4 v[28:31], v1, s[4:7], s67 offen offset:768 sc1
  s_add_u32 s49, s67, 65536
  buffer_load_dwordx4 v[32:35], v1, s[4:7], s49 offen offset:0 sc1
  buffer_load_dwordx4 v[36:39], v1, s[4:7], s49 offen offset:256 sc1
  buffer_load_dwordx4 v[40:43], v1, s[4:7], s49 offen offset:512 sc1
  buffer_load_dwordx4 v[44:47], v1, s[4:7], s49 offen offset:768 sc1
  s_add_u32 s49, s67, 131072
  buffer_load_dwordx4 v[48:51], v1, s[4:7], s49 offen offset:0 sc1
  buffer_load_dwordx4 v[52:55], v1, s[4:7], s49 offen offset:256 sc1
  buffer_load_dwordx4 v[56:59], v1, s[4:7], s49 offen offset:512 sc1
  buffer_load_dwordx4 v[60:63], v1, s[4:7], s49 offen offset:768 sc1
  s_add_u32 s49, s67, 196608
  buffer_load_dwordx4 v[64:67], v1, s[4:7], s49 offen offset:0 sc1
  buffer_load_dwordx4 v[68:71], v1, s[4:7], s49 offen offset:256 sc1
  buffer_load_dwordx4 v[72:75], v1, s[4:7], s49 offen offset:512 sc1
  buffer_load_dwordx4 v[76:79], v1, s[4:7], s49 offen offset:768 sc1
L_f3_l1:
  s_mov_b32 s70, s73
  s_mov_b32 s71, s74
  s_mov_b32 s72, s75
  s_add_u32 s66, s66, 6
  s_lshr_b32 s45, s66, 2
  s_and_b32 s46, s66, 3
  s_mul_i32 s47, s45, 0x40000
  s_lshr_b32 s48, s46, 1
  s_lshl_b32 s49, s48, 10
  s_add_u32 s47, s47, s49
  s_and_b32 s49, s46, 1
  s_lshl_b32 s49, s49, 7
  s_add_u32 s47, s47, s49
  s_add_u32 s67, s47, 0x9000000
  s_lshl_b32 s47, s66, 13
  s_add_u32 s68, s47, 0x5e00000
  s_add_u32 s73, s47, 0x5c00000
  s_lshl_b32 s47, s45, 7
  s_add_u32 s69, s47, 0x116000
  s_lshl_b32 s48, s48, 14
  s_add_u32 s48, s48, s49
  s_lshl_b32 s49, s45, 15
  s_add_u32 s48, s48, s49
  s_add_u32 s74, s48, 0x5800000
  s_lshl_b32 s46, s46, 2
  s_add_u32 s46, s46, s47
  s_add_u32 s75, s46, 0x11a000
  s_waitcnt vmcnt(0)
  v_and_b32 v6, 63, v0
  v_lshlrev_b32 v6, 2, v6
  v_add_u32 v6, s69, v6
  s_mov_b64 exec, 0xffff
  buffer_load_dword v7, v6, s[4:7], 0 offen sc1
  s_mov_b64 exec, -1
  s_barrier
  v_mov_b32 v10, s76
  v_mov_b32 v11, 1
  s_mov_b64 exec, s[80:81]
  buffer_store_dword v11, v10, s[4:7], 0 offen sc1
  s_mov_b64 exec, -1
  s_mov_b32 s76, 0x128000
  s_mov_b32 s49, 0xffff0000
  v_lshlrev_b32 v176, 16, v80
  v_and_b32 v177, s49, v80
  v_lshlrev_b32 v178, 16, v81
  v_and_b32 v179, s49, v81
  v_lshlrev_b32 v180, 16, v82
  v_and_b32 v181, s49, v82
  v_lshlrev_b32 v182, 16, v83
  v_and_b32 v183, s49, v83
  v_lshlrev_b32 v184, 16, v84
  v_and_b32 v185, s49, v84
  v_lshlrev_b32 v186, 16, v85
  v_and_b32 v187, s49, v85
  v_lshlrev_b32 v188, 16, v86
  v_and_b32 v189, s49, v86
  v_lshlrev_b32 v190, 16, v87
  v_and_b32 v191, s49, v87
  v_add_f32 v176, v176, v16
  v_add_f32 v177, v177, v17
  v_add_f32 v178, v178, v18
  v_add_f32 v179, v179, v19
  v_add_f32 v180, v180, v20
  v_add_f32 v181, v181, v21
  v_add_f32 v182, v182, v22
  v_add_f32 v183, v183, v23
  v_add_f32 v184, v184, v24
  v_add_f32 v185, v185, v25
  v_add_f32 v186, v186, v26
  v_add_f32 v187, v187, v27
  v_add_f32 v188, v188, v28
  v_add_f32 v189, v189, v29
  v_add_f32 v190, v190, v30
  v_add_f32 v191, v191, v31
  v_add_f32 v176, v176, v32
  v_add_f32 v177, v177, v33
  v_add_f32 v178, v178, v34
  v_add_f32 v179, v179, v35
  v_add_f32 v180, v180, v36
  v_add_f32 v181, v181, v37
  v_add_f32 v182, v182, v38
  v_add_f32 v183, v183, v39
  v_add_f32 v184, v184, v40
  v_add_f32 v185, v185, v41
  v_add_f32 v186, v186, v42
  v_add_f32 v187, v187, v43
  v_add_f32 v188, v188, v44
  v_add_f32 v189, v189, v45
  v_add_f32 v190, v190, v46
  v_add_f32 v191, v191, v47
  v_add_f32 v176, v176, v48
  v_add_f32 v177, v177, v49
  v_add_f32 v178, v178, v50
  v_add_f32 v179, v179, v51
  v_add_f32 v180, v180, v52
  v_add_f32 v181, v181, v53
  v_add_f32 v182, v182, v54
  v_add_f32 v183, v183, v55
  v_add_f32 v184, v184, v56
  v_add_f32 v185, v185, v57
  v_add_f32 v186, v186, v58
  v_add_f32 v187, v187, v59
  v_add_f32 v188, v188, v60
  v_add_f32 v189, v189, v61
  v_add_f32 v190, v190, v62
  v_add_f32 v191, v191, v63
  v_add_f32 v176, v176, v64
  v_add_f32 v177, v177, v65
  v_add_f32 v178, v178, v66
  v_add_f32 v179, v179, v67
  v_add_f32 v180, v180, v68
  v_add_f32 v181, v181, v69
  v_add_f32 v182, v182, v70
  v_add_f32 v183, v183, v71
  v_add_f32 v184, v184, v72
  v_add_f32 v185, v185, v73
  v_add_f32 v186, v186, v74
  v_add_f32 v187, v187, v75
  v_add_f32 v188, v188, v76
  v_add_f32 v189, v189, v77
  v_add_f32 v190, v190, v78
  v_add_f32 v191, v191, v79
  v_cvt_pk_bf16_f32 v80, v176, v177
  v_cvt_pk_bf16_f32 v81, v178, v179
  v_cvt_pk_bf16_f32 v82, v180, v181
  v_cvt_pk_bf16_f32 v83, v182, v183
  v_cvt_pk_bf16_f32 v84, v184, v185
  v_cvt_pk_bf16_f32 v85, v186, v187
  v_cvt_pk_bf16_f32 v86, v188, v189
  v_cvt_pk_bf16_f32 v87, v190, v191
  buffer_store_dwordx4 v[80:83], v8, s[4:7], s70 offen sc1
  buffer_store_dwordx4 v[84:87], v9, s[4:7], s70 offen sc1
  v_lshlrev_b32 v176, 16, v80
  v_and_b32 v177, s49, v80
  v_lshlrev_b32 v178, 16, v81
  v_and_b32 v179, s49, v81
  v_lshlrev_b32 v180, 16, v82
  v_and_b32 v181, s49, v82
  v_lshlrev_b32 v182, 16, v83
  v_and_b32 v183, s49, v83
  v_lshlrev_b32 v184, 16, v84
  v_and_b32 v185, s49, v84
  v_lshlrev_b32 v186, 16, v85
  v_and_b32 v187, s49, v85
  v_lshlrev_b32 v188, 16, v86
  v_and_b32 v189, s49, v86
  v_lshlrev_b32 v190, 16, v87
  v_and_b32 v191, s49, v87
  v_add_f32 v192, v176, v177
  v_add_f32 v193, v178, v179
  v_add_f32 v192, v192, v180
  v_add_f32 v193, v193, v181
  v_add_f32 v192, v192, v182
  v_add_f32 v193, v193, v183
  v_add_f32 v192, v192, v184
  v_add_f32 v193, v193, v185
  v_add_f32 v192, v192, v186
  v_add_f32 v193, v193, v187
  v_add_f32 v192, v192, v188
  v_add_f32 v193, v193, v189
  v_add_f32 v192, v192, v190
  v_add_f32 v193, v193, v191
  v_add_f32 v192, v192, v193
  s_nop 1
  v_add_f32_dpp v192, v192, v192 row_ror:8 row_mask:0xf bank_mask:0xf
  v_mov_b32 v193, v192
  s_nop 1
  v_permlane16_swap_b32 v192, v193
  v_add_f32 v192, v192, v193
  v_mov_b32 v193, v192
  s_nop 1
  v_permlane32_swap_b32 v192, v193
  v_add_f32 v192, v192, v193
  ds_write_b32 v4, v192 offset:0
  s_waitcnt vmcnt(3)
  v_mov_b32 v10, 0x1000
  v_cmp_ne_u32 vcc, 0, v7
  s_and_b32 s77, vcc_lo, 0xffff
  s_cmp_eq_u32 s77, 0xffff
  s_cselect_b32 s77, 1, 0
  v_mov_b32 v7, s77
  s_cmp_eq_u32 s16, 0
  s_cbranch_scc0 L_fw_139
  s_mov_b64 exec, 1
  ds_write_b32 v10, v7
  s_mov_b64 exec, -1
L_fw_139:
  s_waitcnt lgkmcnt(0)
  s_barrier
  ds_read_b32 v192, v5 offset:0
  ds_read_b32 v193, v5 offset:256
  ds_read_b32 v194, v5 offset:512
  ds_read_b32 v195, v5 offset:768
  s_waitcnt lgkmcnt(0)
  v_add_f32 v192, v192, v193
  v_add_f32 v194, v194, v195
  v_add_f32 v192, v192, v194
  ds_read_b32 v7, v10
  s_waitcnt lgkmcnt(0)
  v_readfirstlane_b32 s77, v7
  s_mov_b32 s78, 0
  s_cmp_lt_u32 s66, 256
  s_cbranch_scc0 L_fn_140
  s_cmp_eq_u32 s77, 1
  s_cbranch_scc0 L_fn_140
  buffer_load_dwordx4 v[160:163], v8, s[4:7], s68 offen sc1
  buffer_load_dwordx4 v[164:167], v9, s[4:7], s68 offen sc1
  buffer_load_dwordx4 v[96:99], v1, s[4:7], s67 offen offset:0 sc1
  buffer_load_dwordx4 v[100:103], v1, s[4:7], s67 offen offset:256 sc1
  buffer_load_dwordx4 v[104:107], v1, s[4:7], s67 offen offset:512 sc1
  buffer_load_dwordx4 v[108:111], v1, s[4:7], s67 offen offset:768 sc1
  s_add_u32 s49, s67, 65536
  buffer_load_dwordx4 v[112:115], v1, s[4:7], s49 offen offset:0 sc1
  buffer_load_dwordx4 v[116:119], v1, s[4:7], s49 offen offset:256 sc1
  buffer_load_dwordx4 v[120:123], v1, s[4:7], s49 offen offset:512 sc1
  buffer_load_dwordx4 v[124:127], v1, s[4:7], s49 offen offset:768 sc1
  s_add_u32 s49, s67, 131072
  buffer_load_dwordx4 v[128:131], v1, s[4:7], s49 offen offset:0 sc1
  buffer_load_dwordx4 v[132:135], v1, s[4:7], s49 offen offset:256 sc1
  buffer_load_dwordx4 v[136:139], v1, s[4:7], s49 offen offset:512 sc1
  buffer_load_dwordx4 v[140:143], v1, s[4:7], s49 offen offset:768 sc1
  s_add_u32 s49, s67, 196608
  buffer_load_dwordx4 v[144:147], v1, s[4:7], s49 offen offset:0 sc1
  buffer_load_dwordx4 v[148:151], v1, s[4:7], s49 offen offset:256 sc1
  buffer_load_dwordx4 v[152:155], v1, s[4:7], s49 offen offset:512 sc1
  buffer_load_dwordx4 v[156:159], v1, s[4:7], s49 offen offset:768 sc1
  s_mov_b32 s78, 1
L_fn_140:
  v_mul_f32 v192, 0x3b000000, v192
  v_sub_f32 v176, v176, v192
  v_sub_f32 v177, v177, v192
  v_sub_f32 v178, v178, v192
  v_sub_f32 v179, v179, v192
  v_sub_f32 v180, v180, v192
  v_sub_f32 v181, v181, v192
  v_sub_f32 v182, v182, v192
  v_sub_f32 v183, v183, v192
  v_sub_f32 v184, v184, v192
  v_sub_f32 v185, v185, v192
  v_sub_f32 v186, v186, v192
  v_sub_f32 v187, v187, v192
  v_sub_f32 v188, v188, v192
  v_sub_f32 v189, v189, v192
  v_sub_f32 v190, v190, v192
  v_sub_f32 v191, v191, v192
  v_mul_f32 v192, v176, v176
  v_mul_f32 v193, v177, v177
  v_fmac_f32 v192, v178, v178
  v_fmac_f32 v193, v179, v179
  v_fmac_f32 v192, v180, v180
  v_fmac_f32 v193, v181, v181
  v_fmac_f32 v192, v182, v182
  v_fmac_f32 v193, v183, v183
  v_fmac_f32 v192, v184, v184
  v_fmac_f32 v193, v185, v185
  v_fmac_f32 v192, v186, v186
  v_fmac_f32 v193, v187, v187
  v_fmac_f32 v192, v188, v188
  v_fmac_f32 v193, v189, v189
  v_fmac_f32 v192, v190, v190
  v_fmac_f32 v193, v191, v191
  v_add_f32 v192, v192, v193
  s_nop 1
  v_add_f32_dpp v192, v192, v192 row_ror:8 row_mask:0xf bank_mask:0xf
  v_mov_b32 v193, v192
  s_nop 1
  v_permlane16_swap_b32 v192, v193
  v_add_f32 v192, v192, v193
  v_mov_b32 v193, v192
  s_nop 1
  v_permlane32_swap_b32 v192, v193
  v_add_f32 v192, v192, v193
  ds_write_b32 v4, v192 offset:1024
  s_waitcnt lgkmcnt(0)
  s_barrier
  ds_read_b32 v192, v5 offset:1024
  ds_read_b32 v193, v5 offset:1280
  ds_read_b32 v194, v5 offset:1536
  ds_read_b32 v195, v5 offset:1792
  s_waitcnt lgkmcnt(0)
  v_add_f32 v192, v192, v193
  v_add_f32 v194, v194, v195
  v_add_f32 v192, v192, v194
  v_mov_b32 v193, 0x3727c5ac
  v_fmac_f32 v193, 0x3b000000, v192
  v_rsq_f32 v192, v193
  s_nop 0
  v_mul_f32 v176, v176, v192
  v_mul_f32 v177, v177, v192
  v_mul_f32 v178, v178, v192
  v_mul_f32 v179, v179, v192
  v_mul_f32 v180, v180, v192
  v_mul_f32 v181, v181, v192
  v_mul_f32 v182, v182, v192
  v_mul_f32 v183, v183, v192
  v_mul_f32 v184, v184, v192
  v_mul_f32 v185, v185, v192
  v_mul_f32 v186, v186, v192
  v_mul_f32 v187, v187, v192
  v_mul_f32 v188, v188, v192
  v_mul_f32 v189, v189, v192
  v_mul_f32 v190, v190, v192
  v_mul_f32 v191, v191, v192
  v_cvt_pk_bf16_f32 v80, v176, v177
  v_cvt_pk_bf16_f32 v81, v178, v179
  v_cvt_pk_bf16_f32 v82, v180, v181
  v_cvt_pk_bf16_f32 v83, v182, v183
  v_cvt_pk_bf16_f32 v84, v184, v185
  v_cvt_pk_bf16_f32 v85, v186, v187
  v_cvt_pk_bf16_f32 v86, v188, v189
  v_cvt_pk_bf16_f32 v87, v190, v191
  buffer_store_dwordx4 v[80:83], v3, s[4:7], s71 offen sc1
  buffer_store_dwordx4 v[84:87], v3, s[4:7], s71 offen offset:256 sc1
  s_mov_b32 s76, s72
  s_cmp_eq_u32 s78, 1
  s_cbranch_scc1 L_fgo_142
  s_waitcnt vmcnt(0)
  s_barrier
  v_mov_b32 v10, s76
  v_mov_b32 v11, 1
  s_mov_b64 exec, s[80:81]
  buffer_store_dword v11, v10, s[4:7], 0 offen sc1
  s_mov_b64 exec, -1
  s_mov_b32 s76, 0x128000
  s_cmp_ge_u32 s66, 256
  s_cbranch_scc1 L_f3_l1_fin
L_wn_143:
  v_and_b32 v6, 63, v0
  v_lshlrev_b32 v6, 2, v6
  v_add_u32 v6, s69, v6
  s_mov_b64 exec, 0xffff
  buffer_load_dword v7, v6, s[4:7], 0 offen sc1
  s_mov_b64 exec, -1
  s_waitcnt vmcnt(0)
  v_cmp_ne_u32 vcc, 0, v7
  s_and_b32 s45, vcc_lo, 0xffff
  s_cmp_eq_u32 s45, 0xffff
  s_cselect_b32 s45, 1, 0
  s_cmp_eq_u32 s45, 1
  s_cbranch_scc1 L_wnd_144
  s_sub_u32 s64, s64, 1
  s_cbranch_scc1 L_abort
  s_sleep 4
  s_branch L_wn_143
L_wnd_144:
  buffer_load_dwordx4 v[160:163], v8, s[4:7], s68 offen sc1
  buffer_load_dwordx4 v[164:167], v9, s[4:7], s68 offen sc1
  buffer_load_dwordx4 v[96:99], v1, s[4:7], s67 offen offset:0 sc1
  buffer_load_dwordx4 v[100:103], v1, s[4:7], s67 offen offset:256 sc1
  buffer_load_dwordx4 v[104:107], v1, s[4:7], s67 offen offset:512 sc1
  buffer_load_dwordx4 v[108:111], v1, s[4:7], s67 offen offset:768 sc1
  s_add_u32 s49, s67, 65536
  buffer_load_dwordx4 v[112:115], v1, s[4:7], s49 offen offset:0 sc1
  buffer_load_dwordx4 v[116:119], v1, s[4:7], s49 offen offset:256 sc1
  buffer_load_dwordx4 v[120:123], v1, s[4:7], s49 offen offset:512 sc1
  buffer_load_dwordx4 v[124:127], v1, s[4:7], s49 offen offset:768 sc1
  s_add_u32 s49, s67, 131072
  buffer_load_dwordx4 v[128:131], v1, s[4:7], s49 offen offset:0 sc1
  buffer_load_dwordx4 v[132:135], v1, s[4:7], s49 offen offset:256 sc1
  buffer_load_dwordx4 v[136:139], v1, s[4:7], s49 offen offset:512 sc1
  buffer_load_dwordx4 v[140:143], v1, s[4:7], s49 offen offset:768 sc1
  s_add_u32 s49, s67, 196608
  buffer_load_dwordx4 v[144:147], v1, s[4:7], s49 offen offset:0 sc1
  buffer_load_dwordx4 v[148:151], v1, s[4:7], s49 offen offset:256 sc1
  buffer_load_dwordx4 v[152:155], v1, s[4:7], s49 offen offset:512 sc1
  buffer_load_dwordx4 v[156:159], v1, s[4:7], s49 offen offset:768 sc1
L_fgo_142:
  s_mov_b32 s70, s73
  s_mov_b32 s71, s74
  s_mov_b32 s72, s75
  s_add_u32 s66, s66, 6
  s_lshr_b32 s45, s66, 2
  s_and_b32 s46, s66, 3
  s_mul_i32 s47, s45, 0x40000
  s_lshr_b32 s48, s46, 1
  s_lshl_b32 s49, s48, 10
  s_add_u32 s47, s47, s49
  s_and_b32 s49, s46, 1
  s_lshl_b32 s49, s49, 7
  s_add_u32 s47, s47, s49
  s_add_u32 s67, s47, 0x9000000
  s_lshl_b32 s47, s66, 13
  s_add_u32 s68, s47, 0x5e00000
  s_add_u32 s73, s47, 0x5c00000
  s_lshl_b32 s47, s45, 7
  s_add_u32 s69, s47, 0x116000
  s_lshl_b32 s48, s48, 14
  s_add_u32 s48, s48, s49
  s_lshl_b32 s49, s45, 15
  s_add_u32 s48, s48, s49
  s_add_u32 s74, s48, 0x5800000
  s_lshl_b32 s46, s46, 2
  s_add_u32 s46, s46, s47
  s_add_u32 s75, s46, 0x11a000
  s_waitcnt vmcnt(0)
  v_and_b32 v6, 63, v0
  v_lshlrev_b32 v6, 2, v6
  v_add_u32 v6, s69, v6
  s_mov_b64 exec, 0xffff
  buffer_load_dword v7, v6, s[4:7], 0 offen sc1
  s_mov_b64 exec, -1
  s_barrier
  v_mov_b32 v10, s76
  v_mov_b32 v11, 1
  s_mov_b64 exec, s[80:81]
  buffer_store_dword v11, v10, s[4:7], 0 offen sc1
  s_mov_b64 exec, -1
  s_mov_b32 s76, 0x128000
  s_mov_b32 s49, 0xffff0000
  v_lshlrev_b32 v176, 16, v160
  v_and_b32 v177, s49, v160
  v_lshlrev_b32 v178, 16, v161
  v_and_b32 v179, s49, v161
  v_lshlrev_b32 v180, 16, v162
  v_and_b32 v181, s49, v162
  v_lshlrev_b32 v182, 16, v163
  v_and_b32 v183, s49, v163
  v_lshlrev_b32 v184, 16, v164
  v_and_b32 v185, s49, v164
  v_lshlrev_b32 v186, 16, v165
  v_and_b32 v187, s49, v165
  v_lshlrev_b32 v188, 16, v166
  v_and_b32 v189, s49, v166
  v_lshlrev_b32 v190, 16, v167
  v_and_b32 v191, s49, v167
  v_add_f32 v176, v176, v96
  v_add_f32 v177, v177, v97
  v_add_f32 v178, v178, v98
  v_add_f32 v179, v179, v99
  v_add_f32 v180, v180, v100
  v_add_f32 v181, v181, v101
  v_add_f32 v182, v182, v102
  v_add_f32 v183, v183, v103
  v_add_f32 v184, v184, v104
  v_add_f32 v185, v185, v105
  v_add_f32 v186, v186, v106
  v_add_f32 v187, v187, v107
  v_add_f32 v188, v188, v108
  v_add_f32 v189, v189, v109
  v_add_f32 v190, v190, v110
  v_add_f32 v191, v191, v111
  v_add_f32 v176, v176, v112
  v_add_f32 v177, v177, v113
  v_add_f32 v178, v178, v114
  v_add_f32 v179, v179, v115
  v_add_f32 v180, v180, v116
  v_add_f32 v181, v181, v117
  v_add_f32 v182, v182, v118
  v_add_f32 v183, v183, v119
  v_add_f32 v184, v184, v120
  v_add_f32 v185, v185, v121
  v_add_f32 v186, v186, v122
  v_add_f32 v187, v187, v123
  v_add_f32 v188, v188, v124
  v_add_f32 v189, v189, v125
  v_add_f32 v190, v190, v126
  v_add_f32 v191, v191, v127
  v_add_f32 v176, v176, v128
  v_add_f32 v177, v177, v129
  v_add_f32 v178, v178, v130
  v_add_f32 v179, v179, v131
  v_add_f32 v180, v180, v132
  v_add_f32 v181, v181, v133
  v_add_f32 v182, v182, v134
  v_add_f32 v183, v183, v135
  v_add_f32 v184, v184, v136
  v_add_f32 v185, v185, v137
  v_add_f32 v186, v186, v138
  v_add_f32 v187, v187, v139
  v_add_f32 v188, v188, v140
  v_add_f32 v189, v189, v141
  v_add_f32 v190, v190, v142
  v_add_f32 v191, v191, v143
  v_add_f32 v176, v176, v144
  v_add_f32 v177, v177, v145
  v_add_f32 v178, v178, v146
  v_add_f32 v179, v179, v147
  v_add_f32 v180, v180, v148
  v_add_f32 v181, v181, v149
  v_add_f32 v182, v182, v150
  v_add_f32 v183, v183, v151
  v_add_f32 v184, v184, v152
  v_add_f32 v185, v185, v153
  v_add_f32 v186, v186, v154
  v_add_f32 v187, v187, v155
  v_add_f32 v188, v188, v156
  v_add_f32 v189, v189, v157
  v_add_f32 v190, v190, v158
  v_add_f32 v191, v191, v159
  v_cvt_pk_bf16_f32 v160, v176, v177
  v_cvt_pk_bf16_f32 v161, v178, v179
  v_cvt_pk_bf16_f32 v162, v180, v181
  v_cvt_pk_bf16_f32 v163, v182, v183
  v_cvt_pk_bf16_f32 v164, v184, v185
  v_cvt_pk_bf16_f32 v165, v186, v187
  v_cvt_pk_bf16_f32 v166, v188, v189
  v_cvt_pk_bf16_f32 v167, v190, v191
  buffer_store_dwordx4 v[160:163], v8, s[4:7], s70 offen sc1
  buffer_store_dwordx4 v[164:167], v9, s[4:7], s70 offen sc1
  v_lshlrev_b32 v176, 16, v160
  v_and_b32 v177, s49, v160
  v_lshlrev_b32 v178, 16, v161
  v_and_b32 v179, s49, v161
  v_lshlrev_b32 v180, 16, v162
  v_and_b32 v181, s49, v162
  v_lshlrev_b32 v182, 16, v163
  v_and_b32 v183, s49, v163
  v_lshlrev_b32 v184, 16, v164
  v_and_b32 v185, s49, v164
  v_lshlrev_b32 v186, 16, v165
  v_and_b32 v187, s49, v165
  v_lshlrev_b32 v188, 16, v166
  v_and_b32 v189, s49, v166
  v_lshlrev_b32 v190, 16, v167
  v_and_b32 v191, s49, v167
  v_add_f32 v192, v176, v177
  v_add_f32 v193, v178, v179
  v_add_f32 v192, v192, v180
  v_add_f32 v193, v193, v181
  v_add_f32 v192, v192, v182
  v_add_f32 v193, v193, v183
  v_add_f32 v192, v192, v184
  v_add_f32 v193, v193, v185
  v_add_f32 v192, v192, v186
  v_add_f32 v193, v193, v187
  v_add_f32 v192, v192, v188
  v_add_f32 v193, v193, v189
  v_add_f32 v192, v192, v190
  v_add_f32 v193, v193, v191
  v_add_f32 v192, v192, v193
  s_nop 1
  v_add_f32_dpp v192, v192, v192 row_ror:8 row_mask:0xf bank_mask:0xf
  v_mov_b32 v193, v192
  s_nop 1
  v_permlane16_swap_b32 v192, v193
  v_add_f32 v192, v192, v193
  v_mov_b32 v193, v192
  s_nop 1
  v_permlane32_swap_b32 v192, v193
  v_add_f32 v192, v192, v193
  ds_write_b32 v4, v192 offset:0
  s_waitcnt vmcnt(3)
  v_mov_b32 v10, 0x1000
  v_cmp_ne_u32 vcc, 0, v7
  s_and_b32 s77, vcc_lo, 0xffff
  s_cmp_eq_u32 s77, 0xffff
  s_cselect_b32 s77, 1, 0
  v_mov_b32 v7, s77
  s_cmp_eq_u32 s16, 0
  s_cbranch_scc0 L_fw_145
  s_mov_b64 exec, 1
  ds_write_b32 v10, v7
  s_mov_b64 exec, -1
L_fw_145:
  s_waitcnt lgkmcnt(0)
  s_barrier
  ds_read_b32 v192, v5 offset:0
  ds_read_b32 v193, v5 offset:256
  ds_read_b32 v194, v5 offset:512
  ds_read_b32 v195, v5 offset:768
  s_waitcnt lgkmcnt(0)
  v_add_f32 v192, v192, v193
  v_add_f32 v194, v194, v195
  v_add_f32 v192, v192, v194
  ds_read_b32 v7, v10
  s_waitcnt lgkmcnt(0)
  v_readfirstlane_b32 s77, v7
  s_mov_b32 s78, 0
  s_cmp_lt_u32 s66, 256
  s_cbranch_scc0 L_fn_146
  s_cmp_eq_u32 s77, 1
  s_cbranch_scc0 L_fn_146
  buffer_load_dwordx4 v[80:83], v8, s[4:7], s68 offen sc1
  buffer_load_dwordx4 v[84:87], v9, s[4:7], s68 offen sc1
  buffer_load_dwordx4 v[16:19], v1, s[4:7], s67 offen offset:0 sc1
  buffer_load_dwordx4 v[20:23], v1, s[4:7], s67 offen offset:256 sc1
  buffer_load_dwordx4 v[24:27], v1, s[4:7], s67 offen offset:512 sc1
  buffer_load_dwordx4 v[28:31], v1, s[4:7], s67 offen offset:768 sc1
  s_add_u32 s49, s67, 65536
  buffer_load_dwordx4 v[32:35], v1, s[4:7], s49 offen offset:0 sc1
  buffer_load_dwordx4 v[36:39], v1, s[4:7], s49 offen offset:256 sc1
  buffer_load_dwordx4 v[40:43], v1, s[4:7], s49 offen offset:512 sc1
  buffer_load_dwordx4 v[44:47], v1, s[4:7], s49 offen offset:768 sc1
  s_add_u32 s49, s67, 131072
  buffer_load_dwordx4 v[48:51], v1, s[4:7], s49 offen offset:0 sc1
  buffer_load_dwordx4 v[52:55], v1, s[4:7], s49 offen offset:256 sc1
  buffer_load_dwordx4 v[56:59], v1, s[4:7], s49 offen offset:512 sc1
  buffer_load_dwordx4 v[60:63], v1, s[4:7], s49 offen offset:768 sc1
  s_add_u32 s49, s67, 196608
  buffer_load_dwordx4 v[64:67], v1, s[4:7], s49 offen offset:0 sc1
  buffer_load_dwordx4 v[68:71], v1, s[4:7], s49 offen offset:256 sc1
  buffer_load_dwordx4 v[72:75], v1, s[4:7], s49 offen offset:512 sc1
  buffer_load_dwordx4 v[76:79], v1, s[4:7], s49 offen offset:768 sc1
  s_mov_b32 s78, 1
L_fn_146:
  v_mul_f32 v192, 0x3b000000, v192
  v_sub_f32 v176, v176, v192
  v_sub_f32 v177, v177, v192
  v_sub_f32 v178, v178, v192
  v_sub_f32 v179, v179, v192
  v_sub_f32 v180, v180, v192
  v_sub_f32 v181, v181, v192
  v_sub_f32 v182, v182, v192
  v_sub_f32 v183, v183, v192
  v_sub_f32 v184, v184, v192
  v_sub_f32 v185, v185, v192
  v_sub_f32 v186, v186, v192
  v_sub_f32 v187, v187, v192
  v_sub_f32 v188, v188, v192
  v_sub_f32 v189, v189, v192
  v_sub_f32 v190, v190, v192
  v_sub_f32 v191, v191, v192
  v_mul_f32 v192, v176, v176
  v_mul_f32 v193, v177, v177
  v_fmac_f32 v192, v178, v178
  v_fmac_f32 v193, v179, v179
  v_fmac_f32 v192, v180, v180
  v_fmac_f32 v193, v181, v181
  v_fmac_f32 v192, v182, v182
  v_fmac_f32 v193, v183, v183
  v_fmac_f32 v192, v184, v184
  v_fmac_f32 v193, v185, v185
  v_fmac_f32 v192, v186, v186
  v_fmac_f32 v193, v187, v187
  v_fmac_f32 v192, v188, v188
  v_fmac_f32 v193, v189, v189
  v_fmac_f32 v192, v190, v190
  v_fmac_f32 v193, v191, v191
  v_add_f32 v192, v192, v193
  s_nop 1
  v_add_f32_dpp v192, v192, v192 row_ror:8 row_mask:0xf bank_mask:0xf
  v_mov_b32 v193, v192
  s_nop 1
  v_permlane16_swap_b32 v192, v193
  v_add_f32 v192, v192, v193
  v_mov_b32 v193, v192
  s_nop 1
  v_permlane32_swap_b32 v192, v193
  v_add_f32 v192, v192, v193
  ds_write_b32 v4, v192 offset:1024
  s_waitcnt lgkmcnt(0)
  s_barrier
  ds_read_b32 v192, v5 offset:1024
  ds_read_b32 v193, v5 offset:1280
  ds_read_b32 v194, v5 offset:1536
  ds_read_b32 v195, v5 offset:1792
  s_waitcnt lgkmcnt(0)
  v_add_f32 v192, v192, v193
  v_add_f32 v194, v194, v195
  v_add_f32 v192, v192, v194
  v_mov_b32 v193, 0x3727c5ac
  v_fmac_f32 v193, 0x3b000000, v192
  v_rsq_f32 v192, v193
  s_nop 0
  v_mul_f32 v176, v176, v192
  v_mul_f32 v177, v177, v192
  v_mul_f32 v178, v178, v192
  v_mul_f32 v179, v179, v192
  v_mul_f32 v180, v180, v192
  v_mul_f32 v181, v181, v192
  v_mul_f32 v182, v182, v192
  v_mul_f32 v183, v183, v192
  v_mul_f32 v184, v184, v192
  v_mul_f32 v185, v185, v192
  v_mul_f32 v186, v186, v192
  v_mul_f32 v187, v187, v192
  v_mul_f32 v188, v188, v192
  v_mul_f32 v189, v189, v192
  v_mul_f32 v190, v190, v192
  v_mul_f32 v191, v191, v192
  v_cvt_pk_bf16_f32 v160, v176, v177
  v_cvt_pk_bf16_f32 v161, v178, v179
  v_cvt_pk_bf16_f32 v162, v180, v181
  v_cvt_pk_bf16_f32 v163, v182, v183
  v_cvt_pk_bf16_f32 v164, v184, v185
  v_cvt_pk_bf16_f32 v165, v186, v187
  v_cvt_pk_bf16_f32 v166, v188, v189
  v_cvt_pk_bf16_f32 v167, v190, v191
  buffer_store_dwordx4 v[160:163], v3, s[4:7], s71 offen sc1
  buffer_store_dwordx4 v[164:167], v3, s[4:7], s71 offen offset:256 sc1
  s_mov_b32 s76, s72
  s_cmp_eq_u32 s78, 1
  s_cbranch_scc1 L_fgo_148
  s_waitcnt vmcnt(0)
  s_barrier
  v_mov_b32 v10, s76
  v_mov_b32 v11, 1
  s_mov_b64 exec, s[80:81]
  buffer_store_dword v11, v10, s[4:7], 0 offen sc1
  s_mov_b64 exec, -1
  s_mov_b32 s76, 0x128000
  s_cmp_ge_u32 s66, 256
  s_cbranch_scc1 L_f3_l1_fin
L_wn_149:
  v_and_b32 v6, 63, v0
  v_lshlrev_b32 v6, 2, v6
  v_add_u32 v6, s69, v6
  s_mov_b64 exec, 0xffff
  buffer_load_dword v7, v6, s[4:7], 0 offen sc1
  s_mov_b64 exec, -1
  s_waitcnt vmcnt(0)
  v_cmp_ne_u32 vcc, 0, v7
  s_and_b32 s45, vcc_lo, 0xffff
  s_cmp_eq_u32 s45, 0xffff
  s_cselect_b32 s45, 1, 0
  s_cmp_eq_u32 s45, 1
  s_cbranch_scc1 L_wnd_150
  s_sub_u32 s64, s64, 1
  s_cbranch_scc1 L_abort
  s_sleep 4
  s_branch L_wn_149
L_wnd_150:
  buffer_load_dwordx4 v[80:83], v8, s[4:7], s68 offen sc1
  buffer_load_dwordx4 v[84:87], v9, s[4:7], s68 offen sc1
  buffer_load_dwordx4 v[16:19], v1, s[4:7], s67 offen offset:0 sc1
  buffer_load_dwordx4 v[20:23], v1, s[4:7], s67 offen offset:256 sc1
  buffer_load_dwordx4 v[24:27], v1, s[4:7], s67 offen offset:512 sc1
  buffer_load_dwordx4 v[28:31], v1, s[4:7], s67 offen offset:768 sc1
  s_add_u32 s49, s67, 65536
  buffer_load_dwordx4 v[32:35], v1, s[4:7], s49 offen offset:0 sc1
  buffer_load_dwordx4 v[36:39], v1, s[4:7], s49 offen offset:256 sc1
  buffer_load_dwordx4 v[40:43], v1, s[4:7], s49 offen offset:512 sc1
  buffer_load_dwordx4 v[44:47], v1, s[4:7], s49 offen offset:768 sc1
  s_add_u32 s49, s67, 131072
  buffer_load_dwordx4 v[48:51], v1, s[4:7], s49 offen offset:0 sc1
  buffer_load_dwordx4 v[52:55], v1, s[4:7], s49 offen offset:256 sc1
  buffer_load_dwordx4 v[56:59], v1, s[4:7], s49 offen offset:512 sc1
  buffer_load_dwordx4 v[60:63], v1, s[4:7], s49 offen offset:768 sc1
  s_add_u32 s49, s67, 196608
  buffer_load_dwordx4 v[64:67], v1, s[4:7], s49 offen offset:0 sc1
  buffer_load_dwordx4 v[68:71], v1, s[4:7], s49 offen offset:256 sc1
  buffer_load_dwordx4 v[72:75], v1, s[4:7], s49 offen offset:512 sc1
  buffer_load_dwordx4 v[76:79], v1, s[4:7], s49 offen offset:768 sc1
L_fgo_148:
  s_branch L_f3_l1
L_f3_l1_fin:
  s_waitcnt vmcnt(0)
  s_branch L_end
L_role_f5:
  s_cmp_eq_u32 s99, 1
  s_cbranch_scc1 L_gs_done_151
  s_cmp_eq_u32 s16, 0
  s_cbranch_scc0 L_gs_w_152
  v_mov_b32 v100, 32
L_gs_p_153:
  s_mov_b64 exec, 1
  global_load_dword v101, v100, s[40:41] sc1
  s_mov_b64 exec, -1
  s_waitcnt vmcnt(0)
  v_readfirstlane_b32 s45, v101
  s_sub_u32 s64, s64, 1
  s_cbranch_scc1 L_abort
  s_cmp_ge_u32 s45, 256
  s_cbranch_scc1 L_gs_q_154
  s_sleep 4
  s_branch L_gs_p_153
L_gs_q_154:
  v_and_b32 v102, 63, v0
  v_lshlrev_b32 v102, 2, v102
  s_mov_b64 exec, 0xff
  global_load_dword v101, v102, s[40:41] sc1
  s_waitcnt vmcnt(0)
  ds_write_b32 v102, v101
  s_mov_b64 exec, -1
  s_waitcnt lgkmcnt(0)
L_gs_w_152:
  s_barrier
  v_mov_b32 v100, 0
  ds_read_b128 v[104:107], v100
  ds_read_b128 v[108:111], v100 offset:16
  s_waitcnt lgkmcnt(0)
  s_mov_b32 s44, 1
  s_mov_b32 s46, 0
  v_readfirstlane_b32 s45, v104
  s_cmp_eq_u32 s45, 32
  s_cselect_b32 s44, s44, 0
  s_cmp_gt_u32 s18, 0
  s_cselect_b32 s45, s45, 0
  s_add_u32 s46, s46, s45
  v_readfirstlane_b32 s45, v105
  s_cmp_eq_u32 s45, 32
  s_cselect_b32 s44, s44, 0
  s_cmp_gt_u32 s18, 1
  s_cselect_b32 s45, s45, 0
  s_add_u32 s46, s46, s45
  v_readfirstlane_b32 s45, v106
  s_cmp_eq_u32 s45, 32
  s_cselect_b32 s44, s44, 0
  s_cmp_gt_u32 s18, 2
  s_cselect_b32 s45, s45, 0
  s_add_u32 s46, s46, s45
  v_readfirstlane_b32 s45, v107
  s_cmp_eq_u32 s45, 32
  s_cselect_b32 s44, s44, 0
  s_cmp_gt_u32 s18, 3
  s_cselect_b32 s45, s45, 0
  s_add_u32 s46, s46, s45
  v_readfirstlane_b32 s45, v108
  s_cmp_eq_u32 s45, 32
  s_cselect_b32 s44, s44, 0
  s_cmp_gt_u32 s18, 4
  s_cselect_b32 s45, s45, 0
  s_add_u32 s46, s46, s45
  v_readfirstlane_b32 s45, v109
  s_cmp_eq_u32 s45, 32
  s_cselect_b32 s44, s44, 0
  s_cmp_gt_u32 s18, 5
  s_cselect_b32 s45, s45, 0
  s_add_u32 s46, s46, s45
  v_readfirstlane_b32 s45, v110
  s_cmp_eq_u32 s45, 32
  s_cselect_b32 s44, s44, 0
  s_cmp_gt_u32 s18, 6
  s_cselect_b32 s45, s45, 0
  s_add_u32 s46, s46, s45
  v_readfirstlane_b32 s45, v111
  s_cmp_eq_u32 s45, 32
  s_cselect_b32 s44, s44, 0
  s_cmp_gt_u32 s18, 7
  s_cselect_b32 s45, s45, 0
  s_add_u32 s46, s46, s45
  s_barrier
  s_mov_b32 s99, 1
  s_cmp_eq_u32 s44, 1
  s_cbranch_scc1 L_gs_done_151
  s_add_u32 s17, s46, s98
  s_branch L_dispatch
L_gs_done_151:
  v_and_b32 v6, 7, v0
  v_lshrrev_b32 v7, 3, v0
  v_lshlrev_b32 v5, 4, v6
  v_lshl_add_u32 v1, v7, 11, v5
  v_lshlrev_b32 v2, 10, v6
  v_lshl_add_u32 v2, v7, 5, v2
  v_lshrrev_b32 v3, 1, v7
  v_lshlrev_b32 v3, 10, v3
  v_and_b32 v4, 1, v7
  v_lshl_add_u32 v3, v4, 9, v3
  v_add_u32 v3, v3, v5
  v_and_b32 v4, 63, v0
  v_lshlrev_b32 v4, 2, v4
  s_lshl_b32 s45, s16, 8
  v_add_u32 v4, s45, v4
  v_lshlrev_b32 v5, 2, v6
  v_lshlrev_b32 v8, 4, v0
  v_add_u32 v9, 0x1000, v8
  s_mov_b32 s8, s20
  s_and_b32 s9, s21, 0xffff
  s_mov_b32 s10, 0x200000
  s_mov_b32 s11, 0x20000
  s_mov_b32 s12, s38
  s_and_b32 s13, s39, 0xffff
  s_mov_b32 s14, 0x200000
  s_mov_b32 s15, 0x20000
  s_cmp_eq_u32 s19, 0
  s_cbranch_scc0 L_f1_156
L_f0_155:
  s_mov_b32 s66, s17
  s_mov_b32 s76, 0x128000
  s_cmp_eq_u32 s16, 0
  s_cselect_b32 s80, 1, 0
  s_mov_b32 s81, 0
  s_mov_b32 s65, 0
  s_lshr_b32 s45, s66, 2
  s_and_b32 s46, s66, 3
  s_mul_i32 s47, s45, 0x20000
  s_lshr_b32 s48, s46, 1
  s_lshl_b32 s49, s48, 10
  s_add_u32 s47, s47, s49
  s_and_b32 s49, s46, 1
  s_lshl_b32 s49, s49, 7
  s_add_u32 s47, s47, s49
  s_add_u32 s67, s47, 0xae00000
  s_lshl_b32 s47, s66, 13
  s_add_u32 s68, s47, 0x5a00000
  s_add_u32 s73, s47, 0x5e00000
  s_lshl_b32 s47, s45, 7
  s_add_u32 s69, s47, 0x124000
  s_lshl_b32 s48, s48, 14
  s_add_u32 s48, s48, s49
  s_lshl_b32 s49, s45, 15
  s_add_u32 s48, s48, s49
  s_add_u32 s74, s48, 0x5400000
  s_lshl_b32 s46, s46, 2
  s_add_u32 s46, s46, s47
  s_add_u32 s75, s46, 0x102000
L_wn_157:
  v_and_b32 v6, 63, v0
  v_lshlrev_b32 v6, 2, v6
  v_add_u32 v6, s69, v6
  s_mov_b64 exec, 0xff
  buffer_load_dword v7, v6, s[4:7], 0 offen sc1
  s_mov_b64 exec, -1
  s_waitcnt vmcnt(0)
  v_cmp_ne_u32 vcc, 0, v7
  s_and_b32 s45, vcc_lo, 0xff
  s_cmp_eq_u32 s45, 0xff
  s_cselect_b32 s45, 1, 0
  s_cmp_eq_u32 s45, 1
  s_cbranch_scc1 L_wnd_158
  s_sub_u32 s64, s64, 1
  s_cbranch_scc1 L_abort
  s_sleep 16
  s_branch L_wn_157
L_wnd_158:
  buffer_load_dwordx4 v[80:83], v8, s[4:7], s68 offen sc1
  buffer_load_dwordx4 v[84:87], v9, s[4:7], s68 offen sc1
  buffer_load_dwordx4 v[16:19], v1, s[4:7], s67 offen offset:0 sc1
  buffer_load_dwordx4 v[20:23], v1, s[4:7], s67 offen offset:256 sc1
  buffer_load_dwordx4 v[24:27], v1, s[4:7], s67 offen offset:512 sc1
  buffer_load_dwordx4 v[28:31], v1, s[4:7], s67 offen offset:768 sc1
  s_add_u32 s49, s67, 65536
  buffer_load_dwordx4 v[32:35], v1, s[4:7], s49 offen offset:0 sc1
  buffer_load_dwordx4 v[36:39], v1, s[4:7], s49 offen offset:256 sc1
  buffer_load_dwordx4 v[40:43], v1, s[4:7], s49 offen offset:512 sc1
  buffer_load_dwordx4 v[44:47], v1, s[4:7], s49 offen offset:768 sc1
L_f5_l0:
  s_mov_b32 s70, s73
  s_mov_b32 s71, s74
  s_mov_b32 s72, s75
  s_add_u32 s66, s66, 4
  s_lshr_b32 s45, s66, 2
  s_and_b32 s46, s66, 3
  s_mul_i32 s47, s45, 0x20000
  s_lshr_b32 s48, s46, 1
  s_lshl_b32 s49, s48, 10
  s_add_u32 s47, s47, s49
  s_and_b32 s49, s46, 1
  s_lshl_b32 s49, s49, 7
  s_add_u32 s47, s47, s49
  s_add_u32 s67, s47, 0xae00000
  s_lshl_b32 s47, s66, 13
  s_add_u32 s68, s47, 0x5a00000
  s_add_u32 s73, s47, 0x5e00000
  s_lshl_b32 s47, s45, 7
  s_add_u32 s69, s47, 0x124000
  s_lshl_b32 s48, s48, 14
  s_add_u32 s48, s48, s49
  s_lshl_b32 s49, s45, 15
  s_add_u32 s48, s48, s49
  s_add_u32 s74, s48, 0x5400000
  s_lshl_b32 s46, s46, 2
  s_add_u32 s46, s46, s47
  s_add_u32 s75, s46, 0x102000
  s_waitcnt vmcnt(0)
  v_and_b32 v6, 63, v0
  v_lshlrev_b32 v6, 2, v6
  v_add_u32 v6, s69, v6
  s_mov_b64 exec, 0xff
  buffer_load_dword v7, v6, s[4:7], 0 offen sc1
  s_mov_b64 exec, -1
  s_barrier
  v_mov_b32 v10, s76
  v_mov_b32 v11, 1
  s_mov_b64 exec, s[80:81]
  buffer_store_dword v11, v10, s[4:7], 0 offen sc1
  s_mov_b64 exec, -1
  s_mov_b32 s76, 0x128000
  s_mov_b32 s49, 0xffff0000
  v_lshlrev_b32 v176, 16, v80
  v_and_b32 v177, s49, v80
  v_lshlrev_b32 v178, 16, v81
  v_and_b32 v179, s49, v81
  v_lshlrev_b32 v180, 16, v82
  v_and_b32 v181, s49, v82
  v_lshlrev_b32 v182, 16, v83
  v_and_b32 v183, s49, v83
  v_lshlrev_b32 v184, 16, v84
  v_and_b32 v185, s49, v84
  v_lshlrev_b32 v186, 16, v85
  v_and_b32 v187, s49, v85
  v_lshlrev_b32 v188, 16, v86
  v_and_b32 v189, s49, v86
  v_lshlrev_b32 v190, 16, v87
  v_and_b32 v191, s49, v87
  v_add_f32 v176, v176, v16
  v_add_f32 v177, v177, v17
  v_add_f32 v178, v178, v18
  v_add_f32 v179, v179, v19
  v_add_f32 v180, v180, v20
  v_add_f32 v181, v181, v21
  v_add_f32 v182, v182, v22
  v_add_f32 v183, v183, v23
  v_add_f32 v184, v184, v24
  v_add_f32 v185, v185, v25
  v_add_f32 v186, v186, v26
  v_add_f32 v187, v187, v27
  v_add_f32 v188, v188, v28
  v_add_f32 v189, v189, v29
  v_add_f32 v190, v190, v30
  v_add_f32 v191, v191, v31
  v_add_f32 v176, v176, v32
  v_add_f32 v177, v177, v33
  v_add_f32 v178, v178, v34
  v_add_f32 v179, v179, v35
  v_add_f32 v180, v180, v36
  v_add_f32 v181, v181, v37
  v_add_f32 v182, v182, v38
  v_add_f32 v183, v183, v39
  v_add_f32 v184, v184, v40
  v_add_f32 v185, v185, v41
  v_add_f32 v186, v186, v42
  v_add_f32 v187, v187, v43
  v_add_f32 v188, v188, v44
  v_add_f32 v189, v189, v45
  v_add_f32 v190, v190, v46
  v_add_f32 v191, v191, v47
  v_cvt_pk_bf16_f32 v80, v176, v177
  v_cvt_pk_bf16_f32 v81, v178, v179
  v_cvt_pk_bf16_f32 v82, v180, v181
  v_cvt_pk_bf16_f32 v83, v182, v183
  v_cvt_pk_bf16_f32 v84, v184, v185
  v_cvt_pk_bf16_f32 v85, v186, v187
  v_cvt_pk_bf16_f32 v86, v188, v189
  v_cvt_pk_bf16_f32 v87, v190, v191
  buffer_store_dwordx4 v[80:83], v8, s[4:7], s70 offen sc1
  buffer_store_dwordx4 v[84:87], v9, s[4:7], s70 offen sc1
  v_lshlrev_b32 v176, 16, v80
  v_and_b32 v177, s49, v80
  v_lshlrev_b32 v178, 16, v81
  v_and_b32 v179, s49, v81
  v_lshlrev_b32 v180, 16, v82
  v_and_b32 v181, s49, v82
  v_lshlrev_b32 v182, 16, v83
  v_and_b32 v183, s49, v83
  v_lshlrev_b32 v184, 16, v84
  v_and_b32 v185, s49, v84
  v_lshlrev_b32 v186, 16, v85
  v_and_b32 v187, s49, v85
  v_lshlrev_b32 v188, 16, v86
  v_and_b32 v189, s49, v86
  v_lshlrev_b32 v190, 16, v87
  v_and_b32 v191, s49, v87
  v_add_f32 v192, v176, v177
  v_add_f32 v193, v178, v179
  v_add_f32 v192, v192, v180
  v_add_f32 v193, v193, v181
  v_add_f32 v192, v192, v182
  v_add_f32 v193, v193, v183
  v_add_f32 v192, v192, v184
  v_add_f32 v193, v193, v185
  v_add_f32 v192, v192, v186
  v_add_f32 v193, v193, v187
  v_add_f32 v192, v192, v188
  v_add_f32 v193, v193, v189
  v_add_f32 v192, v192, v190
  v_add_f32 v193, v193, v191
  v_add_f32 v192, v192, v193
  s_nop 1
  v_add_f32_dpp v192, v192, v192 row_ror:8 row_mask:0xf bank_mask:0xf
  v_mov_b32 v193, v192
  s_nop 1
  v_permlane16_swap_b32 v192, v193
  v_add_f32 v192, v192, v193
  v_mov_b32 v193, v192
  s_nop 1
  v_permlane32_swap_b32 v192, v193
  v_add_f32 v192, v192, v193
  ds_write_b32 v4, v192 offset:0
  s_waitcnt vmcnt(3)
  v_mov_b32 v10, 0x1000
  v_cmp_ne_u32 vcc, 0, v7
  s_and_b32 s77, vcc_lo, 0xff
  s_cmp_eq_u32 s77, 0xff
  s_cselect_b32 s77, 1, 0
  v_mov_b32 v7, s77
  s_cmp_eq_u32 s16, 0
  s_cbranch_scc0 L_fw_159
  s_mov_b64 exec, 1
  ds_write_b32 v10, v7
  s_mov_b64 exec, -1
L_fw_159:
  s_waitcnt lgkmcnt(0)
  s_barrier
  ds_read_b32 v192, v5 offset:0
  ds_read_b32 v193, v5 offset:256
  ds_read_b32 v194, v5 offset:512
  ds_read_b32 v195, v5 offset:768
  s_waitcnt lgkmcnt(0)
  v_add_f32 v192, v192, v193
  v_add_f32 v194, v194, v195
  v_add_f32 v192, v192, v194
  ds_read_b32 v7, v10
  s_waitcnt lgkmcnt(0)
  v_readfirstlane_b32 s77, v7
  s_mov_b32 s78, 0
  s_cmp_lt_u32 s66, 256
  s_cbranch_scc0 L_fn_160
  s_cmp_eq_u32 s77, 1
  s_cbranch_scc0 L_fn_160
  buffer_load_dwordx4 v[160:163], v8, s[4:7], s68 offen sc1
  buffer_load_dwordx4 v[164:167], v9, s[4:7], s68 offen sc1
  buffer_load_dwordx4 v[96:99], v1, s[4:7], s67 offen offset:0 sc1
  buffer_load_dwordx4 v[100:103], v1, s[4:7], s67 offen offset:256 sc1
  buffer_load_dwordx4 v[104:107], v1, s[4:7], s67 offen offset:512 sc1
  buffer_load_dwordx4 v[108:111], v1, s[4:7], s67 offen offset:768 sc1
  s_add_u32 s49, s67, 65536
  buffer_load_dwordx4 v[112:115], v1, s[4:7], s49 offen offset:0 sc1
  buffer_load_dwordx4 v[116:119], v1, s[4:7], s49 offen offset:256 sc1
  buffer_load_dwordx4 v[120:123], v1, s[4:7], s49 offen offset:512 sc1
  buffer_load_dwordx4 v[124:127], v1, s[4:7], s49 offen offset:768 sc1
  s_mov_b32 s78, 1
L_fn_160:
  v_mul_f32 v192, 0x3b000000, v192
  v_sub_f32 v176, v176, v192
  v_sub_f32 v177, v177, v192
  v_sub_f32 v178, v178, v192
  v_sub_f32 v179, v179, v192
  v_sub_f32 v180, v180, v192
  v_sub_f32 v181, v181, v192
  v_sub_f32 v182, v182, v192
  v_sub_f32 v183, v183, v192
  v_sub_f32 v184, v184, v192
  v_sub_f32 v185, v185, v192
  v_sub_f32 v186, v186, v192
  v_sub_f32 v187, v187, v192
  v_sub_f32 v188, v188, v192
  v_sub_f32 v189, v189, v192
  v_sub_f32 v190, v190, v192
  v_sub_f32 v191, v191, v192
  v_mul_f32 v192, v176, v176
  v_mul_f32 v193, v177, v177
  v_fmac_f32 v192, v178, v178
  v_fmac_f32 v193, v179, v179
  v_fmac_f32 v192, v180, v180
  v_fmac_f32 v193, v181, v181
  v_fmac_f32 v192, v182, v182
  v_fmac_f32 v193, v183, v183
  v_fmac_f32 v192, v184, v184
  v_fmac_f32 v193, v185, v185
  v_fmac_f32 v192, v186, v186
  v_fmac_f32 v193, v187, v187
  v_fmac_f32 v192, v188, v188
  v_fmac_f32 v193, v189, v189
  v_fmac_f32 v192, v190, v190
  v_fmac_f32 v193, v191, v191
  v_add_f32 v192, v192, v193
  s_nop 1
  v_add_f32_dpp v192, v192, v192 row_ror:8 row_mask:0xf bank_mask:0xf
  v_mov_b32 v193, v192
  s_nop 1
  v_permlane16_swap_b32 v192, v193
  v_add_f32 v192, v192, v193
  v_mov_b32 v193, v192
  s_nop 1
  v_permlane32_swap_b32 v192, v193
  v_add_f32 v192, v192, v193
  ds_write_b32 v4, v192 offset:1024
  s_waitcnt lgkmcnt(0)
  s_barrier
  ds_read_b32 v192, v5 offset:1024
  ds_read_b32 v193, v5 offset:1280
  ds_read_b32 v194, v5 offset:1536
  ds_read_b32 v195, v5 offset:1792
  s_waitcnt lgkmcnt(0)
  v_add_f32 v192, v192, v193
  v_add_f32 v194, v194, v195
  v_add_f32 v192, v192, v194
  v_mov_b32 v193, 0x3727c5ac
  v_fmac_f32 v193, 0x3b000000, v192
  v_rsq_f32 v192, v193
  s_nop 0
  v_mul_f32 v176, v176, v192
  v_mul_f32 v177, v177, v192
  v_mul_f32 v178, v178, v192
  v_mul_f32 v179, v179, v192
  v_mul_f32 v180, v180, v192
  v_mul_f32 v181, v181, v192
  v_mul_f32 v182, v182, v192
  v_mul_f32 v183, v183, v192
  v_mul_f32 v184, v184, v192
  v_mul_f32 v185, v185, v192
  v_mul_f32 v186, v186, v192
  v_mul_f32 v187, v187, v192
  v_mul_f32 v188, v188, v192
  v_mul_f32 v189, v189, v192
  v_mul_f32 v190, v190, v192
  v_mul_f32 v191, v191, v192
  v_cvt_pk_bf16_f32 v80, v176, v177
  v_cvt_pk_bf16_f32 v81, v178, v179
  v_cvt_pk_bf16_f32 v82, v180, v181
  v_cvt_pk_bf16_f32 v83, v182, v183
  v_cvt_pk_bf16_f32 v84, v184, v185
  v_cvt_pk_bf16_f32 v85, v186, v187
  v_cvt_pk_bf16_f32 v86, v188, v189
  v_cvt_pk_bf16_f32 v87, v190, v191
  buffer_store_dwordx4 v[80:83], v3, s[4:7], s71 offen sc1
  buffer_store_dwordx4 v[84:87], v3, s[4:7], s71 offen offset:256 sc1
  s_mov_b32 s76, s72
  s_cmp_eq_u32 s78, 1
  s_cbranch_scc1 L_fgo_162
  s_waitcnt vmcnt(0)
  s_barrier
  v_mov_b32 v10, s76
  v_mov_b32 v11, 1
  s_mov_b64 exec, s[80:81]
  buffer_store_dword v11, v10, s[4:7], 0 offen sc1
  s_mov_b64 exec, -1
  s_mov_b32 s76, 0x128000
  s_cmp_ge_u32 s66, 256
  s_cbranch_scc1 L_f5_l0_fin
L_wn_163:
  v_and_b32 v6, 63, v0
  v_lshlrev_b32 v6, 2, v6
  v_add_u32 v6, s69, v6
  s_mov_b64 exec, 0xff
  buffer_load_dword v7, v6, s[4:7], 0 offen sc1
  s_mov_b64 exec, -1
  s_waitcnt vmcnt(0)
  v_cmp_ne_u32 vcc, 0, v7
  s_and_b32 s45, vcc_lo, 0xff
  s_cmp_eq_u32 s45, 0xff
  s_cselect_b32 s45, 1, 0
  s_cmp_eq_u32 s45, 1
  s_cbranch_scc1 L_wnd_164
  s_sub_u32 s64, s64, 1
  s_cbranch_scc1 L_abort
  s_sleep 4
  s_branch L_wn_163
L_wnd_164:
  buffer_load_dwordx4 v[160:163], v8, s[4:7], s68 offen sc1
  buffer_load_dwordx4 v[164:167], v9, s[4:7], s68 offen sc1
  buffer_load_dwordx4 v[96:99], v1, s[4:7], s67 offen offset:0 sc1
  buffer_load_dwordx4 v[100:103], v1, s[4:7], s67 offen offset:256 sc1
  buffer_load_dwordx4 v[104:107], v1, s[4:7], s67 offen offset:512 sc1
  buffer_load_dwordx4 v[108:111], v1, s[4:7], s67 offen offset:768 sc1
  s_add_u32 s49, s67, 65536
  buffer_load_dwordx4 v[112:115], v1, s[4:7], s49 offen offset:0 sc1
  buffer_load_dwordx4 v[116:119], v1, s[4:7], s49 offen offset:256 sc1
  buffer_load_dwordx4 v[120:123], v1, s[4:7], s49 offen offset:512 sc1
  buffer_load_dwordx4 v[124:127], v1, s[4:7], s49 offen offset:768 sc1
L_fgo_162:
  s_mov_b32 s70, s73
  s_mov_b32 s71, s74
  s_mov_b32 s72, s75
  s_add_u32 s66, s66, 4
  s_lshr_b32 s45, s66, 2
  s_and_b32 s46, s66, 3
  s_mul_i32 s47, s45, 0x20000
  s_lshr_b32 s48, s46, 1
  s_lshl_b32 s49, s48, 10
  s_add_u32 s47, s47, s49
  s_and_b32 s49, s46, 1
  s_lshl_b32 s49, s49, 7
  s_add_u32 s47, s47, s49
  s_add_u32 s67, s47, 0xae00000
  s_lshl_b32 s47, s66, 13
  s_add_u32 s68, s47, 0x5a00000
  s_add_u32 s73, s47, 0x5e00000
  s_lshl_b32 s47, s45, 7
  s_add_u32 s69, s47, 0x124000
  s_lshl_b32 s48, s48, 14
  s_add_u32 s48, s48, s49
  s_lshl_b32 s49, s45, 15
  s_add_u32 s48, s48, s49
  s_add_u32 s74, s48, 0x5400000
  s_lshl_b32 s46, s46, 2
  s_add_u32 s46, s46, s47
  s_add_u32 s75, s46, 0x102000
  s_waitcnt vmcnt(0)
  v_and_b32 v6, 63, v0
  v_lshlrev_b32 v6, 2, v6
  v_add_u32 v6, s69, v6
  s_mov_b64 exec, 0xff
  buffer_load_dword v7, v6, s[4:7], 0 offen sc1
  s_mov_b64 exec, -1
  s_barrier
  v_mov_b32 v10, s76
  v_mov_b32 v11, 1
  s_mov_b64 exec, s[80:81]
  buffer_store_dword v11, v10, s[4:7], 0 offen sc1
  s_mov_b64 exec, -1
  s_mov_b32 s76, 0x128000
  s_mov_b32 s49, 0xffff0000
  v_lshlrev_b32 v176, 16, v160
  v_and_b32 v177, s49, v160
  v_lshlrev_b32 v178, 16, v161
  v_and_b32 v179, s49, v161
  v_lshlrev_b32 v180, 16, v162
  v_and_b32 v181, s49, v162
  v_lshlrev_b32 v182, 16, v163
  v_and_b32 v183, s49, v163
  v_lshlrev_b32 v184, 16, v164
  v_and_b32 v185, s49, v164
  v_lshlrev_b32 v186, 16, v165
  v_and_b32 v187, s49, v165
  v_lshlrev_b32 v188, 16, v166
  v_and_b32 v189, s49, v166
  v_lshlrev_b32 v190, 16, v167
  v_and_b32 v191, s49, v167
  v_add_f32 v176, v176, v96
  v_add_f32 v177, v177, v97
  v_add_f32 v178, v178, v98
  v_add_f32 v179, v179, v99
  v_add_f32 v180, v180, v100
  v_add_f32 v181, v181, v101
  v_add_f32 v182, v182, v102
  v_add_f32 v183, v183, v103
  v_add_f32 v184, v184, v104
  v_add_f32 v185, v185, v105
  v_add_f32 v186, v186, v106
  v_add_f32 v187, v187, v107
  v_add_f32 v188, v188, v108
  v_add_f32 v189, v189, v109
  v_add_f32 v190, v190, v110
  v_add_f32 v191, v191, v111
  v_add_f32 v176, v176, v112
  v_add_f32 v177, v177, v113
  v_add_f32 v178, v178, v114
  v_add_f32 v179, v179, v115
  v_add_f32 v180, v180, v116
  v_add_f32 v181, v181, v117
  v_add_f32 v182, v182, v118
  v_add_f32 v183, v183, v119
  v_add_f32 v184, v184, v120
  v_add_f32 v185, v185, v121
  v_add_f32 v186, v186, v122
  v_add_f32 v187, v187, v123
  v_add_f32 v188, v188, v124
  v_add_f32 v189, v189, v125
  v_add_f32 v190, v190, v126
  v_add_f32 v191, v191, v127
  v_cvt_pk_bf16_f32 v160, v176, v177
  v_cvt_pk_bf16_f32 v161, v178, v179
  v_cvt_pk_bf16_f32 v162, v180, v181
  v_cvt_pk_bf16_f32 v163, v182, v183
  v_cvt_pk_bf16_f32 v164, v184, v185
  v_cvt_pk_bf16_f32 v165, v186, v187
  v_cvt_pk_bf16_f32 v166, v188, v189
  v_cvt_pk_bf16_f32 v167, v190, v191
  buffer_store_dwordx4 v[160:163], v8, s[4:7], s70 offen sc1
  buffer_store_dwordx4 v[164:167], v9, s[4:7], s70 offen sc1
  v_lshlrev_b32 v176, 16, v160
  v_and_b32 v177, s49, v160
  v_lshlrev_b32 v178, 16, v161
  v_and_b32 v179, s49, v161
  v_lshlrev_b32 v180, 16, v162
  v_and_b32 v181, s49, v162
  v_lshlrev_b32 v182, 16, v163
  v_and_b32 v183, s49, v163
  v_lshlrev_b32 v184, 16, v164
  v_and_b32 v185, s49, v164
  v_lshlrev_b32 v186, 16, v165
  v_and_b32 v187, s49, v165
  v_lshlrev_b32 v188, 16, v166
  v_and_b32 v189, s49, v166
  v_lshlrev_b32 v190, 16, v167
  v_and_b32 v191, s49, v167
  v_add_f32 v192, v176, v177
  v_add_f32 v193, v178, v179
  v_add_f32 v192, v192, v180
  v_add_f32 v193, v193, v181
  v_add_f32 v192, v192, v182
  v_add_f32 v193, v193, v183
  v_add_f32 v192, v192, v184
  v_add_f32 v193, v193, v185
  v_add_f32 v192, v192, v186
  v_add_f32 v193, v193, v187
  v_add_f32 v192, v192, v188
  v_add_f32 v193, v193, v189
  v_add_f32 v192, v192, v190
  v_add_f32 v193, v193, v191
  v_add_f32 v192, v192, v193
  s_nop 1
  v_add_f32_dpp v192, v192, v192 row_ror:8 row_mask:0xf bank_mask:0xf
  v_mov_b32 v193, v192
  s_nop 1
  v_permlane16_swap_b32 v192, v193
  v_add_f32 v192, v192, v193
  v_mov_b32 v193, v192
  s_nop 1
  v_permlane32_swap_b32 v192, v193
  v_add_f32 v192, v192, v193
  ds_write_b32 v4, v192 offset:0
  s_waitcnt vmcnt(3)
  v_mov_b32 v10, 0x1000
  v_cmp_ne_u32 vcc, 0, v7
  s_and_b32 s77, vcc_lo, 0xff
  s_cmp_eq_u32 s77, 0xff
  s_cselect_b32 s77, 1, 0
  v_mov_b32 v7, s77
  s_cmp_eq_u32 s16, 0
  s_cbranch_scc0 L_fw_165
  s_mov_b64 exec, 1
  ds_write_b32 v10, v7
  s_mov_b64 exec, -1
L_fw_165:
  s_waitcnt lgkmcnt(0)
  s_barrier
  ds_read_b32 v192, v5 offset:0
  ds_read_b32 v193, v5 offset:256
  ds_read_b32 v194, v5 offset:512
  ds_read_b32 v195, v5 offset:768
  s_waitcnt lgkmcnt(0)
  v_add_f32 v192, v192, v193
  v_add_f32 v194, v194, v195
  v_add_f32 v192, v192, v194
  ds_read_b32 v7, v10
  s_waitcnt lgkmcnt(0)
  v_readfirstlane_b32 s77, v7
  s_mov_b32 s78, 0
  s_cmp_lt_u32 s66, 256
  s_cbranch_scc0 L_fn_166
  s_cmp_eq_u32 s77, 1
  s_cbranch_scc0 L_fn_166
  buffer_load_dwordx4 v[80:83], v8, s[4:7], s68 offen sc1
  buffer_load_dwordx4 v[84:87], v9, s[4:7], s68 offen sc1
  buffer_load_dwordx4 v[16:19], v1, s[4:7], s67 offen offset:0 sc1
  buffer_load_dwordx4 v[20:23], v1, s[4:7], s67 offen offset:256 sc1
  buffer_load_dwordx4 v[24:27], v1, s[4:7], s67 offen offset:512 sc1
  buffer_load_dwordx4 v[28:31], v1, s[4:7], s67 offen offset:768 sc1
  s_add_u32 s49, s67, 65536
  buffer_load_dwordx4 v[32:35], v1, s[4:7], s49 offen offset:0 sc1
  buffer_load_dwordx4 v[36:39], v1, s[4:7], s49 offen offset:256 sc1
  buffer_load_dwordx4 v[40:43], v1, s[4:7], s49 offen offset:512 sc1
  buffer_load_dwordx4 v[44:47], v1, s[4:7], s49 offen offset:768 sc1
  s_mov_b32 s78, 1
L_fn_166:
  v_mul_f32 v192, 0x3b000000, v192
  v_sub_f32 v176, v176, v192
  v_sub_f32 v177, v177, v192
  v_sub_f32 v178, v178, v192
  v_sub_f32 v179, v179, v192
  v_sub_f32 v180, v180, v192
  v_sub_f32 v181, v181, v192
  v_sub_f32 v182, v182, v192
  v_sub_f32 v183, v183, v192
  v_sub_f32 v184, v184, v192
  v_sub_f32 v185, v185, v192
  v_sub_f32 v186, v186, v192
  v_sub_f32 v187, v187, v192
  v_sub_f32 v188, v188, v192
  v_sub_f32 v189, v189, v192
  v_sub_f32 v190, v190, v192
  v_sub_f32 v191, v191, v192
  v_mul_f32 v192, v176, v176
  v_mul_f32 v193, v177, v177
  v_fmac_f32 v192, v178, v178
  v_fmac_f32 v193, v179, v179
  v_fmac_f32 v192, v180, v180
  v_fmac_f32 v193, v181, v181
  v_fmac_f32 v192, v182, v182
  v_fmac_f32 v193, v183, v183
  v_fmac_f32 v192, v184, v184
  v_fmac_f32 v193, v185, v185
  v_fmac_f32 v192, v186, v186
  v_fmac_f32 v193, v187, v187
  v_fmac_f32 v192, v188, v188
  v_fmac_f32 v193, v189, v189
  v_fmac_f32 v192, v190, v190
  v_fmac_f32 v193, v191, v191
  v_add_f32 v192, v192, v193
  s_nop 1
  v_add_f32_dpp v192, v192, v192 row_ror:8 row_mask:0xf bank_mask:0xf
  v_mov_b32 v193, v192
  s_nop 1
  v_permlane16_swap_b32 v192, v193
  v_add_f32 v192, v192, v193
  v_mov_b32 v193, v192
  s_nop 1
  v_permlane32_swap_b32 v192, v193
  v_add_f32 v192, v192, v193
  ds_write_b32 v4, v192 offset:1024
  s_waitcnt lgkmcnt(0)
  s_barrier
  ds_read_b32 v192, v5 offset:1024
  ds_read_b32 v193, v5 offset:1280
  ds_read_b32 v194, v5 offset:1536
  ds_read_b32 v195, v5 offset:1792
  s_waitcnt lgkmcnt(0)
  v_add_f32 v192, v192, v193
  v_add_f32 v194, v194, v195
  v_add_f32 v192, v192, v194
  v_mov_b32 v193, 0x3727c5ac
  v_fmac_f32 v193, 0x3b000000, v192
  v_rsq_f32 v192, v193
  s_nop 0
  v_mul_f32 v176, v176, v192
  v_mul_f32 v177, v177, v192
  v_mul_f32 v178, v178, v192
  v_mul_f32 v179, v179, v192
  v_mul_f32 v180, v180, v192
  v_mul_f32 v181, v181, v192
  v_mul_f32 v182, v182, v192
  v_mul_f32 v183, v183, v192
  v_mul_f32 v184, v184, v192
  v_mul_f32 v185, v185, v192
  v_mul_f32 v186, v186, v192
  v_mul_f32 v187, v187, v192
  v_mul_f32 v188, v188, v192
  v_mul_f32 v189, v189, v192
  v_mul_f32 v190, v190, v192
  v_mul_f32 v191, v191, v192
  v_cvt_pk_bf16_f32 v160, v176, v177
  v_cvt_pk_bf16_f32 v161, v178, v179
  v_cvt_pk_bf16_f32 v162, v180, v181
  v_cvt_pk_bf16_f32 v163, v182, v183
  v_cvt_pk_bf16_f32 v164, v184, v185
  v_cvt_pk_bf16_f32 v165, v186, v187
  v_cvt_pk_bf16_f32 v166, v188, v189
  v_cvt_pk_bf16_f32 v167, v190, v191
  buffer_store_dwordx4 v[160:163], v3, s[4:7], s71 offen sc1
  buffer_store_dwordx4 v[164:167], v3, s[4:7], s71 offen offset:256 sc1
  s_mov_b32 s76, s72
  s_cmp_eq_u32 s78, 1
  s_cbranch_scc1 L_fgo_168
  s_waitcnt vmcnt(0)
  s_barrier
  v_mov_b32 v10, s76
  v_mov_b32 v11, 1
  s_mov_b64 exec, s[80:81]
  buffer_store_dword v11, v10, s[4:7], 0 offen sc1
  s_mov_b64 exec, -1
  s_mov_b32 s76, 0x128000
  s_cmp_ge_u32 s66, 256
  s_cbranch_scc1 L_f5_l0_fin
L_wn_169:
  v_and_b32 v6, 63, v0
  v_lshlrev_b32 v6, 2, v6
  v_add_u32 v6, s69, v6
  s_mov_b64 exec, 0xff
  buffer_load_dword v7, v6, s[4:7], 0 offen sc1
  s_mov_b64 exec, -1
  s_waitcnt vmcnt(0)
  v_cmp_ne_u32 vcc, 0, v7
  s_and_b32 s45, vcc_lo, 0xff
  s_cmp_eq_u32 s45, 0xff
  s_cselect_b32 s45, 1, 0
  s_cmp_eq_u32 s45, 1
  s_cbranch_scc1 L_wnd_170
  s_sub_u32 s64, s64, 1
  s_cbranch_scc1 L_abort
  s_sleep 4
  s_branch L_wn_169
L_wnd_170:
  buffer_load_dwordx4 v[80:83], v8, s[4:7], s68 offen sc1
  buffer_load_dwordx4 v[84:87], v9, s[4:7], s68 offen sc1
  buffer_load_dwordx4 v[16:19], v1, s[4:7], s67 offen offset:0 sc1
  buffer_load_dwordx4 v[20:23], v1, s[4:7], s67 offen offset:256 sc1
  buffer_load_dwordx4 v[24:27], v1, s[4:7], s67 offen offset:512 sc1
  buffer_load_dwordx4 v[28:31], v1, s[4:7], s67 offen offset:768 sc1
  s_add_u32 s49, s67, 65536
  buffer_load_dwordx4 v[32:35], v1, s[4:7], s49 offen offset:0 sc1
  buffer_load_dwordx4 v[36:39], v1, s[4:7], s49 offen offset:256 sc1
  buffer_load_dwordx4 v[40:43], v1, s[4:7], s49 offen offset:512 sc1
  buffer_load_dwordx4 v[44:47], v1, s[4:7], s49 offen offset:768 sc1
L_fgo_168:
  s_branch L_f5_l0
L_f5_l0_fin:
  s_waitcnt vmcnt(0)
  s_branch L_end
L_f1_156:
  s_mov_b32 s66, s17
  s_mov_b32 s76, 0x128000
  s_cmp_eq_u32 s16, 0
  s_cselect_b32 s80, 1, 0
  s_mov_b32 s81, 0
  s_mov_b32 s65, 0
  s_lshr_b32 s45, s66, 2
  s_and_b32 s46, s66, 3
  s_mul_i32 s47, s45, 0x20000
  s_lshr_b32 s48, s46, 1
  s_lshl_b32 s49, s48, 10
  s_add_u32 s47, s47, s49
  s_and_b32 s49, s46, 1
  s_lshl_b32 s49, s49, 7
  s_add_u32 s47, s47, s49
  s_add_u32 s67, s47, 0xb600000
  s_lshl_b32 s47, s66, 13
  s_add_u32 s68, s47, 0x5c00000
  s_add_u32 s73, s47, 0x0
  s_lshl_b32 s47, s45, 7
  s_add_u32 s69, s47, 0x126000
L_wn_171:
  v_and_b32 v6, 63, v0
  v_lshlrev_b32 v6, 2, v6
  v_add_u32 v6, s69, v6
  s_mov_b64 exec, 0xff
  buffer_load_dword v7, v6, s[4:7], 0 offen sc1
  s_mov_b64 exec, -1
  s_waitcnt vmcnt(0)
  v_cmp_ne_u32 vcc, 0, v7
  s_and_b32 s45, vcc_lo, 0xff
  s_cmp_eq_u32 s45, 0xff
  s_cselect_b32 s45, 1, 0
  s_cmp_eq_u32 s45, 1
  s_cbranch_scc1 L_wnd_172
  s_sub_u32 s64, s64, 1
  s_cbranch_scc1 L_abort
  s_sleep 16
  s_branch L_wn_171
L_wnd_172:
  buffer_load_dwordx4 v[80:83], v8, s[4:7], s68 offen sc1
  buffer_load_dwordx4 v[84:87], v9, s[4:7], s68 offen sc1
  buffer_load_dwordx4 v[16:19], v1, s[4:7], s67 offen offset:0 sc1
  buffer_load_dwordx4 v[20:23], v1, s[4:7], s67 offen offset:256 sc1
  buffer_load_dwordx4 v[24:27], v1, s[4:7], s67 offen offset:512 sc1
  buffer_load_dwordx4 v[28:31], v1, s[4:7], s67 offen offset:768 sc1
  s_add_u32 s49, s67, 65536
  buffer_load_dwordx4 v[32:35], v1, s[4:7], s49 offen offset:0 sc1
  buffer_load_dwordx4 v[36:39], v1, s[4:7], s49 offen offset:256 sc1
  buffer_load_dwordx4 v[40:43], v1, s[4:7], s49 offen offset:512 sc1
  buffer_load_dwordx4 v[44:47], v1, s[4:7], s49 offen offset:768 sc1
L_f5_l1:
  s_mov_b32 s70, s73
  s_add_u32 s66, s66, 4
  s_lshr_b32 s45, s66, 2
  s_and_b32 s46, s66, 3
  s_mul_i32 s47, s45, 0x20000
  s_lshr_b32 s48, s46, 1
  s_lshl_b32 s49, s48, 10
  s_add_u32 s47, s47, s49
  s_and_b32 s49, s46, 1
  s_lshl_b32 s49, s49, 7
  s_add_u32 s47, s47, s49
  s_add_u32 s67, s47, 0xb600000
  s_lshl_b32 s47, s66, 13
  s_add_u32 s68, s47, 0x5c00000
  s_add_u32 s73, s47, 0x0
  s_lshl_b32 s47, s45, 7
  s_add_u32 s69, s47, 0x126000
  s_waitcnt vmcnt(0)
  v_and_b32 v6, 63, v0
  v_lshlrev_b32 v6, 2, v6
  v_add_u32 v6, s69, v6
  s_mov_b64 exec, 0xff
  buffer_load_dword v7, v6, s[4:7], 0 offen sc1
  s_mov_b64 exec, -1
  s_mov_b32 s49, 0xffff0000
  v_lshlrev_b32 v176, 16, v80
  v_and_b32 v177, s49, v80
  v_lshlrev_b32 v178, 16, v81
  v_and_b32 v179, s49, v81
  v_lshlrev_b32 v180, 16, v82
  v_and_b32 v181, s49, v82
  v_lshlrev_b32 v182, 16, v83
  v_and_b32 v183, s49, v83
  v_lshlrev_b32 v184, 16, v84
  v_and_b32 v185, s49, v84
  v_lshlrev_b32 v186, 16, v85
  v_and_b32 v187, s49, v85
  v_lshlrev_b32 v188, 16, v86
  v_and_b32 v189, s49, v86
  v_lshlrev_b32 v190, 16, v87
  v_and_b32 v191, s49, v87
  v_add_f32 v176, v176, v16
  v_add_f32 v177, v177, v17
  v_add_f32 v178, v178, v18
  v_add_f32 v179, v179, v19
  v_add_f32 v180, v180, v20
  v_add_f32 v181, v181, v21
  v_add_f32 v182, v182, v22
  v_add_f32 v183, v183, v23
  v_add_f32 v184, v184, v24
  v_add_f32 v185, v185, v25
  v_add_f32 v186, v186, v26
  v_add_f32 v187, v187, v27
  v_add_f32 v188, v188, v28
  v_add_f32 v189, v189, v29
  v_add_f32 v190, v190, v30
  v_add_f32 v191, v191, v31
  v_add_f32 v176, v176, v32
  v_add_f32 v177, v177, v33
  v_add_f32 v178, v178, v34
  v_add_f32 v179, v179, v35
  v_add_f32 v180, v180, v36
  v_add_f32 v181, v181, v37
  v_add_f32 v182, v182, v38
  v_add_f32 v183, v183, v39
  v_add_f32 v184, v184, v40
  v_add_f32 v185, v185, v41
  v_add_f32 v186, v186, v42
  v_add_f32 v187, v187, v43
  v_add_f32 v188, v188, v44
  v_add_f32 v189, v189, v45
  v_add_f32 v190, v190, v46
  v_add_f32 v191, v191, v47
  v_cvt_pk_bf16_f32 v80, v176, v177
  v_cvt_pk_bf16_f32 v81, v178, v179
  v_cvt_pk_bf16_f32 v82, v180, v181
  v_cvt_pk_bf16_f32 v83, v182, v183
  v_cvt_pk_bf16_f32 v84, v184, v185
  v_cvt_pk_bf16_f32 v85, v186, v187
  v_cvt_pk_bf16_f32 v86, v188, v189
  v_cvt_pk_bf16_f32 v87, v190, v191
  buffer_store_dwordx4 v[80:83], v2, s[12:15], s70 offen
  buffer_store_dwordx4 v[84:87], v2, s[12:15], s70 offen offset:16
  s_waitcnt vmcnt(2)
  v_cmp_ne_u32 vcc, 0, v7
  s_and_b32 s77, vcc_lo, 0xff
  s_cmp_eq_u32 s77, 0xff
  s_cselect_b32 s77, 1, 0
  s_mov_b32 s78, 0
  s_cmp_lt_u32 s66, 256
  s_cbranch_scc0 L_fn_173
  s_cmp_eq_u32 s77, 1
  s_cbranch_scc0 L_fn_173
  buffer_load_dwordx4 v[160:163], v8, s[4:7], s68 offen sc1
  buffer_load_dwordx4 v[164:167], v9, s[4:7], s68 offen sc1
  buffer_load_dwordx4 v[96:99], v1, s[4:7], s67 offen offset:0 sc1
  buffer_load_dwordx4 v[100:103], v1, s[4:7], s67 offen offset:256 sc1
  buffer_load_dwordx4 v[104:107], v1, s[4:7], s67 offen offset:512 sc1
  buffer_load_dwordx4 v[108:111], v1, s[4:7], s67 offen offset:768 sc1
  s_add_u32 s49, s67, 65536
  buffer_load_dwordx4 v[112:115], v1, s[4:7], s49 offen offset:0 sc1
  buffer_load_dwordx4 v[116:119], v1, s[4:7], s49 offen offset:256 sc1
  buffer_load_dwordx4 v[120:123], v1, s[4:7], s49 offen offset:512 sc1
  buffer_load_dwordx4 v[124:127], v1, s[4:7], s49 offen offset:768 sc1
  s_mov_b32 s78, 1
L_fn_173:
  s_cmp_eq_u32 s78, 1
  s_cbranch_scc1 L_fgo_175
  s_waitcnt vmcnt(0)
  s_cmp_ge_u32 s66, 256
  s_cbranch_scc1 L_f5_l1_fin
L_wn_176:
  v_and_b32 v6, 63, v0
  v_lshlrev_b32 v6, 2, v6
  v_add_u32 v6, s69, v6
  s_mov_b64 exec, 0xff
  buffer_load_dword v7, v6, s[4:7], 0 offen sc1
  s_mov_b64 exec, -1
  s_waitcnt vmcnt(0)
  v_cmp_ne_u32 vcc, 0, v7
  s_and_b32 s45, vcc_lo, 0xff
  s_cmp_eq_u32 s45, 0xff
  s_cselect_b32 s45, 1, 0
  s_cmp_eq_u32 s45, 1
  s_cbranch_scc1 L_wnd_177
  s_sub_u32 s64, s64, 1
  s_cbranch_scc1 L_abort
  s_sleep 4
  s_branch L_wn_176
L_wnd_177:
  buffer_load_dwordx4 v[160:163], v8, s[4:7], s68 offen sc1
  buffer_load_dwordx4 v[164:167], v9, s[4:7], s68 offen sc1
  buffer_load_dwordx4 v[96:99], v1, s[4:7], s67 offen offset:0 sc1
  buffer_load_dwordx4 v[100:103], v1, s[4:7], s67 offen offset:256 sc1
  buffer_load_dwordx4 v[104:107], v1, s[4:7], s67 offen offset:512 sc1
  buffer_load_dwordx4 v[108:111], v1, s[4:7], s67 offen offset:768 sc1
  s_add_u32 s49, s67, 65536
  buffer_load_dwordx4 v[112:115], v1, s[4:7], s49 offen offset:0 sc1
  buffer_load_dwordx4 v[116:119], v1, s[4:7], s49 offen offset:256 sc1
  buffer_load_dwordx4 v[120:123], v1, s[4:7], s49 offen offset:512 sc1
  buffer_load_dwordx4 v[124:127], v1, s[4:7], s49 offen offset:768 sc1
L_fgo_175:
  s_mov_b32 s70, s73
  s_add_u32 s66, s66, 4
  s_lshr_b32 s45, s66, 2
  s_and_b32 s46, s66, 3
  s_mul_i32 s47, s45, 0x20000
  s_lshr_b32 s48, s46, 1
  s_lshl_b32 s49, s48, 10
  s_add_u32 s47, s47, s49
  s_and_b32 s49, s46, 1
  s_lshl_b32 s49, s49, 7
  s_add_u32 s47, s47, s49
  s_add_u32 s67, s47, 0xb600000
  s_lshl_b32 s47, s66, 13
  s_add_u32 s68, s47, 0x5c00000
  s_add_u32 s73, s47, 0x0
  s_lshl_b32 s47, s45, 7
  s_add_u32 s69, s47, 0x126000
  s_waitcnt vmcnt(0)
  v_and_b32 v6, 63, v0
  v_lshlrev_b32 v6, 2, v6
  v_add_u32 v6, s69, v6
  s_mov_b64 exec, 0xff
  buffer_load_dword v7, v6, s[4:7], 0 offen sc1
  s_mov_b64 exec, -1
  s_mov_b32 s49, 0xffff0000
  v_lshlrev_b32 v176, 16, v160
  v_and_b32 v177, s49, v160
  v_lshlrev_b32 v178, 16, v161
  v_and_b32 v179, s49, v161
  v_lshlrev_b32 v180, 16, v162
  v_and_b32 v181, s49, v162
  v_lshlrev_b32 v182, 16, v163
  v_and_b32 v183, s49, v163
  v_lshlrev_b32 v184, 16, v164
  v_and_b32 v185, s49, v164
  v_lshlrev_b32 v186, 16, v165
  v_and_b32 v187, s49, v165
  v_lshlrev_b32 v188, 16, v166
  v_and_b32 v189, s49, v166
  v_lshlrev_b32 v190, 16, v167
  v_and_b32 v191, s49, v167
  v_add_f32 v176, v176, v96
  v_add_f32 v177, v177, v97
  v_add_f32 v178, v178, v98
  v_add_f32 v179, v179, v99
  v_add_f32 v180, v180, v100
  v_add_f32 v181, v181, v101
  v_add_f32 v182, v182, v102
  v_add_f32 v183, v183, v103
  v_add_f32 v184, v184, v104
  v_add_f32 v185, v185, v105
  v_add_f32 v186, v186, v106
  v_add_f32 v187, v187, v107
  v_add_f32 v188, v188, v108
  v_add_f32 v189, v189, v109
  v_add_f32 v190, v190, v110
  v_add_f32 v191, v191, v111
  v_add_f32 v176, v176, v112
  v_add_f32 v177, v177, v113
  v_add_f32 v178, v178, v114
  v_add_f32 v179, v179, v115
  v_add_f32 v180, v180, v116
  v_add_f32 v181, v181, v117
  v_add_f32 v182, v182, v118
  v_add_f32 v183, v183, v119
  v_add_f32 v184, v184, v120
  v_add_f32 v185, v185, v121
  v_add_f32 v186, v186, v122
  v_add_f32 v187, v187, v123
  v_add_f32 v188, v188, v124
  v_add_f32 v189, v189, v125
  v_add_f32 v190, v190, v126
  v_add_f32 v191, v191, v127
  v_cvt_pk_bf16_f32 v160, v176, v177
  v_cvt_pk_bf16_f32 v161, v178, v179
  v_cvt_pk_bf16_f32 v162, v180, v181
  v_cvt_pk_bf16_f32 v163, v182, v183
  v_cvt_pk_bf16_f32 v164, v184, v185
  v_cvt_pk_bf16_f32 v165, v186, v187
  v_cvt_pk_bf16_f32 v166, v188, v189
  v_cvt_pk_bf16_f32 v167, v190, v191
  buffer_store_dwordx4 v[160:163], v2, s[12:15], s70 offen
  buffer_store_dwordx4 v[164:167], v2, s[12:15], s70 offen offset:16
  s_waitcnt vmcnt(2)
  v_cmp_ne_u32 vcc, 0, v7
  s_and_b32 s77, vcc_lo, 0xff
  s_cmp_eq_u32 s77, 0xff
  s_cselect_b32 s77, 1, 0
  s_mov_b32 s78, 0
  s_cmp_lt_u32 s66, 256
  s_cbranch_scc0 L_fn_178
  s_cmp_eq_u32 s77, 1
  s_cbranch_scc0 L_fn_178
  buffer_load_dwordx4 v[80:83], v8, s[4:7], s68 offen sc1
  buffer_load_dwordx4 v[84:87], v9, s[4:7], s68 offen sc1
  buffer_load_dwordx4 v[16:19], v1, s[4:7], s67 offen offset:0 sc1
  buffer_load_dwordx4 v[20:23], v1, s[4:7], s67 offen offset:256 sc1
  buffer_load_dwordx4 v[24:27], v1, s[4:7], s67 offen offset:512 sc1
  buffer_load_dwordx4 v[28:31], v1, s[4:7], s67 offen offset:768 sc1
  s_add_u32 s49, s67, 65536
  buffer_load_dwordx4 v[32:35], v1, s[4:7], s49 offen offset:0 sc1
  buffer_load_dwordx4 v[36:39], v1, s[4:7], s49 offen offset:256 sc1
  buffer_load_dwordx4 v[40:43], v1, s[4:7], s49 offen offset:512 sc1
  buffer_load_dwordx4 v[44:47], v1, s[4:7], s49 offen offset:768 sc1
  s_mov_b32 s78, 1
L_fn_178:
  s_cmp_eq_u32 s78, 1
  s_cbranch_scc1 L_fgo_180
  s_waitcnt vmcnt(0)
  s_cmp_ge_u32 s66, 256
  s_cbranch_scc1 L_f5_l1_fin
L_wn_181:
  v_and_b32 v6, 63, v0
  v_lshlrev_b32 v6, 2, v6
  v_add_u32 v6, s69, v6
  s_mov_b64 exec, 0xff
  buffer_load_dword v7, v6, s[4:7], 0 offen sc1
  s_mov_b64 exec, -1
  s_waitcnt vmcnt(0)
  v_cmp_ne_u32 vcc, 0, v7
  s_and_b32 s45, vcc_lo, 0xff
  s_cmp_eq_u32 s45, 0xff
  s_cselect_b32 s45, 1, 0
  s_cmp_eq_u32 s45, 1
  s_cbranch_scc1 L_wnd_182
  s_sub_u32 s64, s64, 1
  s_cbranch_scc1 L_abort
  s_sleep 4
  s_branch L_wn_181
L_wnd_182:
  buffer_load_dwordx4 v[80:83], v8, s[4:7], s68 offen sc1
  buffer_load_dwordx4 v[84:87], v9, s[4:7], s68 offen sc1
  buffer_load_dwordx4 v[16:19], v1, s[4:7], s67 offen offset:0 sc1
  buffer_load_dwordx4 v[20:23], v1, s[4:7], s67 offen offset:256 sc1
  buffer_load_dwordx4 v[24:27], v1, s[4:7], s67 offen offset:512 sc1
  buffer_load_dwordx4 v[28:31], v1, s[4:7], s67 offen offset:768 sc1
  s_add_u32 s49, s67, 65536
  buffer_load_dwordx4 v[32:35], v1, s[4:7], s49 offen offset:0 sc1
  buffer_load_dwordx4 v[36:39], v1, s[4:7], s49 offen offset:256 sc1
  buffer_load_dwordx4 v[40:43], v1, s[4:7], s49 offen offset:512 sc1
  buffer_load_dwordx4 v[44:47], v1, s[4:7], s49 offen offset:768 sc1
L_fgo_180:
  s_branch L_f5_l1
L_f5_l1_fin:
  s_waitcnt vmcnt(0)
  s_branch L_end
L_abort:
  v_mov_b32 v2, 240
  v_mov_b32 v3, 1
  s_mov_b64 exec, 1
  global_atomic_add v2, v3, s[40:41] sc1
  s_waitcnt vmcnt(0)
L_end:
  s_endpgm
.section .rodata,"a"
.p2align 6
.amdhsa_kernel interleave_layers__memory_aug_recurrent_mem_tr__glu_gated_bilinear__prompt_kernel
.amdhsa_next_free_vgpr 512
.amdhsa_next_free_sgpr 102
.amdhsa_accum_offset 256
.amdhsa_group_segment_fixed_size 0
.amdhsa_kernarg_size 112
.amdhsa_user_sgpr_count 2
.amdhsa_user_sgpr_kernarg_segment_ptr 1
.amdhsa_system_sgpr_workgroup_id_x 1
.end_amdhsa_kernel
```
